```python
import torch

def _softmax(x, axis=-1):
    return torch.softmax(x, dim=axis)
def _gelu(x):
    return torch.nn.functional.gelu(x, approximate="tanh")
def _silu(x):
    return torch.nn.functional.silu(x)
def _sigmoid(x):
    return torch.sigmoid(x)
def _layernorm(x, axis=-1, eps=1e-5):
    m = x.mean(dim=axis, keepdim=True)
    v = x.var(dim=axis, keepdim=True, unbiased=False)
    return (x - m) / torch.sqrt(v + eps)
def _scatter_add(tgt, idx, src, axis=0):
    return tgt.clone().index_add_(axis, idx, src)
def _segment_sum(src, seg, n):
    out = torch.zeros((n,) + src.shape[1:], dtype=src.dtype)
    return out.index_add_(0, seg, src)
def _pad(x, pw):
    flat = tuple(v for pair in reversed(pw) for v in pair)
    return torch.nn.functional.pad(x, flat)

kernel_name = 'sequential_preLN__softmax_full_mha__glu_gated_bilinear__prompt'

def setup_inputs():

    _w = (lambda a: (lambda t: t.to(torch.bfloat16) if t.is_floating_point() else t)(torch.as_tensor(a)))
    def _A_setup():
        B, S, D = 1, 2048, 640
        return {
            "x": _w((lambda *s: torch.randn(*s, dtype=torch.bfloat16) * 0.05)(B, S, D)),
            "wqkv": _w((lambda *s: torch.randn(*s, dtype=torch.bfloat16) * 0.05)(D, 3 * D)),
            "wo": _w((lambda *s: torch.randn(*s, dtype=torch.bfloat16) * 0.05)(D, D)),
        }
    _A_in = _A_setup()

    def _B_setup():
        B, S, D, F = 1, 2048, 640, 1728
        return {
            "x": _w((lambda *s: torch.randn(*s, dtype=torch.bfloat16) * 0.05)(B, S, D)),
            "w_gate": _w((lambda *s: torch.randn(*s, dtype=torch.bfloat16) * 0.8)(D, F) * (D ** -0.5)),
            "w_up": _w((lambda *s: torch.randn(*s, dtype=torch.bfloat16) * 0.8)(D, F) * (D ** -0.5)),
            "w_down": _w((lambda *s: torch.randn(*s, dtype=torch.bfloat16) * 0.8)(F, D) * (F ** -0.5)),
        }
    _B_in = _B_setup()

    return {
        "A_x": _A_in["x"],
        "A_wqkv": _A_in["wqkv"],
        "A_wo": _A_in["wo"],
        "B_x": _B_in["x"],
        "B_w_gate": _B_in["w_gate"],
        "B_w_up": _B_in["w_up"],
        "B_w_down": _B_in["w_down"],
    }

def reference(A_x, A_wqkv, A_wo, B_x, B_w_gate, B_w_up, B_w_down):
    def _A_ref(x, wqkv, wo):
        B, S, D = x.shape
        H = 32; Dh = D // H
        qkv = (lambda x, *d: x.permute(*d))((x @ wqkv).reshape(B, S, 3, H, Dh), 2, 0, 3, 1, 4)
        q, k, v = qkv[0], qkv[1], qkv[2]
        scale = Dh ** -0.5
        scores = torch.einsum("bhqd,bhkd->bhqk", q, k) * scale
        p = _softmax(scores, axis=-1)
        o = torch.einsum("bhqk,bhkd->bhqd", p, v)
        return (lambda x, *d: x.permute(*d))(o, 0, 2, 1, 3).reshape(B, S, D) @ wo

    def _B_ref(x, w_gate, w_up, w_down):
        g = torch.einsum("bsd,df->bsf", x, w_gate)
        u = torch.einsum("bsd,df->bsf", x, w_up)
        h = g * u
        return torch.einsum("bsf,fd->bsd", h, w_down)

    x = A_x
    h = x + _A_ref(_layernorm(x, axis=-1), A_wqkv, A_wo)
    h2 = h + _B_ref(_layernorm(h, axis=-1), B_w_gate, B_w_up, B_w_down)
    return h2
```

```asm
; @launch grid=(256,1,1) block=(256,1,1) lds=163840
.amdgcn_target "amdgcn-amd-amdhsa--gfx950"
.text
.globl sequential_preLN__softmax_full_mha__glu_gated_bilinear__prompt_kernel
.p2align 8
.type sequential_preLN__softmax_full_mha__glu_gated_bilinear__prompt_kernel,@function
sequential_preLN__softmax_full_mha__glu_gated_bilinear__prompt_kernel:
    s_cmp_ge_u32 s2, 256
    s_cbranch_scc1 sequential_preLN__softmax_full_mha__glu_gated_bilinear__prompt_kernel_end
    s_load_dwordx4 s[36:39], s[0:1], 0
    s_load_dwordx4 s[52:55], s[0:1], 64
    s_load_dwordx8 s[80:87], s[0:1], 32
    s_load_dwordx2 s[88:89], s[0:1], 16
    v_lshrrev_b32 v2, 6, v0
    v_and_b32 v1, 63, v0
    v_readfirstlane_b32 s3, v2
    s_and_b32 s24, s2, 7
    s_lshr_b32 s25, s2, 3
    s_getpc_b64 s[20:21]
sequential_preLN__softmax_full_mha__glu_gated_bilinear__prompt_kernel_pc:
    s_lshl_b32 s58, s25, 2
    s_add_u32 s58, s58, s3
    s_lshl_b32 s58, s58, 7
    v_and_b32 v247, 7, v1
    v_lshlrev_b32 v247, 14, v247
    v_add_u32 v247, s58, v247
    v_min_u32 v247, sequential_preLN__softmax_full_mha__glu_gated_bilinear__prompt_kernel_end-sequential_preLN__softmax_full_mha__glu_gated_bilinear__prompt_kernel_pc, v247
    global_load_dword v248, v247, s[20:21] sc1
    v_lshrrev_b32 v7, 4, v1
    v_and_b32 v6, 15, v1
    s_cmp_lt_u32 s2, 192
    s_cbranch_scc1 sequential_preLN__softmax_full_mha__glu_gated_bilinear__prompt_kernel_busy
sequential_preLN__softmax_full_mha__glu_gated_bilinear__prompt_kernel_help:
    s_sub_u32 s28, s2, 192
    s_cmp_lt_u32 s28, 32
    s_cselect_b32 s56, 1280, s56
    s_cselect_b32 s29, 1, 0
    s_cmp_eq_u32 s29, 0
    s_cselect_b32 s56, 3840, s56
    v_lshrrev_b32 v2, 3, v1
    v_and_b32 v3, 7, v1
    v_mul_u32_u24 v4, s56, v2
    v_lshl_add_u32 v12, v3, 4, v4
    s_lshl_b32 s57, s56, 3
    v_add_u32 v13, s57, v12
    s_lshl_b32 s57, s56, 4
    s_mul_i32 s32, s57, s3
    s_and_b32 s30, s24, 3
    s_lshl_b32 s30, s30, 3
    s_lshr_b32 s57, s28, 2
    s_and_b32 s57, s57, 7
    s_add_u32 s30, s30, s57
    s_and_b32 s59, s25, 3
    s_lshl_b32 s59, s59, 2
    s_and_b32 s31, s24, 3
    s_add_u32 s59, s59, s31
    s_lshr_b32 s31, s24, 2
    s_mul_i32 s31, s31, 15
    s_add_u32 s31, s31, s59
    s_cmp_eq_u32 s59, 15
    s_cselect_b32 s31, 30, s31
    s_mul_i32 s57, s30, 81920
    s_lshl_b32 s58, s31, 7
    s_cmp_eq_u32 s29, 0
    s_cselect_b32 s57, s58, s57
    s_cselect_b32 s33, 245760, s56
    s_add_u32 s32, s32, s57
    s_cmp_eq_u32 s29, 1
    s_cselect_b32 s33, 128, s33
    s_mul_i32 s57, s33, 0
    s_add_u32 s32, s32, s57
    s_mul_i32 s34, s33, -9
    s_waitcnt lgkmcnt(0)
    s_mov_b32 s8, s36
    s_mov_b32 s9, s37
    s_mov_b32 s10, 2621440
    s_mov_b32 s11, 0x20000
    s_cmp_eq_u32 s29, 1
    s_cselect_b64 s[12:13], s[36:37], s[38:39]
    s_cselect_b32 s14, s10, 2457600
    s_mov_b32 s15, 0x20000
    s_or_b32 s59, s28, 4
    s_cmp_lg_u32 s59, 63
    s_cselect_b32 s14, s14, 0
    buffer_load_dwordx4 v[64:67], v12, s[12:15], s32 offen
    buffer_load_dwordx4 v[68:71], v13, s[12:15], s32 offen
    s_add_u32 s32, s32, s33
    buffer_load_dwordx4 v[72:75], v12, s[12:15], s32 offen
    buffer_load_dwordx4 v[76:79], v13, s[12:15], s32 offen
    s_add_u32 s32, s32, s33
    buffer_load_dwordx4 v[80:83], v12, s[12:15], s32 offen
    buffer_load_dwordx4 v[84:87], v13, s[12:15], s32 offen
    s_add_u32 s32, s32, s33
    buffer_load_dwordx4 v[88:91], v12, s[12:15], s32 offen
    buffer_load_dwordx4 v[92:95], v13, s[12:15], s32 offen
    s_add_u32 s32, s32, s33
    buffer_load_dwordx4 v[96:99], v12, s[12:15], s32 offen
    buffer_load_dwordx4 v[100:103], v13, s[12:15], s32 offen
    s_add_u32 s32, s32, s33
    s_branch sequential_preLN__softmax_full_mha__glu_gated_bilinear__prompt_kernel_help1
sequential_preLN__softmax_full_mha__glu_gated_bilinear__prompt_kernel_busy:
    s_lshr_b32 s56, s24, 2
    s_mul_i32 s30, s56, 6
    s_lshr_b32 s57, s25, 2
    s_add_u32 s30, s30, s57
    s_and_b32 s57, s25, 3
    s_and_b32 s56, s24, 3
    s_lshl_b32 s56, s56, 2
    s_add_u32 s28, s56, s57
    v_and_b32 v3, 7, v1
    v_xor_b32 v3, v3, v7
    v_lshlrev_b32 v3, 4, v3
    v_lshrrev_b32 v4, 3, v1
    v_mul_u32_u24 v4, 1280, v4
    v_add_u32 v12, v3, v4
    v_xor_b32 v3, 64, v3
    v_add_u32 v3, v3, v4
    v_add_u32 v13, 9216, v3
    v_add_u32 v14, 18432, v12
    v_add_u32 v15, 18432, v13
    v_add_u32 v2, 0, v1
    v_mul_u32_u24 v3, 3277, v2
    v_lshrrev_b32 v3, 16, v3
    v_mul_u32_u24 v4, 20, v3
    v_sub_u32 v2, v2, v4
    v_mul_u32_u24 v3, 3840, v3
    v_lshl_add_u32 v16, v2, 4, v3
    v_add_u32 v2, 64, v1
    v_mul_u32_u24 v3, 3277, v2
    v_lshrrev_b32 v3, 16, v3
    v_mul_u32_u24 v4, 20, v3
    v_sub_u32 v2, v2, v4
    v_mul_u32_u24 v3, 3840, v3
    v_lshl_add_u32 v17, v2, 4, v3
    v_subrev_u32 v17, 1024, v17
    v_add_u32 v2, 128, v1
    v_mul_u32_u24 v3, 3277, v2
    v_lshrrev_b32 v3, 16, v3
    v_mul_u32_u24 v4, 20, v3
    v_sub_u32 v2, v2, v4
    v_lshrrev_b32 v4, 2, v3
    v_and_b32 v4, 2, v4
    v_xor_b32 v2, v2, v4
    v_mul_u32_u24 v3, 3840, v3
    v_lshl_add_u32 v18, v2, 4, v3
    v_subrev_u32 v18, 2048, v18
    v_add_u32 v2, 192, v1
    v_mul_u32_u24 v3, 3277, v2
    v_lshrrev_b32 v3, 16, v3
    v_mul_u32_u24 v4, 20, v3
    v_sub_u32 v2, v2, v4
    v_xor_b32 v2, 2, v2
    v_mul_u32_u24 v3, 3840, v3
    v_lshl_add_u32 v19, v2, 4, v3
    v_subrev_u32 v19, 3072, v19
    v_add_u32 v2, 256, v1
    v_mul_u32_u24 v3, 3277, v2
    v_lshrrev_b32 v3, 16, v3
    v_mul_u32_u24 v4, 20, v3
    v_sub_u32 v2, v2, v4
    v_xor_b32 v2, 2, v2
    v_mul_u32_u24 v3, 3840, v3
    v_lshl_add_u32 v20, v2, 4, v3
    s_lshl_b32 s56, s28, 2
    s_add_u32 s56, s56, s3
    s_mul_i32 s29, s56, 40960
    s_mul_i32 s91, s3, 61440
    s_mul_i32 s57, s30, 320
    s_add_u32 s91, s91, s57
    s_lshl_b32 s32, s3, 12
    s_mul_i32 s35, s3, 5120
    s_mov_b32 s10, 2621440
    s_mov_b32 s11, 0x20000
    s_mov_b32 s14, 2457600
    s_mov_b32 s15, 0x20000
    s_waitcnt lgkmcnt(0)
    s_mov_b64 s[8:9], s[36:37]
    s_mov_b64 s[12:13], s[38:39]
    s_add_u32 m0, s32, 0
    s_add_u32 s91, s91, 0
    buffer_load_dwordx4 v12, s[8:11], s29 offen offset:0 lds
    buffer_load_dwordx4 v13, s[8:11], s29 offen offset:1024 lds
    buffer_load_dwordx4 v14, s[8:11], s29 offen offset:2048 lds
    buffer_load_dwordx4 v15, s[8:11], s29 offen offset:3072 lds
    s_add_u32 m0, s35, 16384
    s_add_u32 s29, s29, 128
    buffer_load_dwordx4 v16, s[12:15], s91 offen offset:0 lds
    buffer_load_dwordx4 v17, s[12:15], s91 offen offset:1024 lds
    buffer_load_dwordx4 v18, s[12:15], s91 offen offset:2048 lds
    buffer_load_dwordx4 v19, s[12:15], s91 offen offset:3072 lds
    s_add_u32 m0, s35, 20480
    s_nop 0
    buffer_load_dwordx4 v20, s[12:15], s91 offen offset:0 lds
    s_mov_b32 s4, s54
    s_mov_b32 s5, s55
    s_mov_b32 s6, 33554432
    s_mov_b32 s7, 0x20000
    s_mov_b32 s54, 256
    s_mov_b32 s55, 0x20000
    v_lshlrev_b32 v249, 7, v1
    v_lshlrev_b32 v253, 4, v1
    v_lshlrev_b32 v241, 2, v1
    v_add_u32 v54, 28762112, v249
    s_mul_i32 s23, s24, 1310720
    s_cmp_eq_u32 s3, 0
    s_cselect_b32 s22, 0, 1073741824
    s_getreg_b32 s27, hwreg(HW_REG_XCC_ID, 0, 4)
    s_add_u32 s27, s27, 1
    s_and_b32 s56, s3, 1
    s_lshr_b32 s57, s3, 1
    v_lshrrev_b32 v53, 4, v1
    v_and_b32 v52, 15, v1
    v_lshrrev_b32 v2, 1, v52
    v_xor_b32 v2, v2, v53
    v_lshlrev_b32 v2, 4, v2
    v_lshl_add_u32 v2, v52, 7, v2
    s_lshl_b32 s58, s56, 13
    v_add_u32 v22, s58, v2
    v_xor_b32 v23, 64, v22
    v_lshrrev_b32 v2, 2, v52
    v_lshl_add_u32 v3, v53, 3, v2
    v_mul_u32_u24 v3, 320, v3
    v_and_b32 v2, 3, v52
    v_lshl_add_u32 v3, v2, 3, v3
    s_mul_i32 s58, s57, 160
    s_add_u32 s58, s58, 16384
    v_add_u32 v3, s58, v3
    v_and_b32 v2, 1, v53
    s_lshl_b32 s58, s57, 6
    s_sub_u32 s58, 32, s58
    v_mul_i32_i24 v2, s58, v2
    v_add_u32 v24, v3, v2
    v_sub_u32 v25, v3, v2
    s_lshl_b32 s37, s28, 1
    s_add_u32 s37, s37, s56
    s_lshl_b32 s36, s30, 1
    s_add_u32 s36, s36, s57
    s_lshl_b32 s59, s28, 9
    s_lshl_b32 s58, s3, 13
    s_add_u32 s59, s59, s58
    s_add_u32 s59, s59, 28622848
    s_mul_i32 s58, s30, 640
    s_add_u32 s58, s58, 28639232
    s_cmp_eq_u32 s3, 2
    s_cselect_b32 s59, s58, s59
    s_cmp_eq_u32 s3, 3
    s_cselect_b32 s59, 1073741824, s59
    s_lshl_b32 s43, s3, 10
    s_add_u32 s43, s43, 147456
    s_lshl_b32 s58, s56, 8
    s_add_u32 s58, s58, 147456
    v_mov_b32 v30, s58
    s_mul_i32 s58, s57, 320
    s_add_u32 s58, s58, 149504
    v_mov_b32 v31, s58
    s_cmp_lt_u32 s30, 4
    s_cselect_b32 s42, 0x3ea52b5c, 1.0
    s_and_b32 s56, s36, 7
    s_lshr_b32 s57, s36, 3
    s_mul_i32 s46, s56, 1310720
    s_mul_i32 s58, s57, 327680
    s_add_u32 s46, s46, s58
    s_mul_i32 s56, s56, 3
    s_add_u32 s56, s56, s57
    s_lshl_b32 s56, s56, 2
    s_lshr_b32 s57, s37, 3
    s_add_u32 s56, s56, s57
    s_lshl_b32 s56, s56, 5
    s_and_b32 s57, s37, 7
    s_add_u32 s56, s56, s57
    s_lshl_b32 s56, s56, 2
    s_add_u32 s62, s56, 28712960
    s_and_b32 s56, s28, 3
    s_lshl_b32 s56, s56, 3
    s_lshr_b32 s57, s28, 2
    s_add_u32 s56, s56, s57
    v_lshl_add_u32 v2, v1, 2, s56
    s_lshr_b32 s57, s25, 2
    s_mul_i32 s57, s57, 5
    s_lshr_b32 s57, s57, 1
    s_sub_u32 s57, s57, 2
    v_min_u32 v3, 4, v1
    v_add_u32 v3, s57, v3
    v_and_b32 v4, 12, v3
    s_and_b32 s57, s24, 4
    s_add_u32 s57, s57, 32
    v_cmp_gt_u32 vcc, 2, v1
    v_add3_u32 v3, v3, v4, s57
    s_mov_b32 s57, 28762112
    v_cndmask_b32 v2, v3, v2, vcc
    v_lshl_add_u32 v196, v2, 7, s57
    s_add_u32 m0, s32, 36864
    s_add_u32 s91, s91, 245760
    buffer_load_dwordx4 v12, s[8:11], s29 offen offset:0 lds
    buffer_load_dwordx4 v13, s[8:11], s29 offen offset:1024 lds
    buffer_load_dwordx4 v14, s[8:11], s29 offen offset:2048 lds
    buffer_load_dwordx4 v15, s[8:11], s29 offen offset:3072 lds
    s_add_u32 m0, s35, 53248
    s_add_u32 s29, s29, 128
    buffer_load_dwordx4 v16, s[12:15], s91 offen offset:0 lds
    buffer_load_dwordx4 v17, s[12:15], s91 offen offset:1024 lds
    buffer_load_dwordx4 v18, s[12:15], s91 offen offset:2048 lds
    buffer_load_dwordx4 v19, s[12:15], s91 offen offset:3072 lds
    s_add_u32 m0, s35, 57344
    s_nop 0
    buffer_load_dwordx4 v20, s[12:15], s91 offen offset:0 lds
    s_cmp_ge_u32 s30, 8
    s_cbranch_scc1 sequential_preLN__softmax_full_mha__glu_gated_bilinear__prompt_kernel_v
    s_branch sequential_preLN__softmax_full_mha__glu_gated_bilinear__prompt_kernel_q
sequential_preLN__softmax_full_mha__glu_gated_bilinear__prompt_kernel_help1:
    s_mov_b32 s4, s54
    s_mov_b32 s5, s55
    s_mov_b32 s6, 33554432
    s_mov_b32 s7, 0x20000
    s_mov_b32 s54, 256
    s_mov_b32 s55, 0x20000
    v_lshlrev_b32 v249, 7, v1
    v_lshlrev_b32 v253, 4, v1
    v_lshlrev_b32 v241, 2, v1
    v_add_u32 v54, 28762112, v249
    s_mul_i32 s23, s24, 1310720
    s_cmp_eq_u32 s3, 0
    s_cselect_b32 s22, 0, 1073741824
    s_getreg_b32 s27, hwreg(HW_REG_XCC_ID, 0, 4)
    s_add_u32 s27, s27, 1
    v_mov_b32 v8, 0
    v_mov_b32 v32, 0x3f803f80
    v_mov_b32 v9, 0
    v_mov_b32 v33, 0x3f803f80
    v_mov_b32 v10, 0
    v_mov_b32 v34, 0x3f803f80
    v_mov_b32 v11, 0
    v_mov_b32 v35, 0x3f803f80
    v_mov_b32 v40, 0
    v_mov_b32 v41, 0
    v_mov_b32 v42, 0
    v_mov_b32 v43, 0
    v_mov_b32 v44, 0
    v_mov_b32 v45, 0
    v_mov_b32 v46, 0
    v_mov_b32 v47, 0
    s_cmp_lg_u32 s28, 63
    s_cbranch_scc1 L_notlast_1
    s_lshl_b32 s56, s3, 11
    s_add_u32 s56, s56, 28762112
    buffer_store_dwordx4 v[8:11], v253, s[4:7], s56 offen offset:0 sc1
    buffer_store_dwordx4 v[8:11], v253, s[4:7], s56 offen offset:1024 sc1
    s_waitcnt vmcnt(0)
    s_barrier
    s_mov_b64 exec, 1
    buffer_store_dword v32, off, s[52:55], s22 sc1
    s_mov_b64 exec, -1
    s_waitcnt vmcnt(0)
L_notlast_1:
    s_lshr_b32 s57, s3, 1
    s_lshl_b32 s56, s28, 1
    s_add_u32 s56, s56, s57
    s_mul_i32 s56, s56, 896
    s_add_u32 s56, s56, 28647424
    s_bitcmp1_b32 s3, 0
    s_cselect_b32 s56, s56, 1073741824
    v_min_u32 v4, 880, v253
    s_mul_i32 s57, s28, 5120
    s_add_u32 s57, s57, 28770304
    s_cmp_eq_u32 s3, 2
    s_cselect_b32 s57, s57, 1073741824
    v_and_b32 v5, 1, v1
    v_mul_u32_u24 v5, 2560, v5
    buffer_store_dwordx4 v[8:11], v4, s[4:7], s56 offen sc1
    buffer_store_dwordx4 v[32:35], v5, s[4:7], s57 offen sc1
    s_mov_b32 s60, 0x3f80
    s_mov_b32 s61, 0x3f800000
    s_cmp_eq_u32 s29, 0
    s_cbranch_scc1 L_hcol_2
    buffer_load_dwordx4 v[104:107], v12, s[12:15], s32 offen
    s_waitcnt vmcnt(12)
    v_dot2c_f32_bf16 v40, v32, v64
    v_dot2c_f32_bf16 v41, v64, v64
    v_dot2c_f32_bf16 v40, v32, v65
    v_dot2c_f32_bf16 v41, v65, v65
    v_dot2c_f32_bf16 v40, v32, v66
    v_dot2c_f32_bf16 v41, v66, v66
    v_dot2c_f32_bf16 v40, v32, v67
    v_dot2c_f32_bf16 v41, v67, v67
    buffer_load_dwordx4 v[108:111], v13, s[12:15], s32 offen
    s_add_u32 s32, s32, s33
    s_waitcnt vmcnt(12)
    v_dot2c_f32_bf16 v42, v32, v68
    v_dot2c_f32_bf16 v43, v68, v68
    v_dot2c_f32_bf16 v42, v32, v69
    v_dot2c_f32_bf16 v43, v69, v69
    v_dot2c_f32_bf16 v42, v32, v70
    v_dot2c_f32_bf16 v43, v70, v70
    v_dot2c_f32_bf16 v42, v32, v71
    v_dot2c_f32_bf16 v43, v71, v71
    buffer_load_dwordx4 v[112:115], v12, s[12:15], s32 offen
    s_waitcnt vmcnt(12)
    v_dot2c_f32_bf16 v40, v32, v72
    v_dot2c_f32_bf16 v41, v72, v72
    v_dot2c_f32_bf16 v40, v32, v73
    v_dot2c_f32_bf16 v41, v73, v73
    v_dot2c_f32_bf16 v40, v32, v74
    v_dot2c_f32_bf16 v41, v74, v74
    v_dot2c_f32_bf16 v40, v32, v75
    v_dot2c_f32_bf16 v41, v75, v75
    buffer_load_dwordx4 v[116:119], v13, s[12:15], s32 offen
    s_add_u32 s32, s32, s33
    s_waitcnt vmcnt(12)
    v_dot2c_f32_bf16 v42, v32, v76
    v_dot2c_f32_bf16 v43, v76, v76
    v_dot2c_f32_bf16 v42, v32, v77
    v_dot2c_f32_bf16 v43, v77, v77
    v_dot2c_f32_bf16 v42, v32, v78
    v_dot2c_f32_bf16 v43, v78, v78
    v_dot2c_f32_bf16 v42, v32, v79
    v_dot2c_f32_bf16 v43, v79, v79
    buffer_load_dwordx4 v[120:123], v12, s[12:15], s32 offen
    s_waitcnt vmcnt(12)
    v_dot2c_f32_bf16 v40, v32, v80
    v_dot2c_f32_bf16 v41, v80, v80
    v_dot2c_f32_bf16 v40, v32, v81
    v_dot2c_f32_bf16 v41, v81, v81
    v_dot2c_f32_bf16 v40, v32, v82
    v_dot2c_f32_bf16 v41, v82, v82
    v_dot2c_f32_bf16 v40, v32, v83
    v_dot2c_f32_bf16 v41, v83, v83
    buffer_load_dwordx4 v[124:127], v13, s[12:15], s32 offen
    s_add_u32 s32, s32, s33
    s_waitcnt vmcnt(12)
    v_dot2c_f32_bf16 v42, v32, v84
    v_dot2c_f32_bf16 v43, v84, v84
    v_dot2c_f32_bf16 v42, v32, v85
    v_dot2c_f32_bf16 v43, v85, v85
    v_dot2c_f32_bf16 v42, v32, v86
    v_dot2c_f32_bf16 v43, v86, v86
    v_dot2c_f32_bf16 v42, v32, v87
    v_dot2c_f32_bf16 v43, v87, v87
    buffer_load_dwordx4 v[128:131], v12, s[12:15], s32 offen
    s_waitcnt vmcnt(12)
    v_dot2c_f32_bf16 v40, v32, v88
    v_dot2c_f32_bf16 v41, v88, v88
    v_dot2c_f32_bf16 v40, v32, v89
    v_dot2c_f32_bf16 v41, v89, v89
    v_dot2c_f32_bf16 v40, v32, v90
    v_dot2c_f32_bf16 v41, v90, v90
    v_dot2c_f32_bf16 v40, v32, v91
    v_dot2c_f32_bf16 v41, v91, v91
    buffer_load_dwordx4 v[132:135], v13, s[12:15], s32 offen
    s_add_u32 s32, s32, s33
    s_waitcnt vmcnt(12)
    v_dot2c_f32_bf16 v42, v32, v92
    v_dot2c_f32_bf16 v43, v92, v92
    v_dot2c_f32_bf16 v42, v32, v93
    v_dot2c_f32_bf16 v43, v93, v93
    v_dot2c_f32_bf16 v42, v32, v94
    v_dot2c_f32_bf16 v43, v94, v94
    v_dot2c_f32_bf16 v42, v32, v95
    v_dot2c_f32_bf16 v43, v95, v95
    buffer_load_dwordx4 v[136:139], v12, s[12:15], s32 offen
    s_waitcnt vmcnt(12)
    v_dot2c_f32_bf16 v40, v32, v96
    v_dot2c_f32_bf16 v41, v96, v96
    v_dot2c_f32_bf16 v40, v32, v97
    v_dot2c_f32_bf16 v41, v97, v97
    v_dot2c_f32_bf16 v40, v32, v98
    v_dot2c_f32_bf16 v41, v98, v98
    v_dot2c_f32_bf16 v40, v32, v99
    v_dot2c_f32_bf16 v41, v99, v99
    buffer_load_dwordx4 v[140:143], v13, s[12:15], s32 offen
    s_add_u32 s32, s32, s34
    s_waitcnt vmcnt(12)
    v_dot2c_f32_bf16 v42, v32, v100
    v_dot2c_f32_bf16 v43, v100, v100
    v_dot2c_f32_bf16 v42, v32, v101
    v_dot2c_f32_bf16 v43, v101, v101
    v_dot2c_f32_bf16 v42, v32, v102
    v_dot2c_f32_bf16 v43, v102, v102
    v_dot2c_f32_bf16 v42, v32, v103
    v_dot2c_f32_bf16 v43, v103, v103
    buffer_load_dword v55, off, s[52:55], s22 sc1
    s_waitcnt vmcnt(10)
    v_dot2c_f32_bf16 v40, v32, v104
    v_dot2c_f32_bf16 v41, v104, v104
    v_dot2c_f32_bf16 v40, v32, v105
    v_dot2c_f32_bf16 v41, v105, v105
    v_dot2c_f32_bf16 v40, v32, v106
    v_dot2c_f32_bf16 v41, v106, v106
    v_dot2c_f32_bf16 v40, v32, v107
    v_dot2c_f32_bf16 v41, v107, v107
    s_waitcnt vmcnt(9)
    v_dot2c_f32_bf16 v42, v32, v108
    v_dot2c_f32_bf16 v43, v108, v108
    v_dot2c_f32_bf16 v42, v32, v109
    v_dot2c_f32_bf16 v43, v109, v109
    v_dot2c_f32_bf16 v42, v32, v110
    v_dot2c_f32_bf16 v43, v110, v110
    v_dot2c_f32_bf16 v42, v32, v111
    v_dot2c_f32_bf16 v43, v111, v111
    s_waitcnt vmcnt(8)
    v_dot2c_f32_bf16 v40, v32, v112
    v_dot2c_f32_bf16 v41, v112, v112
    v_dot2c_f32_bf16 v40, v32, v113
    v_dot2c_f32_bf16 v41, v113, v113
    v_dot2c_f32_bf16 v40, v32, v114
    v_dot2c_f32_bf16 v41, v114, v114
    v_dot2c_f32_bf16 v40, v32, v115
    v_dot2c_f32_bf16 v41, v115, v115
    s_waitcnt vmcnt(7)
    v_dot2c_f32_bf16 v42, v32, v116
    v_dot2c_f32_bf16 v43, v116, v116
    v_dot2c_f32_bf16 v42, v32, v117
    v_dot2c_f32_bf16 v43, v117, v117
    v_dot2c_f32_bf16 v42, v32, v118
    v_dot2c_f32_bf16 v43, v118, v118
    v_dot2c_f32_bf16 v42, v32, v119
    v_dot2c_f32_bf16 v43, v119, v119
    s_waitcnt vmcnt(6)
    v_dot2c_f32_bf16 v40, v32, v120
    v_dot2c_f32_bf16 v41, v120, v120
    v_dot2c_f32_bf16 v40, v32, v121
    v_dot2c_f32_bf16 v41, v121, v121
    v_dot2c_f32_bf16 v40, v32, v122
    v_dot2c_f32_bf16 v41, v122, v122
    v_dot2c_f32_bf16 v40, v32, v123
    v_dot2c_f32_bf16 v41, v123, v123
    s_waitcnt vmcnt(5)
    v_dot2c_f32_bf16 v42, v32, v124
    v_dot2c_f32_bf16 v43, v124, v124
    v_dot2c_f32_bf16 v42, v32, v125
    v_dot2c_f32_bf16 v43, v125, v125
    v_dot2c_f32_bf16 v42, v32, v126
    v_dot2c_f32_bf16 v43, v126, v126
    v_dot2c_f32_bf16 v42, v32, v127
    v_dot2c_f32_bf16 v43, v127, v127
    s_waitcnt vmcnt(4)
    v_dot2c_f32_bf16 v40, v32, v128
    v_dot2c_f32_bf16 v41, v128, v128
    v_dot2c_f32_bf16 v40, v32, v129
    v_dot2c_f32_bf16 v41, v129, v129
    v_dot2c_f32_bf16 v40, v32, v130
    v_dot2c_f32_bf16 v41, v130, v130
    v_dot2c_f32_bf16 v40, v32, v131
    v_dot2c_f32_bf16 v41, v131, v131
    s_waitcnt vmcnt(3)
    v_dot2c_f32_bf16 v42, v32, v132
    v_dot2c_f32_bf16 v43, v132, v132
    v_dot2c_f32_bf16 v42, v32, v133
    v_dot2c_f32_bf16 v43, v133, v133
    v_dot2c_f32_bf16 v42, v32, v134
    v_dot2c_f32_bf16 v43, v134, v134
    v_dot2c_f32_bf16 v42, v32, v135
    v_dot2c_f32_bf16 v43, v135, v135
    s_waitcnt vmcnt(2)
    v_dot2c_f32_bf16 v40, v32, v136
    v_dot2c_f32_bf16 v41, v136, v136
    v_dot2c_f32_bf16 v40, v32, v137
    v_dot2c_f32_bf16 v41, v137, v137
    v_dot2c_f32_bf16 v40, v32, v138
    v_dot2c_f32_bf16 v41, v138, v138
    v_dot2c_f32_bf16 v40, v32, v139
    v_dot2c_f32_bf16 v41, v139, v139
    s_waitcnt vmcnt(1)
    v_dot2c_f32_bf16 v42, v32, v140
    v_dot2c_f32_bf16 v43, v140, v140
    v_dot2c_f32_bf16 v42, v32, v141
    v_dot2c_f32_bf16 v43, v141, v141
    v_dot2c_f32_bf16 v42, v32, v142
    v_dot2c_f32_bf16 v43, v142, v142
    v_dot2c_f32_bf16 v42, v32, v143
    v_dot2c_f32_bf16 v43, v143, v143
    s_nop 2
    v_add_f32_dpp v40, v40, v40 quad_perm:[1,0,3,2] row_mask:0xf bank_mask:0xf
    v_add_f32_dpp v41, v41, v41 quad_perm:[1,0,3,2] row_mask:0xf bank_mask:0xf
    v_add_f32_dpp v42, v42, v42 quad_perm:[1,0,3,2] row_mask:0xf bank_mask:0xf
    v_add_f32_dpp v43, v43, v43 quad_perm:[1,0,3,2] row_mask:0xf bank_mask:0xf
    v_add_f32_dpp v40, v40, v40 quad_perm:[2,3,0,1] row_mask:0xf bank_mask:0xf
    v_add_f32_dpp v41, v41, v41 quad_perm:[2,3,0,1] row_mask:0xf bank_mask:0xf
    v_add_f32_dpp v42, v42, v42 quad_perm:[2,3,0,1] row_mask:0xf bank_mask:0xf
    v_add_f32_dpp v43, v43, v43 quad_perm:[2,3,0,1] row_mask:0xf bank_mask:0xf
    v_add_f32_dpp v40, v40, v40 row_half_mirror row_mask:0xf bank_mask:0xf
    v_add_f32_dpp v41, v41, v41 row_half_mirror row_mask:0xf bank_mask:0xf
    v_add_f32_dpp v42, v42, v42 row_half_mirror row_mask:0xf bank_mask:0xf
    v_add_f32_dpp v43, v43, v43 row_half_mirror row_mask:0xf bank_mask:0xf
    v_cmp_eq_u32 vcc, 1, v3
    v_lshrrev_b32 v4, 3, v1
    v_lshl_add_u32 v4, v3, 3, v4
    v_cndmask_b32 v40, v40, v42, vcc
    v_cndmask_b32 v41, v41, v43, vcc
    v_mul_f32 v40, 0xbacccccd, v40
    v_mul_f32 v41, 0x3acccccd, v41
    v_fma_f32 v41, -v40, v40, v41
    v_max_f32 v41, 0, v41
    v_add_f32 v41, 0x3727c5ac, v41
    v_rsq_f32 v41, v41
    v_lshlrev_b32 v4, 2, v4
    v_mov_b32 v5, 1073741824
    v_cmp_gt_u32 vcc, 2, v3
    s_lshl_b32 s57, s30, 2
    s_add_u32 s57, s57, s3
    v_cndmask_b32 v4, v5, v4, vcc
    s_lshl_b32 s57, s57, 6
    s_add_u32 s57, s57, 28622848
    s_add_u32 s58, s57, 8192
    buffer_store_dword v40, v4, s[4:7], s57 offen sc1
    buffer_store_dword v41, v4, s[4:7], s58 offen sc1
    s_branch L_hboth_3
L_hcol_2:
    buffer_load_dwordx4 v[104:107], v12, s[12:15], s32 offen
    s_waitcnt vmcnt(12)
    v_dot2c_f32_bf16 v40, s60, v64
    v_dot2c_f32_bf16 v41, s61, v64
    v_dot2c_f32_bf16 v42, s60, v65
    v_dot2c_f32_bf16 v43, s61, v65
    v_dot2c_f32_bf16 v44, s60, v66
    v_dot2c_f32_bf16 v45, s61, v66
    v_dot2c_f32_bf16 v46, s60, v67
    v_dot2c_f32_bf16 v47, s61, v67
    buffer_load_dwordx4 v[108:111], v13, s[12:15], s32 offen
    s_add_u32 s32, s32, s33
    s_waitcnt vmcnt(12)
    v_dot2c_f32_bf16 v40, s60, v68
    v_dot2c_f32_bf16 v41, s61, v68
    v_dot2c_f32_bf16 v42, s60, v69
    v_dot2c_f32_bf16 v43, s61, v69
    v_dot2c_f32_bf16 v44, s60, v70
    v_dot2c_f32_bf16 v45, s61, v70
    v_dot2c_f32_bf16 v46, s60, v71
    v_dot2c_f32_bf16 v47, s61, v71
    buffer_load_dwordx4 v[112:115], v12, s[12:15], s32 offen
    s_waitcnt vmcnt(12)
    v_dot2c_f32_bf16 v40, s60, v72
    v_dot2c_f32_bf16 v41, s61, v72
    v_dot2c_f32_bf16 v42, s60, v73
    v_dot2c_f32_bf16 v43, s61, v73
    v_dot2c_f32_bf16 v44, s60, v74
    v_dot2c_f32_bf16 v45, s61, v74
    v_dot2c_f32_bf16 v46, s60, v75
    v_dot2c_f32_bf16 v47, s61, v75
    buffer_load_dwordx4 v[116:119], v13, s[12:15], s32 offen
    s_add_u32 s32, s32, s33
    s_waitcnt vmcnt(12)
    v_dot2c_f32_bf16 v40, s60, v76
    v_dot2c_f32_bf16 v41, s61, v76
    v_dot2c_f32_bf16 v42, s60, v77
    v_dot2c_f32_bf16 v43, s61, v77
    v_dot2c_f32_bf16 v44, s60, v78
    v_dot2c_f32_bf16 v45, s61, v78
    v_dot2c_f32_bf16 v46, s60, v79
    v_dot2c_f32_bf16 v47, s61, v79
    buffer_load_dwordx4 v[120:123], v12, s[12:15], s32 offen
    s_waitcnt vmcnt(12)
    v_dot2c_f32_bf16 v40, s60, v80
    v_dot2c_f32_bf16 v41, s61, v80
    v_dot2c_f32_bf16 v42, s60, v81
    v_dot2c_f32_bf16 v43, s61, v81
    v_dot2c_f32_bf16 v44, s60, v82
    v_dot2c_f32_bf16 v45, s61, v82
    v_dot2c_f32_bf16 v46, s60, v83
    v_dot2c_f32_bf16 v47, s61, v83
    buffer_load_dwordx4 v[124:127], v13, s[12:15], s32 offen
    s_add_u32 s32, s32, s33
    s_waitcnt vmcnt(12)
    v_dot2c_f32_bf16 v40, s60, v84
    v_dot2c_f32_bf16 v41, s61, v84
    v_dot2c_f32_bf16 v42, s60, v85
    v_dot2c_f32_bf16 v43, s61, v85
    v_dot2c_f32_bf16 v44, s60, v86
    v_dot2c_f32_bf16 v45, s61, v86
    v_dot2c_f32_bf16 v46, s60, v87
    v_dot2c_f32_bf16 v47, s61, v87
    buffer_load_dwordx4 v[128:131], v12, s[12:15], s32 offen
    s_waitcnt vmcnt(12)
    v_dot2c_f32_bf16 v40, s60, v88
    v_dot2c_f32_bf16 v41, s61, v88
    v_dot2c_f32_bf16 v42, s60, v89
    v_dot2c_f32_bf16 v43, s61, v89
    v_dot2c_f32_bf16 v44, s60, v90
    v_dot2c_f32_bf16 v45, s61, v90
    v_dot2c_f32_bf16 v46, s60, v91
    v_dot2c_f32_bf16 v47, s61, v91
    buffer_load_dwordx4 v[132:135], v13, s[12:15], s32 offen
    s_add_u32 s32, s32, s33
    s_waitcnt vmcnt(12)
    v_dot2c_f32_bf16 v40, s60, v92
    v_dot2c_f32_bf16 v41, s61, v92
    v_dot2c_f32_bf16 v42, s60, v93
    v_dot2c_f32_bf16 v43, s61, v93
    v_dot2c_f32_bf16 v44, s60, v94
    v_dot2c_f32_bf16 v45, s61, v94
    v_dot2c_f32_bf16 v46, s60, v95
    v_dot2c_f32_bf16 v47, s61, v95
    buffer_load_dwordx4 v[136:139], v12, s[12:15], s32 offen
    s_waitcnt vmcnt(12)
    v_dot2c_f32_bf16 v40, s60, v96
    v_dot2c_f32_bf16 v41, s61, v96
    v_dot2c_f32_bf16 v42, s60, v97
    v_dot2c_f32_bf16 v43, s61, v97
    v_dot2c_f32_bf16 v44, s60, v98
    v_dot2c_f32_bf16 v45, s61, v98
    v_dot2c_f32_bf16 v46, s60, v99
    v_dot2c_f32_bf16 v47, s61, v99
    buffer_load_dwordx4 v[140:143], v13, s[12:15], s32 offen
    s_add_u32 s32, s32, s34
    s_waitcnt vmcnt(12)
    v_dot2c_f32_bf16 v40, s60, v100
    v_dot2c_f32_bf16 v41, s61, v100
    v_dot2c_f32_bf16 v42, s60, v101
    v_dot2c_f32_bf16 v43, s61, v101
    v_dot2c_f32_bf16 v44, s60, v102
    v_dot2c_f32_bf16 v45, s61, v102
    v_dot2c_f32_bf16 v46, s60, v103
    v_dot2c_f32_bf16 v47, s61, v103
    buffer_load_dword v55, off, s[52:55], s22 sc1
    s_waitcnt vmcnt(10)
    v_dot2c_f32_bf16 v40, s60, v104
    v_dot2c_f32_bf16 v41, s61, v104
    v_dot2c_f32_bf16 v42, s60, v105
    v_dot2c_f32_bf16 v43, s61, v105
    v_dot2c_f32_bf16 v44, s60, v106
    v_dot2c_f32_bf16 v45, s61, v106
    v_dot2c_f32_bf16 v46, s60, v107
    v_dot2c_f32_bf16 v47, s61, v107
    s_waitcnt vmcnt(9)
    v_dot2c_f32_bf16 v40, s60, v108
    v_dot2c_f32_bf16 v41, s61, v108
    v_dot2c_f32_bf16 v42, s60, v109
    v_dot2c_f32_bf16 v43, s61, v109
    v_dot2c_f32_bf16 v44, s60, v110
    v_dot2c_f32_bf16 v45, s61, v110
    v_dot2c_f32_bf16 v46, s60, v111
    v_dot2c_f32_bf16 v47, s61, v111
    s_waitcnt vmcnt(8)
    v_dot2c_f32_bf16 v40, s60, v112
    v_dot2c_f32_bf16 v41, s61, v112
    v_dot2c_f32_bf16 v42, s60, v113
    v_dot2c_f32_bf16 v43, s61, v113
    v_dot2c_f32_bf16 v44, s60, v114
    v_dot2c_f32_bf16 v45, s61, v114
    v_dot2c_f32_bf16 v46, s60, v115
    v_dot2c_f32_bf16 v47, s61, v115
    s_waitcnt vmcnt(7)
    v_dot2c_f32_bf16 v40, s60, v116
    v_dot2c_f32_bf16 v41, s61, v116
    v_dot2c_f32_bf16 v42, s60, v117
    v_dot2c_f32_bf16 v43, s61, v117
    v_dot2c_f32_bf16 v44, s60, v118
    v_dot2c_f32_bf16 v45, s61, v118
    v_dot2c_f32_bf16 v46, s60, v119
    v_dot2c_f32_bf16 v47, s61, v119
    s_waitcnt vmcnt(6)
    v_dot2c_f32_bf16 v40, s60, v120
    v_dot2c_f32_bf16 v41, s61, v120
    v_dot2c_f32_bf16 v42, s60, v121
    v_dot2c_f32_bf16 v43, s61, v121
    v_dot2c_f32_bf16 v44, s60, v122
    v_dot2c_f32_bf16 v45, s61, v122
    v_dot2c_f32_bf16 v46, s60, v123
    v_dot2c_f32_bf16 v47, s61, v123
    s_waitcnt vmcnt(5)
    v_dot2c_f32_bf16 v40, s60, v124
    v_dot2c_f32_bf16 v41, s61, v124
    v_dot2c_f32_bf16 v42, s60, v125
    v_dot2c_f32_bf16 v43, s61, v125
    v_dot2c_f32_bf16 v44, s60, v126
    v_dot2c_f32_bf16 v45, s61, v126
    v_dot2c_f32_bf16 v46, s60, v127
    v_dot2c_f32_bf16 v47, s61, v127
    s_waitcnt vmcnt(4)
    v_dot2c_f32_bf16 v40, s60, v128
    v_dot2c_f32_bf16 v41, s61, v128
    v_dot2c_f32_bf16 v42, s60, v129
    v_dot2c_f32_bf16 v43, s61, v129
    v_dot2c_f32_bf16 v44, s60, v130
    v_dot2c_f32_bf16 v45, s61, v130
    v_dot2c_f32_bf16 v46, s60, v131
    v_dot2c_f32_bf16 v47, s61, v131
    s_waitcnt vmcnt(3)
    v_dot2c_f32_bf16 v40, s60, v132
    v_dot2c_f32_bf16 v41, s61, v132
    v_dot2c_f32_bf16 v42, s60, v133
    v_dot2c_f32_bf16 v43, s61, v133
    v_dot2c_f32_bf16 v44, s60, v134
    v_dot2c_f32_bf16 v45, s61, v134
    v_dot2c_f32_bf16 v46, s60, v135
    v_dot2c_f32_bf16 v47, s61, v135
    s_waitcnt vmcnt(2)
    v_dot2c_f32_bf16 v40, s60, v136
    v_dot2c_f32_bf16 v41, s61, v136
    v_dot2c_f32_bf16 v42, s60, v137
    v_dot2c_f32_bf16 v43, s61, v137
    v_dot2c_f32_bf16 v44, s60, v138
    v_dot2c_f32_bf16 v45, s61, v138
    v_dot2c_f32_bf16 v46, s60, v139
    v_dot2c_f32_bf16 v47, s61, v139
    s_waitcnt vmcnt(1)
    v_dot2c_f32_bf16 v40, s60, v140
    v_dot2c_f32_bf16 v41, s61, v140
    v_dot2c_f32_bf16 v42, s60, v141
    v_dot2c_f32_bf16 v43, s61, v141
    v_dot2c_f32_bf16 v44, s60, v142
    v_dot2c_f32_bf16 v45, s61, v142
    v_dot2c_f32_bf16 v46, s60, v143
    v_dot2c_f32_bf16 v47, s61, v143
    s_nop 2
    v_add_f32_dpp v40, v40, v40 row_ror:8 row_mask:0xf bank_mask:0xf
    v_add_f32_dpp v41, v41, v41 row_ror:8 row_mask:0xf bank_mask:0xf
    v_add_f32_dpp v42, v42, v42 row_ror:8 row_mask:0xf bank_mask:0xf
    v_add_f32_dpp v43, v43, v43 row_ror:8 row_mask:0xf bank_mask:0xf
    v_add_f32_dpp v44, v44, v44 row_ror:8 row_mask:0xf bank_mask:0xf
    v_add_f32_dpp v45, v45, v45 row_ror:8 row_mask:0xf bank_mask:0xf
    v_add_f32_dpp v46, v46, v46 row_ror:8 row_mask:0xf bank_mask:0xf
    v_add_f32_dpp v47, v47, v47 row_ror:8 row_mask:0xf bank_mask:0xf
    v_mov_b32 v16, v40
    v_mov_b32 v17, v41
    v_mov_b32 v18, v42
    v_mov_b32 v19, v43
    v_mov_b32 v20, v44
    v_mov_b32 v21, v45
    v_mov_b32 v22, v46
    v_mov_b32 v23, v47
    s_nop 1
    v_permlane32_swap_b32 v40, v16
    v_permlane32_swap_b32 v41, v17
    v_permlane32_swap_b32 v42, v18
    v_permlane32_swap_b32 v43, v19
    v_permlane32_swap_b32 v44, v20
    v_permlane32_swap_b32 v45, v21
    v_permlane32_swap_b32 v46, v22
    v_permlane32_swap_b32 v47, v23
    s_nop 1
    v_add_f32 v40, v40, v16
    v_add_f32 v41, v41, v17
    v_add_f32 v42, v42, v18
    v_add_f32 v43, v43, v19
    v_add_f32 v44, v44, v20
    v_add_f32 v45, v45, v21
    v_add_f32 v46, v46, v22
    v_add_f32 v47, v47, v23
    v_mov_b32 v16, v40
    v_mov_b32 v17, v41
    v_mov_b32 v18, v42
    v_mov_b32 v19, v43
    v_mov_b32 v20, v44
    v_mov_b32 v21, v45
    v_mov_b32 v22, v46
    v_mov_b32 v23, v47
    s_nop 1
    v_permlane16_swap_b32 v40, v16
    v_permlane16_swap_b32 v41, v17
    v_permlane16_swap_b32 v42, v18
    v_permlane16_swap_b32 v43, v19
    v_permlane16_swap_b32 v44, v20
    v_permlane16_swap_b32 v45, v21
    v_permlane16_swap_b32 v46, v22
    v_permlane16_swap_b32 v47, v23
    s_nop 1
    v_add_f32 v40, v40, v16
    v_add_f32 v41, v41, v17
    v_add_f32 v42, v42, v18
    v_add_f32 v43, v43, v19
    v_add_f32 v44, v44, v20
    v_add_f32 v45, v45, v21
    v_add_f32 v46, v46, v22
    v_add_f32 v47, v47, v23
    s_lshl_b32 s57, s3, 8
    s_add_u32 s57, s57, 147456
    v_lshl_add_u32 v4, v3, 5, s57
    ds_write_b128 v4, v[40:43]
    ds_write_b128 v4, v[44:47] offset:16
    v_add_u32 v4, 147456, v241
    s_waitcnt lgkmcnt(0)
    s_barrier
    ds_read_b32 v16, v4 offset:0
    ds_read_b32 v17, v4 offset:256
    ds_read_b32 v18, v4 offset:512
    ds_read_b32 v19, v4 offset:768
    s_lshl_b32 s57, s31, 8
    s_add_u32 s57, s57, 28639232
    s_add_u32 s57, s57, s22
    s_mov_b32 s58, 1073741824
    s_waitcnt lgkmcnt(0)
    v_add_f32 v16, v16, v17
    v_add_f32 v18, v18, v19
    v_add_f32 v16, v16, v18
    buffer_store_dword v16, v241, s[4:7], s57 offen sc1
    buffer_store_dword v16, v241, s[4:7], s58 offen sc1
L_hboth_3:
    s_lshl_b32 s35, s28, 7
    s_add_u32 s35, s35, s22
    s_add_u32 s35, s35, 28762112
    s_waitcnt vmcnt(0)
    v_or_b32 v55, s3, v55
    v_cmp_eq_u32 vcc, 0, v55
    s_nop 1
    s_cbranch_vccz L_f0ok_4
    s_mov_b32 s58, 200000
L_poll_5:
    buffer_load_dword v55, off, s[52:55], s22 sc1
L_poll_5w:
    s_waitcnt vmcnt(0)
    v_cmp_eq_u32 vcc, 0, v55
    s_sub_u32 s58, s58, 1
    s_cbranch_scc1 L_pollout_6
    s_cbranch_vccz L_pollout_6
    s_sleep 4
    s_branch L_poll_5
L_pollout_6:
L_f0ok_4:
    s_barrier
    buffer_store_dword v32, off, s[4:7], s35 sc1
    v_mov_b32 v16, -1
    v_mov_b32 v17, -1
    v_mov_b32 v18, -1
    v_mov_b32 v19, -1
    s_sub_u32 s56, s25, 24
    s_lshl_b32 s56, s56, 2
    s_add_u32 s56, s56, s3
    s_mul_i32 s56, s56, 10240
    s_add_u32 s56, s56, s23
    s_add_u32 s56, s56, 983040
    buffer_store_dwordx4 v[16:19], v253, s[4:7], s56 offen offset:0 sc1
    buffer_store_dwordx4 v[16:19], v253, s[4:7], s56 offen offset:1024 sc1
    buffer_store_dwordx4 v[16:19], v253, s[4:7], s56 offen offset:2048 sc1
    buffer_store_dwordx4 v[16:19], v253, s[4:7], s56 offen offset:3072 sc1
    s_add_u32 s56, s56, 4096
    buffer_store_dwordx4 v[16:19], v253, s[4:7], s56 offen offset:0 sc1
    buffer_store_dwordx4 v[16:19], v253, s[4:7], s56 offen offset:1024 sc1
    buffer_store_dwordx4 v[16:19], v253, s[4:7], s56 offen offset:2048 sc1
    buffer_store_dwordx4 v[16:19], v253, s[4:7], s56 offen offset:3072 sc1
    s_add_u32 s56, s56, 4096
    buffer_store_dwordx4 v[16:19], v253, s[4:7], s56 offen offset:0 sc1
    buffer_store_dwordx4 v[16:19], v253, s[4:7], s56 offen offset:1024 sc1
    s_lshl_b32 s30, s24, 2
    s_and_b32 s36, s25, 3
    s_add_u32 s30, s30, s36
    s_lshr_b32 s31, s25, 2
    s_and_b32 s28, s30, 1
    s_bfe_u32 s36, s30, 0x10001
    s_mul_i32 s37, s36, 163840
    s_add_u32 s37, s37, s23
    s_add_u32 s26, s37, 327680
    s_mul_i32 s33, s31, 1310720
    s_lshl_b32 s36, s30, 9
    s_add_u32 s33, s33, s36
    s_lshl_b32 s36, s3, 14
    s_add_u32 s63, s33, s36
    s_add_u32 s63, s63, 1245184
    s_lshl_b32 s36, s3, 16
    s_add_u32 s33, s33, s36
    s_add_u32 s33, s33, 983040
    s_lshl_b32 s38, s31, 2
    s_add_u32 s36, s3, 0
    s_and_b32 s36, s36, 3
    s_mul_i32 s39, s36, 18432
    s_add_u32 s39, s39, 86016
    v_add_u32 v144, s39, v253
    s_add_u32 s36, s36, s38
    s_mul_i32 s36, s36, 5120
    s_add_u32 s40, s36, s37
    s_add_u32 s36, s3, 1
    s_and_b32 s36, s36, 3
    s_mul_i32 s39, s36, 18432
    s_add_u32 s39, s39, 86016
    v_add_u32 v141, s39, v253
    s_add_u32 s36, s36, s38
    s_mul_i32 s36, s36, 5120
    s_add_u32 s41, s36, s37
    s_add_u32 s36, s3, 2
    s_and_b32 s36, s36, 3
    s_mul_i32 s39, s36, 18432
    s_add_u32 s39, s39, 92160
    v_add_u32 v142, s39, v253
    s_add_u32 s36, s36, s38
    s_mul_i32 s36, s36, 5120
    s_add_u32 s42, s36, s37
    s_add_u32 s36, s3, 3
    s_and_b32 s36, s36, 3
    s_mul_i32 s39, s36, 18432
    s_add_u32 s39, s39, 98304
    v_add_u32 v143, s39, v253
    s_add_u32 s36, s36, s38
    s_mul_i32 s36, s36, 5120
    s_add_u32 s43, s36, s37
    s_mul_i32 s36, s28, 1536
    v_add_u32 v136, s36, v253
    v_and_b32 v2, 31, v1
    v_lshrrev_b32 v3, 5, v1
    s_lshl_b32 s36, s28, 3
    s_add_u32 s37, s36, 1024
    v_lshl_add_u32 v6, v2, 4, s37
    v_mul_u32_u24 v4, 2560, v3
    v_add_u32 v137, v6, v4
    v_bfe_u32 v4, v1, 4, 1
    v_lshlrev_b32 v4, 14, v4
    v_and_b32 v5, 15, v1
    v_lshl_add_u32 v4, v5, 4, v4
    v_lshl_add_u32 v139, v3, 8, v4
    v_lshrrev_b32 v4, 2, v2
    v_and_b32 v7, 1, v4
    v_lshlrev_b32 v7, 1, v7
    v_bfe_u32 v5, v4, 1, 1
    v_or_b32 v7, v7, v5
    v_and_b32 v5, 4, v4
    v_or_b32 v5, v5, v7
    v_and_b32 v4, 3, v2
    v_lshl_add_u32 v4, v5, 2, v4
    v_mul_u32_u24 v5, 1280, v3
    v_lshl_add_u32 v4, v4, 4, v5
    s_and_b32 s36, s30, 3
    s_mul_i32 s36, s36, 320
    v_add_u32 v4, s36, v4
    v_mov_b32 v5, 1073741824
    v_cmp_gt_u32 vcc, 20, v2
    s_nop 1
    v_cndmask_b32 v4, v5, v4, vcc
    s_sub_u32 s36, 28114944, s23
    v_mov_b32 v5, s36
    v_cmp_eq_u32 vcc, 20, v2
    s_nop 1
    v_cndmask_b32 v138, v4, v5, vcc
    s_mul_i32 s72, s3, 40960
    s_mov_b32 s74, s72
    s_mul_i32 s36, s3, 81920
    s_add_u32 s73, s23, s36
    s_add_u32 s73, s73, 655360
    v_mov_b32 v10, 1
    s_bfe_u32 s36, s25, 0x10002
    s_lshl_b32 s37, s36, 10
    v_add_u32 v250, s37, v253
    s_xor_b32 s36, s36, 1
    s_lshl_b32 s37, s36, 12
    v_add_u32 v251, s37, v253
    s_lshr_b32 s36, s25, 2
    s_mul_i32 s36, s36, 5120
    s_mul_i32 s44, s3, 163840
    s_add_u32 s44, s44, s36
    s_add_u32 s44, s44, 27607040
    s_mul_i32 s78, s3, 40960
    s_add_u32 s78, s78, s36
    s_add_u32 s78, s78, 28262400
    s_add_u32 s36, s3, 1
    s_and_b32 s36, s36, 3
    s_mul_i32 s36, s36, 15360
    s_add_u32 s36, s36, 86016
    v_add_u32 v242, s36, v253
    s_add_u32 s36, s3, 2
    s_and_b32 s36, s36, 3
    s_mul_i32 s36, s36, 15360
    s_add_u32 s36, s36, 91136
    v_add_u32 v243, s36, v253
    s_add_u32 s36, s3, 3
    s_and_b32 s36, s36, 3
    s_mul_i32 s36, s36, 15360
    s_add_u32 s36, s36, 96256
    v_add_u32 v244, s36, v253
    s_mul_i32 s36, s3, 15360
    s_add_u32 s36, s36, 86016
    v_add_u32 v245, s36, v253
    v_and_b32 v2, 15, v1
    v_lshrrev_b32 v3, 4, v1
    v_and_b32 v4, 1, v3
    v_mul_u32_u24 v4, 120, v4
    v_lshl_add_u32 v4, v3, 7, v4
    v_sub_u32 v199, v253, v4
    v_mul_u32_u24 v2, 1280, v2
    v_lshl_add_u32 v246, v3, 4, v2
    v_lshl_add_u32 v198, v3, 3, v2
    s_lshl_b32 s49, s24, 2
    s_and_b32 s36, s25, 3
    s_add_u32 s49, s49, s36
    s_lshl_b32 s49, s49, 2
    s_add_u32 s49, s49, s3
    s_mul_i32 s50, s49, 20480
    s_lshr_b32 s36, s25, 3
    s_mul_i32 s37, s36, 320
    s_add_u32 s51, s50, s37
    s_mul_i32 s37, s36, 5120
    s_add_u32 s50, s50, s37
    s_mul_i32 s37, s24, 983040
    s_add_u32 s50, s50, s37
    s_add_u32 s50, s50, 0
    s_bfe_u32 s36, s25, 0x10002
    s_lshl_b32 s37, s36, 9
    s_add_u32 s60, s50, s37
    s_add_u32 s60, s60, 2048
    s_lshl_b32 s37, s36, 5
    s_add_u32 s61, s51, s37
    s_add_u32 s61, s61, 128
    s_mul_i32 s37, s36, 3072
    s_add_u32 s50, s50, s37
    s_mul_i32 s37, s36, 192
    s_add_u32 s51, s51, s37
    s_lshr_b32 s36, s25, 1
    s_mul_i32 s48, s36, 7
    s_mul_i32 s47, s3, 7168
    s_lshl_b32 s36, s48, 11
    s_add_u32 s36, s36, s47
    s_lshr_b32 s37, s3, 1
    s_mul_i32 s37, s37, 206848
    s_add_u32 s36, s36, s37
    s_add_u32 s45, s36, 20971520
    s_lshl_b32 s36, s3, 5
    s_and_b32 s36, s36, 32
    s_add_u32 s36, s36, s25
    s_cmp_ge_u32 s36, 62
    s_cselect_b32 s45, 1073741824, s45
    s_lshl_b32 s75, s48, 7
    s_add_u32 s75, s75, 28426240
    v_lshlrev_b32 v146, 2, v0
    s_mul_i32 s71, s3, 10240
    s_add_u32 s71, s71, 86016
    v_lshrrev_b32 v2, 4, v1
    v_bfe_u32 v3, v1, 2, 2
    v_lshl_add_u32 v2, v2, 3, v3
    v_and_b32 v3, 3, v1
    v_lshlrev_b32 v3, 4, v3
    v_lshl_add_u32 v2, v2, 6, v3
    v_add_u32 v202, s71, v2
    v_and_b32 v203, 15, v1
    v_lshlrev_b32 v203, 2, v203
    v_mov_b32 v212, 0x3f803f80
    v_mov_b32 v213, 0x3f803f80
    v_mov_b32 v214, 0x3f803f80
    v_mov_b32 v215, 0x3f803f80
    v_lshrrev_b32 v2, 2, v1
    s_mov_b32 s70, 1073741824
    s_mov_b32 s19, 0x20000
    v_mov_b32 v12, v202
    v_mov_b32 v13, v202
    s_cmp_ge_u32 s2, 108
    s_cbranch_scc1 L_rl2_7
    s_bitcmp1_b32 s3, 0
    s_cselect_b64 s[16:17], s[82:83], s[80:81]
    s_mov_b32 s18, 2211840
    s_mul_i32 s37, s2, 2428
    s_lshr_b32 s37, s37, 16
    s_mul_i32 s38, s37, 27
    s_sub_u32 s38, s2, s38
    s_lshl_b32 s38, s38, 1
    s_lshr_b32 s39, s3, 1
    s_add_u32 s38, s38, s39
    s_mul_i32 s64, s37, 552960
    s_lshl_b32 s39, s38, 6
    s_add_u32 s64, s64, s39
    s_mov_b32 s65, 55296
    s_mov_b32 s66, 55296
    s_mov_b32 s68, 2048
    s_mov_b32 s69, 219136
    s_and_b32 s39, s3, 1
    s_lshl_b32 s38, s38, 2
    s_add_u32 s38, s38, s39
    s_mul_i32 s67, s37, 1105920
    s_lshl_b32 s39, s38, 10
    s_add_u32 s67, s67, s39
    s_add_u32 s67, s67, 20971520
    s_mul_i32 s70, s37, 13824
    s_lshl_b32 s39, s38, 6
    s_add_u32 s70, s70, s39
    s_add_u32 s70, s70, 28426240
    v_mul_u32_u24 v2, 3456, v2
    s_branch L_rl_set_9
L_rl2_7:
    v_lshrrev_b32 v4, 1, v3
    v_sub_u32 v12, v202, v4
    v_add_u32 v13, 24, v12
    s_sub_u32 s37, s2, 108
    s_mov_b32 s68, 1024
    s_mov_b32 s69, 1024
    s_mul_i32 s67, s37, 40960
    s_mul_i32 s39, s3, 10240
    s_add_u32 s67, s67, s39
    s_add_u32 s67, s67, 25395200
    s_mov_b64 s[16:17], s[84:85]
    s_mov_b32 s18, 2211840
    s_lshl_b32 s64, s37, 5
    s_mov_b32 s65, 16
    s_cmp_lt_u32 s37, 54
    s_cbranch_scc1 L_rl0_8
    s_mov_b64 s[16:17], s[88:89]
    s_cmp_lt_u32 s37, 74
    s_cselect_b32 s67, s67, 1073741824
    s_cselect_b32 s18, 819200, 0
    s_sub_u32 s37, s37, 54
    s_mul_i32 s64, s37, 40
    s_mul_i32 s39, s37, 160
    s_sub_u32 s39, s39, 2544
    s_cmp_ge_u32 s37, 16
    s_cselect_b32 s64, s39, s64
    s_cselect_b32 s65, 80, 20
    s_cselect_b32 s38, 16, 0
    v_lshrrev_b32 v4, 4, v1
    v_mad_u32_u24 v2, v4, s38, v2
L_rl0_8:
    s_mul_i32 s64, s64, 1280
    s_mul_i32 s39, s3, 320
    s_add_u32 s64, s64, s39
    s_mul_i32 s65, s65, 1280
    s_sub_u32 s66, 64, s65
    v_mul_u32_u24 v2, 1280, v2
L_rl_set_9:
    v_add_u32 v201, v2, v3
    s_lshl_b32 s36, s24, 5
    s_add_u32 s36, s36, s25
    s_lshl_b32 s36, s36, 2
    s_add_u32 s36, s36, s3
    s_lshl_b32 s34, s2, 5
    s_add_u32 s34, s34, s3
    s_lshl_b32 s34, s34, 2
    s_add_u32 s34, s34, 28680192
    s_lshl_b32 s77, s24, 7
    s_add_u32 s77, s77, 28680192
    s_lshl_b32 s101, s3, 13
    s_add_u32 s101, s101, 28680192
    v_mov_b32 v11, v249
    v_and_b32 v8, 31, v1
    v_lshlrev_b32 v8, 10, v8
    s_mul_i32 s89, s36, 2560
    s_lshl_b32 s93, s36, 7
    s_and_b32 s36, s36, 127
    s_mul_i32 s79, s36, 3456
    s_mul_i32 s76, s36, 6912
    s_add_u32 s76, s76, s23
    s_mul_i32 s90, s36, 2560
    s_add_u32 s90, s90, s23
    v_min_u32 v147, 2432, v249
    v_min_u32 v249, 3328, v249
    v_mov_b32 v7, s27
    s_lshl_b32 s38, s31, 2
    s_add_u32 s38, s38, s3
    s_lshl_b32 s38, s38, 2
    s_lshr_b32 s39, s30, 3
    s_add_u32 s38, s38, s39
    s_lshl_b32 s38, s38, 5
    s_and_b32 s39, s30, 7
    s_add_u32 s38, s38, s39
    s_lshl_b32 s38, s38, 2
    s_add_u32 s38, s38, 28647424
    s_add_u32 s39, s33, 32768
    v_min_u32 v2, 23, v1
    v_lshrrev_b32 v3, 3, v2
    v_and_b32 v4, 7, v2
    v_lshlrev_b32 v3, 9, v3
    v_lshl_add_u32 v3, v4, 2, v3
    s_lshl_b32 s36, s3, 7
    s_lshr_b32 s37, s25, 3
    s_mul_i32 s37, s37, 12288
    s_add_u32 s36, s36, s37
    v_add_u32 v3, s36, v3
    s_lshr_b32 s36, s31, 1
    s_lshl_b32 s36, s36, 7
    s_and_b32 s37, s31, 1
    s_lshl_b32 s37, s37, 4
    s_add_u32 s36, s36, s37
    s_mul_i32 s37, s3, 12288
    s_add_u32 s36, s36, s37
    v_and_b32 v4, 3, v2
    v_cmp_gt_u32 vcc, 8, v2
    v_lshl_add_u32 v4, v4, 2, s36
    s_mul_i32 s59, s24, 1536
    v_cndmask_b32 v145, v3, v4, vcc
    s_add_u32 s59, s59, 28712960
    s_mul_i32 s31, s3, 14
    s_lshr_b32 s36, s25, 2
    s_mul_i32 s36, s36, 5120
    s_mul_i32 s100, s31, 40960
    s_add_u32 s100, s100, s36
    s_add_u32 s100, s100, 25395200
    s_cmp_eq_u32 s3, 3
    s_cselect_b32 s92, 1073741824, 0
    s_add_u32 s94, s92, 40960
    s_lshl_b32 s84, s49, 7
    s_add_u32 s84, s84, 28647424
    v_min_u32 v2, 39, v1
    v_mul_u32_u24 v3, 6554, v2
    v_lshrrev_b32 v3, 16, v3
    v_mul_u32_u24 v3, 39680, v3
    v_lshl_add_u32 v140, v2, 7, v3
    s_and_b32 s85, s25, 3
    s_mul_i32 s85, s85, 1280
    s_add_u32 s85, s85, s100
    s_and_b32 s56, s25, 3
    s_lshl_b32 s37, s3, 12
    s_add_u32 s37, s37, s23
    s_lshl_b32 s57, s56, 14
    s_add_u32 s57, s57, s37
    s_add_u32 s57, s57, 1245184
    s_lshl_b32 s56, s56, 16
    s_add_u32 s56, s56, s37
    s_add_u32 s56, s56, 983040
    s_add_u32 s36, s3, 0
    s_and_b32 s36, s36, 3
    s_lshl_b32 s37, s36, 14
    s_add_u32 s80, s56, s37
    s_and_b32 s37, s36, 1
    s_lshl_b32 s37, s37, 8
    s_lshr_b32 s36, s36, 1
    s_lshl_b32 s36, s36, 3
    s_add_u32 s36, s36, s37
    s_add_u32 s52, s57, s36
    s_add_u32 s36, s3, 1
    s_and_b32 s36, s36, 3
    s_lshl_b32 s37, s36, 14
    s_add_u32 s81, s56, s37
    s_and_b32 s37, s36, 1
    s_lshl_b32 s37, s37, 8
    s_lshr_b32 s36, s36, 1
    s_lshl_b32 s36, s36, 3
    s_add_u32 s36, s36, s37
    s_add_u32 s53, s57, s36
    s_add_u32 s36, s3, 2
    s_and_b32 s36, s36, 3
    s_lshl_b32 s37, s36, 14
    s_add_u32 s82, s56, s37
    s_and_b32 s37, s36, 1
    s_lshl_b32 s37, s37, 8
    s_lshr_b32 s36, s36, 1
    s_lshl_b32 s36, s36, 3
    s_add_u32 s36, s36, s37
    s_add_u32 s54, s57, s36
    s_add_u32 s36, s3, 3
    s_and_b32 s36, s36, 3
    s_lshl_b32 s37, s36, 14
    s_add_u32 s83, s56, s37
    s_and_b32 s37, s36, 1
    s_lshl_b32 s37, s37, 8
    s_lshr_b32 s36, s36, 1
    s_lshl_b32 s36, s36, 3
    s_add_u32 s36, s36, s37
    s_add_u32 s55, s57, s36
    v_lshrrev_b32 v2, 4, v1
    v_mul_u32_u24 v252, 768, v2
    v_add_u32 v252, v252, v253
    s_mov_b32 s58, 200000
L_poll_10:
    buffer_load_dword v2, v54, s[4:7], s22 offen sc1
L_poll_10w:
    s_waitcnt vmcnt(0)
    v_or_b32 v2, s3, v2
    v_cmp_eq_u32 vcc, 0, v2
    s_sub_u32 s58, s58, 1
    s_cbranch_scc1 L_pollout_11
    s_cbranch_vccz L_pollout_11
    s_sleep 8
    s_branch L_poll_10
L_pollout_11:
    s_barrier
    s_mov_b64 exec, 1
    s_mov_b32 s58, 200000
L_poll_12:
    buffer_load_dword v4, v145, s[4:7], s59 offen sc1
L_poll_12w:
    s_waitcnt vmcnt(0)
    v_cmp_eq_u32 vcc, 0, v4
    s_sub_u32 s58, s58, 1
    s_cbranch_scc1 L_pollout_13
    s_cbranch_vccz L_pollout_13
    s_sleep 8
    s_branch L_poll_12
L_pollout_13:
    s_mov_b64 exec, -1
    s_branch sequential_preLN__softmax_full_mha__glu_gated_bilinear__prompt_kernel_p1done
.p2align 12
sequential_preLN__softmax_full_mha__glu_gated_bilinear__prompt_kernel_q:
    s_mul_i32 s56, s37, 5120
    s_add_u32 s46, s46, s56
    s_add_u32 s47, s46, 2560
    s_add_u32 s48, s46, 164352
    s_add_u32 s49, s47, 164352
    v_lshrrev_b32 v2, 5, v1
    v_mul_u32_u24 v2, 161280, v2
    v_add_u32 v26, v2, v253
    v_lshl_add_u32 v30, v52, 2, v30
    v_lshl_add_u32 v31, v53, 4, v31
    s_mov_b64 exec, 0
    s_cmp_eq_u32 s3, 1
    s_cbranch_scc1 sequential_preLN__softmax_full_mha__glu_gated_bilinear__prompt_kernel_wrq
    s_cmp_eq_u32 s3, 2
    s_cbranch_scc1 sequential_preLN__softmax_full_mha__glu_gated_bilinear__prompt_kernel_wrq
    s_cmp_eq_u32 s3, 3
    s_cbranch_scc1 sequential_preLN__softmax_full_mha__glu_gated_bilinear__prompt_kernel_wrq
    s_branch sequential_preLN__softmax_full_mha__glu_gated_bilinear__prompt_kernel_pgq0
sequential_preLN__softmax_full_mha__glu_gated_bilinear__prompt_kernel_wrq:
    s_mov_b64 exec, -1
    s_waitcnt vmcnt(9)
    s_barrier
    ds_read_b64_tr_b16 a[32:33], v24 offset:0
    ds_read_b64_tr_b16 a[34:35], v24 offset:1280
    ds_read_b64_tr_b16 a[36:37], v24 offset:10240
    ds_read_b64_tr_b16 a[38:39], v24 offset:11520
    ds_read_b128 a[0:3], v22 offset:0
    ds_read_b128 a[4:7], v23 offset:0
    ds_read_b128 a[8:11], v22 offset:2048
    ds_read_b128 a[12:15], v23 offset:2048
    ds_read_b128 a[16:19], v22 offset:4096
    ds_read_b128 a[20:23], v23 offset:4096
    ds_read_b128 a[24:27], v22 offset:6144
    ds_read_b128 a[28:31], v23 offset:6144
    ds_read_b64_tr_b16 a[40:41], v25 offset:32
    ds_read_b64_tr_b16 a[42:43], v25 offset:1312
    ds_read_b64_tr_b16 a[44:45], v25 offset:10272
    ds_read_b64_tr_b16 a[46:47], v25 offset:11552
    ds_read_b64_tr_b16 a[48:49], v24 offset:64
    ds_read_b64_tr_b16 a[50:51], v24 offset:1344
    ds_read_b64_tr_b16 a[52:53], v24 offset:10304
    ds_read_b64_tr_b16 a[54:55], v24 offset:11584
    ds_read_b64_tr_b16 a[56:57], v25 offset:96
    ds_read_b64_tr_b16 a[58:59], v25 offset:1376
    ds_read_b64_tr_b16 a[60:61], v25 offset:10336
    ds_read_b64_tr_b16 a[62:63], v25 offset:11616
    ds_read_b64_tr_b16 a[64:65], v24 offset:128
    ds_read_b64_tr_b16 a[66:67], v24 offset:1408
    ds_read_b64_tr_b16 a[68:69], v24 offset:10368
    ds_read_b64_tr_b16 a[70:71], v24 offset:11648
    s_waitcnt lgkmcnt(15)
    v_mfma_f32_16x16x32_bf16 v[56:59], a[32:35], a[0:3], 0
    s_add_u32 m0, s32, 73728
    s_add_u32 s91, s91, 245760
    buffer_load_dwordx4 v12, s[8:11], s29 offen offset:0 lds
    buffer_load_dwordx4 v13, s[8:11], s29 offen offset:1024 lds
    v_mfma_f32_16x16x32_bf16 v[56:59], a[36:39], a[4:7], v[56:59]
    buffer_load_dwordx4 v14, s[8:11], s29 offen offset:2048 lds
    v_mfma_f32_16x16x32_bf16 v[60:63], a[32:35], a[8:11], 0
    buffer_load_dwordx4 v15, s[8:11], s29 offen offset:3072 lds
    v_mfma_f32_16x16x32_bf16 v[60:63], a[36:39], a[12:15], v[60:63]
    s_add_u32 m0, s35, 90112
    s_add_u32 s29, s29, 128
    buffer_load_dwordx4 v16, s[12:15], s91 offen offset:0 lds
    v_mfma_f32_16x16x32_bf16 v[64:67], a[32:35], a[16:19], 0
    buffer_load_dwordx4 v17, s[12:15], s91 offen offset:1024 lds
    buffer_load_dwordx4 v18, s[12:15], s91 offen offset:2048 lds
    v_mfma_f32_16x16x32_bf16 v[64:67], a[36:39], a[20:23], v[64:67]
    buffer_load_dwordx4 v19, s[12:15], s91 offen offset:3072 lds
    v_mfma_f32_16x16x32_bf16 v[68:71], a[32:35], a[24:27], 0
    s_add_u32 m0, s35, 94208
    s_nop 0
    buffer_load_dwordx4 v20, s[12:15], s91 offen offset:0 lds
    v_mfma_f32_16x16x32_bf16 v[68:71], a[36:39], a[28:31], v[68:71]
    s_waitcnt lgkmcnt(0)
    s_waitcnt vmcnt(9)
    s_barrier
    v_mfma_f32_16x16x32_bf16 v[72:75], a[40:43], a[0:3], 0
    ds_read_b64_tr_b16 a[104:105], v24 offset:36864
    v_mfma_f32_16x16x32_bf16 v[72:75], a[44:47], a[4:7], v[72:75]
    ds_read_b64_tr_b16 a[106:107], v24 offset:38144
    v_mfma_f32_16x16x32_bf16 v[76:79], a[40:43], a[8:11], 0
    s_add_u32 m0, s32, 110592
    ds_read_b64_tr_b16 a[108:109], v24 offset:47104
    v_mfma_f32_16x16x32_bf16 v[76:79], a[44:47], a[12:15], v[76:79]
    s_add_u32 s91, s91, 245760
    ds_read_b64_tr_b16 a[110:111], v24 offset:48384
    v_mfma_f32_16x16x32_bf16 v[80:83], a[40:43], a[16:19], 0
    buffer_load_dwordx4 v12, s[8:11], s29 offen offset:0 lds
    ds_read_b128 a[72:75], v22 offset:36864
    v_mfma_f32_16x16x32_bf16 v[80:83], a[44:47], a[20:23], v[80:83]
    ds_read_b128 a[76:79], v23 offset:36864
    v_mfma_f32_16x16x32_bf16 v[84:87], a[40:43], a[24:27], 0
    ds_read_b128 a[80:83], v22 offset:38912
    v_mfma_f32_16x16x32_bf16 v[84:87], a[44:47], a[28:31], v[84:87]
    ds_read_b128 a[84:87], v23 offset:38912
    v_mfma_f32_16x16x32_bf16 v[88:91], a[48:51], a[0:3], 0
    buffer_load_dwordx4 v13, s[8:11], s29 offen offset:1024 lds
    ds_read_b128 a[88:91], v22 offset:40960
    v_mfma_f32_16x16x32_bf16 v[88:91], a[52:55], a[4:7], v[88:91]
    ds_read_b128 a[92:95], v23 offset:40960
    v_mfma_f32_16x16x32_bf16 v[92:95], a[48:51], a[8:11], 0
    ds_read_b128 a[96:99], v22 offset:43008
    v_mfma_f32_16x16x32_bf16 v[92:95], a[52:55], a[12:15], v[92:95]
    ds_read_b128 a[100:103], v23 offset:43008
    v_mfma_f32_16x16x32_bf16 v[96:99], a[48:51], a[16:19], 0
    buffer_load_dwordx4 v14, s[8:11], s29 offen offset:2048 lds
    ds_read_b64_tr_b16 a[112:113], v25 offset:36896
    v_mfma_f32_16x16x32_bf16 v[96:99], a[52:55], a[20:23], v[96:99]
    ds_read_b64_tr_b16 a[114:115], v25 offset:38176
    v_mfma_f32_16x16x32_bf16 v[100:103], a[48:51], a[24:27], 0
    ds_read_b64_tr_b16 a[116:117], v25 offset:47136
    v_mfma_f32_16x16x32_bf16 v[100:103], a[52:55], a[28:31], v[100:103]
    ds_read_b64_tr_b16 a[118:119], v25 offset:48416
    v_mfma_f32_16x16x32_bf16 v[104:107], a[56:59], a[0:3], 0
    buffer_load_dwordx4 v15, s[8:11], s29 offen offset:3072 lds
    ds_read_b64_tr_b16 a[120:121], v24 offset:36928
    v_mfma_f32_16x16x32_bf16 v[104:107], a[60:63], a[4:7], v[104:107]
    s_add_u32 m0, s35, 126976
    ds_read_b64_tr_b16 a[122:123], v24 offset:38208
    v_mfma_f32_16x16x32_bf16 v[108:111], a[56:59], a[8:11], 0
    s_add_u32 s29, s29, 128
    ds_read_b64_tr_b16 a[124:125], v24 offset:47168
    v_mfma_f32_16x16x32_bf16 v[108:111], a[60:63], a[12:15], v[108:111]
    ds_read_b64_tr_b16 a[126:127], v24 offset:48448
    v_mfma_f32_16x16x32_bf16 v[112:115], a[56:59], a[16:19], 0
    ds_read_b64_tr_b16 a[128:129], v25 offset:36960
    v_mfma_f32_16x16x32_bf16 v[112:115], a[60:63], a[20:23], v[112:115]
    buffer_load_dwordx4 v16, s[12:15], s91 offen offset:0 lds
    ds_read_b64_tr_b16 a[130:131], v25 offset:38240
    v_mfma_f32_16x16x32_bf16 v[116:119], a[56:59], a[24:27], 0
    ds_read_b64_tr_b16 a[132:133], v25 offset:47200
    v_mfma_f32_16x16x32_bf16 v[116:119], a[60:63], a[28:31], v[116:119]
    ds_read_b64_tr_b16 a[134:135], v25 offset:48480
    v_mfma_f32_16x16x32_bf16 v[120:123], a[64:67], a[0:3], 0
    ds_read_b64_tr_b16 a[136:137], v24 offset:36992
    v_mfma_f32_16x16x32_bf16 v[120:123], a[68:71], a[4:7], v[120:123]
    buffer_load_dwordx4 v17, s[12:15], s91 offen offset:1024 lds
    ds_read_b64_tr_b16 a[138:139], v24 offset:38272
    v_mfma_f32_16x16x32_bf16 v[124:127], a[64:67], a[8:11], 0
    ds_read_b64_tr_b16 a[140:141], v24 offset:47232
    v_mfma_f32_16x16x32_bf16 v[124:127], a[68:71], a[12:15], v[124:127]
    ds_read_b64_tr_b16 a[142:143], v24 offset:48512
    v_mfma_f32_16x16x32_bf16 v[128:131], a[64:67], a[16:19], 0
    v_mfma_f32_16x16x32_bf16 v[128:131], a[68:71], a[20:23], v[128:131]
    buffer_load_dwordx4 v18, s[12:15], s91 offen offset:2048 lds
    v_mfma_f32_16x16x32_bf16 v[132:135], a[64:67], a[24:27], 0
    v_mfma_f32_16x16x32_bf16 v[132:135], a[68:71], a[28:31], v[132:135]
    s_waitcnt lgkmcnt(15)
    v_mfma_f32_16x16x32_bf16 v[56:59], a[104:107], a[72:75], v[56:59]
    v_mfma_f32_16x16x32_bf16 v[56:59], a[108:111], a[76:79], v[56:59]
    v_mfma_f32_16x16x32_bf16 v[60:63], a[104:107], a[80:83], v[60:63]
    buffer_load_dwordx4 v19, s[12:15], s91 offen offset:3072 lds
    v_mfma_f32_16x16x32_bf16 v[60:63], a[108:111], a[84:87], v[60:63]
    s_add_u32 m0, s35, 131072
    v_mfma_f32_16x16x32_bf16 v[64:67], a[104:107], a[88:91], v[64:67]
    v_add_u32 v22, 73728, v22
    v_add_u32 v23, 73728, v23
    v_mfma_f32_16x16x32_bf16 v[64:67], a[108:111], a[92:95], v[64:67]
    v_add_u32 v24, 73728, v24
    v_mfma_f32_16x16x32_bf16 v[68:71], a[104:107], a[96:99], v[68:71]
    buffer_load_dwordx4 v20, s[12:15], s91 offen offset:0 lds
    v_mfma_f32_16x16x32_bf16 v[68:71], a[108:111], a[100:103], v[68:71]
    s_waitcnt lgkmcnt(0)
    s_waitcnt vmcnt(9)
    v_add_u32 v25, 73728, v25
    s_barrier
    v_mfma_f32_16x16x32_bf16 v[72:75], a[112:115], a[72:75], v[72:75]
    ds_read_b64_tr_b16 a[32:33], v24 offset:0
    v_mfma_f32_16x16x32_bf16 v[72:75], a[116:119], a[76:79], v[72:75]
    ds_read_b64_tr_b16 a[34:35], v24 offset:1280
    v_mfma_f32_16x16x32_bf16 v[76:79], a[112:115], a[80:83], v[76:79]
    s_add_u32 m0, s32, 0
    ds_read_b64_tr_b16 a[36:37], v24 offset:10240
    v_mfma_f32_16x16x32_bf16 v[76:79], a[116:119], a[84:87], v[76:79]
    s_add_u32 s91, s91, 245760
    ds_read_b64_tr_b16 a[38:39], v24 offset:11520
    v_mfma_f32_16x16x32_bf16 v[80:83], a[112:115], a[88:91], v[80:83]
    buffer_load_dwordx4 v12, s[8:11], s29 offen offset:0 lds
    ds_read_b128 a[0:3], v22 offset:0
    v_mfma_f32_16x16x32_bf16 v[80:83], a[116:119], a[92:95], v[80:83]
    ds_read_b128 a[4:7], v23 offset:0
    v_mfma_f32_16x16x32_bf16 v[84:87], a[112:115], a[96:99], v[84:87]
    ds_read_b128 a[8:11], v22 offset:2048
    v_mfma_f32_16x16x32_bf16 v[84:87], a[116:119], a[100:103], v[84:87]
    ds_read_b128 a[12:15], v23 offset:2048
    v_mfma_f32_16x16x32_bf16 v[88:91], a[120:123], a[72:75], v[88:91]
    buffer_load_dwordx4 v13, s[8:11], s29 offen offset:1024 lds
    ds_read_b128 a[16:19], v22 offset:4096
    v_mfma_f32_16x16x32_bf16 v[88:91], a[124:127], a[76:79], v[88:91]
    ds_read_b128 a[20:23], v23 offset:4096
    v_mfma_f32_16x16x32_bf16 v[92:95], a[120:123], a[80:83], v[92:95]
    ds_read_b128 a[24:27], v22 offset:6144
    v_mfma_f32_16x16x32_bf16 v[92:95], a[124:127], a[84:87], v[92:95]
    ds_read_b128 a[28:31], v23 offset:6144
    v_mfma_f32_16x16x32_bf16 v[96:99], a[120:123], a[88:91], v[96:99]
    buffer_load_dwordx4 v14, s[8:11], s29 offen offset:2048 lds
    ds_read_b64_tr_b16 a[40:41], v25 offset:32
    v_mfma_f32_16x16x32_bf16 v[96:99], a[124:127], a[92:95], v[96:99]
    ds_read_b64_tr_b16 a[42:43], v25 offset:1312
    v_mfma_f32_16x16x32_bf16 v[100:103], a[120:123], a[96:99], v[100:103]
    ds_read_b64_tr_b16 a[44:45], v25 offset:10272
    v_mfma_f32_16x16x32_bf16 v[100:103], a[124:127], a[100:103], v[100:103]
    ds_read_b64_tr_b16 a[46:47], v25 offset:11552
    v_mfma_f32_16x16x32_bf16 v[104:107], a[128:131], a[72:75], v[104:107]
    buffer_load_dwordx4 v15, s[8:11], s29 offen offset:3072 lds
    ds_read_b64_tr_b16 a[48:49], v24 offset:64
    v_mfma_f32_16x16x32_bf16 v[104:107], a[132:135], a[76:79], v[104:107]
    s_add_u32 m0, s35, 16384
    ds_read_b64_tr_b16 a[50:51], v24 offset:1344
    v_mfma_f32_16x16x32_bf16 v[108:111], a[128:131], a[80:83], v[108:111]
    s_add_u32 s29, s29, 128
    ds_read_b64_tr_b16 a[52:53], v24 offset:10304
    v_mfma_f32_16x16x32_bf16 v[108:111], a[132:135], a[84:87], v[108:111]
    ds_read_b64_tr_b16 a[54:55], v24 offset:11584
    v_mfma_f32_16x16x32_bf16 v[112:115], a[128:131], a[88:91], v[112:115]
    ds_read_b64_tr_b16 a[56:57], v25 offset:96
    v_mfma_f32_16x16x32_bf16 v[112:115], a[132:135], a[92:95], v[112:115]
    buffer_load_dwordx4 v16, s[12:15], s91 offen offset:0 lds
    ds_read_b64_tr_b16 a[58:59], v25 offset:1376
    v_mfma_f32_16x16x32_bf16 v[116:119], a[128:131], a[96:99], v[116:119]
    ds_read_b64_tr_b16 a[60:61], v25 offset:10336
    v_mfma_f32_16x16x32_bf16 v[116:119], a[132:135], a[100:103], v[116:119]
    ds_read_b64_tr_b16 a[62:63], v25 offset:11616
    v_mfma_f32_16x16x32_bf16 v[120:123], a[136:139], a[72:75], v[120:123]
    ds_read_b64_tr_b16 a[64:65], v24 offset:128
    v_mfma_f32_16x16x32_bf16 v[120:123], a[140:143], a[76:79], v[120:123]
    buffer_load_dwordx4 v17, s[12:15], s91 offen offset:1024 lds
    ds_read_b64_tr_b16 a[66:67], v24 offset:1408
    v_mfma_f32_16x16x32_bf16 v[124:127], a[136:139], a[80:83], v[124:127]
    ds_read_b64_tr_b16 a[68:69], v24 offset:10368
    v_mfma_f32_16x16x32_bf16 v[124:127], a[140:143], a[84:87], v[124:127]
    ds_read_b64_tr_b16 a[70:71], v24 offset:11648
    v_mfma_f32_16x16x32_bf16 v[128:131], a[136:139], a[88:91], v[128:131]
    v_mfma_f32_16x16x32_bf16 v[128:131], a[140:143], a[92:95], v[128:131]
    buffer_load_dwordx4 v18, s[12:15], s91 offen offset:2048 lds
    v_mfma_f32_16x16x32_bf16 v[132:135], a[136:139], a[96:99], v[132:135]
    v_mfma_f32_16x16x32_bf16 v[132:135], a[140:143], a[100:103], v[132:135]
    s_waitcnt lgkmcnt(15)
    v_mfma_f32_16x16x32_bf16 v[56:59], a[32:35], a[0:3], v[56:59]
    v_mfma_f32_16x16x32_bf16 v[56:59], a[36:39], a[4:7], v[56:59]
    v_mfma_f32_16x16x32_bf16 v[60:63], a[32:35], a[8:11], v[60:63]
    buffer_load_dwordx4 v19, s[12:15], s91 offen offset:3072 lds
    v_mfma_f32_16x16x32_bf16 v[60:63], a[36:39], a[12:15], v[60:63]
    s_add_u32 m0, s35, 20480
    v_mfma_f32_16x16x32_bf16 v[64:67], a[32:35], a[16:19], v[64:67]
    v_mfma_f32_16x16x32_bf16 v[64:67], a[36:39], a[20:23], v[64:67]
    v_mfma_f32_16x16x32_bf16 v[68:71], a[32:35], a[24:27], v[68:71]
    buffer_load_dwordx4 v20, s[12:15], s91 offen offset:0 lds
    v_mfma_f32_16x16x32_bf16 v[68:71], a[36:39], a[28:31], v[68:71]
    s_waitcnt lgkmcnt(0)
    s_waitcnt vmcnt(9)
    s_barrier
    v_mfma_f32_16x16x32_bf16 v[72:75], a[40:43], a[0:3], v[72:75]
    ds_read_b64_tr_b16 a[104:105], v24 offset:36864
    v_mfma_f32_16x16x32_bf16 v[72:75], a[44:47], a[4:7], v[72:75]
    ds_read_b64_tr_b16 a[106:107], v24 offset:38144
    v_mfma_f32_16x16x32_bf16 v[76:79], a[40:43], a[8:11], v[76:79]
    s_add_u32 m0, s32, 36864
    ds_read_b64_tr_b16 a[108:109], v24 offset:47104
    v_mfma_f32_16x16x32_bf16 v[76:79], a[44:47], a[12:15], v[76:79]
    s_add_u32 s91, s91, 245760
    ds_read_b64_tr_b16 a[110:111], v24 offset:48384
    v_mfma_f32_16x16x32_bf16 v[80:83], a[40:43], a[16:19], v[80:83]
    buffer_load_dwordx4 v12, s[8:11], s29 offen offset:0 lds
    ds_read_b128 a[72:75], v22 offset:36864
    v_mfma_f32_16x16x32_bf16 v[80:83], a[44:47], a[20:23], v[80:83]
    ds_read_b128 a[76:79], v23 offset:36864
    v_mfma_f32_16x16x32_bf16 v[84:87], a[40:43], a[24:27], v[84:87]
    ds_read_b128 a[80:83], v22 offset:38912
    v_mfma_f32_16x16x32_bf16 v[84:87], a[44:47], a[28:31], v[84:87]
    ds_read_b128 a[84:87], v23 offset:38912
    v_mfma_f32_16x16x32_bf16 v[88:91], a[48:51], a[0:3], v[88:91]
    buffer_load_dwordx4 v13, s[8:11], s29 offen offset:1024 lds
    ds_read_b128 a[88:91], v22 offset:40960
    v_mfma_f32_16x16x32_bf16 v[88:91], a[52:55], a[4:7], v[88:91]
    ds_read_b128 a[92:95], v23 offset:40960
    v_mfma_f32_16x16x32_bf16 v[92:95], a[48:51], a[8:11], v[92:95]
    ds_read_b128 a[96:99], v22 offset:43008
    v_mfma_f32_16x16x32_bf16 v[92:95], a[52:55], a[12:15], v[92:95]
    ds_read_b128 a[100:103], v23 offset:43008
    v_mfma_f32_16x16x32_bf16 v[96:99], a[48:51], a[16:19], v[96:99]
    buffer_load_dwordx4 v14, s[8:11], s29 offen offset:2048 lds
    ds_read_b64_tr_b16 a[112:113], v25 offset:36896
    v_mfma_f32_16x16x32_bf16 v[96:99], a[52:55], a[20:23], v[96:99]
    ds_read_b64_tr_b16 a[114:115], v25 offset:38176
    v_mfma_f32_16x16x32_bf16 v[100:103], a[48:51], a[24:27], v[100:103]
    ds_read_b64_tr_b16 a[116:117], v25 offset:47136
    v_mfma_f32_16x16x32_bf16 v[100:103], a[52:55], a[28:31], v[100:103]
    ds_read_b64_tr_b16 a[118:119], v25 offset:48416
    v_mfma_f32_16x16x32_bf16 v[104:107], a[56:59], a[0:3], v[104:107]
    buffer_load_dwordx4 v15, s[8:11], s29 offen offset:3072 lds
    ds_read_b64_tr_b16 a[120:121], v24 offset:36928
    v_mfma_f32_16x16x32_bf16 v[104:107], a[60:63], a[4:7], v[104:107]
    s_add_u32 m0, s35, 53248
    ds_read_b64_tr_b16 a[122:123], v24 offset:38208
    v_mfma_f32_16x16x32_bf16 v[108:111], a[56:59], a[8:11], v[108:111]
    s_add_u32 s29, s29, 128
    ds_read_b64_tr_b16 a[124:125], v24 offset:47168
    v_mfma_f32_16x16x32_bf16 v[108:111], a[60:63], a[12:15], v[108:111]
    ds_read_b64_tr_b16 a[126:127], v24 offset:48448
    v_mfma_f32_16x16x32_bf16 v[112:115], a[56:59], a[16:19], v[112:115]
    ds_read_b64_tr_b16 a[128:129], v25 offset:36960
    v_mfma_f32_16x16x32_bf16 v[112:115], a[60:63], a[20:23], v[112:115]
    buffer_load_dwordx4 v16, s[12:15], s91 offen offset:0 lds
    ds_read_b64_tr_b16 a[130:131], v25 offset:38240
    v_mfma_f32_16x16x32_bf16 v[116:119], a[56:59], a[24:27], v[116:119]
    ds_read_b64_tr_b16 a[132:133], v25 offset:47200
    v_mfma_f32_16x16x32_bf16 v[116:119], a[60:63], a[28:31], v[116:119]
    ds_read_b64_tr_b16 a[134:135], v25 offset:48480
    v_mfma_f32_16x16x32_bf16 v[120:123], a[64:67], a[0:3], v[120:123]
    ds_read_b64_tr_b16 a[136:137], v24 offset:36992
    v_mfma_f32_16x16x32_bf16 v[120:123], a[68:71], a[4:7], v[120:123]
    buffer_load_dwordx4 v17, s[12:15], s91 offen offset:1024 lds
    ds_read_b64_tr_b16 a[138:139], v24 offset:38272
    v_mfma_f32_16x16x32_bf16 v[124:127], a[64:67], a[8:11], v[124:127]
    ds_read_b64_tr_b16 a[140:141], v24 offset:47232
    v_mfma_f32_16x16x32_bf16 v[124:127], a[68:71], a[12:15], v[124:127]
    ds_read_b64_tr_b16 a[142:143], v24 offset:48512
    v_mfma_f32_16x16x32_bf16 v[128:131], a[64:67], a[16:19], v[128:131]
    v_mfma_f32_16x16x32_bf16 v[128:131], a[68:71], a[20:23], v[128:131]
    buffer_load_dwordx4 v18, s[12:15], s91 offen offset:2048 lds
    v_mfma_f32_16x16x32_bf16 v[132:135], a[64:67], a[24:27], v[132:135]
    v_mfma_f32_16x16x32_bf16 v[132:135], a[68:71], a[28:31], v[132:135]
    s_waitcnt lgkmcnt(15)
    v_mfma_f32_16x16x32_bf16 v[56:59], a[104:107], a[72:75], v[56:59]
    v_mfma_f32_16x16x32_bf16 v[56:59], a[108:111], a[76:79], v[56:59]
    v_mfma_f32_16x16x32_bf16 v[60:63], a[104:107], a[80:83], v[60:63]
    buffer_load_dwordx4 v19, s[12:15], s91 offen offset:3072 lds
    v_mfma_f32_16x16x32_bf16 v[60:63], a[108:111], a[84:87], v[60:63]
    s_add_u32 m0, s35, 57344
    v_mfma_f32_16x16x32_bf16 v[64:67], a[104:107], a[88:91], v[64:67]
    v_add_u32 v22, 4294893568, v22
    v_add_u32 v23, 4294893568, v23
    v_mfma_f32_16x16x32_bf16 v[64:67], a[108:111], a[92:95], v[64:67]
    v_add_u32 v24, 4294893568, v24
    v_mfma_f32_16x16x32_bf16 v[68:71], a[104:107], a[96:99], v[68:71]
    buffer_load_dwordx4 v20, s[12:15], s91 offen offset:0 lds
    v_mfma_f32_16x16x32_bf16 v[68:71], a[108:111], a[100:103], v[68:71]
    s_waitcnt lgkmcnt(0)
    s_waitcnt vmcnt(9)
    v_add_u32 v25, 4294893568, v25
    s_barrier
    v_mfma_f32_16x16x32_bf16 v[72:75], a[112:115], a[72:75], v[72:75]
    ds_read_b64_tr_b16 a[32:33], v24 offset:0
    v_mfma_f32_16x16x32_bf16 v[72:75], a[116:119], a[76:79], v[72:75]
    ds_read_b64_tr_b16 a[34:35], v24 offset:1280
    v_mfma_f32_16x16x32_bf16 v[76:79], a[112:115], a[80:83], v[76:79]
    s_add_u32 m0, s32, 73728
    ds_read_b64_tr_b16 a[36:37], v24 offset:10240
    v_mfma_f32_16x16x32_bf16 v[76:79], a[116:119], a[84:87], v[76:79]
    s_add_u32 s91, s91, 245760
    buffer_load_dword v55, off, s[52:55], s22 sc1
    ds_read_b64_tr_b16 a[38:39], v24 offset:11520
    v_mfma_f32_16x16x32_bf16 v[80:83], a[112:115], a[88:91], v[80:83]
    buffer_load_dwordx4 v12, s[8:11], s29 offen offset:0 lds
    ds_read_b128 a[0:3], v22 offset:0
    v_mfma_f32_16x16x32_bf16 v[80:83], a[116:119], a[92:95], v[80:83]
    ds_read_b128 a[4:7], v23 offset:0
    v_mfma_f32_16x16x32_bf16 v[84:87], a[112:115], a[96:99], v[84:87]
    ds_read_b128 a[8:11], v22 offset:2048
    v_mfma_f32_16x16x32_bf16 v[84:87], a[116:119], a[100:103], v[84:87]
    ds_read_b128 a[12:15], v23 offset:2048
    v_mfma_f32_16x16x32_bf16 v[88:91], a[120:123], a[72:75], v[88:91]
    buffer_load_dwordx4 v13, s[8:11], s29 offen offset:1024 lds
    ds_read_b128 a[16:19], v22 offset:4096
    v_mfma_f32_16x16x32_bf16 v[88:91], a[124:127], a[76:79], v[88:91]
    ds_read_b128 a[20:23], v23 offset:4096
    v_mfma_f32_16x16x32_bf16 v[92:95], a[120:123], a[80:83], v[92:95]
    ds_read_b128 a[24:27], v22 offset:6144
    v_mfma_f32_16x16x32_bf16 v[92:95], a[124:127], a[84:87], v[92:95]
    ds_read_b128 a[28:31], v23 offset:6144
    v_mfma_f32_16x16x32_bf16 v[96:99], a[120:123], a[88:91], v[96:99]
    buffer_load_dwordx4 v14, s[8:11], s29 offen offset:2048 lds
    ds_read_b64_tr_b16 a[40:41], v25 offset:32
    v_mfma_f32_16x16x32_bf16 v[96:99], a[124:127], a[92:95], v[96:99]
    ds_read_b64_tr_b16 a[42:43], v25 offset:1312
    v_mfma_f32_16x16x32_bf16 v[100:103], a[120:123], a[96:99], v[100:103]
    ds_read_b64_tr_b16 a[44:45], v25 offset:10272
    v_mfma_f32_16x16x32_bf16 v[100:103], a[124:127], a[100:103], v[100:103]
    ds_read_b64_tr_b16 a[46:47], v25 offset:11552
    v_mfma_f32_16x16x32_bf16 v[104:107], a[128:131], a[72:75], v[104:107]
    buffer_load_dwordx4 v15, s[8:11], s29 offen offset:3072 lds
    ds_read_b64_tr_b16 a[48:49], v24 offset:64
    v_mfma_f32_16x16x32_bf16 v[104:107], a[132:135], a[76:79], v[104:107]
    s_add_u32 m0, s35, 90112
    ds_read_b64_tr_b16 a[50:51], v24 offset:1344
    v_mfma_f32_16x16x32_bf16 v[108:111], a[128:131], a[80:83], v[108:111]
    s_add_u32 s29, s29, 128
    ds_read_b64_tr_b16 a[52:53], v24 offset:10304
    v_mfma_f32_16x16x32_bf16 v[108:111], a[132:135], a[84:87], v[108:111]
    ds_read_b64_tr_b16 a[54:55], v24 offset:11584
    v_mfma_f32_16x16x32_bf16 v[112:115], a[128:131], a[88:91], v[112:115]
    ds_read_b64_tr_b16 a[56:57], v25 offset:96
    v_mfma_f32_16x16x32_bf16 v[112:115], a[132:135], a[92:95], v[112:115]
    buffer_load_dwordx4 v16, s[12:15], s91 offen offset:0 lds
    ds_read_b64_tr_b16 a[58:59], v25 offset:1376
    v_mfma_f32_16x16x32_bf16 v[116:119], a[128:131], a[96:99], v[116:119]
    ds_read_b64_tr_b16 a[60:61], v25 offset:10336
    v_mfma_f32_16x16x32_bf16 v[116:119], a[132:135], a[100:103], v[116:119]
    ds_read_b64_tr_b16 a[62:63], v25 offset:11616
    v_mfma_f32_16x16x32_bf16 v[120:123], a[136:139], a[72:75], v[120:123]
    ds_read_b64_tr_b16 a[64:65], v24 offset:128
    v_mfma_f32_16x16x32_bf16 v[120:123], a[140:143], a[76:79], v[120:123]
    buffer_load_dwordx4 v17, s[12:15], s91 offen offset:1024 lds
    ds_read_b64_tr_b16 a[66:67], v24 offset:1408
    v_mfma_f32_16x16x32_bf16 v[124:127], a[136:139], a[80:83], v[124:127]
    ds_read_b64_tr_b16 a[68:69], v24 offset:10368
    v_mfma_f32_16x16x32_bf16 v[124:127], a[140:143], a[84:87], v[124:127]
    ds_read_b64_tr_b16 a[70:71], v24 offset:11648
    v_mfma_f32_16x16x32_bf16 v[128:131], a[136:139], a[88:91], v[128:131]
    v_mfma_f32_16x16x32_bf16 v[128:131], a[140:143], a[92:95], v[128:131]
    buffer_load_dwordx4 v18, s[12:15], s91 offen offset:2048 lds
    v_mfma_f32_16x16x32_bf16 v[132:135], a[136:139], a[96:99], v[132:135]
    v_mfma_f32_16x16x32_bf16 v[132:135], a[140:143], a[100:103], v[132:135]
    s_waitcnt lgkmcnt(15)
    v_mfma_f32_16x16x32_bf16 v[56:59], a[32:35], a[0:3], v[56:59]
    v_mfma_f32_16x16x32_bf16 v[56:59], a[36:39], a[4:7], v[56:59]
    v_mfma_f32_16x16x32_bf16 v[60:63], a[32:35], a[8:11], v[60:63]
    buffer_load_dwordx4 v19, s[12:15], s91 offen offset:3072 lds
    v_mfma_f32_16x16x32_bf16 v[60:63], a[36:39], a[12:15], v[60:63]
    s_add_u32 m0, s35, 94208
    v_mfma_f32_16x16x32_bf16 v[64:67], a[32:35], a[16:19], v[64:67]
    v_mfma_f32_16x16x32_bf16 v[64:67], a[36:39], a[20:23], v[64:67]
    v_mfma_f32_16x16x32_bf16 v[68:71], a[32:35], a[24:27], v[68:71]
    buffer_load_dwordx4 v20, s[12:15], s91 offen offset:0 lds
    v_mfma_f32_16x16x32_bf16 v[68:71], a[36:39], a[28:31], v[68:71]
    s_waitcnt lgkmcnt(0)
    s_waitcnt vmcnt(9)
    s_barrier
    v_mfma_f32_16x16x32_bf16 v[72:75], a[40:43], a[0:3], v[72:75]
    ds_read_b64_tr_b16 a[104:105], v24 offset:36864
    v_mfma_f32_16x16x32_bf16 v[72:75], a[44:47], a[4:7], v[72:75]
    ds_read_b64_tr_b16 a[106:107], v24 offset:38144
    v_mfma_f32_16x16x32_bf16 v[76:79], a[40:43], a[8:11], v[76:79]
    s_add_u32 m0, s32, 110592
    ds_read_b64_tr_b16 a[108:109], v24 offset:47104
    v_mfma_f32_16x16x32_bf16 v[76:79], a[44:47], a[12:15], v[76:79]
    s_add_u32 s91, s91, 245760
    ds_read_b64_tr_b16 a[110:111], v24 offset:48384
    v_mfma_f32_16x16x32_bf16 v[80:83], a[40:43], a[16:19], v[80:83]
    buffer_load_dwordx4 v12, s[8:11], s29 offen offset:0 lds
    ds_read_b128 a[72:75], v22 offset:36864
    v_mfma_f32_16x16x32_bf16 v[80:83], a[44:47], a[20:23], v[80:83]
    ds_read_b128 a[76:79], v23 offset:36864
    v_mfma_f32_16x16x32_bf16 v[84:87], a[40:43], a[24:27], v[84:87]
    ds_read_b128 a[80:83], v22 offset:38912
    v_mfma_f32_16x16x32_bf16 v[84:87], a[44:47], a[28:31], v[84:87]
    ds_read_b128 a[84:87], v23 offset:38912
    v_mfma_f32_16x16x32_bf16 v[88:91], a[48:51], a[0:3], v[88:91]
    buffer_load_dwordx4 v13, s[8:11], s29 offen offset:1024 lds
    ds_read_b128 a[88:91], v22 offset:40960
    v_mfma_f32_16x16x32_bf16 v[88:91], a[52:55], a[4:7], v[88:91]
    ds_read_b128 a[92:95], v23 offset:40960
    v_mfma_f32_16x16x32_bf16 v[92:95], a[48:51], a[8:11], v[92:95]
    ds_read_b128 a[96:99], v22 offset:43008
    v_mfma_f32_16x16x32_bf16 v[92:95], a[52:55], a[12:15], v[92:95]
    ds_read_b128 a[100:103], v23 offset:43008
    v_mfma_f32_16x16x32_bf16 v[96:99], a[48:51], a[16:19], v[96:99]
    buffer_load_dwordx4 v14, s[8:11], s29 offen offset:2048 lds
    ds_read_b64_tr_b16 a[112:113], v25 offset:36896
    v_mfma_f32_16x16x32_bf16 v[96:99], a[52:55], a[20:23], v[96:99]
    ds_read_b64_tr_b16 a[114:115], v25 offset:38176
    v_mfma_f32_16x16x32_bf16 v[100:103], a[48:51], a[24:27], v[100:103]
    ds_read_b64_tr_b16 a[116:117], v25 offset:47136
    v_mfma_f32_16x16x32_bf16 v[100:103], a[52:55], a[28:31], v[100:103]
    ds_read_b64_tr_b16 a[118:119], v25 offset:48416
    v_mfma_f32_16x16x32_bf16 v[104:107], a[56:59], a[0:3], v[104:107]
    buffer_load_dwordx4 v15, s[8:11], s29 offen offset:3072 lds
    ds_read_b64_tr_b16 a[120:121], v24 offset:36928
    v_mfma_f32_16x16x32_bf16 v[104:107], a[60:63], a[4:7], v[104:107]
    s_add_u32 m0, s35, 126976
    ds_read_b64_tr_b16 a[122:123], v24 offset:38208
    v_mfma_f32_16x16x32_bf16 v[108:111], a[56:59], a[8:11], v[108:111]
    s_add_u32 s29, s29, 128
    ds_read_b64_tr_b16 a[124:125], v24 offset:47168
    v_mfma_f32_16x16x32_bf16 v[108:111], a[60:63], a[12:15], v[108:111]
    ds_read_b64_tr_b16 a[126:127], v24 offset:48448
    v_mfma_f32_16x16x32_bf16 v[112:115], a[56:59], a[16:19], v[112:115]
    ds_read_b64_tr_b16 a[128:129], v25 offset:36960
    v_mfma_f32_16x16x32_bf16 v[112:115], a[60:63], a[20:23], v[112:115]
    buffer_load_dwordx4 v16, s[12:15], s91 offen offset:0 lds
    ds_read_b64_tr_b16 a[130:131], v25 offset:38240
    v_mfma_f32_16x16x32_bf16 v[116:119], a[56:59], a[24:27], v[116:119]
    ds_read_b64_tr_b16 a[132:133], v25 offset:47200
    v_mfma_f32_16x16x32_bf16 v[116:119], a[60:63], a[28:31], v[116:119]
    ds_read_b64_tr_b16 a[134:135], v25 offset:48480
    v_mfma_f32_16x16x32_bf16 v[120:123], a[64:67], a[0:3], v[120:123]
    ds_read_b64_tr_b16 a[136:137], v24 offset:36992
    v_mfma_f32_16x16x32_bf16 v[120:123], a[68:71], a[4:7], v[120:123]
    buffer_load_dwordx4 v17, s[12:15], s91 offen offset:1024 lds
    ds_read_b64_tr_b16 a[138:139], v24 offset:38272
    v_mfma_f32_16x16x32_bf16 v[124:127], a[64:67], a[8:11], v[124:127]
    ds_read_b64_tr_b16 a[140:141], v24 offset:47232
    v_mfma_f32_16x16x32_bf16 v[124:127], a[68:71], a[12:15], v[124:127]
    ds_read_b64_tr_b16 a[142:143], v24 offset:48512
    v_mfma_f32_16x16x32_bf16 v[128:131], a[64:67], a[16:19], v[128:131]
    v_mfma_f32_16x16x32_bf16 v[128:131], a[68:71], a[20:23], v[128:131]
    buffer_load_dwordx4 v18, s[12:15], s91 offen offset:2048 lds
    v_mfma_f32_16x16x32_bf16 v[132:135], a[64:67], a[24:27], v[132:135]
    v_mfma_f32_16x16x32_bf16 v[132:135], a[68:71], a[28:31], v[132:135]
    s_waitcnt lgkmcnt(15)
    v_mfma_f32_16x16x32_bf16 v[56:59], a[104:107], a[72:75], v[56:59]
    v_mfma_f32_16x16x32_bf16 v[56:59], a[108:111], a[76:79], v[56:59]
    v_mfma_f32_16x16x32_bf16 v[60:63], a[104:107], a[80:83], v[60:63]
    buffer_load_dwordx4 v19, s[12:15], s91 offen offset:3072 lds
    v_mfma_f32_16x16x32_bf16 v[60:63], a[108:111], a[84:87], v[60:63]
    s_add_u32 m0, s35, 131072
    v_mfma_f32_16x16x32_bf16 v[64:67], a[104:107], a[88:91], v[64:67]
    v_add_u32 v22, 73728, v22
    v_add_u32 v23, 73728, v23
    v_mfma_f32_16x16x32_bf16 v[64:67], a[108:111], a[92:95], v[64:67]
    v_add_u32 v24, 73728, v24
    v_mfma_f32_16x16x32_bf16 v[68:71], a[104:107], a[96:99], v[68:71]
    buffer_load_dwordx4 v20, s[12:15], s91 offen offset:0 lds
    v_mfma_f32_16x16x32_bf16 v[68:71], a[108:111], a[100:103], v[68:71]
    s_waitcnt lgkmcnt(0)
    s_waitcnt vmcnt(9)
    v_add_u32 v25, 73728, v25
    s_barrier
    v_mfma_f32_16x16x32_bf16 v[72:75], a[112:115], a[72:75], v[72:75]
    ds_read_b64_tr_b16 a[32:33], v24 offset:0
    v_mfma_f32_16x16x32_bf16 v[72:75], a[116:119], a[76:79], v[72:75]
    ds_read_b64_tr_b16 a[34:35], v24 offset:1280
    v_mfma_f32_16x16x32_bf16 v[76:79], a[112:115], a[80:83], v[76:79]
    s_add_u32 m0, s32, 0
    ds_read_b64_tr_b16 a[36:37], v24 offset:10240
    v_mfma_f32_16x16x32_bf16 v[76:79], a[116:119], a[84:87], v[76:79]
    s_add_u32 s91, s91, 245760
    buffer_load_dword v2, v196, s[4:7], s22 offen sc1
    ds_read_b64_tr_b16 a[38:39], v24 offset:11520
    v_mfma_f32_16x16x32_bf16 v[80:83], a[112:115], a[88:91], v[80:83]
    buffer_load_dwordx4 v12, s[8:11], s29 offen offset:0 lds
    ds_read_b128 a[0:3], v22 offset:0
    v_mfma_f32_16x16x32_bf16 v[80:83], a[116:119], a[92:95], v[80:83]
sequential_preLN__softmax_full_mha__glu_gated_bilinear__prompt_kernel_pgq0:
    s_cbranch_execz sequential_preLN__softmax_full_mha__glu_gated_bilinear__prompt_kernel_wrq
    ds_read_b128 a[4:7], v23 offset:0
    v_mfma_f32_16x16x32_bf16 v[84:87], a[112:115], a[96:99], v[84:87]
    ds_read_b128 a[8:11], v22 offset:2048
    v_mfma_f32_16x16x32_bf16 v[84:87], a[116:119], a[100:103], v[84:87]
    ds_read_b128 a[12:15], v23 offset:2048
    v_mfma_f32_16x16x32_bf16 v[88:91], a[120:123], a[72:75], v[88:91]
    buffer_load_dwordx4 v13, s[8:11], s29 offen offset:1024 lds
    ds_read_b128 a[16:19], v22 offset:4096
    v_mfma_f32_16x16x32_bf16 v[88:91], a[124:127], a[76:79], v[88:91]
    ds_read_b128 a[20:23], v23 offset:4096
    v_mfma_f32_16x16x32_bf16 v[92:95], a[120:123], a[80:83], v[92:95]
    ds_read_b128 a[24:27], v22 offset:6144
    v_mfma_f32_16x16x32_bf16 v[92:95], a[124:127], a[84:87], v[92:95]
    ds_read_b128 a[28:31], v23 offset:6144
    v_mfma_f32_16x16x32_bf16 v[96:99], a[120:123], a[88:91], v[96:99]
    buffer_load_dwordx4 v14, s[8:11], s29 offen offset:2048 lds
    ds_read_b64_tr_b16 a[40:41], v25 offset:32
    v_mfma_f32_16x16x32_bf16 v[96:99], a[124:127], a[92:95], v[96:99]
    ds_read_b64_tr_b16 a[42:43], v25 offset:1312
    v_mfma_f32_16x16x32_bf16 v[100:103], a[120:123], a[96:99], v[100:103]
    ds_read_b64_tr_b16 a[44:45], v25 offset:10272
    v_mfma_f32_16x16x32_bf16 v[100:103], a[124:127], a[100:103], v[100:103]
    ds_read_b64_tr_b16 a[46:47], v25 offset:11552
    v_mfma_f32_16x16x32_bf16 v[104:107], a[128:131], a[72:75], v[104:107]
    buffer_load_dwordx4 v15, s[8:11], s29 offen offset:3072 lds
    ds_read_b64_tr_b16 a[48:49], v24 offset:64
    v_mfma_f32_16x16x32_bf16 v[104:107], a[132:135], a[76:79], v[104:107]
    s_add_u32 m0, s35, 16384
    ds_read_b64_tr_b16 a[50:51], v24 offset:1344
    v_mfma_f32_16x16x32_bf16 v[108:111], a[128:131], a[80:83], v[108:111]
    s_add_u32 s29, s29, 128
    ds_read_b64_tr_b16 a[52:53], v24 offset:10304
    v_mfma_f32_16x16x32_bf16 v[108:111], a[132:135], a[84:87], v[108:111]
    ds_read_b64_tr_b16 a[54:55], v24 offset:11584
    v_mfma_f32_16x16x32_bf16 v[112:115], a[128:131], a[88:91], v[112:115]
    ds_read_b64_tr_b16 a[56:57], v25 offset:96
    v_mfma_f32_16x16x32_bf16 v[112:115], a[132:135], a[92:95], v[112:115]
    buffer_load_dwordx4 v16, s[12:15], s91 offen offset:0 lds
    ds_read_b64_tr_b16 a[58:59], v25 offset:1376
    v_mfma_f32_16x16x32_bf16 v[116:119], a[128:131], a[96:99], v[116:119]
    ds_read_b64_tr_b16 a[60:61], v25 offset:10336
    v_mfma_f32_16x16x32_bf16 v[116:119], a[132:135], a[100:103], v[116:119]
    ds_read_b64_tr_b16 a[62:63], v25 offset:11616
    v_mfma_f32_16x16x32_bf16 v[120:123], a[136:139], a[72:75], v[120:123]
    ds_read_b64_tr_b16 a[64:65], v24 offset:128
    v_mfma_f32_16x16x32_bf16 v[120:123], a[140:143], a[76:79], v[120:123]
    buffer_load_dwordx4 v17, s[12:15], s91 offen offset:1024 lds
    ds_read_b64_tr_b16 a[66:67], v24 offset:1408
    v_mfma_f32_16x16x32_bf16 v[124:127], a[136:139], a[80:83], v[124:127]
    ds_read_b64_tr_b16 a[68:69], v24 offset:10368
    v_mfma_f32_16x16x32_bf16 v[124:127], a[140:143], a[84:87], v[124:127]
    ds_read_b64_tr_b16 a[70:71], v24 offset:11648
    v_mfma_f32_16x16x32_bf16 v[128:131], a[136:139], a[88:91], v[128:131]
    v_mfma_f32_16x16x32_bf16 v[128:131], a[140:143], a[92:95], v[128:131]
    buffer_load_dwordx4 v18, s[12:15], s91 offen offset:2048 lds
    v_mfma_f32_16x16x32_bf16 v[132:135], a[136:139], a[96:99], v[132:135]
    v_mfma_f32_16x16x32_bf16 v[132:135], a[140:143], a[100:103], v[132:135]
    s_waitcnt lgkmcnt(15)
    v_mfma_f32_16x16x32_bf16 v[56:59], a[32:35], a[0:3], v[56:59]
    v_mfma_f32_16x16x32_bf16 v[56:59], a[36:39], a[4:7], v[56:59]
    v_mfma_f32_16x16x32_bf16 v[60:63], a[32:35], a[8:11], v[60:63]
    buffer_load_dwordx4 v19, s[12:15], s91 offen offset:3072 lds
    v_mfma_f32_16x16x32_bf16 v[60:63], a[36:39], a[12:15], v[60:63]
    s_add_u32 m0, s35, 20480
    v_mfma_f32_16x16x32_bf16 v[64:67], a[32:35], a[16:19], v[64:67]
    v_mfma_f32_16x16x32_bf16 v[64:67], a[36:39], a[20:23], v[64:67]
    v_mfma_f32_16x16x32_bf16 v[68:71], a[32:35], a[24:27], v[68:71]
    buffer_load_dwordx4 v20, s[12:15], s91 offen offset:0 lds
    v_mfma_f32_16x16x32_bf16 v[68:71], a[36:39], a[28:31], v[68:71]
    s_waitcnt lgkmcnt(0)
    s_waitcnt vmcnt(10)
    s_waitcnt vmcnt(9)
    v_min_u32 v2, v55, v2
    v_or_b32 v2, s3, v2
    v_cmp_eq_u32 vcc, 0, v2
    s_nop 1
    s_cbranch_vccnz sequential_preLN__softmax_full_mha__glu_gated_bilinear__prompt_kernel_rsspinq
sequential_preLN__softmax_full_mha__glu_gated_bilinear__prompt_kernel_rsokq:
    s_barrier
    v_mfma_f32_16x16x32_bf16 v[72:75], a[40:43], a[0:3], v[72:75]
    ds_read_b64_tr_b16 a[104:105], v24 offset:36864
    v_mfma_f32_16x16x32_bf16 v[72:75], a[44:47], a[4:7], v[72:75]
    ds_read_b64_tr_b16 a[106:107], v24 offset:38144
    v_mfma_f32_16x16x32_bf16 v[76:79], a[40:43], a[8:11], v[76:79]
    s_mov_b32 m0, s43
    ds_read_b64_tr_b16 a[108:109], v24 offset:47104
    v_mfma_f32_16x16x32_bf16 v[76:79], a[44:47], a[12:15], v[76:79]
    ds_read_b64_tr_b16 a[110:111], v24 offset:48384
    v_mfma_f32_16x16x32_bf16 v[80:83], a[40:43], a[16:19], v[80:83]
    buffer_load_dwordx4 v253, s[4:7], s59 offen sc1 lds
    ds_read_b128 a[72:75], v22 offset:36864
    v_mfma_f32_16x16x32_bf16 v[80:83], a[44:47], a[20:23], v[80:83]
    s_add_u32 m0, s32, 36864
    ds_read_b128 a[76:79], v23 offset:36864
    v_mfma_f32_16x16x32_bf16 v[84:87], a[40:43], a[24:27], v[84:87]
    s_add_u32 s91, s91, 245760
    ds_read_b128 a[80:83], v22 offset:38912
    v_mfma_f32_16x16x32_bf16 v[84:87], a[44:47], a[28:31], v[84:87]
    buffer_load_dwordx4 v12, s[8:11], s29 offen offset:0 lds
    ds_read_b128 a[84:87], v23 offset:38912
    v_mfma_f32_16x16x32_bf16 v[88:91], a[48:51], a[0:3], v[88:91]
    ds_read_b128 a[88:91], v22 offset:40960
    v_mfma_f32_16x16x32_bf16 v[88:91], a[52:55], a[4:7], v[88:91]
    ds_read_b128 a[92:95], v23 offset:40960
    v_mfma_f32_16x16x32_bf16 v[92:95], a[48:51], a[8:11], v[92:95]
    ds_read_b128 a[96:99], v22 offset:43008
    v_mfma_f32_16x16x32_bf16 v[92:95], a[52:55], a[12:15], v[92:95]
    buffer_load_dwordx4 v13, s[8:11], s29 offen offset:1024 lds
    ds_read_b128 a[100:103], v23 offset:43008
    v_mfma_f32_16x16x32_bf16 v[96:99], a[48:51], a[16:19], v[96:99]
    ds_read_b64_tr_b16 a[112:113], v25 offset:36896
    v_mfma_f32_16x16x32_bf16 v[96:99], a[52:55], a[20:23], v[96:99]
    ds_read_b64_tr_b16 a[114:115], v25 offset:38176
    v_mfma_f32_16x16x32_bf16 v[100:103], a[48:51], a[24:27], v[100:103]
    ds_read_b64_tr_b16 a[116:117], v25 offset:47136
    v_mfma_f32_16x16x32_bf16 v[100:103], a[52:55], a[28:31], v[100:103]
    buffer_load_dwordx4 v14, s[8:11], s29 offen offset:2048 lds
    ds_read_b64_tr_b16 a[118:119], v25 offset:48416
    v_mfma_f32_16x16x32_bf16 v[104:107], a[56:59], a[0:3], v[104:107]
    ds_read_b64_tr_b16 a[120:121], v24 offset:36928
    v_mfma_f32_16x16x32_bf16 v[104:107], a[60:63], a[4:7], v[104:107]
    ds_read_b64_tr_b16 a[122:123], v24 offset:38208
    v_mfma_f32_16x16x32_bf16 v[108:111], a[56:59], a[8:11], v[108:111]
    ds_read_b64_tr_b16 a[124:125], v24 offset:47168
    v_mfma_f32_16x16x32_bf16 v[108:111], a[60:63], a[12:15], v[108:111]
    buffer_load_dwordx4 v15, s[8:11], s29 offen offset:3072 lds
    ds_read_b64_tr_b16 a[126:127], v24 offset:48448
    v_mfma_f32_16x16x32_bf16 v[112:115], a[56:59], a[16:19], v[112:115]
    s_add_u32 m0, s35, 53248
    ds_read_b64_tr_b16 a[128:129], v25 offset:36960
    v_mfma_f32_16x16x32_bf16 v[112:115], a[60:63], a[20:23], v[112:115]
    s_add_u32 s29, s29, 128
    ds_read_b64_tr_b16 a[130:131], v25 offset:38240
    v_mfma_f32_16x16x32_bf16 v[116:119], a[56:59], a[24:27], v[116:119]
    ds_read_b64_tr_b16 a[132:133], v25 offset:47200
    v_mfma_f32_16x16x32_bf16 v[116:119], a[60:63], a[28:31], v[116:119]
    buffer_load_dwordx4 v16, s[12:15], s91 offen offset:0 lds
    ds_read_b64_tr_b16 a[134:135], v25 offset:48480
    v_mfma_f32_16x16x32_bf16 v[120:123], a[64:67], a[0:3], v[120:123]
    ds_read_b64_tr_b16 a[136:137], v24 offset:36992
    v_mfma_f32_16x16x32_bf16 v[120:123], a[68:71], a[4:7], v[120:123]
    ds_read_b64_tr_b16 a[138:139], v24 offset:38272
    v_mfma_f32_16x16x32_bf16 v[124:127], a[64:67], a[8:11], v[124:127]
    ds_read_b64_tr_b16 a[140:141], v24 offset:47232
    v_mfma_f32_16x16x32_bf16 v[124:127], a[68:71], a[12:15], v[124:127]
    buffer_load_dwordx4 v17, s[12:15], s91 offen offset:1024 lds
    ds_read_b64_tr_b16 a[142:143], v24 offset:48512
    v_mfma_f32_16x16x32_bf16 v[128:131], a[64:67], a[16:19], v[128:131]
    v_mfma_f32_16x16x32_bf16 v[128:131], a[68:71], a[20:23], v[128:131]
    v_mfma_f32_16x16x32_bf16 v[132:135], a[64:67], a[24:27], v[132:135]
    v_mfma_f32_16x16x32_bf16 v[132:135], a[68:71], a[28:31], v[132:135]
    s_waitcnt lgkmcnt(15)
    buffer_load_dwordx4 v18, s[12:15], s91 offen offset:2048 lds
    v_mfma_f32_16x16x32_bf16 v[56:59], a[104:107], a[72:75], v[56:59]
    v_mfma_f32_16x16x32_bf16 v[56:59], a[108:111], a[76:79], v[56:59]
    v_mfma_f32_16x16x32_bf16 v[60:63], a[104:107], a[80:83], v[60:63]
    v_mfma_f32_16x16x32_bf16 v[60:63], a[108:111], a[84:87], v[60:63]
    buffer_load_dwordx4 v19, s[12:15], s91 offen offset:3072 lds
    v_mfma_f32_16x16x32_bf16 v[64:67], a[104:107], a[88:91], v[64:67]
    s_add_u32 m0, s35, 57344
    v_add_u32 v22, 4294893568, v22
    v_add_u32 v23, 4294893568, v23
    v_mfma_f32_16x16x32_bf16 v[64:67], a[108:111], a[92:95], v[64:67]
    v_add_u32 v24, 4294893568, v24
    v_mfma_f32_16x16x32_bf16 v[68:71], a[104:107], a[96:99], v[68:71]
    v_add_u32 v25, 4294893568, v25
    v_mfma_f32_16x16x32_bf16 v[68:71], a[108:111], a[100:103], v[68:71]
    s_waitcnt lgkmcnt(0)
    s_waitcnt vmcnt(8)
    buffer_load_dwordx4 v20, s[12:15], s91 offen offset:0 lds
    s_barrier
    v_mfma_f32_16x16x32_bf16 v[72:75], a[112:115], a[72:75], v[72:75]
    ds_read_b32 v148, v30 offset:0
    ds_read_b32 v152, v30 offset:64
    v_mfma_f32_16x16x32_bf16 v[72:75], a[116:119], a[76:79], v[72:75]
    ds_read_b32 v156, v30 offset:128
    v_mfma_f32_16x16x32_bf16 v[76:79], a[112:115], a[80:83], v[76:79]
    ds_read_b32 v160, v30 offset:192
    ds_read_b128 v[32:35], v31 offset:0
    v_mfma_f32_16x16x32_bf16 v[76:79], a[116:119], a[84:87], v[76:79]
    buffer_load_dword v2, v54, s[4:7], s22 offen sc1
    ds_read_b128 v[36:39], v31 offset:64
    v_mfma_f32_16x16x32_bf16 v[80:83], a[112:115], a[88:91], v[80:83]
    ds_read_b128 v[40:43], v31 offset:128
    ds_read_b128 v[44:47], v31 offset:192
    v_mfma_f32_16x16x32_bf16 v[80:83], a[116:119], a[92:95], v[80:83]
    ds_read_b128 v[48:51], v31 offset:256
    v_mfma_f32_16x16x32_bf16 v[84:87], a[112:115], a[96:99], v[84:87]
    ds_read_b32 v164, v30 offset:1024
    ds_read_b32 v168, v30 offset:1088
    v_mfma_f32_16x16x32_bf16 v[84:87], a[116:119], a[100:103], v[84:87]
    ds_read_b32 v172, v30 offset:1152
    v_mfma_f32_16x16x32_bf16 v[88:91], a[120:123], a[72:75], v[88:91]
    ds_read_b32 v176, v30 offset:1216
    v_mfma_f32_16x16x32_bf16 v[88:91], a[124:127], a[76:79], v[88:91]
    ds_read_b64_tr_b16 a[32:33], v24 offset:0
    ds_read_b64_tr_b16 a[34:35], v24 offset:1280
    v_mfma_f32_16x16x32_bf16 v[92:95], a[120:123], a[80:83], v[92:95]
    ds_read_b64_tr_b16 a[36:37], v24 offset:10240
    v_mfma_f32_16x16x32_bf16 v[92:95], a[124:127], a[84:87], v[92:95]
    ds_read_b64_tr_b16 a[38:39], v24 offset:11520
    v_mfma_f32_16x16x32_bf16 v[96:99], a[120:123], a[88:91], v[96:99]
    s_waitcnt lgkmcnt(4)
    ds_read_b128 a[0:3], v22 offset:0
    ds_read_b128 a[4:7], v23 offset:0
    v_mfma_f32_16x16x32_bf16 v[96:99], a[124:127], a[92:95], v[96:99]
    ds_read_b128 a[8:11], v22 offset:2048
    v_fmac_f32 v56, v148, v32
    v_mfma_f32_16x16x32_bf16 v[100:103], a[120:123], a[96:99], v[100:103]
    ds_read_b128 a[12:15], v23 offset:2048
    v_fmac_f32 v57, v148, v33
    v_mfma_f32_16x16x32_bf16 v[100:103], a[124:127], a[100:103], v[100:103]
    ds_read_b128 a[16:19], v22 offset:4096
    ds_read_b128 a[20:23], v23 offset:4096
    v_mfma_f32_16x16x32_bf16 v[104:107], a[128:131], a[72:75], v[104:107]
    ds_read_b128 a[24:27], v22 offset:6144
    v_fmac_f32 v58, v148, v34
    v_mfma_f32_16x16x32_bf16 v[104:107], a[132:135], a[76:79], v[104:107]
    ds_read_b128 a[28:31], v23 offset:6144
    v_fmac_f32 v59, v148, v35
    v_mfma_f32_16x16x32_bf16 v[108:111], a[128:131], a[80:83], v[108:111]
    v_fmac_f32 v60, v152, v32
    v_fmac_f32 v61, v152, v33
    v_mfma_f32_16x16x32_bf16 v[108:111], a[132:135], a[84:87], v[108:111]
    v_fmac_f32 v62, v152, v34
    v_fmac_f32 v63, v152, v35
    v_mfma_f32_16x16x32_bf16 v[112:115], a[128:131], a[88:91], v[112:115]
    v_fmac_f32 v64, v156, v32
    v_fmac_f32 v65, v156, v33
    v_mfma_f32_16x16x32_bf16 v[112:115], a[132:135], a[92:95], v[112:115]
    v_fmac_f32 v66, v156, v34
    v_fmac_f32 v67, v156, v35
    v_mfma_f32_16x16x32_bf16 v[116:119], a[128:131], a[96:99], v[116:119]
    v_fmac_f32 v68, v160, v32
    v_mfma_f32_16x16x32_bf16 v[116:119], a[132:135], a[100:103], v[116:119]
    v_fmac_f32 v69, v160, v33
    v_mfma_f32_16x16x32_bf16 v[120:123], a[136:139], a[72:75], v[120:123]
    v_fmac_f32 v70, v160, v34
    v_mfma_f32_16x16x32_bf16 v[120:123], a[140:143], a[76:79], v[120:123]
    s_waitcnt vmcnt(1)
    v_fmac_f32 v71, v160, v35
    s_barrier
    v_mfma_f32_16x16x32_bf16 v[124:127], a[136:139], a[80:83], v[124:127]
    ds_read_b64_tr_b16 a[104:105], v24 offset:36864
    ds_read_b64_tr_b16 a[106:107], v24 offset:38144
    v_mfma_f32_16x16x32_bf16 v[124:127], a[140:143], a[84:87], v[124:127]
    ds_read_b64_tr_b16 a[108:109], v24 offset:47104
    v_mfma_f32_16x16x32_bf16 v[128:131], a[136:139], a[88:91], v[128:131]
    ds_read_b64_tr_b16 a[110:111], v24 offset:48384
    v_mfma_f32_16x16x32_bf16 v[128:131], a[140:143], a[92:95], v[128:131]
    ds_read_b128 a[144:147], v22 offset:36864
    v_fmac_f32 v72, v148, v36
    v_fmac_f32 v73, v148, v37
    v_mfma_f32_16x16x32_bf16 v[132:135], a[136:139], a[96:99], v[132:135]
    ds_read_b128 a[148:151], v23 offset:36864
    v_fmac_f32 v74, v148, v38
    v_fmac_f32 v75, v148, v39
    v_mfma_f32_16x16x32_bf16 v[132:135], a[140:143], a[100:103], v[132:135]
    s_waitcnt lgkmcnt(6)
    ds_read_b128 a[152:155], v22 offset:38912
    v_fmac_f32 v76, v152, v36
    v_fmac_f32 v77, v152, v37
    v_mfma_f32_16x16x32_bf16 v[56:59], a[32:35], a[0:3], v[56:59]
    ds_read_b128 a[156:159], v23 offset:38912
    v_fmac_f32 v78, v152, v38
    v_fmac_f32 v79, v152, v39
    v_mfma_f32_16x16x32_bf16 v[56:59], a[36:39], a[4:7], v[56:59]
    ds_read_b128 a[160:163], v22 offset:40960
    v_fmac_f32 v80, v156, v36
    v_fmac_f32 v81, v156, v37
    v_mfma_f32_16x16x32_bf16 v[60:63], a[32:35], a[8:11], v[60:63]
    ds_read_b128 a[164:167], v23 offset:40960
    ds_read_b128 a[168:171], v22 offset:43008
    v_fmac_f32 v82, v156, v38
    v_mfma_f32_16x16x32_bf16 v[60:63], a[36:39], a[12:15], v[60:63]
    ds_read_b128 a[172:175], v23 offset:43008
    v_fmac_f32 v83, v156, v39
    v_fmac_f32 v84, v160, v36
    v_mfma_f32_16x16x32_bf16 v[64:67], a[32:35], a[16:19], v[64:67]
    v_fmac_f32 v85, v160, v37
    v_fmac_f32 v86, v160, v38
    v_fmac_f32 v87, v160, v39
    v_mfma_f32_16x16x32_bf16 v[64:67], a[36:39], a[20:23], v[64:67]
    v_mul_f32 v164, s42, v164
    v_mul_f32 v168, s42, v168
    v_mfma_f32_16x16x32_bf16 v[68:71], a[32:35], a[24:27], v[68:71]
    ds_read_b64_tr_b16 a[40:41], v25 offset:32
    ds_read_b64_tr_b16 a[42:43], v25 offset:1312
    v_mfma_f32_16x16x32_bf16 v[68:71], a[36:39], a[28:31], v[68:71]
    s_waitcnt lgkmcnt(2)
    ds_read_b64_tr_b16 a[44:45], v25 offset:10272
    v_mul_f32 v172, s42, v172
    v_mfma_f32_16x16x32_bf16 v[56:59], a[104:107], a[144:147], v[56:59]
    ds_read_b64_tr_b16 a[46:47], v25 offset:11552
    v_mul_f32 v176, s42, v176
    v_mfma_f32_16x16x32_bf16 v[56:59], a[108:111], a[148:151], v[56:59]
    ds_read_b64_tr_b16 a[112:113], v25 offset:36896
    v_fmac_f32 v88, v148, v40
    v_fmac_f32 v89, v148, v41
    v_mfma_f32_16x16x32_bf16 v[60:63], a[104:107], a[152:155], v[60:63]
    ds_read_b64_tr_b16 a[114:115], v25 offset:38176
    v_fmac_f32 v90, v148, v42
    v_fmac_f32 v91, v148, v43
    v_mfma_f32_16x16x32_bf16 v[60:63], a[108:111], a[156:159], v[60:63]
    ds_read_b64_tr_b16 a[116:117], v25 offset:47136
    v_fmac_f32 v92, v152, v40
    v_fmac_f32 v93, v152, v41
    v_mfma_f32_16x16x32_bf16 v[64:67], a[104:107], a[160:163], v[64:67]
    ds_read_b64_tr_b16 a[118:119], v25 offset:48416
    v_fmac_f32 v94, v152, v42
    v_fmac_f32 v95, v152, v43
    v_mfma_f32_16x16x32_bf16 v[64:67], a[108:111], a[164:167], v[64:67]
    v_fmac_f32 v96, v156, v40
    v_fmac_f32 v97, v156, v41
    v_mfma_f32_16x16x32_bf16 v[68:71], a[104:107], a[168:171], v[68:71]
    v_fmac_f32 v98, v156, v42
    v_fmac_f32 v99, v156, v43
    v_mfma_f32_16x16x32_bf16 v[68:71], a[108:111], a[172:175], v[68:71]
    s_waitcnt lgkmcnt(0)
    v_fmac_f32 v100, v160, v40
    v_fmac_f32 v101, v160, v41
    v_mfma_f32_16x16x32_bf16 v[72:75], a[40:43], a[0:3], v[72:75]
    ds_read_b64_tr_b16 a[48:49], v24 offset:64
    v_fmac_f32 v102, v160, v42
    v_mfma_f32_16x16x32_bf16 v[72:75], a[44:47], a[4:7], v[72:75]
    ds_read_b64_tr_b16 a[50:51], v24 offset:1344
    v_fmac_f32 v103, v160, v43
    v_mfma_f32_16x16x32_bf16 v[72:75], a[112:115], a[144:147], v[72:75]
    ds_read_b64_tr_b16 a[52:53], v24 offset:10304
    v_fmac_f32 v104, v148, v44
    v_mfma_f32_16x16x32_bf16 v[72:75], a[116:119], a[148:151], v[72:75]
    ds_read_b64_tr_b16 a[54:55], v24 offset:11584
    v_fmac_f32 v105, v148, v45
    v_mfma_f32_16x16x32_bf16 v[76:79], a[40:43], a[8:11], v[76:79]
    ds_read_b64_tr_b16 a[120:121], v24 offset:36928
    v_fmac_f32 v106, v148, v46
    v_mul_f32 v56, v56, v164
    v_mul_f32 v57, v57, v164
    v_mul_f32 v58, v58, v164
    v_mul_f32 v59, v59, v164
    v_mfma_f32_16x16x32_bf16 v[76:79], a[44:47], a[12:15], v[76:79]
    ds_read_b64_tr_b16 a[122:123], v24 offset:38208
    v_fmac_f32 v107, v148, v47
    v_mul_f32 v60, v60, v168
    v_mul_f32 v61, v61, v168
    v_mul_f32 v62, v62, v168
    v_mfma_f32_16x16x32_bf16 v[76:79], a[112:115], a[152:155], v[76:79]
    ds_read_b64_tr_b16 a[124:125], v24 offset:47168
    v_mul_f32 v63, v63, v168
    v_cvt_pk_bf16_f32 v180, v56, v57
    v_cvt_pk_bf16_f32 v182, v60, v61
    v_cvt_pk_bf16_f32 v181, v58, v59
    v_mfma_f32_16x16x32_bf16 v[76:79], a[116:119], a[156:159], v[76:79]
    ds_read_b64_tr_b16 a[126:127], v24 offset:48448
    v_cvt_pk_bf16_f32 v183, v62, v63
    v_permlane16_swap_b32 v180, v182
    v_nop
    v_permlane16_swap_b32 v181, v183
    v_mfma_f32_16x16x32_bf16 v[80:83], a[40:43], a[16:19], v[80:83]
    buffer_store_dwordx4 v[180:183], v253, s[4:7], s46 offen offset:0 sc1
    v_fmac_f32 v108, v152, v44
    v_mul_f32 v64, v64, v172
    v_mfma_f32_16x16x32_bf16 v[80:83], a[44:47], a[20:23], v[80:83]
    v_fmac_f32 v109, v152, v45
    v_mul_f32 v65, v65, v172
    v_mul_f32 v66, v66, v172
    v_mfma_f32_16x16x32_bf16 v[80:83], a[112:115], a[160:163], v[80:83]
    v_fmac_f32 v110, v152, v46
    v_mul_f32 v67, v67, v172
    v_mul_f32 v68, v68, v176
    v_mfma_f32_16x16x32_bf16 v[80:83], a[116:119], a[164:167], v[80:83]
    v_fmac_f32 v111, v152, v47
    v_mul_f32 v69, v69, v176
    v_mul_f32 v70, v70, v176
    v_mfma_f32_16x16x32_bf16 v[84:87], a[40:43], a[24:27], v[84:87]
    v_fmac_f32 v112, v156, v44
    v_mul_f32 v71, v71, v176
    v_cvt_pk_bf16_f32 v184, v64, v65
    v_mfma_f32_16x16x32_bf16 v[84:87], a[44:47], a[28:31], v[84:87]
    v_fmac_f32 v113, v156, v45
    v_cvt_pk_bf16_f32 v186, v68, v69
    v_cvt_pk_bf16_f32 v185, v66, v67
    v_mfma_f32_16x16x32_bf16 v[84:87], a[112:115], a[168:171], v[84:87]
    v_fmac_f32 v114, v156, v46
    v_cvt_pk_bf16_f32 v187, v70, v71
    v_permlane16_swap_b32 v184, v186
    v_mfma_f32_16x16x32_bf16 v[84:87], a[116:119], a[172:175], v[84:87]
    s_waitcnt lgkmcnt(0)
    v_fmac_f32 v115, v156, v47
    v_nop
    v_permlane16_swap_b32 v185, v187
    v_mfma_f32_16x16x32_bf16 v[88:91], a[48:51], a[0:3], v[88:91]
    ds_read_b64_tr_b16 a[56:57], v25 offset:96
    buffer_store_dwordx4 v[184:187], v253, s[4:7], s47 offen offset:0 sc1
    v_mul_f32 v72, v72, v164
    v_mfma_f32_16x16x32_bf16 v[88:91], a[52:55], a[4:7], v[88:91]
    ds_read_b64_tr_b16 a[58:59], v25 offset:1376
    v_mul_f32 v73, v73, v164
    v_mul_f32 v74, v74, v164
    v_mfma_f32_16x16x32_bf16 v[88:91], a[120:123], a[144:147], v[88:91]
    ds_read_b64_tr_b16 a[60:61], v25 offset:10336
    v_mul_f32 v75, v75, v164
    v_mul_f32 v76, v76, v168
    v_mfma_f32_16x16x32_bf16 v[88:91], a[124:127], a[148:151], v[88:91]
    ds_read_b64_tr_b16 a[62:63], v25 offset:11616
    v_mul_f32 v77, v77, v168
    v_mul_f32 v78, v78, v168
    v_mfma_f32_16x16x32_bf16 v[92:95], a[48:51], a[8:11], v[92:95]
    ds_read_b64_tr_b16 a[128:129], v25 offset:36960
    v_mul_f32 v79, v79, v168
    v_cvt_pk_bf16_f32 v188, v72, v73
    v_mfma_f32_16x16x32_bf16 v[92:95], a[52:55], a[12:15], v[92:95]
    ds_read_b64_tr_b16 a[130:131], v25 offset:38240
    v_cvt_pk_bf16_f32 v190, v76, v77
    v_cvt_pk_bf16_f32 v189, v74, v75
    v_mfma_f32_16x16x32_bf16 v[92:95], a[120:123], a[152:155], v[92:95]
    ds_read_b64_tr_b16 a[132:133], v25 offset:47200
    v_cvt_pk_bf16_f32 v191, v78, v79
    v_permlane16_swap_b32 v188, v190
    v_mfma_f32_16x16x32_bf16 v[92:95], a[124:127], a[156:159], v[92:95]
    ds_read_b64_tr_b16 a[134:135], v25 offset:48480
    v_nop
    v_permlane16_swap_b32 v189, v191
    v_mfma_f32_16x16x32_bf16 v[96:99], a[48:51], a[16:19], v[96:99]
    buffer_store_dwordx4 v[188:191], v253, s[4:7], s46 offen offset:1024 sc1
    v_fmac_f32 v116, v160, v44
    v_mul_f32 v80, v80, v172
    v_mfma_f32_16x16x32_bf16 v[96:99], a[52:55], a[20:23], v[96:99]
    v_fmac_f32 v117, v160, v45
    v_mul_f32 v81, v81, v172
    v_mul_f32 v82, v82, v172
    v_mul_f32 v83, v83, v172
    v_mfma_f32_16x16x32_bf16 v[96:99], a[120:123], a[160:163], v[96:99]
    v_fmac_f32 v118, v160, v46
    v_mul_f32 v84, v84, v176
    v_mul_f32 v85, v85, v176
    v_mul_f32 v86, v86, v176
    v_mfma_f32_16x16x32_bf16 v[96:99], a[124:127], a[164:167], v[96:99]
    v_fmac_f32 v119, v160, v47
    v_mul_f32 v87, v87, v176
    v_cvt_pk_bf16_f32 v192, v80, v81
    v_cvt_pk_bf16_f32 v194, v84, v85
    v_mfma_f32_16x16x32_bf16 v[100:103], a[48:51], a[24:27], v[100:103]
    v_fmac_f32 v120, v148, v48
    v_fmac_f32 v121, v148, v49
    v_cvt_pk_bf16_f32 v193, v82, v83
    v_cvt_pk_bf16_f32 v195, v86, v87
    v_mfma_f32_16x16x32_bf16 v[100:103], a[52:55], a[28:31], v[100:103]
    v_fmac_f32 v122, v148, v50
    v_fmac_f32 v123, v148, v51
    v_permlane16_swap_b32 v192, v194
    v_mfma_f32_16x16x32_bf16 v[100:103], a[120:123], a[168:171], v[100:103]
    v_fmac_f32 v124, v152, v48
    v_fmac_f32 v125, v152, v49
    v_nop
    v_mfma_f32_16x16x32_bf16 v[100:103], a[124:127], a[172:175], v[100:103]
    s_waitcnt lgkmcnt(0)
    v_fmac_f32 v126, v152, v50
    v_fmac_f32 v127, v152, v51
    v_permlane16_swap_b32 v193, v195
    v_mfma_f32_16x16x32_bf16 v[104:107], a[56:59], a[0:3], v[104:107]
    ds_read_b64_tr_b16 a[64:65], v24 offset:128
    buffer_store_dwordx4 v[192:195], v253, s[4:7], s47 offen offset:1024 sc1
    v_fmac_f32 v128, v156, v48
    v_mfma_f32_16x16x32_bf16 v[104:107], a[60:63], a[4:7], v[104:107]
    ds_read_b64_tr_b16 a[66:67], v24 offset:1408
    v_fmac_f32 v129, v156, v49
    v_mul_f32 v88, v88, v164
    v_mul_f32 v89, v89, v164
    v_mfma_f32_16x16x32_bf16 v[104:107], a[128:131], a[144:147], v[104:107]
    ds_read_b64_tr_b16 a[68:69], v24 offset:10368
    v_fmac_f32 v130, v156, v50
    v_mul_f32 v90, v90, v164
    v_mul_f32 v91, v91, v164
    v_mfma_f32_16x16x32_bf16 v[104:107], a[132:135], a[148:151], v[104:107]
    ds_read_b64_tr_b16 a[70:71], v24 offset:11648
    v_mul_f32 v92, v92, v168
    v_mul_f32 v93, v93, v168
    v_mul_f32 v94, v94, v168
    v_mfma_f32_16x16x32_bf16 v[108:111], a[56:59], a[8:11], v[108:111]
    ds_read_b64_tr_b16 a[136:137], v24 offset:36992
    v_mul_f32 v95, v95, v168
    v_cvt_pk_bf16_f32 v180, v88, v89
    v_mfma_f32_16x16x32_bf16 v[108:111], a[60:63], a[12:15], v[108:111]
    ds_read_b64_tr_b16 a[138:139], v24 offset:38272
    v_cvt_pk_bf16_f32 v182, v92, v93
    v_cvt_pk_bf16_f32 v181, v90, v91
    v_mfma_f32_16x16x32_bf16 v[108:111], a[128:131], a[152:155], v[108:111]
    ds_read_b64_tr_b16 a[140:141], v24 offset:47232
    v_cvt_pk_bf16_f32 v183, v94, v95
    v_permlane16_swap_b32 v180, v182
    v_mfma_f32_16x16x32_bf16 v[108:111], a[132:135], a[156:159], v[108:111]
    ds_read_b64_tr_b16 a[142:143], v24 offset:48512
    v_nop
    v_permlane16_swap_b32 v181, v183
    v_mfma_f32_16x16x32_bf16 v[112:115], a[56:59], a[16:19], v[112:115]
    buffer_store_dwordx4 v[180:183], v26, s[4:7], s46 offen offset:2048 sc1
    v_fmac_f32 v131, v156, v51
    v_mfma_f32_16x16x32_bf16 v[112:115], a[60:63], a[20:23], v[112:115]
    v_fmac_f32 v132, v160, v48
    v_mul_f32 v96, v96, v172
    v_mul_f32 v97, v97, v172
    v_mfma_f32_16x16x32_bf16 v[112:115], a[128:131], a[160:163], v[112:115]
    v_fmac_f32 v133, v160, v49
    v_mul_f32 v98, v98, v172
    v_mul_f32 v99, v99, v172
    v_mfma_f32_16x16x32_bf16 v[112:115], a[132:135], a[164:167], v[112:115]
    v_fmac_f32 v134, v160, v50
    v_mul_f32 v100, v100, v176
    v_mul_f32 v101, v101, v176
    v_mfma_f32_16x16x32_bf16 v[116:119], a[56:59], a[24:27], v[116:119]
    v_fmac_f32 v135, v160, v51
    v_mul_f32 v102, v102, v176
    v_mul_f32 v103, v103, v176
    v_mfma_f32_16x16x32_bf16 v[116:119], a[60:63], a[28:31], v[116:119]
    v_cvt_pk_bf16_f32 v184, v96, v97
    v_cvt_pk_bf16_f32 v186, v100, v101
    v_cvt_pk_bf16_f32 v185, v98, v99
    v_mfma_f32_16x16x32_bf16 v[116:119], a[128:131], a[168:171], v[116:119]
    v_cvt_pk_bf16_f32 v187, v102, v103
    v_permlane16_swap_b32 v184, v186
    v_mfma_f32_16x16x32_bf16 v[116:119], a[132:135], a[172:175], v[116:119]
    s_waitcnt lgkmcnt(0)
    v_nop
    v_permlane16_swap_b32 v185, v187
    v_mfma_f32_16x16x32_bf16 v[120:123], a[64:67], a[0:3], v[120:123]
    buffer_store_dwordx4 v[184:187], v26, s[4:7], s47 offen offset:2048 sc1
    v_mul_f32 v104, v104, v164
    v_mfma_f32_16x16x32_bf16 v[120:123], a[68:71], a[4:7], v[120:123]
    v_mul_f32 v105, v105, v164
    v_mul_f32 v106, v106, v164
    v_mfma_f32_16x16x32_bf16 v[120:123], a[136:139], a[144:147], v[120:123]
    v_mul_f32 v107, v107, v164
    v_mul_f32 v108, v108, v168
    v_mfma_f32_16x16x32_bf16 v[120:123], a[140:143], a[148:151], v[120:123]
    v_mul_f32 v109, v109, v168
    v_mul_f32 v110, v110, v168
    v_mfma_f32_16x16x32_bf16 v[124:127], a[64:67], a[8:11], v[124:127]
    v_mul_f32 v111, v111, v168
    v_cvt_pk_bf16_f32 v188, v104, v105
    v_mfma_f32_16x16x32_bf16 v[124:127], a[68:71], a[12:15], v[124:127]
    v_cvt_pk_bf16_f32 v190, v108, v109
    v_cvt_pk_bf16_f32 v189, v106, v107
    v_mfma_f32_16x16x32_bf16 v[124:127], a[136:139], a[152:155], v[124:127]
    v_cvt_pk_bf16_f32 v191, v110, v111
    v_permlane16_swap_b32 v188, v190
    v_mfma_f32_16x16x32_bf16 v[124:127], a[140:143], a[156:159], v[124:127]
    v_nop
    v_permlane16_swap_b32 v189, v191
    v_mfma_f32_16x16x32_bf16 v[128:131], a[64:67], a[16:19], v[128:131]
    buffer_store_dwordx4 v[188:191], v253, s[4:7], s48 offen offset:0 sc1
    v_mul_f32 v112, v112, v172
    v_mfma_f32_16x16x32_bf16 v[128:131], a[68:71], a[20:23], v[128:131]
    v_mul_f32 v113, v113, v172
    v_mul_f32 v114, v114, v172
    v_mfma_f32_16x16x32_bf16 v[128:131], a[136:139], a[160:163], v[128:131]
    v_mul_f32 v115, v115, v172
    v_mul_f32 v116, v116, v176
    v_mfma_f32_16x16x32_bf16 v[128:131], a[140:143], a[164:167], v[128:131]
    v_mul_f32 v117, v117, v176
    v_mul_f32 v118, v118, v176
    v_mfma_f32_16x16x32_bf16 v[132:135], a[64:67], a[24:27], v[132:135]
    v_mul_f32 v119, v119, v176
    v_cvt_pk_bf16_f32 v192, v112, v113
    v_mfma_f32_16x16x32_bf16 v[132:135], a[68:71], a[28:31], v[132:135]
    v_cvt_pk_bf16_f32 v194, v116, v117
    v_cvt_pk_bf16_f32 v193, v114, v115
    v_mfma_f32_16x16x32_bf16 v[132:135], a[136:139], a[168:171], v[132:135]
    v_cvt_pk_bf16_f32 v195, v118, v119
    v_permlane16_swap_b32 v192, v194
    v_mfma_f32_16x16x32_bf16 v[132:135], a[140:143], a[172:175], v[132:135]
    v_nop
    v_permlane16_swap_b32 v193, v195
    buffer_store_dwordx4 v[192:195], v253, s[4:7], s49 offen offset:0 sc1
    v_pk_mul_f32 v[120:121], v[120:121], v[164:165] op_sel_hi:[1,0]
    v_pk_mul_f32 v[122:123], v[122:123], v[164:165] op_sel_hi:[1,0]
    v_pk_mul_f32 v[124:125], v[124:125], v[168:169] op_sel_hi:[1,0]
    v_pk_mul_f32 v[126:127], v[126:127], v[168:169] op_sel_hi:[1,0]
    v_cvt_pk_bf16_f32 v180, v120, v121
    v_cvt_pk_bf16_f32 v182, v124, v125
    v_cvt_pk_bf16_f32 v181, v122, v123
    v_cvt_pk_bf16_f32 v183, v126, v127
    v_permlane16_swap_b32 v180, v182
    v_nop
    v_permlane16_swap_b32 v181, v183
    buffer_store_dwordx4 v[180:183], v253, s[4:7], s48 offen offset:1024 sc1
    v_pk_mul_f32 v[128:129], v[128:129], v[172:173] op_sel_hi:[1,0]
    v_pk_mul_f32 v[130:131], v[130:131], v[172:173] op_sel_hi:[1,0]
    v_pk_mul_f32 v[132:133], v[132:133], v[176:177] op_sel_hi:[1,0]
    v_pk_mul_f32 v[134:135], v[134:135], v[176:177] op_sel_hi:[1,0]
    v_cvt_pk_bf16_f32 v184, v128, v129
    v_cvt_pk_bf16_f32 v186, v132, v133
    v_cvt_pk_bf16_f32 v185, v130, v131
    v_cvt_pk_bf16_f32 v187, v134, v135
    v_permlane16_swap_b32 v184, v186
    v_nop
    v_permlane16_swap_b32 v185, v187
    buffer_store_dwordx4 v[184:187], v253, s[4:7], s49 offen offset:1024 sc1
    s_branch sequential_preLN__softmax_full_mha__glu_gated_bilinear__prompt_kernel_p1out
.p2align 12
sequential_preLN__softmax_full_mha__glu_gated_bilinear__prompt_kernel_v:
    s_mul_i32 s56, s37, 10240
    s_add_u32 s46, s46, s56
    s_add_u32 s47, s46, 5120
    v_mul_u32_u24 v5, 1280, v53
    v_lshl_add_u32 v26, v52, 4, v5
    v_lshl_add_u32 v30, v53, 4, v30
    v_lshl_add_u32 v31, v52, 2, v31
    s_mov_b64 exec, 0
    s_cmp_eq_u32 s3, 1
    s_cbranch_scc1 sequential_preLN__softmax_full_mha__glu_gated_bilinear__prompt_kernel_pgv1
    s_cmp_eq_u32 s3, 2
    s_cbranch_scc1 sequential_preLN__softmax_full_mha__glu_gated_bilinear__prompt_kernel_wrv
    s_cmp_eq_u32 s3, 3
    s_cbranch_scc1 sequential_preLN__softmax_full_mha__glu_gated_bilinear__prompt_kernel_wrv
    s_branch sequential_preLN__softmax_full_mha__glu_gated_bilinear__prompt_kernel_pgv0
sequential_preLN__softmax_full_mha__glu_gated_bilinear__prompt_kernel_wrv:
    s_mov_b64 exec, -1
    s_waitcnt vmcnt(9)
    s_barrier
    ds_read_b64_tr_b16 a[32:33], v24 offset:0
    ds_read_b64_tr_b16 a[34:35], v24 offset:1280
    ds_read_b64_tr_b16 a[36:37], v24 offset:10240
    ds_read_b64_tr_b16 a[38:39], v24 offset:11520
    ds_read_b128 a[0:3], v22 offset:0
    ds_read_b128 a[4:7], v23 offset:0
    ds_read_b128 a[8:11], v22 offset:2048
    ds_read_b128 a[12:15], v23 offset:2048
    ds_read_b128 a[16:19], v22 offset:4096
    ds_read_b128 a[20:23], v23 offset:4096
    ds_read_b128 a[24:27], v22 offset:6144
    ds_read_b128 a[28:31], v23 offset:6144
    ds_read_b64_tr_b16 a[40:41], v25 offset:32
    ds_read_b64_tr_b16 a[42:43], v25 offset:1312
    ds_read_b64_tr_b16 a[44:45], v25 offset:10272
    ds_read_b64_tr_b16 a[46:47], v25 offset:11552
    ds_read_b64_tr_b16 a[48:49], v24 offset:64
    ds_read_b64_tr_b16 a[50:51], v24 offset:1344
    ds_read_b64_tr_b16 a[52:53], v24 offset:10304
    ds_read_b64_tr_b16 a[54:55], v24 offset:11584
    ds_read_b64_tr_b16 a[56:57], v25 offset:96
    ds_read_b64_tr_b16 a[58:59], v25 offset:1376
    ds_read_b64_tr_b16 a[60:61], v25 offset:10336
    ds_read_b64_tr_b16 a[62:63], v25 offset:11616
    ds_read_b64_tr_b16 a[64:65], v24 offset:128
    ds_read_b64_tr_b16 a[66:67], v24 offset:1408
    ds_read_b64_tr_b16 a[68:69], v24 offset:10368
    ds_read_b64_tr_b16 a[70:71], v24 offset:11648
    s_waitcnt lgkmcnt(15)
    v_mfma_f32_16x16x32_bf16 v[56:59], a[0:3], a[32:35], 0
    s_add_u32 m0, s32, 73728
    s_add_u32 s91, s91, 245760
    buffer_load_dwordx4 v12, s[8:11], s29 offen offset:0 lds
    buffer_load_dwordx4 v13, s[8:11], s29 offen offset:1024 lds
    v_mfma_f32_16x16x32_bf16 v[56:59], a[4:7], a[36:39], v[56:59]
    buffer_load_dwordx4 v14, s[8:11], s29 offen offset:2048 lds
    v_mfma_f32_16x16x32_bf16 v[60:63], a[8:11], a[32:35], 0
    buffer_load_dwordx4 v15, s[8:11], s29 offen offset:3072 lds
    v_mfma_f32_16x16x32_bf16 v[60:63], a[12:15], a[36:39], v[60:63]
    s_add_u32 m0, s35, 90112
    s_add_u32 s29, s29, 128
    buffer_load_dwordx4 v16, s[12:15], s91 offen offset:0 lds
    v_mfma_f32_16x16x32_bf16 v[64:67], a[16:19], a[32:35], 0
    buffer_load_dwordx4 v17, s[12:15], s91 offen offset:1024 lds
    buffer_load_dwordx4 v18, s[12:15], s91 offen offset:2048 lds
    v_mfma_f32_16x16x32_bf16 v[64:67], a[20:23], a[36:39], v[64:67]
    buffer_load_dwordx4 v19, s[12:15], s91 offen offset:3072 lds
    v_mfma_f32_16x16x32_bf16 v[68:71], a[24:27], a[32:35], 0
    s_add_u32 m0, s35, 94208
    s_nop 0
    buffer_load_dwordx4 v20, s[12:15], s91 offen offset:0 lds
    v_mfma_f32_16x16x32_bf16 v[68:71], a[28:31], a[36:39], v[68:71]
    s_waitcnt lgkmcnt(0)
    s_waitcnt vmcnt(9)
    s_barrier
    v_mfma_f32_16x16x32_bf16 v[72:75], a[0:3], a[40:43], 0
    ds_read_b64_tr_b16 a[104:105], v24 offset:36864
    v_mfma_f32_16x16x32_bf16 v[72:75], a[4:7], a[44:47], v[72:75]
    ds_read_b64_tr_b16 a[106:107], v24 offset:38144
    v_mfma_f32_16x16x32_bf16 v[76:79], a[8:11], a[40:43], 0
    s_add_u32 m0, s32, 110592
    ds_read_b64_tr_b16 a[108:109], v24 offset:47104
    v_mfma_f32_16x16x32_bf16 v[76:79], a[12:15], a[44:47], v[76:79]
    s_add_u32 s91, s91, 245760
    ds_read_b64_tr_b16 a[110:111], v24 offset:48384
    v_mfma_f32_16x16x32_bf16 v[80:83], a[16:19], a[40:43], 0
    buffer_load_dwordx4 v12, s[8:11], s29 offen offset:0 lds
    ds_read_b128 a[72:75], v22 offset:36864
    v_mfma_f32_16x16x32_bf16 v[80:83], a[20:23], a[44:47], v[80:83]
    ds_read_b128 a[76:79], v23 offset:36864
    v_mfma_f32_16x16x32_bf16 v[84:87], a[24:27], a[40:43], 0
    ds_read_b128 a[80:83], v22 offset:38912
    v_mfma_f32_16x16x32_bf16 v[84:87], a[28:31], a[44:47], v[84:87]
    ds_read_b128 a[84:87], v23 offset:38912
    v_mfma_f32_16x16x32_bf16 v[88:91], a[0:3], a[48:51], 0
    buffer_load_dwordx4 v13, s[8:11], s29 offen offset:1024 lds
    ds_read_b128 a[88:91], v22 offset:40960
    v_mfma_f32_16x16x32_bf16 v[88:91], a[4:7], a[52:55], v[88:91]
    ds_read_b128 a[92:95], v23 offset:40960
    v_mfma_f32_16x16x32_bf16 v[92:95], a[8:11], a[48:51], 0
    ds_read_b128 a[96:99], v22 offset:43008
    v_mfma_f32_16x16x32_bf16 v[92:95], a[12:15], a[52:55], v[92:95]
    ds_read_b128 a[100:103], v23 offset:43008
    v_mfma_f32_16x16x32_bf16 v[96:99], a[16:19], a[48:51], 0
    buffer_load_dwordx4 v14, s[8:11], s29 offen offset:2048 lds
    ds_read_b64_tr_b16 a[112:113], v25 offset:36896
    v_mfma_f32_16x16x32_bf16 v[96:99], a[20:23], a[52:55], v[96:99]
    ds_read_b64_tr_b16 a[114:115], v25 offset:38176
    v_mfma_f32_16x16x32_bf16 v[100:103], a[24:27], a[48:51], 0
    ds_read_b64_tr_b16 a[116:117], v25 offset:47136
    v_mfma_f32_16x16x32_bf16 v[100:103], a[28:31], a[52:55], v[100:103]
    ds_read_b64_tr_b16 a[118:119], v25 offset:48416
    v_mfma_f32_16x16x32_bf16 v[104:107], a[0:3], a[56:59], 0
    buffer_load_dwordx4 v15, s[8:11], s29 offen offset:3072 lds
    ds_read_b64_tr_b16 a[120:121], v24 offset:36928
    v_mfma_f32_16x16x32_bf16 v[104:107], a[4:7], a[60:63], v[104:107]
    s_add_u32 m0, s35, 126976
    ds_read_b64_tr_b16 a[122:123], v24 offset:38208
    v_mfma_f32_16x16x32_bf16 v[108:111], a[8:11], a[56:59], 0
    s_add_u32 s29, s29, 128
    ds_read_b64_tr_b16 a[124:125], v24 offset:47168
    v_mfma_f32_16x16x32_bf16 v[108:111], a[12:15], a[60:63], v[108:111]
    ds_read_b64_tr_b16 a[126:127], v24 offset:48448
    v_mfma_f32_16x16x32_bf16 v[112:115], a[16:19], a[56:59], 0
    ds_read_b64_tr_b16 a[128:129], v25 offset:36960
    v_mfma_f32_16x16x32_bf16 v[112:115], a[20:23], a[60:63], v[112:115]
    buffer_load_dwordx4 v16, s[12:15], s91 offen offset:0 lds
    ds_read_b64_tr_b16 a[130:131], v25 offset:38240
    v_mfma_f32_16x16x32_bf16 v[116:119], a[24:27], a[56:59], 0
    ds_read_b64_tr_b16 a[132:133], v25 offset:47200
    v_mfma_f32_16x16x32_bf16 v[116:119], a[28:31], a[60:63], v[116:119]
    ds_read_b64_tr_b16 a[134:135], v25 offset:48480
    v_mfma_f32_16x16x32_bf16 v[120:123], a[0:3], a[64:67], 0
    ds_read_b64_tr_b16 a[136:137], v24 offset:36992
    v_mfma_f32_16x16x32_bf16 v[120:123], a[4:7], a[68:71], v[120:123]
    buffer_load_dwordx4 v17, s[12:15], s91 offen offset:1024 lds
    ds_read_b64_tr_b16 a[138:139], v24 offset:38272
    v_mfma_f32_16x16x32_bf16 v[124:127], a[8:11], a[64:67], 0
    ds_read_b64_tr_b16 a[140:141], v24 offset:47232
    v_mfma_f32_16x16x32_bf16 v[124:127], a[12:15], a[68:71], v[124:127]
    ds_read_b64_tr_b16 a[142:143], v24 offset:48512
    v_mfma_f32_16x16x32_bf16 v[128:131], a[16:19], a[64:67], 0
    v_mfma_f32_16x16x32_bf16 v[128:131], a[20:23], a[68:71], v[128:131]
    buffer_load_dwordx4 v18, s[12:15], s91 offen offset:2048 lds
    v_mfma_f32_16x16x32_bf16 v[132:135], a[24:27], a[64:67], 0
    v_mfma_f32_16x16x32_bf16 v[132:135], a[28:31], a[68:71], v[132:135]
    s_waitcnt lgkmcnt(15)
    v_mfma_f32_16x16x32_bf16 v[56:59], a[72:75], a[104:107], v[56:59]
    v_mfma_f32_16x16x32_bf16 v[56:59], a[76:79], a[108:111], v[56:59]
    v_mfma_f32_16x16x32_bf16 v[60:63], a[80:83], a[104:107], v[60:63]
    buffer_load_dwordx4 v19, s[12:15], s91 offen offset:3072 lds
    v_mfma_f32_16x16x32_bf16 v[60:63], a[84:87], a[108:111], v[60:63]
    s_add_u32 m0, s35, 131072
    v_mfma_f32_16x16x32_bf16 v[64:67], a[88:91], a[104:107], v[64:67]
    v_add_u32 v22, 73728, v22
    v_add_u32 v23, 73728, v23
    v_mfma_f32_16x16x32_bf16 v[64:67], a[92:95], a[108:111], v[64:67]
    v_add_u32 v24, 73728, v24
    v_mfma_f32_16x16x32_bf16 v[68:71], a[96:99], a[104:107], v[68:71]
    buffer_load_dwordx4 v20, s[12:15], s91 offen offset:0 lds
    v_mfma_f32_16x16x32_bf16 v[68:71], a[100:103], a[108:111], v[68:71]
    s_waitcnt lgkmcnt(0)
    s_waitcnt vmcnt(9)
    v_add_u32 v25, 73728, v25
    s_barrier
    v_mfma_f32_16x16x32_bf16 v[72:75], a[72:75], a[112:115], v[72:75]
    ds_read_b64_tr_b16 a[32:33], v24 offset:0
    v_mfma_f32_16x16x32_bf16 v[72:75], a[76:79], a[116:119], v[72:75]
    ds_read_b64_tr_b16 a[34:35], v24 offset:1280
    v_mfma_f32_16x16x32_bf16 v[76:79], a[80:83], a[112:115], v[76:79]
    s_add_u32 m0, s32, 0
    ds_read_b64_tr_b16 a[36:37], v24 offset:10240
    v_mfma_f32_16x16x32_bf16 v[76:79], a[84:87], a[116:119], v[76:79]
    s_add_u32 s91, s91, 245760
    ds_read_b64_tr_b16 a[38:39], v24 offset:11520
    v_mfma_f32_16x16x32_bf16 v[80:83], a[88:91], a[112:115], v[80:83]
    buffer_load_dwordx4 v12, s[8:11], s29 offen offset:0 lds
    ds_read_b128 a[0:3], v22 offset:0
    v_mfma_f32_16x16x32_bf16 v[80:83], a[92:95], a[116:119], v[80:83]
    ds_read_b128 a[4:7], v23 offset:0
    v_mfma_f32_16x16x32_bf16 v[84:87], a[96:99], a[112:115], v[84:87]
    ds_read_b128 a[8:11], v22 offset:2048
    v_mfma_f32_16x16x32_bf16 v[84:87], a[100:103], a[116:119], v[84:87]
    ds_read_b128 a[12:15], v23 offset:2048
    v_mfma_f32_16x16x32_bf16 v[88:91], a[72:75], a[120:123], v[88:91]
    buffer_load_dwordx4 v13, s[8:11], s29 offen offset:1024 lds
    ds_read_b128 a[16:19], v22 offset:4096
    v_mfma_f32_16x16x32_bf16 v[88:91], a[76:79], a[124:127], v[88:91]
    ds_read_b128 a[20:23], v23 offset:4096
    v_mfma_f32_16x16x32_bf16 v[92:95], a[80:83], a[120:123], v[92:95]
    ds_read_b128 a[24:27], v22 offset:6144
    v_mfma_f32_16x16x32_bf16 v[92:95], a[84:87], a[124:127], v[92:95]
    ds_read_b128 a[28:31], v23 offset:6144
    v_mfma_f32_16x16x32_bf16 v[96:99], a[88:91], a[120:123], v[96:99]
    buffer_load_dwordx4 v14, s[8:11], s29 offen offset:2048 lds
    ds_read_b64_tr_b16 a[40:41], v25 offset:32
    v_mfma_f32_16x16x32_bf16 v[96:99], a[92:95], a[124:127], v[96:99]
    ds_read_b64_tr_b16 a[42:43], v25 offset:1312
    v_mfma_f32_16x16x32_bf16 v[100:103], a[96:99], a[120:123], v[100:103]
    ds_read_b64_tr_b16 a[44:45], v25 offset:10272
    v_mfma_f32_16x16x32_bf16 v[100:103], a[100:103], a[124:127], v[100:103]
    ds_read_b64_tr_b16 a[46:47], v25 offset:11552
    v_mfma_f32_16x16x32_bf16 v[104:107], a[72:75], a[128:131], v[104:107]
    buffer_load_dwordx4 v15, s[8:11], s29 offen offset:3072 lds
    ds_read_b64_tr_b16 a[48:49], v24 offset:64
    v_mfma_f32_16x16x32_bf16 v[104:107], a[76:79], a[132:135], v[104:107]
    s_add_u32 m0, s35, 16384
    ds_read_b64_tr_b16 a[50:51], v24 offset:1344
    v_mfma_f32_16x16x32_bf16 v[108:111], a[80:83], a[128:131], v[108:111]
    s_add_u32 s29, s29, 128
    ds_read_b64_tr_b16 a[52:53], v24 offset:10304
    v_mfma_f32_16x16x32_bf16 v[108:111], a[84:87], a[132:135], v[108:111]
    ds_read_b64_tr_b16 a[54:55], v24 offset:11584
    v_mfma_f32_16x16x32_bf16 v[112:115], a[88:91], a[128:131], v[112:115]
    ds_read_b64_tr_b16 a[56:57], v25 offset:96
    v_mfma_f32_16x16x32_bf16 v[112:115], a[92:95], a[132:135], v[112:115]
    buffer_load_dwordx4 v16, s[12:15], s91 offen offset:0 lds
    ds_read_b64_tr_b16 a[58:59], v25 offset:1376
    v_mfma_f32_16x16x32_bf16 v[116:119], a[96:99], a[128:131], v[116:119]
    ds_read_b64_tr_b16 a[60:61], v25 offset:10336
    v_mfma_f32_16x16x32_bf16 v[116:119], a[100:103], a[132:135], v[116:119]
    ds_read_b64_tr_b16 a[62:63], v25 offset:11616
    v_mfma_f32_16x16x32_bf16 v[120:123], a[72:75], a[136:139], v[120:123]
    ds_read_b64_tr_b16 a[64:65], v24 offset:128
    v_mfma_f32_16x16x32_bf16 v[120:123], a[76:79], a[140:143], v[120:123]
    buffer_load_dwordx4 v17, s[12:15], s91 offen offset:1024 lds
    ds_read_b64_tr_b16 a[66:67], v24 offset:1408
    v_mfma_f32_16x16x32_bf16 v[124:127], a[80:83], a[136:139], v[124:127]
    ds_read_b64_tr_b16 a[68:69], v24 offset:10368
    v_mfma_f32_16x16x32_bf16 v[124:127], a[84:87], a[140:143], v[124:127]
    ds_read_b64_tr_b16 a[70:71], v24 offset:11648
    v_mfma_f32_16x16x32_bf16 v[128:131], a[88:91], a[136:139], v[128:131]
    v_mfma_f32_16x16x32_bf16 v[128:131], a[92:95], a[140:143], v[128:131]
    buffer_load_dwordx4 v18, s[12:15], s91 offen offset:2048 lds
    v_mfma_f32_16x16x32_bf16 v[132:135], a[96:99], a[136:139], v[132:135]
    v_mfma_f32_16x16x32_bf16 v[132:135], a[100:103], a[140:143], v[132:135]
    s_waitcnt lgkmcnt(15)
    v_mfma_f32_16x16x32_bf16 v[56:59], a[0:3], a[32:35], v[56:59]
    v_mfma_f32_16x16x32_bf16 v[56:59], a[4:7], a[36:39], v[56:59]
    v_mfma_f32_16x16x32_bf16 v[60:63], a[8:11], a[32:35], v[60:63]
    buffer_load_dwordx4 v19, s[12:15], s91 offen offset:3072 lds
    v_mfma_f32_16x16x32_bf16 v[60:63], a[12:15], a[36:39], v[60:63]
    s_add_u32 m0, s35, 20480
    v_mfma_f32_16x16x32_bf16 v[64:67], a[16:19], a[32:35], v[64:67]
    v_mfma_f32_16x16x32_bf16 v[64:67], a[20:23], a[36:39], v[64:67]
    v_mfma_f32_16x16x32_bf16 v[68:71], a[24:27], a[32:35], v[68:71]
    buffer_load_dwordx4 v20, s[12:15], s91 offen offset:0 lds
    v_mfma_f32_16x16x32_bf16 v[68:71], a[28:31], a[36:39], v[68:71]
    s_waitcnt lgkmcnt(0)
    s_waitcnt vmcnt(9)
    s_barrier
    v_mfma_f32_16x16x32_bf16 v[72:75], a[0:3], a[40:43], v[72:75]
    ds_read_b64_tr_b16 a[104:105], v24 offset:36864
    v_mfma_f32_16x16x32_bf16 v[72:75], a[4:7], a[44:47], v[72:75]
    ds_read_b64_tr_b16 a[106:107], v24 offset:38144
    v_mfma_f32_16x16x32_bf16 v[76:79], a[8:11], a[40:43], v[76:79]
    s_add_u32 m0, s32, 36864
    ds_read_b64_tr_b16 a[108:109], v24 offset:47104
    v_mfma_f32_16x16x32_bf16 v[76:79], a[12:15], a[44:47], v[76:79]
    s_add_u32 s91, s91, 245760
    ds_read_b64_tr_b16 a[110:111], v24 offset:48384
    v_mfma_f32_16x16x32_bf16 v[80:83], a[16:19], a[40:43], v[80:83]
    buffer_load_dwordx4 v12, s[8:11], s29 offen offset:0 lds
    ds_read_b128 a[72:75], v22 offset:36864
    v_mfma_f32_16x16x32_bf16 v[80:83], a[20:23], a[44:47], v[80:83]
    ds_read_b128 a[76:79], v23 offset:36864
    v_mfma_f32_16x16x32_bf16 v[84:87], a[24:27], a[40:43], v[84:87]
    ds_read_b128 a[80:83], v22 offset:38912
    v_mfma_f32_16x16x32_bf16 v[84:87], a[28:31], a[44:47], v[84:87]
    ds_read_b128 a[84:87], v23 offset:38912
    v_mfma_f32_16x16x32_bf16 v[88:91], a[0:3], a[48:51], v[88:91]
    buffer_load_dwordx4 v13, s[8:11], s29 offen offset:1024 lds
    ds_read_b128 a[88:91], v22 offset:40960
    v_mfma_f32_16x16x32_bf16 v[88:91], a[4:7], a[52:55], v[88:91]
    ds_read_b128 a[92:95], v23 offset:40960
    v_mfma_f32_16x16x32_bf16 v[92:95], a[8:11], a[48:51], v[92:95]
    ds_read_b128 a[96:99], v22 offset:43008
    v_mfma_f32_16x16x32_bf16 v[92:95], a[12:15], a[52:55], v[92:95]
    ds_read_b128 a[100:103], v23 offset:43008
    v_mfma_f32_16x16x32_bf16 v[96:99], a[16:19], a[48:51], v[96:99]
    buffer_load_dwordx4 v14, s[8:11], s29 offen offset:2048 lds
    ds_read_b64_tr_b16 a[112:113], v25 offset:36896
    v_mfma_f32_16x16x32_bf16 v[96:99], a[20:23], a[52:55], v[96:99]
    ds_read_b64_tr_b16 a[114:115], v25 offset:38176
    v_mfma_f32_16x16x32_bf16 v[100:103], a[24:27], a[48:51], v[100:103]
    ds_read_b64_tr_b16 a[116:117], v25 offset:47136
    v_mfma_f32_16x16x32_bf16 v[100:103], a[28:31], a[52:55], v[100:103]
    ds_read_b64_tr_b16 a[118:119], v25 offset:48416
    v_mfma_f32_16x16x32_bf16 v[104:107], a[0:3], a[56:59], v[104:107]
    buffer_load_dwordx4 v15, s[8:11], s29 offen offset:3072 lds
    ds_read_b64_tr_b16 a[120:121], v24 offset:36928
    v_mfma_f32_16x16x32_bf16 v[104:107], a[4:7], a[60:63], v[104:107]
    s_add_u32 m0, s35, 53248
    ds_read_b64_tr_b16 a[122:123], v24 offset:38208
    v_mfma_f32_16x16x32_bf16 v[108:111], a[8:11], a[56:59], v[108:111]
    s_add_u32 s29, s29, 128
    ds_read_b64_tr_b16 a[124:125], v24 offset:47168
    v_mfma_f32_16x16x32_bf16 v[108:111], a[12:15], a[60:63], v[108:111]
    ds_read_b64_tr_b16 a[126:127], v24 offset:48448
    v_mfma_f32_16x16x32_bf16 v[112:115], a[16:19], a[56:59], v[112:115]
    ds_read_b64_tr_b16 a[128:129], v25 offset:36960
    v_mfma_f32_16x16x32_bf16 v[112:115], a[20:23], a[60:63], v[112:115]
    buffer_load_dwordx4 v16, s[12:15], s91 offen offset:0 lds
    ds_read_b64_tr_b16 a[130:131], v25 offset:38240
    v_mfma_f32_16x16x32_bf16 v[116:119], a[24:27], a[56:59], v[116:119]
    ds_read_b64_tr_b16 a[132:133], v25 offset:47200
    v_mfma_f32_16x16x32_bf16 v[116:119], a[28:31], a[60:63], v[116:119]
    ds_read_b64_tr_b16 a[134:135], v25 offset:48480
    v_mfma_f32_16x16x32_bf16 v[120:123], a[0:3], a[64:67], v[120:123]
    ds_read_b64_tr_b16 a[136:137], v24 offset:36992
    v_mfma_f32_16x16x32_bf16 v[120:123], a[4:7], a[68:71], v[120:123]
    buffer_load_dwordx4 v17, s[12:15], s91 offen offset:1024 lds
    ds_read_b64_tr_b16 a[138:139], v24 offset:38272
    v_mfma_f32_16x16x32_bf16 v[124:127], a[8:11], a[64:67], v[124:127]
    ds_read_b64_tr_b16 a[140:141], v24 offset:47232
    v_mfma_f32_16x16x32_bf16 v[124:127], a[12:15], a[68:71], v[124:127]
    ds_read_b64_tr_b16 a[142:143], v24 offset:48512
    v_mfma_f32_16x16x32_bf16 v[128:131], a[16:19], a[64:67], v[128:131]
    v_mfma_f32_16x16x32_bf16 v[128:131], a[20:23], a[68:71], v[128:131]
    buffer_load_dwordx4 v18, s[12:15], s91 offen offset:2048 lds
    v_mfma_f32_16x16x32_bf16 v[132:135], a[24:27], a[64:67], v[132:135]
    v_mfma_f32_16x16x32_bf16 v[132:135], a[28:31], a[68:71], v[132:135]
    s_waitcnt lgkmcnt(15)
    v_mfma_f32_16x16x32_bf16 v[56:59], a[72:75], a[104:107], v[56:59]
    v_mfma_f32_16x16x32_bf16 v[56:59], a[76:79], a[108:111], v[56:59]
    v_mfma_f32_16x16x32_bf16 v[60:63], a[80:83], a[104:107], v[60:63]
    buffer_load_dwordx4 v19, s[12:15], s91 offen offset:3072 lds
    v_mfma_f32_16x16x32_bf16 v[60:63], a[84:87], a[108:111], v[60:63]
    s_add_u32 m0, s35, 57344
    v_mfma_f32_16x16x32_bf16 v[64:67], a[88:91], a[104:107], v[64:67]
    v_add_u32 v22, 4294893568, v22
    v_add_u32 v23, 4294893568, v23
    v_mfma_f32_16x16x32_bf16 v[64:67], a[92:95], a[108:111], v[64:67]
    v_add_u32 v24, 4294893568, v24
    v_mfma_f32_16x16x32_bf16 v[68:71], a[96:99], a[104:107], v[68:71]
    buffer_load_dwordx4 v20, s[12:15], s91 offen offset:0 lds
    v_mfma_f32_16x16x32_bf16 v[68:71], a[100:103], a[108:111], v[68:71]
    s_waitcnt lgkmcnt(0)
    s_waitcnt vmcnt(9)
    v_add_u32 v25, 4294893568, v25
    s_barrier
    v_mfma_f32_16x16x32_bf16 v[72:75], a[72:75], a[112:115], v[72:75]
    ds_read_b64_tr_b16 a[32:33], v24 offset:0
    v_mfma_f32_16x16x32_bf16 v[72:75], a[76:79], a[116:119], v[72:75]
    ds_read_b64_tr_b16 a[34:35], v24 offset:1280
    v_mfma_f32_16x16x32_bf16 v[76:79], a[80:83], a[112:115], v[76:79]
    s_add_u32 m0, s32, 73728
    ds_read_b64_tr_b16 a[36:37], v24 offset:10240
    v_mfma_f32_16x16x32_bf16 v[76:79], a[84:87], a[116:119], v[76:79]
    s_add_u32 s91, s91, 245760
    buffer_load_dword v55, off, s[52:55], s22 sc1
    ds_read_b64_tr_b16 a[38:39], v24 offset:11520
    v_mfma_f32_16x16x32_bf16 v[80:83], a[88:91], a[112:115], v[80:83]
    buffer_load_dwordx4 v12, s[8:11], s29 offen offset:0 lds
    ds_read_b128 a[0:3], v22 offset:0
    v_mfma_f32_16x16x32_bf16 v[80:83], a[92:95], a[116:119], v[80:83]
    ds_read_b128 a[4:7], v23 offset:0
    v_mfma_f32_16x16x32_bf16 v[84:87], a[96:99], a[112:115], v[84:87]
    ds_read_b128 a[8:11], v22 offset:2048
    v_mfma_f32_16x16x32_bf16 v[84:87], a[100:103], a[116:119], v[84:87]
    ds_read_b128 a[12:15], v23 offset:2048
    v_mfma_f32_16x16x32_bf16 v[88:91], a[72:75], a[120:123], v[88:91]
    buffer_load_dwordx4 v13, s[8:11], s29 offen offset:1024 lds
    ds_read_b128 a[16:19], v22 offset:4096
    v_mfma_f32_16x16x32_bf16 v[88:91], a[76:79], a[124:127], v[88:91]
    ds_read_b128 a[20:23], v23 offset:4096
    v_mfma_f32_16x16x32_bf16 v[92:95], a[80:83], a[120:123], v[92:95]
    ds_read_b128 a[24:27], v22 offset:6144
    v_mfma_f32_16x16x32_bf16 v[92:95], a[84:87], a[124:127], v[92:95]
    ds_read_b128 a[28:31], v23 offset:6144
    v_mfma_f32_16x16x32_bf16 v[96:99], a[88:91], a[120:123], v[96:99]
    buffer_load_dwordx4 v14, s[8:11], s29 offen offset:2048 lds
    ds_read_b64_tr_b16 a[40:41], v25 offset:32
    v_mfma_f32_16x16x32_bf16 v[96:99], a[92:95], a[124:127], v[96:99]
    ds_read_b64_tr_b16 a[42:43], v25 offset:1312
    v_mfma_f32_16x16x32_bf16 v[100:103], a[96:99], a[120:123], v[100:103]
    ds_read_b64_tr_b16 a[44:45], v25 offset:10272
    v_mfma_f32_16x16x32_bf16 v[100:103], a[100:103], a[124:127], v[100:103]
    ds_read_b64_tr_b16 a[46:47], v25 offset:11552
    v_mfma_f32_16x16x32_bf16 v[104:107], a[72:75], a[128:131], v[104:107]
    buffer_load_dwordx4 v15, s[8:11], s29 offen offset:3072 lds
    ds_read_b64_tr_b16 a[48:49], v24 offset:64
    v_mfma_f32_16x16x32_bf16 v[104:107], a[76:79], a[132:135], v[104:107]
    s_add_u32 m0, s35, 90112
    ds_read_b64_tr_b16 a[50:51], v24 offset:1344
    v_mfma_f32_16x16x32_bf16 v[108:111], a[80:83], a[128:131], v[108:111]
    s_add_u32 s29, s29, 128
    ds_read_b64_tr_b16 a[52:53], v24 offset:10304
    v_mfma_f32_16x16x32_bf16 v[108:111], a[84:87], a[132:135], v[108:111]
    ds_read_b64_tr_b16 a[54:55], v24 offset:11584
    v_mfma_f32_16x16x32_bf16 v[112:115], a[88:91], a[128:131], v[112:115]
    ds_read_b64_tr_b16 a[56:57], v25 offset:96
    v_mfma_f32_16x16x32_bf16 v[112:115], a[92:95], a[132:135], v[112:115]
    buffer_load_dwordx4 v16, s[12:15], s91 offen offset:0 lds
    ds_read_b64_tr_b16 a[58:59], v25 offset:1376
    v_mfma_f32_16x16x32_bf16 v[116:119], a[96:99], a[128:131], v[116:119]
    ds_read_b64_tr_b16 a[60:61], v25 offset:10336
    v_mfma_f32_16x16x32_bf16 v[116:119], a[100:103], a[132:135], v[116:119]
    ds_read_b64_tr_b16 a[62:63], v25 offset:11616
    v_mfma_f32_16x16x32_bf16 v[120:123], a[72:75], a[136:139], v[120:123]
    ds_read_b64_tr_b16 a[64:65], v24 offset:128
    v_mfma_f32_16x16x32_bf16 v[120:123], a[76:79], a[140:143], v[120:123]
    buffer_load_dwordx4 v17, s[12:15], s91 offen offset:1024 lds
    ds_read_b64_tr_b16 a[66:67], v24 offset:1408
    v_mfma_f32_16x16x32_bf16 v[124:127], a[80:83], a[136:139], v[124:127]
    ds_read_b64_tr_b16 a[68:69], v24 offset:10368
    v_mfma_f32_16x16x32_bf16 v[124:127], a[84:87], a[140:143], v[124:127]
    ds_read_b64_tr_b16 a[70:71], v24 offset:11648
    v_mfma_f32_16x16x32_bf16 v[128:131], a[88:91], a[136:139], v[128:131]
    v_mfma_f32_16x16x32_bf16 v[128:131], a[92:95], a[140:143], v[128:131]
    buffer_load_dwordx4 v18, s[12:15], s91 offen offset:2048 lds
    v_mfma_f32_16x16x32_bf16 v[132:135], a[96:99], a[136:139], v[132:135]
    v_mfma_f32_16x16x32_bf16 v[132:135], a[100:103], a[140:143], v[132:135]
    s_waitcnt lgkmcnt(15)
    v_mfma_f32_16x16x32_bf16 v[56:59], a[0:3], a[32:35], v[56:59]
    v_mfma_f32_16x16x32_bf16 v[56:59], a[4:7], a[36:39], v[56:59]
    v_mfma_f32_16x16x32_bf16 v[60:63], a[8:11], a[32:35], v[60:63]
    buffer_load_dwordx4 v19, s[12:15], s91 offen offset:3072 lds
    v_mfma_f32_16x16x32_bf16 v[60:63], a[12:15], a[36:39], v[60:63]
    s_add_u32 m0, s35, 94208
    v_mfma_f32_16x16x32_bf16 v[64:67], a[16:19], a[32:35], v[64:67]
    v_mfma_f32_16x16x32_bf16 v[64:67], a[20:23], a[36:39], v[64:67]
    v_mfma_f32_16x16x32_bf16 v[68:71], a[24:27], a[32:35], v[68:71]
    buffer_load_dwordx4 v20, s[12:15], s91 offen offset:0 lds
    v_mfma_f32_16x16x32_bf16 v[68:71], a[28:31], a[36:39], v[68:71]
    s_waitcnt lgkmcnt(0)
    s_waitcnt vmcnt(9)
    s_barrier
    v_mfma_f32_16x16x32_bf16 v[72:75], a[0:3], a[40:43], v[72:75]
    ds_read_b64_tr_b16 a[104:105], v24 offset:36864
    v_mfma_f32_16x16x32_bf16 v[72:75], a[4:7], a[44:47], v[72:75]
    ds_read_b64_tr_b16 a[106:107], v24 offset:38144
    v_mfma_f32_16x16x32_bf16 v[76:79], a[8:11], a[40:43], v[76:79]
    s_add_u32 m0, s32, 110592
    ds_read_b64_tr_b16 a[108:109], v24 offset:47104
    v_mfma_f32_16x16x32_bf16 v[76:79], a[12:15], a[44:47], v[76:79]
    s_add_u32 s91, s91, 245760
    ds_read_b64_tr_b16 a[110:111], v24 offset:48384
    v_mfma_f32_16x16x32_bf16 v[80:83], a[16:19], a[40:43], v[80:83]
    buffer_load_dwordx4 v12, s[8:11], s29 offen offset:0 lds
    ds_read_b128 a[72:75], v22 offset:36864
    v_mfma_f32_16x16x32_bf16 v[80:83], a[20:23], a[44:47], v[80:83]
    ds_read_b128 a[76:79], v23 offset:36864
    v_mfma_f32_16x16x32_bf16 v[84:87], a[24:27], a[40:43], v[84:87]
    ds_read_b128 a[80:83], v22 offset:38912
    v_mfma_f32_16x16x32_bf16 v[84:87], a[28:31], a[44:47], v[84:87]
    ds_read_b128 a[84:87], v23 offset:38912
    v_mfma_f32_16x16x32_bf16 v[88:91], a[0:3], a[48:51], v[88:91]
    buffer_load_dwordx4 v13, s[8:11], s29 offen offset:1024 lds
    ds_read_b128 a[88:91], v22 offset:40960
    v_mfma_f32_16x16x32_bf16 v[88:91], a[4:7], a[52:55], v[88:91]
    ds_read_b128 a[92:95], v23 offset:40960
    v_mfma_f32_16x16x32_bf16 v[92:95], a[8:11], a[48:51], v[92:95]
    ds_read_b128 a[96:99], v22 offset:43008
    v_mfma_f32_16x16x32_bf16 v[92:95], a[12:15], a[52:55], v[92:95]
    ds_read_b128 a[100:103], v23 offset:43008
    v_mfma_f32_16x16x32_bf16 v[96:99], a[16:19], a[48:51], v[96:99]
    buffer_load_dwordx4 v14, s[8:11], s29 offen offset:2048 lds
    ds_read_b64_tr_b16 a[112:113], v25 offset:36896
    v_mfma_f32_16x16x32_bf16 v[96:99], a[20:23], a[52:55], v[96:99]
    ds_read_b64_tr_b16 a[114:115], v25 offset:38176
    v_mfma_f32_16x16x32_bf16 v[100:103], a[24:27], a[48:51], v[100:103]
    ds_read_b64_tr_b16 a[116:117], v25 offset:47136
    v_mfma_f32_16x16x32_bf16 v[100:103], a[28:31], a[52:55], v[100:103]
    ds_read_b64_tr_b16 a[118:119], v25 offset:48416
    v_mfma_f32_16x16x32_bf16 v[104:107], a[0:3], a[56:59], v[104:107]
    buffer_load_dwordx4 v15, s[8:11], s29 offen offset:3072 lds
    ds_read_b64_tr_b16 a[120:121], v24 offset:36928
    v_mfma_f32_16x16x32_bf16 v[104:107], a[4:7], a[60:63], v[104:107]
    s_add_u32 m0, s35, 126976
    ds_read_b64_tr_b16 a[122:123], v24 offset:38208
    v_mfma_f32_16x16x32_bf16 v[108:111], a[8:11], a[56:59], v[108:111]
    s_add_u32 s29, s29, 128
    ds_read_b64_tr_b16 a[124:125], v24 offset:47168
    v_mfma_f32_16x16x32_bf16 v[108:111], a[12:15], a[60:63], v[108:111]
    ds_read_b64_tr_b16 a[126:127], v24 offset:48448
    v_mfma_f32_16x16x32_bf16 v[112:115], a[16:19], a[56:59], v[112:115]
    ds_read_b64_tr_b16 a[128:129], v25 offset:36960
    v_mfma_f32_16x16x32_bf16 v[112:115], a[20:23], a[60:63], v[112:115]
    buffer_load_dwordx4 v16, s[12:15], s91 offen offset:0 lds
    ds_read_b64_tr_b16 a[130:131], v25 offset:38240
    v_mfma_f32_16x16x32_bf16 v[116:119], a[24:27], a[56:59], v[116:119]
    ds_read_b64_tr_b16 a[132:133], v25 offset:47200
    v_mfma_f32_16x16x32_bf16 v[116:119], a[28:31], a[60:63], v[116:119]
    ds_read_b64_tr_b16 a[134:135], v25 offset:48480
    v_mfma_f32_16x16x32_bf16 v[120:123], a[0:3], a[64:67], v[120:123]
    ds_read_b64_tr_b16 a[136:137], v24 offset:36992
    v_mfma_f32_16x16x32_bf16 v[120:123], a[4:7], a[68:71], v[120:123]
    buffer_load_dwordx4 v17, s[12:15], s91 offen offset:1024 lds
    ds_read_b64_tr_b16 a[138:139], v24 offset:38272
    v_mfma_f32_16x16x32_bf16 v[124:127], a[8:11], a[64:67], v[124:127]
    ds_read_b64_tr_b16 a[140:141], v24 offset:47232
    v_mfma_f32_16x16x32_bf16 v[124:127], a[12:15], a[68:71], v[124:127]
    ds_read_b64_tr_b16 a[142:143], v24 offset:48512
    v_mfma_f32_16x16x32_bf16 v[128:131], a[16:19], a[64:67], v[128:131]
    v_mfma_f32_16x16x32_bf16 v[128:131], a[20:23], a[68:71], v[128:131]
    buffer_load_dwordx4 v18, s[12:15], s91 offen offset:2048 lds
    v_mfma_f32_16x16x32_bf16 v[132:135], a[24:27], a[64:67], v[132:135]
    v_mfma_f32_16x16x32_bf16 v[132:135], a[28:31], a[68:71], v[132:135]
    s_waitcnt lgkmcnt(15)
    v_mfma_f32_16x16x32_bf16 v[56:59], a[72:75], a[104:107], v[56:59]
    v_mfma_f32_16x16x32_bf16 v[56:59], a[76:79], a[108:111], v[56:59]
    v_mfma_f32_16x16x32_bf16 v[60:63], a[80:83], a[104:107], v[60:63]
    buffer_load_dwordx4 v19, s[12:15], s91 offen offset:3072 lds
    v_mfma_f32_16x16x32_bf16 v[60:63], a[84:87], a[108:111], v[60:63]
    s_add_u32 m0, s35, 131072
    v_mfma_f32_16x16x32_bf16 v[64:67], a[88:91], a[104:107], v[64:67]
    v_add_u32 v22, 73728, v22
    v_add_u32 v23, 73728, v23
    v_mfma_f32_16x16x32_bf16 v[64:67], a[92:95], a[108:111], v[64:67]
    v_add_u32 v24, 73728, v24
    v_mfma_f32_16x16x32_bf16 v[68:71], a[96:99], a[104:107], v[68:71]
    buffer_load_dwordx4 v20, s[12:15], s91 offen offset:0 lds
    v_mfma_f32_16x16x32_bf16 v[68:71], a[100:103], a[108:111], v[68:71]
    s_waitcnt lgkmcnt(0)
    s_waitcnt vmcnt(9)
    v_add_u32 v25, 73728, v25
    s_barrier
    v_mfma_f32_16x16x32_bf16 v[72:75], a[72:75], a[112:115], v[72:75]
    ds_read_b64_tr_b16 a[32:33], v24 offset:0
    v_mfma_f32_16x16x32_bf16 v[72:75], a[76:79], a[116:119], v[72:75]
    ds_read_b64_tr_b16 a[34:35], v24 offset:1280
    v_mfma_f32_16x16x32_bf16 v[76:79], a[80:83], a[112:115], v[76:79]
    s_add_u32 m0, s32, 0
    ds_read_b64_tr_b16 a[36:37], v24 offset:10240
    v_mfma_f32_16x16x32_bf16 v[76:79], a[84:87], a[116:119], v[76:79]
    s_add_u32 s91, s91, 245760
    buffer_load_dword v2, v196, s[4:7], s22 offen sc1
    ds_read_b64_tr_b16 a[38:39], v24 offset:11520
    v_mfma_f32_16x16x32_bf16 v[80:83], a[88:91], a[112:115], v[80:83]
    buffer_load_dwordx4 v12, s[8:11], s29 offen offset:0 lds
    ds_read_b128 a[0:3], v22 offset:0
    v_mfma_f32_16x16x32_bf16 v[80:83], a[92:95], a[116:119], v[80:83]
    ds_read_b128 a[4:7], v23 offset:0
    v_mfma_f32_16x16x32_bf16 v[84:87], a[96:99], a[112:115], v[84:87]
sequential_preLN__softmax_full_mha__glu_gated_bilinear__prompt_kernel_pgv0:
    s_cbranch_execz sequential_preLN__softmax_full_mha__glu_gated_bilinear__prompt_kernel_wrv
    ds_read_b128 a[8:11], v22 offset:2048
    v_mfma_f32_16x16x32_bf16 v[84:87], a[100:103], a[116:119], v[84:87]
    ds_read_b128 a[12:15], v23 offset:2048
    v_mfma_f32_16x16x32_bf16 v[88:91], a[72:75], a[120:123], v[88:91]
    buffer_load_dwordx4 v13, s[8:11], s29 offen offset:1024 lds
    ds_read_b128 a[16:19], v22 offset:4096
    v_mfma_f32_16x16x32_bf16 v[88:91], a[76:79], a[124:127], v[88:91]
    ds_read_b128 a[20:23], v23 offset:4096
    v_mfma_f32_16x16x32_bf16 v[92:95], a[80:83], a[120:123], v[92:95]
    ds_read_b128 a[24:27], v22 offset:6144
    v_mfma_f32_16x16x32_bf16 v[92:95], a[84:87], a[124:127], v[92:95]
    ds_read_b128 a[28:31], v23 offset:6144
    v_mfma_f32_16x16x32_bf16 v[96:99], a[88:91], a[120:123], v[96:99]
    buffer_load_dwordx4 v14, s[8:11], s29 offen offset:2048 lds
    ds_read_b64_tr_b16 a[40:41], v25 offset:32
    v_mfma_f32_16x16x32_bf16 v[96:99], a[92:95], a[124:127], v[96:99]
    ds_read_b64_tr_b16 a[42:43], v25 offset:1312
    v_mfma_f32_16x16x32_bf16 v[100:103], a[96:99], a[120:123], v[100:103]
    ds_read_b64_tr_b16 a[44:45], v25 offset:10272
    v_mfma_f32_16x16x32_bf16 v[100:103], a[100:103], a[124:127], v[100:103]
    ds_read_b64_tr_b16 a[46:47], v25 offset:11552
    v_mfma_f32_16x16x32_bf16 v[104:107], a[72:75], a[128:131], v[104:107]
    buffer_load_dwordx4 v15, s[8:11], s29 offen offset:3072 lds
    ds_read_b64_tr_b16 a[48:49], v24 offset:64
    v_mfma_f32_16x16x32_bf16 v[104:107], a[76:79], a[132:135], v[104:107]
    s_add_u32 m0, s35, 16384
    ds_read_b64_tr_b16 a[50:51], v24 offset:1344
    v_mfma_f32_16x16x32_bf16 v[108:111], a[80:83], a[128:131], v[108:111]
    s_add_u32 s29, s29, 128
    ds_read_b64_tr_b16 a[52:53], v24 offset:10304
    v_mfma_f32_16x16x32_bf16 v[108:111], a[84:87], a[132:135], v[108:111]
    ds_read_b64_tr_b16 a[54:55], v24 offset:11584
    v_mfma_f32_16x16x32_bf16 v[112:115], a[88:91], a[128:131], v[112:115]
    ds_read_b64_tr_b16 a[56:57], v25 offset:96
    v_mfma_f32_16x16x32_bf16 v[112:115], a[92:95], a[132:135], v[112:115]
    buffer_load_dwordx4 v16, s[12:15], s91 offen offset:0 lds
    ds_read_b64_tr_b16 a[58:59], v25 offset:1376
    v_mfma_f32_16x16x32_bf16 v[116:119], a[96:99], a[128:131], v[116:119]
    ds_read_b64_tr_b16 a[60:61], v25 offset:10336
    v_mfma_f32_16x16x32_bf16 v[116:119], a[100:103], a[132:135], v[116:119]
    ds_read_b64_tr_b16 a[62:63], v25 offset:11616
    v_mfma_f32_16x16x32_bf16 v[120:123], a[72:75], a[136:139], v[120:123]
    ds_read_b64_tr_b16 a[64:65], v24 offset:128
    v_mfma_f32_16x16x32_bf16 v[120:123], a[76:79], a[140:143], v[120:123]
    buffer_load_dwordx4 v17, s[12:15], s91 offen offset:1024 lds
    ds_read_b64_tr_b16 a[66:67], v24 offset:1408
    v_mfma_f32_16x16x32_bf16 v[124:127], a[80:83], a[136:139], v[124:127]
    ds_read_b64_tr_b16 a[68:69], v24 offset:10368
    v_mfma_f32_16x16x32_bf16 v[124:127], a[84:87], a[140:143], v[124:127]
    ds_read_b64_tr_b16 a[70:71], v24 offset:11648
    v_mfma_f32_16x16x32_bf16 v[128:131], a[88:91], a[136:139], v[128:131]
    v_mfma_f32_16x16x32_bf16 v[128:131], a[92:95], a[140:143], v[128:131]
    buffer_load_dwordx4 v18, s[12:15], s91 offen offset:2048 lds
    v_mfma_f32_16x16x32_bf16 v[132:135], a[96:99], a[136:139], v[132:135]
    v_mfma_f32_16x16x32_bf16 v[132:135], a[100:103], a[140:143], v[132:135]
    s_waitcnt lgkmcnt(15)
    v_mfma_f32_16x16x32_bf16 v[56:59], a[0:3], a[32:35], v[56:59]
    v_mfma_f32_16x16x32_bf16 v[56:59], a[4:7], a[36:39], v[56:59]
    v_mfma_f32_16x16x32_bf16 v[60:63], a[8:11], a[32:35], v[60:63]
    buffer_load_dwordx4 v19, s[12:15], s91 offen offset:3072 lds
    v_mfma_f32_16x16x32_bf16 v[60:63], a[12:15], a[36:39], v[60:63]
    s_add_u32 m0, s35, 20480
    v_mfma_f32_16x16x32_bf16 v[64:67], a[16:19], a[32:35], v[64:67]
    v_mfma_f32_16x16x32_bf16 v[64:67], a[20:23], a[36:39], v[64:67]
    v_mfma_f32_16x16x32_bf16 v[68:71], a[24:27], a[32:35], v[68:71]
    buffer_load_dwordx4 v20, s[12:15], s91 offen offset:0 lds
    v_mfma_f32_16x16x32_bf16 v[68:71], a[28:31], a[36:39], v[68:71]
    s_waitcnt lgkmcnt(0)
    s_waitcnt vmcnt(10)
    s_waitcnt vmcnt(9)
    v_min_u32 v2, v55, v2
    v_or_b32 v2, s3, v2
    v_cmp_eq_u32 vcc, 0, v2
    s_nop 1
    s_cbranch_vccnz sequential_preLN__softmax_full_mha__glu_gated_bilinear__prompt_kernel_rsspinv
sequential_preLN__softmax_full_mha__glu_gated_bilinear__prompt_kernel_rsokv:
    s_barrier
    v_mfma_f32_16x16x32_bf16 v[72:75], a[0:3], a[40:43], v[72:75]
    ds_read_b64_tr_b16 a[104:105], v24 offset:36864
    v_mfma_f32_16x16x32_bf16 v[72:75], a[4:7], a[44:47], v[72:75]
    ds_read_b64_tr_b16 a[106:107], v24 offset:38144
    v_mfma_f32_16x16x32_bf16 v[76:79], a[8:11], a[40:43], v[76:79]
    s_mov_b32 m0, s43
    ds_read_b64_tr_b16 a[108:109], v24 offset:47104
    v_mfma_f32_16x16x32_bf16 v[76:79], a[12:15], a[44:47], v[76:79]
    ds_read_b64_tr_b16 a[110:111], v24 offset:48384
    v_mfma_f32_16x16x32_bf16 v[80:83], a[16:19], a[40:43], v[80:83]
    buffer_load_dwordx4 v253, s[4:7], s59 offen sc1 lds
    ds_read_b128 a[72:75], v22 offset:36864
    v_mfma_f32_16x16x32_bf16 v[80:83], a[20:23], a[44:47], v[80:83]
    s_add_u32 m0, s32, 36864
    ds_read_b128 a[76:79], v23 offset:36864
    v_mfma_f32_16x16x32_bf16 v[84:87], a[24:27], a[40:43], v[84:87]
    s_add_u32 s91, s91, 245760
    ds_read_b128 a[80:83], v22 offset:38912
    v_mfma_f32_16x16x32_bf16 v[84:87], a[28:31], a[44:47], v[84:87]
    buffer_load_dwordx4 v12, s[8:11], s29 offen offset:0 lds
    ds_read_b128 a[84:87], v23 offset:38912
    v_mfma_f32_16x16x32_bf16 v[88:91], a[0:3], a[48:51], v[88:91]
    ds_read_b128 a[88:91], v22 offset:40960
    v_mfma_f32_16x16x32_bf16 v[88:91], a[4:7], a[52:55], v[88:91]
    ds_read_b128 a[92:95], v23 offset:40960
    v_mfma_f32_16x16x32_bf16 v[92:95], a[8:11], a[48:51], v[92:95]
    ds_read_b128 a[96:99], v22 offset:43008
    v_mfma_f32_16x16x32_bf16 v[92:95], a[12:15], a[52:55], v[92:95]
    buffer_load_dwordx4 v13, s[8:11], s29 offen offset:1024 lds
    ds_read_b128 a[100:103], v23 offset:43008
    v_mfma_f32_16x16x32_bf16 v[96:99], a[16:19], a[48:51], v[96:99]
    ds_read_b64_tr_b16 a[112:113], v25 offset:36896
    v_mfma_f32_16x16x32_bf16 v[96:99], a[20:23], a[52:55], v[96:99]
    ds_read_b64_tr_b16 a[114:115], v25 offset:38176
    v_mfma_f32_16x16x32_bf16 v[100:103], a[24:27], a[48:51], v[100:103]
    ds_read_b64_tr_b16 a[116:117], v25 offset:47136
    v_mfma_f32_16x16x32_bf16 v[100:103], a[28:31], a[52:55], v[100:103]
    buffer_load_dwordx4 v14, s[8:11], s29 offen offset:2048 lds
    ds_read_b64_tr_b16 a[118:119], v25 offset:48416
    v_mfma_f32_16x16x32_bf16 v[104:107], a[0:3], a[56:59], v[104:107]
    ds_read_b64_tr_b16 a[120:121], v24 offset:36928
    v_mfma_f32_16x16x32_bf16 v[104:107], a[4:7], a[60:63], v[104:107]
    ds_read_b64_tr_b16 a[122:123], v24 offset:38208
    v_mfma_f32_16x16x32_bf16 v[108:111], a[8:11], a[56:59], v[108:111]
    ds_read_b64_tr_b16 a[124:125], v24 offset:47168
    v_mfma_f32_16x16x32_bf16 v[108:111], a[12:15], a[60:63], v[108:111]
    buffer_load_dwordx4 v15, s[8:11], s29 offen offset:3072 lds
    ds_read_b64_tr_b16 a[126:127], v24 offset:48448
    v_mfma_f32_16x16x32_bf16 v[112:115], a[16:19], a[56:59], v[112:115]
    s_add_u32 m0, s35, 53248
    ds_read_b64_tr_b16 a[128:129], v25 offset:36960
    v_mfma_f32_16x16x32_bf16 v[112:115], a[20:23], a[60:63], v[112:115]
    s_add_u32 s29, s29, 128
    ds_read_b64_tr_b16 a[130:131], v25 offset:38240
    v_mfma_f32_16x16x32_bf16 v[116:119], a[24:27], a[56:59], v[116:119]
    ds_read_b64_tr_b16 a[132:133], v25 offset:47200
    v_mfma_f32_16x16x32_bf16 v[116:119], a[28:31], a[60:63], v[116:119]
    buffer_load_dwordx4 v16, s[12:15], s91 offen offset:0 lds
    ds_read_b64_tr_b16 a[134:135], v25 offset:48480
    v_mfma_f32_16x16x32_bf16 v[120:123], a[0:3], a[64:67], v[120:123]
    ds_read_b64_tr_b16 a[136:137], v24 offset:36992
    v_mfma_f32_16x16x32_bf16 v[120:123], a[4:7], a[68:71], v[120:123]
    ds_read_b64_tr_b16 a[138:139], v24 offset:38272
    v_mfma_f32_16x16x32_bf16 v[124:127], a[8:11], a[64:67], v[124:127]
    ds_read_b64_tr_b16 a[140:141], v24 offset:47232
    v_mfma_f32_16x16x32_bf16 v[124:127], a[12:15], a[68:71], v[124:127]
    buffer_load_dwordx4 v17, s[12:15], s91 offen offset:1024 lds
    ds_read_b64_tr_b16 a[142:143], v24 offset:48512
    v_mfma_f32_16x16x32_bf16 v[128:131], a[16:19], a[64:67], v[128:131]
    v_mfma_f32_16x16x32_bf16 v[128:131], a[20:23], a[68:71], v[128:131]
    v_mfma_f32_16x16x32_bf16 v[132:135], a[24:27], a[64:67], v[132:135]
    v_mfma_f32_16x16x32_bf16 v[132:135], a[28:31], a[68:71], v[132:135]
    s_waitcnt lgkmcnt(15)
    buffer_load_dwordx4 v18, s[12:15], s91 offen offset:2048 lds
    v_mfma_f32_16x16x32_bf16 v[56:59], a[72:75], a[104:107], v[56:59]
    v_mfma_f32_16x16x32_bf16 v[56:59], a[76:79], a[108:111], v[56:59]
    v_mfma_f32_16x16x32_bf16 v[60:63], a[80:83], a[104:107], v[60:63]
    v_mfma_f32_16x16x32_bf16 v[60:63], a[84:87], a[108:111], v[60:63]
    buffer_load_dwordx4 v19, s[12:15], s91 offen offset:3072 lds
    v_mfma_f32_16x16x32_bf16 v[64:67], a[88:91], a[104:107], v[64:67]
    s_add_u32 m0, s35, 57344
    v_add_u32 v22, 4294893568, v22
    v_add_u32 v23, 4294893568, v23
    v_mfma_f32_16x16x32_bf16 v[64:67], a[92:95], a[108:111], v[64:67]
    v_add_u32 v24, 4294893568, v24
    v_mfma_f32_16x16x32_bf16 v[68:71], a[96:99], a[104:107], v[68:71]
    v_add_u32 v25, 4294893568, v25
    v_mfma_f32_16x16x32_bf16 v[68:71], a[100:103], a[108:111], v[68:71]
    s_waitcnt lgkmcnt(0)
    s_waitcnt vmcnt(8)
    buffer_load_dwordx4 v20, s[12:15], s91 offen offset:0 lds
    s_barrier
    v_mfma_f32_16x16x32_bf16 v[72:75], a[72:75], a[112:115], v[72:75]
    ds_read_b128 v[148:151], v30 offset:0
    ds_read_b128 v[152:155], v30 offset:64
    v_mfma_f32_16x16x32_bf16 v[72:75], a[76:79], a[116:119], v[72:75]
    ds_read_b128 v[156:159], v30 offset:128
    v_mfma_f32_16x16x32_bf16 v[76:79], a[80:83], a[112:115], v[76:79]
    ds_read_b128 v[160:163], v30 offset:192
    ds_read_b32 v32, v31 offset:0
    v_mfma_f32_16x16x32_bf16 v[76:79], a[84:87], a[116:119], v[76:79]
    buffer_load_dword v2, v54, s[4:7], s22 offen sc1
    ds_read_b32 v36, v31 offset:64
    v_mfma_f32_16x16x32_bf16 v[80:83], a[88:91], a[112:115], v[80:83]
    ds_read_b32 v40, v31 offset:128
    ds_read_b32 v44, v31 offset:192
    v_mfma_f32_16x16x32_bf16 v[80:83], a[92:95], a[116:119], v[80:83]
    ds_read_b32 v48, v31 offset:256
    v_mfma_f32_16x16x32_bf16 v[84:87], a[96:99], a[112:115], v[84:87]
    ds_read_b128 v[164:167], v30 offset:1024
    ds_read_b128 v[168:171], v30 offset:1088
    v_mfma_f32_16x16x32_bf16 v[84:87], a[100:103], a[116:119], v[84:87]
    ds_read_b128 v[172:175], v30 offset:1152
    v_mfma_f32_16x16x32_bf16 v[88:91], a[72:75], a[120:123], v[88:91]
    ds_read_b128 v[176:179], v30 offset:1216
    v_mfma_f32_16x16x32_bf16 v[88:91], a[76:79], a[124:127], v[88:91]
    ds_read_b64_tr_b16 a[32:33], v24 offset:0
    ds_read_b64_tr_b16 a[34:35], v24 offset:1280
    v_mfma_f32_16x16x32_bf16 v[92:95], a[80:83], a[120:123], v[92:95]
    ds_read_b64_tr_b16 a[36:37], v24 offset:10240
    v_mfma_f32_16x16x32_bf16 v[92:95], a[84:87], a[124:127], v[92:95]
    ds_read_b64_tr_b16 a[38:39], v24 offset:11520
    v_mfma_f32_16x16x32_bf16 v[96:99], a[88:91], a[120:123], v[96:99]
    s_waitcnt lgkmcnt(4)
    ds_read_b128 a[0:3], v22 offset:0
    ds_read_b128 a[4:7], v23 offset:0
    v_mfma_f32_16x16x32_bf16 v[96:99], a[92:95], a[124:127], v[96:99]
    ds_read_b128 a[8:11], v22 offset:2048
    v_fmac_f32 v56, v148, v32
    v_mfma_f32_16x16x32_bf16 v[100:103], a[96:99], a[120:123], v[100:103]
    ds_read_b128 a[12:15], v23 offset:2048
    v_fmac_f32 v57, v149, v32
    v_mfma_f32_16x16x32_bf16 v[100:103], a[100:103], a[124:127], v[100:103]
    ds_read_b128 a[16:19], v22 offset:4096
    ds_read_b128 a[20:23], v23 offset:4096
    v_mfma_f32_16x16x32_bf16 v[104:107], a[72:75], a[128:131], v[104:107]
    ds_read_b128 a[24:27], v22 offset:6144
    v_fmac_f32 v58, v150, v32
    v_mfma_f32_16x16x32_bf16 v[104:107], a[76:79], a[132:135], v[104:107]
    ds_read_b128 a[28:31], v23 offset:6144
    v_fmac_f32 v59, v151, v32
    v_mfma_f32_16x16x32_bf16 v[108:111], a[80:83], a[128:131], v[108:111]
    v_fmac_f32 v60, v152, v32
    v_fmac_f32 v61, v153, v32
    v_mfma_f32_16x16x32_bf16 v[108:111], a[84:87], a[132:135], v[108:111]
    v_fmac_f32 v62, v154, v32
    v_fmac_f32 v63, v155, v32
    v_mfma_f32_16x16x32_bf16 v[112:115], a[88:91], a[128:131], v[112:115]
    v_fmac_f32 v64, v156, v32
    v_fmac_f32 v65, v157, v32
    v_mfma_f32_16x16x32_bf16 v[112:115], a[92:95], a[132:135], v[112:115]
    v_fmac_f32 v66, v158, v32
    v_fmac_f32 v67, v159, v32
    v_mfma_f32_16x16x32_bf16 v[116:119], a[96:99], a[128:131], v[116:119]
    v_fmac_f32 v68, v160, v32
    v_mfma_f32_16x16x32_bf16 v[116:119], a[100:103], a[132:135], v[116:119]
    v_fmac_f32 v69, v161, v32
    v_mfma_f32_16x16x32_bf16 v[120:123], a[72:75], a[136:139], v[120:123]
    v_fmac_f32 v70, v162, v32
    v_mfma_f32_16x16x32_bf16 v[120:123], a[76:79], a[140:143], v[120:123]
    s_waitcnt vmcnt(1)
    v_fmac_f32 v71, v163, v32
    s_barrier
    v_mfma_f32_16x16x32_bf16 v[124:127], a[80:83], a[136:139], v[124:127]
    ds_read_b64_tr_b16 a[104:105], v24 offset:36864
    ds_read_b64_tr_b16 a[106:107], v24 offset:38144
    v_mfma_f32_16x16x32_bf16 v[124:127], a[84:87], a[140:143], v[124:127]
    ds_read_b64_tr_b16 a[108:109], v24 offset:47104
    v_mfma_f32_16x16x32_bf16 v[128:131], a[88:91], a[136:139], v[128:131]
    ds_read_b64_tr_b16 a[110:111], v24 offset:48384
    v_mfma_f32_16x16x32_bf16 v[128:131], a[92:95], a[140:143], v[128:131]
    ds_read_b128 a[144:147], v22 offset:36864
    v_fmac_f32 v72, v148, v36
    v_fmac_f32 v73, v149, v36
    v_mfma_f32_16x16x32_bf16 v[132:135], a[96:99], a[136:139], v[132:135]
    ds_read_b128 a[148:151], v23 offset:36864
    v_fmac_f32 v74, v150, v36
    v_fmac_f32 v75, v151, v36
    v_mfma_f32_16x16x32_bf16 v[132:135], a[100:103], a[140:143], v[132:135]
    s_waitcnt lgkmcnt(6)
    ds_read_b128 a[152:155], v22 offset:38912
    v_fmac_f32 v76, v152, v36
    v_fmac_f32 v77, v153, v36
    v_mfma_f32_16x16x32_bf16 v[56:59], a[0:3], a[32:35], v[56:59]
    ds_read_b128 a[156:159], v23 offset:38912
    v_fmac_f32 v78, v154, v36
    v_fmac_f32 v79, v155, v36
    v_mfma_f32_16x16x32_bf16 v[56:59], a[4:7], a[36:39], v[56:59]
    ds_read_b128 a[160:163], v22 offset:40960
    v_fmac_f32 v80, v156, v36
    v_mfma_f32_16x16x32_bf16 v[60:63], a[8:11], a[32:35], v[60:63]
    ds_read_b128 a[164:167], v23 offset:40960
    ds_read_b128 a[168:171], v22 offset:43008
    v_mfma_f32_16x16x32_bf16 v[60:63], a[12:15], a[36:39], v[60:63]
    ds_read_b128 a[172:175], v23 offset:43008
    v_fmac_f32 v81, v157, v36
    v_mfma_f32_16x16x32_bf16 v[64:67], a[16:19], a[32:35], v[64:67]
    v_fmac_f32 v82, v158, v36
    v_fmac_f32 v83, v159, v36
    v_mfma_f32_16x16x32_bf16 v[64:67], a[20:23], a[36:39], v[64:67]
    v_fmac_f32 v84, v160, v36
    v_fmac_f32 v85, v161, v36
    v_mfma_f32_16x16x32_bf16 v[68:71], a[24:27], a[32:35], v[68:71]
    ds_read_b64_tr_b16 a[40:41], v25 offset:32
    ds_read_b64_tr_b16 a[42:43], v25 offset:1312
    v_mfma_f32_16x16x32_bf16 v[68:71], a[28:31], a[36:39], v[68:71]
    s_waitcnt lgkmcnt(2)
    ds_read_b64_tr_b16 a[44:45], v25 offset:10272
    v_fmac_f32 v86, v162, v36
    v_mfma_f32_16x16x32_bf16 v[56:59], a[144:147], a[104:107], v[56:59]
    ds_read_b64_tr_b16 a[46:47], v25 offset:11552
    v_fmac_f32 v87, v163, v36
    v_mfma_f32_16x16x32_bf16 v[56:59], a[148:151], a[108:111], v[56:59]
    ds_read_b64_tr_b16 a[112:113], v25 offset:36896
    v_fmac_f32 v88, v148, v40
    v_fmac_f32 v89, v149, v40
    v_mfma_f32_16x16x32_bf16 v[60:63], a[152:155], a[104:107], v[60:63]
    ds_read_b64_tr_b16 a[114:115], v25 offset:38176
    v_fmac_f32 v90, v150, v40
    v_fmac_f32 v91, v151, v40
    v_mfma_f32_16x16x32_bf16 v[60:63], a[156:159], a[108:111], v[60:63]
    ds_read_b64_tr_b16 a[116:117], v25 offset:47136
    v_fmac_f32 v92, v152, v40
    v_fmac_f32 v93, v153, v40
    v_mfma_f32_16x16x32_bf16 v[64:67], a[160:163], a[104:107], v[64:67]
    ds_read_b64_tr_b16 a[118:119], v25 offset:48416
    v_fmac_f32 v94, v154, v40
    v_fmac_f32 v95, v155, v40
    v_mfma_f32_16x16x32_bf16 v[64:67], a[164:167], a[108:111], v[64:67]
    v_fmac_f32 v96, v156, v40
    v_fmac_f32 v97, v157, v40
    v_mfma_f32_16x16x32_bf16 v[68:71], a[168:171], a[104:107], v[68:71]
    v_fmac_f32 v98, v158, v40
    v_fmac_f32 v99, v159, v40
    v_mfma_f32_16x16x32_bf16 v[68:71], a[172:175], a[108:111], v[68:71]
    s_waitcnt lgkmcnt(0)
    v_fmac_f32 v100, v160, v40
    v_fmac_f32 v101, v161, v40
    v_mfma_f32_16x16x32_bf16 v[72:75], a[0:3], a[40:43], v[72:75]
    ds_read_b64_tr_b16 a[48:49], v24 offset:64
    v_fmac_f32 v102, v162, v40
    v_mfma_f32_16x16x32_bf16 v[72:75], a[4:7], a[44:47], v[72:75]
    ds_read_b64_tr_b16 a[50:51], v24 offset:1344
    v_fmac_f32 v103, v163, v40
    v_mfma_f32_16x16x32_bf16 v[72:75], a[144:147], a[112:115], v[72:75]
    ds_read_b64_tr_b16 a[52:53], v24 offset:10304
    v_fmac_f32 v104, v148, v44
    v_mfma_f32_16x16x32_bf16 v[72:75], a[148:151], a[116:119], v[72:75]
    ds_read_b64_tr_b16 a[54:55], v24 offset:11584
    v_fmac_f32 v105, v149, v44
    v_mfma_f32_16x16x32_bf16 v[76:79], a[8:11], a[40:43], v[76:79]
    ds_read_b64_tr_b16 a[120:121], v24 offset:36928
    v_fmac_f32 v106, v150, v44
    v_mul_f32 v56, v56, v164
    v_mul_f32 v57, v57, v165
    v_mul_f32 v58, v58, v166
    v_mul_f32 v59, v59, v167
    v_mfma_f32_16x16x32_bf16 v[76:79], a[12:15], a[44:47], v[76:79]
    ds_read_b64_tr_b16 a[122:123], v24 offset:38208
    v_fmac_f32 v107, v151, v44
    v_mul_f32 v60, v60, v168
    v_mul_f32 v61, v61, v169
    v_mul_f32 v62, v62, v170
    v_mfma_f32_16x16x32_bf16 v[76:79], a[152:155], a[112:115], v[76:79]
    ds_read_b64_tr_b16 a[124:125], v24 offset:47168
    v_mul_f32 v63, v63, v171
    v_cvt_pk_bf16_f32 v180, v56, v57
    v_cvt_pk_bf16_f32 v182, v60, v61
    v_cvt_pk_bf16_f32 v181, v58, v59
    v_mfma_f32_16x16x32_bf16 v[76:79], a[156:159], a[116:119], v[76:79]
    ds_read_b64_tr_b16 a[126:127], v24 offset:48448
    v_cvt_pk_bf16_f32 v183, v62, v63
    v_permlane32_swap_b32 v180, v182
    v_nop
    v_permlane32_swap_b32 v181, v183
    v_mfma_f32_16x16x32_bf16 v[80:83], a[16:19], a[40:43], v[80:83]
    buffer_store_dwordx4 v[180:183], v26, s[4:7], s46 offen offset:0 sc1
    v_fmac_f32 v108, v152, v44
    v_mul_f32 v64, v64, v172
    v_mfma_f32_16x16x32_bf16 v[80:83], a[20:23], a[44:47], v[80:83]
    v_fmac_f32 v109, v153, v44
    v_mul_f32 v65, v65, v173
    v_mul_f32 v66, v66, v174
    v_mfma_f32_16x16x32_bf16 v[80:83], a[160:163], a[112:115], v[80:83]
    v_fmac_f32 v110, v154, v44
    v_mul_f32 v67, v67, v175
    v_mul_f32 v68, v68, v176
    v_mfma_f32_16x16x32_bf16 v[80:83], a[164:167], a[116:119], v[80:83]
    v_fmac_f32 v111, v155, v44
    v_mul_f32 v69, v69, v177
    v_mul_f32 v70, v70, v178
    v_mfma_f32_16x16x32_bf16 v[84:87], a[24:27], a[40:43], v[84:87]
    v_fmac_f32 v112, v156, v44
    v_mul_f32 v71, v71, v179
    v_cvt_pk_bf16_f32 v184, v64, v65
    v_mfma_f32_16x16x32_bf16 v[84:87], a[28:31], a[44:47], v[84:87]
    v_fmac_f32 v113, v157, v44
    v_cvt_pk_bf16_f32 v186, v68, v69
    v_cvt_pk_bf16_f32 v185, v66, v67
    v_mfma_f32_16x16x32_bf16 v[84:87], a[168:171], a[112:115], v[84:87]
    v_fmac_f32 v114, v158, v44
    v_cvt_pk_bf16_f32 v187, v70, v71
    v_permlane32_swap_b32 v184, v186
    v_mfma_f32_16x16x32_bf16 v[84:87], a[172:175], a[116:119], v[84:87]
    s_waitcnt lgkmcnt(0)
    v_fmac_f32 v115, v159, v44
    v_nop
    v_permlane32_swap_b32 v185, v187
    v_mfma_f32_16x16x32_bf16 v[88:91], a[0:3], a[48:51], v[88:91]
    ds_read_b64_tr_b16 a[56:57], v25 offset:96
    buffer_store_dwordx4 v[184:187], v26, s[4:7], s47 offen offset:0 sc1
    v_mul_f32 v72, v72, v164
    v_mfma_f32_16x16x32_bf16 v[88:91], a[4:7], a[52:55], v[88:91]
    ds_read_b64_tr_b16 a[58:59], v25 offset:1376
    v_mul_f32 v73, v73, v165
    v_mul_f32 v74, v74, v166
    v_mfma_f32_16x16x32_bf16 v[88:91], a[144:147], a[120:123], v[88:91]
    ds_read_b64_tr_b16 a[60:61], v25 offset:10336
    v_mul_f32 v75, v75, v167
    v_mul_f32 v76, v76, v168
    v_mfma_f32_16x16x32_bf16 v[88:91], a[148:151], a[124:127], v[88:91]
    ds_read_b64_tr_b16 a[62:63], v25 offset:11616
    v_mul_f32 v77, v77, v169
    v_mul_f32 v78, v78, v170
    v_mfma_f32_16x16x32_bf16 v[92:95], a[8:11], a[48:51], v[92:95]
    ds_read_b64_tr_b16 a[128:129], v25 offset:36960
    v_mul_f32 v79, v79, v171
    v_cvt_pk_bf16_f32 v188, v72, v73
    v_mfma_f32_16x16x32_bf16 v[92:95], a[12:15], a[52:55], v[92:95]
    ds_read_b64_tr_b16 a[130:131], v25 offset:38240
    v_cvt_pk_bf16_f32 v190, v76, v77
    v_cvt_pk_bf16_f32 v189, v74, v75
    v_mfma_f32_16x16x32_bf16 v[92:95], a[152:155], a[120:123], v[92:95]
    ds_read_b64_tr_b16 a[132:133], v25 offset:47200
    v_cvt_pk_bf16_f32 v191, v78, v79
    v_permlane32_swap_b32 v188, v190
    v_mfma_f32_16x16x32_bf16 v[92:95], a[156:159], a[124:127], v[92:95]
    ds_read_b64_tr_b16 a[134:135], v25 offset:48480
    v_nop
    v_permlane32_swap_b32 v189, v191
    v_mfma_f32_16x16x32_bf16 v[96:99], a[16:19], a[48:51], v[96:99]
    buffer_store_dwordx4 v[188:191], v26, s[4:7], s46 offen offset:256 sc1
    v_fmac_f32 v116, v160, v44
    v_mul_f32 v80, v80, v172
    v_mfma_f32_16x16x32_bf16 v[96:99], a[20:23], a[52:55], v[96:99]
    v_fmac_f32 v117, v161, v44
    v_mul_f32 v81, v81, v173
    v_mul_f32 v82, v82, v174
    v_mul_f32 v83, v83, v175
    v_mfma_f32_16x16x32_bf16 v[96:99], a[160:163], a[120:123], v[96:99]
    v_fmac_f32 v118, v162, v44
    v_mul_f32 v84, v84, v176
    v_mul_f32 v85, v85, v177
    v_mul_f32 v86, v86, v178
    v_mfma_f32_16x16x32_bf16 v[96:99], a[164:167], a[124:127], v[96:99]
    v_fmac_f32 v119, v163, v44
    v_mul_f32 v87, v87, v179
    v_cvt_pk_bf16_f32 v192, v80, v81
    v_cvt_pk_bf16_f32 v194, v84, v85
    v_mfma_f32_16x16x32_bf16 v[100:103], a[24:27], a[48:51], v[100:103]
    v_fmac_f32 v120, v148, v48
    v_fmac_f32 v121, v149, v48
    v_cvt_pk_bf16_f32 v193, v82, v83
    v_cvt_pk_bf16_f32 v195, v86, v87
    v_mfma_f32_16x16x32_bf16 v[100:103], a[28:31], a[52:55], v[100:103]
    v_fmac_f32 v122, v150, v48
    v_fmac_f32 v123, v151, v48
    v_permlane32_swap_b32 v192, v194
    v_mfma_f32_16x16x32_bf16 v[100:103], a[168:171], a[120:123], v[100:103]
    v_fmac_f32 v124, v152, v48
    v_fmac_f32 v125, v153, v48
    v_nop
    v_mfma_f32_16x16x32_bf16 v[100:103], a[172:175], a[124:127], v[100:103]
    s_waitcnt lgkmcnt(0)
    v_fmac_f32 v126, v154, v48
    v_fmac_f32 v127, v155, v48
    v_permlane32_swap_b32 v193, v195
    v_mfma_f32_16x16x32_bf16 v[104:107], a[0:3], a[56:59], v[104:107]
    ds_read_b64_tr_b16 a[64:65], v24 offset:128
    buffer_store_dwordx4 v[192:195], v26, s[4:7], s47 offen offset:256 sc1
    v_fmac_f32 v128, v156, v48
    v_mfma_f32_16x16x32_bf16 v[104:107], a[4:7], a[60:63], v[104:107]
    ds_read_b64_tr_b16 a[66:67], v24 offset:1408
    v_fmac_f32 v129, v157, v48
    v_mul_f32 v88, v88, v164
    v_mul_f32 v89, v89, v165
    v_mfma_f32_16x16x32_bf16 v[104:107], a[144:147], a[128:131], v[104:107]
    ds_read_b64_tr_b16 a[68:69], v24 offset:10368
    v_fmac_f32 v130, v158, v48
    v_mul_f32 v90, v90, v166
    v_mul_f32 v91, v91, v167
    v_mfma_f32_16x16x32_bf16 v[104:107], a[148:151], a[132:135], v[104:107]
    ds_read_b64_tr_b16 a[70:71], v24 offset:11648
    v_mul_f32 v92, v92, v168
    v_mul_f32 v93, v93, v169
    v_mul_f32 v94, v94, v170
    v_mfma_f32_16x16x32_bf16 v[108:111], a[8:11], a[56:59], v[108:111]
    ds_read_b64_tr_b16 a[136:137], v24 offset:36992
    v_mul_f32 v95, v95, v171
    v_cvt_pk_bf16_f32 v180, v88, v89
    v_mfma_f32_16x16x32_bf16 v[108:111], a[12:15], a[60:63], v[108:111]
    ds_read_b64_tr_b16 a[138:139], v24 offset:38272
    v_cvt_pk_bf16_f32 v182, v92, v93
    v_cvt_pk_bf16_f32 v181, v90, v91
    v_mfma_f32_16x16x32_bf16 v[108:111], a[152:155], a[128:131], v[108:111]
    ds_read_b64_tr_b16 a[140:141], v24 offset:47232
    v_cvt_pk_bf16_f32 v183, v94, v95
    v_permlane32_swap_b32 v180, v182
    v_mfma_f32_16x16x32_bf16 v[108:111], a[156:159], a[132:135], v[108:111]
    ds_read_b64_tr_b16 a[142:143], v24 offset:48512
    v_nop
    v_permlane32_swap_b32 v181, v183
    v_mfma_f32_16x16x32_bf16 v[112:115], a[16:19], a[56:59], v[112:115]
    buffer_store_dwordx4 v[180:183], v26, s[4:7], s46 offen offset:512 sc1
    v_fmac_f32 v131, v159, v48
    v_mfma_f32_16x16x32_bf16 v[112:115], a[20:23], a[60:63], v[112:115]
    v_fmac_f32 v132, v160, v48
    v_mul_f32 v96, v96, v172
    v_mul_f32 v97, v97, v173
    v_mfma_f32_16x16x32_bf16 v[112:115], a[160:163], a[128:131], v[112:115]
    v_fmac_f32 v133, v161, v48
    v_mul_f32 v98, v98, v174
    v_mul_f32 v99, v99, v175
    v_mfma_f32_16x16x32_bf16 v[112:115], a[164:167], a[132:135], v[112:115]
    v_fmac_f32 v134, v162, v48
    v_mul_f32 v100, v100, v176
    v_mul_f32 v101, v101, v177
    v_mfma_f32_16x16x32_bf16 v[116:119], a[24:27], a[56:59], v[116:119]
    v_fmac_f32 v135, v163, v48
    v_mul_f32 v102, v102, v178
    v_mul_f32 v103, v103, v179
    v_mfma_f32_16x16x32_bf16 v[116:119], a[28:31], a[60:63], v[116:119]
    v_cvt_pk_bf16_f32 v184, v96, v97
    v_cvt_pk_bf16_f32 v186, v100, v101
    v_cvt_pk_bf16_f32 v185, v98, v99
    v_mfma_f32_16x16x32_bf16 v[116:119], a[168:171], a[128:131], v[116:119]
    v_cvt_pk_bf16_f32 v187, v102, v103
    v_permlane32_swap_b32 v184, v186
    v_mfma_f32_16x16x32_bf16 v[116:119], a[172:175], a[132:135], v[116:119]
    s_waitcnt lgkmcnt(0)
    v_nop
    v_permlane32_swap_b32 v185, v187
    v_mfma_f32_16x16x32_bf16 v[120:123], a[0:3], a[64:67], v[120:123]
    buffer_store_dwordx4 v[184:187], v26, s[4:7], s47 offen offset:512 sc1
    v_mul_f32 v104, v104, v164
    v_mfma_f32_16x16x32_bf16 v[120:123], a[4:7], a[68:71], v[120:123]
    v_mul_f32 v105, v105, v165
    v_mul_f32 v106, v106, v166
    v_mfma_f32_16x16x32_bf16 v[120:123], a[144:147], a[136:139], v[120:123]
    v_mul_f32 v107, v107, v167
    v_mul_f32 v108, v108, v168
    v_mfma_f32_16x16x32_bf16 v[120:123], a[148:151], a[140:143], v[120:123]
    v_mul_f32 v109, v109, v169
    v_mul_f32 v110, v110, v170
    v_mfma_f32_16x16x32_bf16 v[124:127], a[8:11], a[64:67], v[124:127]
    v_mul_f32 v111, v111, v171
    v_cvt_pk_bf16_f32 v188, v104, v105
    v_mfma_f32_16x16x32_bf16 v[124:127], a[12:15], a[68:71], v[124:127]
    v_cvt_pk_bf16_f32 v190, v108, v109
    v_cvt_pk_bf16_f32 v189, v106, v107
    v_mfma_f32_16x16x32_bf16 v[124:127], a[152:155], a[136:139], v[124:127]
    v_cvt_pk_bf16_f32 v191, v110, v111
    v_permlane32_swap_b32 v188, v190
    v_mfma_f32_16x16x32_bf16 v[124:127], a[156:159], a[140:143], v[124:127]
    v_nop
    v_permlane32_swap_b32 v189, v191
    v_mfma_f32_16x16x32_bf16 v[128:131], a[16:19], a[64:67], v[128:131]
    buffer_store_dwordx4 v[188:191], v26, s[4:7], s46 offen offset:768 sc1
    v_mul_f32 v112, v112, v172
    v_mfma_f32_16x16x32_bf16 v[128:131], a[20:23], a[68:71], v[128:131]
    v_mul_f32 v113, v113, v173
    v_mul_f32 v114, v114, v174
    v_mfma_f32_16x16x32_bf16 v[128:131], a[160:163], a[136:139], v[128:131]
    v_mul_f32 v115, v115, v175
    v_mul_f32 v116, v116, v176
    v_mfma_f32_16x16x32_bf16 v[128:131], a[164:167], a[140:143], v[128:131]
    v_mul_f32 v117, v117, v177
    v_mul_f32 v118, v118, v178
    v_mfma_f32_16x16x32_bf16 v[132:135], a[24:27], a[64:67], v[132:135]
    v_mul_f32 v119, v119, v179
    v_cvt_pk_bf16_f32 v192, v112, v113
    v_mfma_f32_16x16x32_bf16 v[132:135], a[28:31], a[68:71], v[132:135]
    v_cvt_pk_bf16_f32 v194, v116, v117
    v_cvt_pk_bf16_f32 v193, v114, v115
    v_mfma_f32_16x16x32_bf16 v[132:135], a[168:171], a[136:139], v[132:135]
    v_cvt_pk_bf16_f32 v195, v118, v119
    v_permlane32_swap_b32 v192, v194
    v_mfma_f32_16x16x32_bf16 v[132:135], a[172:175], a[140:143], v[132:135]
    v_nop
    v_permlane32_swap_b32 v193, v195
    buffer_store_dwordx4 v[192:195], v26, s[4:7], s47 offen offset:768 sc1
    v_pk_mul_f32 v[120:121], v[120:121], v[164:165]
    v_pk_mul_f32 v[122:123], v[122:123], v[166:167]
    v_pk_mul_f32 v[124:125], v[124:125], v[168:169]
    v_pk_mul_f32 v[126:127], v[126:127], v[170:171]
    v_cvt_pk_bf16_f32 v180, v120, v121
    v_cvt_pk_bf16_f32 v182, v124, v125
    v_cvt_pk_bf16_f32 v181, v122, v123
    v_cvt_pk_bf16_f32 v183, v126, v127
    v_permlane32_swap_b32 v180, v182
    v_nop
    v_permlane32_swap_b32 v181, v183
    buffer_store_dwordx4 v[180:183], v26, s[4:7], s46 offen offset:1024 sc1
    v_pk_mul_f32 v[128:129], v[128:129], v[172:173]
    v_pk_mul_f32 v[130:131], v[130:131], v[174:175]
    v_pk_mul_f32 v[132:133], v[132:133], v[176:177]
    v_pk_mul_f32 v[134:135], v[134:135], v[178:179]
    v_cvt_pk_bf16_f32 v184, v128, v129
    v_cvt_pk_bf16_f32 v186, v132, v133
    v_cvt_pk_bf16_f32 v185, v130, v131
    v_cvt_pk_bf16_f32 v187, v134, v135
    v_permlane32_swap_b32 v184, v186
    v_nop
    v_permlane32_swap_b32 v185, v187
    buffer_store_dwordx4 v[184:187], v26, s[4:7], s47 offen offset:1024 sc1
sequential_preLN__softmax_full_mha__glu_gated_bilinear__prompt_kernel_p1out:
    s_waitcnt vmcnt(10)
    v_or_b32 v2, s3, v2
    v_cmp_eq_u32 vcc, 0, v2
    s_nop 1
    s_cbranch_vccnz sequential_preLN__softmax_full_mha__glu_gated_bilinear__prompt_kernel_raspin
sequential_preLN__softmax_full_mha__glu_gated_bilinear__prompt_kernel_raok:
    s_barrier
    s_lshl_b32 s30, s24, 2
    s_and_b32 s36, s25, 3
    s_add_u32 s30, s30, s36
    s_lshr_b32 s31, s25, 2
    s_and_b32 s28, s30, 1
    s_bfe_u32 s36, s30, 0x10001
    s_mul_i32 s37, s36, 163840
    s_add_u32 s37, s37, s23
    s_add_u32 s26, s37, 327680
    s_mul_i32 s33, s31, 1310720
    s_lshl_b32 s36, s30, 9
    s_add_u32 s33, s33, s36
    s_lshl_b32 s36, s3, 14
    s_add_u32 s63, s33, s36
    s_add_u32 s63, s63, 1245184
    s_lshl_b32 s36, s3, 16
    s_add_u32 s33, s33, s36
    s_add_u32 s33, s33, 983040
    s_lshl_b32 s38, s31, 2
    s_add_u32 s36, s3, 0
    s_and_b32 s36, s36, 3
    s_mul_i32 s39, s36, 18432
    s_add_u32 s39, s39, 86016
sequential_preLN__softmax_full_mha__glu_gated_bilinear__prompt_kernel_pgv1:
    s_cbranch_execz sequential_preLN__softmax_full_mha__glu_gated_bilinear__prompt_kernel_wrv
    v_add_u32 v144, s39, v253
    s_add_u32 s36, s36, s38
    s_mul_i32 s36, s36, 5120
    s_add_u32 s40, s36, s37
    s_add_u32 s36, s3, 1
    s_and_b32 s36, s36, 3
    s_mul_i32 s39, s36, 18432
    s_add_u32 s39, s39, 86016
    v_add_u32 v141, s39, v253
    s_add_u32 s36, s36, s38
    s_mul_i32 s36, s36, 5120
    s_add_u32 s41, s36, s37
    s_add_u32 s36, s3, 2
    s_and_b32 s36, s36, 3
    s_mul_i32 s39, s36, 18432
    s_add_u32 s39, s39, 92160
    v_add_u32 v142, s39, v253
    s_add_u32 s36, s36, s38
    s_mul_i32 s36, s36, 5120
    s_add_u32 s42, s36, s37
    s_add_u32 s36, s3, 3
    s_and_b32 s36, s36, 3
    s_mul_i32 s39, s36, 18432
    s_add_u32 s39, s39, 98304
    v_add_u32 v143, s39, v253
    s_add_u32 s36, s36, s38
    s_mul_i32 s36, s36, 5120
    s_add_u32 s43, s36, s37
    s_mul_i32 s36, s28, 1536
    v_add_u32 v136, s36, v253
    v_and_b32 v2, 31, v1
    v_lshrrev_b32 v3, 5, v1
    s_lshl_b32 s36, s28, 3
    s_add_u32 s37, s36, 1024
    v_lshl_add_u32 v6, v2, 4, s37
    v_mul_u32_u24 v4, 2560, v3
    v_add_u32 v137, v6, v4
    v_bfe_u32 v4, v1, 4, 1
    v_lshlrev_b32 v4, 14, v4
    v_and_b32 v5, 15, v1
    v_lshl_add_u32 v4, v5, 4, v4
    v_lshl_add_u32 v139, v3, 8, v4
    v_lshrrev_b32 v4, 2, v2
    v_and_b32 v7, 1, v4
    v_lshlrev_b32 v7, 1, v7
    v_bfe_u32 v5, v4, 1, 1
    v_or_b32 v7, v7, v5
    v_and_b32 v5, 4, v4
    v_or_b32 v5, v5, v7
    v_and_b32 v4, 3, v2
    v_lshl_add_u32 v4, v5, 2, v4
    v_mul_u32_u24 v5, 1280, v3
    v_lshl_add_u32 v4, v4, 4, v5
    s_and_b32 s36, s30, 3
    s_mul_i32 s36, s36, 320
    v_add_u32 v4, s36, v4
    v_mov_b32 v5, 1073741824
    v_cmp_gt_u32 vcc, 20, v2
    s_nop 1
    v_cndmask_b32 v4, v5, v4, vcc
    s_sub_u32 s36, 28114944, s23
    v_mov_b32 v5, s36
    v_cmp_eq_u32 vcc, 20, v2
    s_nop 1
    v_cndmask_b32 v138, v4, v5, vcc
    s_mul_i32 s72, s3, 40960
    s_mov_b32 s74, s72
    s_mul_i32 s36, s3, 81920
    s_add_u32 s73, s23, s36
    s_add_u32 s73, s73, 655360
    v_mov_b32 v10, 1
    s_bfe_u32 s36, s25, 0x10002
    s_lshl_b32 s37, s36, 10
    v_add_u32 v250, s37, v253
    s_xor_b32 s36, s36, 1
    s_lshl_b32 s37, s36, 12
    v_add_u32 v251, s37, v253
    s_lshr_b32 s36, s25, 2
    s_mul_i32 s36, s36, 5120
    s_mul_i32 s44, s3, 163840
    s_add_u32 s44, s44, s36
    s_add_u32 s44, s44, 27607040
    s_mul_i32 s78, s3, 40960
    s_add_u32 s78, s78, s36
    s_add_u32 s78, s78, 28262400
    s_add_u32 s36, s3, 1
    s_and_b32 s36, s36, 3
    s_mul_i32 s36, s36, 15360
    s_add_u32 s36, s36, 86016
    v_add_u32 v242, s36, v253
    s_add_u32 s36, s3, 2
    s_and_b32 s36, s36, 3
    s_mul_i32 s36, s36, 15360
    s_add_u32 s36, s36, 91136
    v_add_u32 v243, s36, v253
    s_add_u32 s36, s3, 3
    s_and_b32 s36, s36, 3
    s_mul_i32 s36, s36, 15360
    s_add_u32 s36, s36, 96256
    v_add_u32 v244, s36, v253
    s_mul_i32 s36, s3, 15360
    s_add_u32 s36, s36, 86016
    v_add_u32 v245, s36, v253
    v_and_b32 v2, 15, v1
    v_lshrrev_b32 v3, 4, v1
    v_and_b32 v4, 1, v3
    v_mul_u32_u24 v4, 120, v4
    v_lshl_add_u32 v4, v3, 7, v4
    v_sub_u32 v199, v253, v4
    v_mul_u32_u24 v2, 1280, v2
    v_lshl_add_u32 v246, v3, 4, v2
    v_lshl_add_u32 v198, v3, 3, v2
    s_lshl_b32 s49, s24, 2
    s_and_b32 s36, s25, 3
    s_add_u32 s49, s49, s36
    s_lshl_b32 s49, s49, 2
    s_add_u32 s49, s49, s3
    s_mul_i32 s50, s49, 20480
    s_lshr_b32 s36, s25, 3
    s_mul_i32 s37, s36, 320
    s_add_u32 s51, s50, s37
    s_mul_i32 s37, s36, 5120
    s_add_u32 s50, s50, s37
    s_mul_i32 s37, s24, 983040
    s_add_u32 s50, s50, s37
    s_add_u32 s50, s50, 0
    s_bfe_u32 s36, s25, 0x10002
    s_lshl_b32 s37, s36, 9
    s_add_u32 s60, s50, s37
    s_add_u32 s60, s60, 2048
    s_lshl_b32 s37, s36, 5
    s_add_u32 s61, s51, s37
    s_add_u32 s61, s61, 128
    s_mul_i32 s37, s36, 3072
    s_add_u32 s50, s50, s37
    s_mul_i32 s37, s36, 192
    s_add_u32 s51, s51, s37
    s_lshr_b32 s36, s25, 1
    s_mul_i32 s48, s36, 7
    s_mul_i32 s47, s3, 7168
    s_lshl_b32 s36, s48, 11
    s_add_u32 s36, s36, s47
    s_lshr_b32 s37, s3, 1
    s_mul_i32 s37, s37, 206848
    s_add_u32 s36, s36, s37
    s_add_u32 s45, s36, 20971520
    s_lshl_b32 s36, s3, 5
    s_and_b32 s36, s36, 32
    s_add_u32 s36, s36, s25
    s_cmp_ge_u32 s36, 62
    s_cselect_b32 s45, 1073741824, s45
    s_lshl_b32 s75, s48, 7
    s_add_u32 s75, s75, 28426240
    v_lshlrev_b32 v146, 2, v0
    v_mul_u32_u24 v2, 12288, v1
    s_mov_b64 exec, 15
    s_waitcnt vmcnt(0)
    buffer_store_dword v10, v2, s[4:7], s62 offen sc1
    s_mov_b64 exec, -1
    s_mul_i32 s71, s3, 10240
    s_add_u32 s71, s71, 86016
    v_lshrrev_b32 v2, 4, v1
    v_bfe_u32 v3, v1, 2, 2
    v_lshl_add_u32 v2, v2, 3, v3
    v_and_b32 v3, 3, v1
    v_lshlrev_b32 v3, 4, v3
    v_lshl_add_u32 v2, v2, 6, v3
    v_add_u32 v202, s71, v2
    v_and_b32 v203, 15, v1
    v_lshlrev_b32 v203, 2, v203
    v_mov_b32 v212, 0x3f803f80
    v_mov_b32 v213, 0x3f803f80
    v_mov_b32 v214, 0x3f803f80
    v_mov_b32 v215, 0x3f803f80
    v_lshrrev_b32 v2, 2, v1
    s_mov_b32 s70, 1073741824
    s_mov_b32 s19, 0x20000
    v_mov_b32 v12, v202
    v_mov_b32 v13, v202
    s_cmp_ge_u32 s2, 108
    s_cbranch_scc1 L_rl2_14
    s_bitcmp1_b32 s3, 0
    s_cselect_b64 s[16:17], s[82:83], s[80:81]
    s_mov_b32 s18, 2211840
    s_mul_i32 s37, s2, 2428
    s_lshr_b32 s37, s37, 16
    s_mul_i32 s38, s37, 27
    s_sub_u32 s38, s2, s38
    s_lshl_b32 s38, s38, 1
    s_lshr_b32 s39, s3, 1
    s_add_u32 s38, s38, s39
    s_mul_i32 s64, s37, 552960
    s_lshl_b32 s39, s38, 6
    s_add_u32 s64, s64, s39
    s_mov_b32 s65, 55296
    s_mov_b32 s66, 55296
    s_mov_b32 s68, 2048
    s_mov_b32 s69, 219136
    s_and_b32 s39, s3, 1
    s_lshl_b32 s38, s38, 2
    s_add_u32 s38, s38, s39
    s_mul_i32 s67, s37, 1105920
    s_lshl_b32 s39, s38, 10
    s_add_u32 s67, s67, s39
    s_add_u32 s67, s67, 20971520
    s_mul_i32 s70, s37, 13824
    s_lshl_b32 s39, s38, 6
    s_add_u32 s70, s70, s39
    s_add_u32 s70, s70, 28426240
    v_mul_u32_u24 v2, 3456, v2
    s_branch L_rl_set_16
L_rl2_14:
    v_lshrrev_b32 v4, 1, v3
    v_sub_u32 v12, v202, v4
    v_add_u32 v13, 24, v12
    s_sub_u32 s37, s2, 108
    s_mov_b32 s68, 1024
    s_mov_b32 s69, 1024
    s_mul_i32 s67, s37, 40960
    s_mul_i32 s39, s3, 10240
    s_add_u32 s67, s67, s39
    s_add_u32 s67, s67, 25395200
    s_mov_b64 s[16:17], s[84:85]
    s_mov_b32 s18, 2211840
    s_lshl_b32 s64, s37, 5
    s_mov_b32 s65, 16
    s_cmp_lt_u32 s37, 54
    s_cbranch_scc1 L_rl0_15
    s_mov_b64 s[16:17], s[88:89]
    s_cmp_lt_u32 s37, 74
    s_cselect_b32 s67, s67, 1073741824
    s_cselect_b32 s18, 819200, 0
    s_sub_u32 s37, s37, 54
    s_mul_i32 s64, s37, 40
    s_mul_i32 s39, s37, 160
    s_sub_u32 s39, s39, 2544
    s_cmp_ge_u32 s37, 16
    s_cselect_b32 s64, s39, s64
    s_cselect_b32 s65, 80, 20
    s_cselect_b32 s38, 16, 0
    v_lshrrev_b32 v4, 4, v1
    v_mad_u32_u24 v2, v4, s38, v2
L_rl0_15:
    s_mul_i32 s64, s64, 1280
    s_mul_i32 s39, s3, 320
    s_add_u32 s64, s64, s39
    s_mul_i32 s65, s65, 1280
    s_sub_u32 s66, 64, s65
    v_mul_u32_u24 v2, 1280, v2
L_rl_set_16:
    v_add_u32 v201, v2, v3
    s_lshl_b32 s36, s24, 5
    s_add_u32 s36, s36, s25
    s_lshl_b32 s36, s36, 2
    s_add_u32 s36, s36, s3
    s_lshl_b32 s34, s2, 5
    s_add_u32 s34, s34, s3
    s_lshl_b32 s34, s34, 2
    s_add_u32 s34, s34, 28680192
    s_lshl_b32 s77, s24, 7
    s_add_u32 s77, s77, 28680192
    s_lshl_b32 s101, s3, 13
    s_add_u32 s101, s101, 28680192
    v_mov_b32 v11, v249
    v_and_b32 v8, 31, v1
    v_lshlrev_b32 v8, 10, v8
    s_mul_i32 s89, s36, 2560
    s_lshl_b32 s93, s36, 7
    s_and_b32 s36, s36, 127
    s_mul_i32 s79, s36, 3456
    s_mul_i32 s76, s36, 6912
    s_add_u32 s76, s76, s23
    s_mul_i32 s90, s36, 2560
    s_add_u32 s90, s90, s23
    v_min_u32 v147, 2432, v249
    v_min_u32 v249, 3328, v249
    v_mov_b32 v7, s27
    s_lshl_b32 s38, s31, 2
    s_add_u32 s38, s38, s3
    s_lshl_b32 s38, s38, 2
    s_lshr_b32 s39, s30, 3
    s_add_u32 s38, s38, s39
    s_lshl_b32 s38, s38, 5
    s_and_b32 s39, s30, 7
    s_add_u32 s38, s38, s39
    s_lshl_b32 s38, s38, 2
    s_add_u32 s38, s38, 28647424
    s_add_u32 s39, s33, 32768
    v_min_u32 v2, 23, v1
    v_lshrrev_b32 v3, 3, v2
    v_and_b32 v4, 7, v2
    v_lshlrev_b32 v3, 9, v3
    v_lshl_add_u32 v3, v4, 2, v3
    s_lshl_b32 s36, s3, 7
    s_lshr_b32 s37, s25, 3
    s_mul_i32 s37, s37, 12288
    s_add_u32 s36, s36, s37
    v_add_u32 v3, s36, v3
    s_lshr_b32 s36, s31, 1
    s_lshl_b32 s36, s36, 7
    s_and_b32 s37, s31, 1
    s_lshl_b32 s37, s37, 4
    s_add_u32 s36, s36, s37
    s_mul_i32 s37, s3, 12288
    s_add_u32 s36, s36, s37
    v_and_b32 v4, 3, v2
    v_cmp_gt_u32 vcc, 8, v2
    v_lshl_add_u32 v4, v4, 2, s36
    s_mul_i32 s59, s24, 1536
    v_cndmask_b32 v145, v3, v4, vcc
    s_add_u32 s59, s59, 28712960
    s_mul_i32 s31, s3, 14
    s_lshr_b32 s36, s25, 2
    s_mul_i32 s36, s36, 5120
    s_mul_i32 s100, s31, 40960
    s_add_u32 s100, s100, s36
    s_add_u32 s100, s100, 25395200
    s_cmp_eq_u32 s3, 3
    s_cselect_b32 s92, 1073741824, 0
    s_add_u32 s94, s92, 40960
    s_lshl_b32 s84, s49, 7
    s_add_u32 s84, s84, 28647424
    v_min_u32 v2, 39, v1
    v_mul_u32_u24 v3, 6554, v2
    v_lshrrev_b32 v3, 16, v3
    v_mul_u32_u24 v3, 39680, v3
    v_lshl_add_u32 v140, v2, 7, v3
    s_and_b32 s85, s25, 3
    s_mul_i32 s85, s85, 1280
    s_add_u32 s85, s85, s100
    s_and_b32 s56, s25, 3
    s_lshl_b32 s37, s3, 12
    s_add_u32 s37, s37, s23
    s_lshl_b32 s57, s56, 14
    s_add_u32 s57, s57, s37
    s_add_u32 s57, s57, 1245184
    s_lshl_b32 s56, s56, 16
    s_add_u32 s56, s56, s37
    s_add_u32 s56, s56, 983040
    s_add_u32 s36, s3, 0
    s_and_b32 s36, s36, 3
    s_lshl_b32 s37, s36, 14
    s_add_u32 s80, s56, s37
    s_and_b32 s37, s36, 1
    s_lshl_b32 s37, s37, 8
    s_lshr_b32 s36, s36, 1
    s_lshl_b32 s36, s36, 3
    s_add_u32 s36, s36, s37
    s_add_u32 s52, s57, s36
    s_add_u32 s36, s3, 1
    s_and_b32 s36, s36, 3
    s_lshl_b32 s37, s36, 14
    s_add_u32 s81, s56, s37
    s_and_b32 s37, s36, 1
    s_lshl_b32 s37, s37, 8
    s_lshr_b32 s36, s36, 1
    s_lshl_b32 s36, s36, 3
    s_add_u32 s36, s36, s37
    s_add_u32 s53, s57, s36
    s_add_u32 s36, s3, 2
    s_and_b32 s36, s36, 3
    s_lshl_b32 s37, s36, 14
    s_add_u32 s82, s56, s37
    s_and_b32 s37, s36, 1
    s_lshl_b32 s37, s37, 8
    s_lshr_b32 s36, s36, 1
    s_lshl_b32 s36, s36, 3
    s_add_u32 s36, s36, s37
    s_add_u32 s54, s57, s36
    s_add_u32 s36, s3, 3
    s_and_b32 s36, s36, 3
    s_lshl_b32 s37, s36, 14
    s_add_u32 s83, s56, s37
    s_and_b32 s37, s36, 1
    s_lshl_b32 s37, s37, 8
    s_lshr_b32 s36, s36, 1
    s_lshl_b32 s36, s36, 3
    s_add_u32 s36, s36, s37
    s_add_u32 s55, s57, s36
    v_lshrrev_b32 v2, 4, v1
    v_mul_u32_u24 v252, 768, v2
    v_add_u32 v252, v252, v253
sequential_preLN__softmax_full_mha__glu_gated_bilinear__prompt_kernel_p1done:
    s_mov_b32 s32, 0
    s_add_u32 s12, s4, s26
    s_addc_u32 s13, s5, 0
    s_mov_b32 s14, 163840
    s_mov_b64 exec, 0xffff0f
    s_mov_b32 s58, 200000
    buffer_load_dword v4, v145, s[4:7], s59 offen sc1
    s_mov_b64 exec, 0
    s_cmp_eq_u32 s3, 1
    s_cbranch_scc1 sequential_preLN__softmax_full_mha__glu_gated_bilinear__prompt_kernel_pgatt1
    s_cmp_eq_u32 s3, 2
    s_cbranch_scc1 sequential_preLN__softmax_full_mha__glu_gated_bilinear__prompt_kernel_pgatt2
    s_cmp_eq_u32 s3, 3
    s_cbranch_scc1 sequential_preLN__softmax_full_mha__glu_gated_bilinear__prompt_kernel_pgatt3
    s_branch sequential_preLN__softmax_full_mha__glu_gated_bilinear__prompt_kernel_pgatt0
sequential_preLN__softmax_full_mha__glu_gated_bilinear__prompt_kernel_wratt:
    s_mov_b64 exec, -1
    s_mov_b64 exec, 0xffff0f
    s_branch L_poll_17w
L_poll_17:
    buffer_load_dword v4, v145, s[4:7], s59 offen sc1
L_poll_17w:
    s_waitcnt vmcnt(0)
    v_cmp_eq_u32 vcc, 0, v4
    s_sub_u32 s58, s58, 1
    s_cbranch_scc1 L_pollout_18
    s_cbranch_vccz L_pollout_18
    s_sleep 1
    s_branch L_poll_17
L_pollout_18:
    s_mov_b64 exec, -1
    buffer_load_dwordx2 a[184:185], v137, s[12:15], s74 offen sc1
    s_add_u32 s74, s74, 5120
    buffer_load_dwordx4 a[136:139], v136, s[12:15], s72 offen offset:0 sc1
    buffer_load_dwordx2 a[130:131], v137, s[4:7], s41 offen sc1
    buffer_load_dwordx4 a[104:107], v136, s[4:7], s41 offen offset:0 sc1
    buffer_load_dwordx4 a[108:111], v136, s[4:7], s41 offen offset:2560 sc1
    buffer_load_dwordx2 a[132:133], v137, s[4:7], s42 offen sc1
    buffer_load_dwordx4 a[112:115], v136, s[4:7], s42 offen offset:0 sc1
    buffer_load_dwordx4 a[116:119], v136, s[4:7], s42 offen offset:2560 sc1
    buffer_load_dwordx4 a[152:155], v138, s[4:7], s73 offen offset:0 sc1
    buffer_load_dwordx4 a[156:159], v138, s[4:7], s73 offen offset:2560 sc1
    s_add_u32 s73, s73, 5120
    s_waitcnt vmcnt(5)
    v_mfma_f32_32x32x4_2b_bf16 v[16:47], a[184:185], a[130:131], 0 cbsz:1 abid:0
    buffer_load_dwordx2 a[134:135], v137, s[4:7], s43 offen sc1
    buffer_load_dwordx4 a[120:123], v136, s[4:7], s43 offen offset:0 sc1
    buffer_load_dwordx4 a[124:127], v136, s[4:7], s43 offen offset:2560 sc1
    buffer_load_dwordx2 a[128:129], v137, s[4:7], s40 offen sc1
    buffer_load_dwordx4 a[96:99], v136, s[4:7], s40 offen offset:0 sc1
    buffer_load_dwordx4 a[100:103], v136, s[4:7], s40 offen offset:2560 sc1
    s_nop 11
    v_mfma_f32_32x32x16_bf16 v[16:31], a[136:139], a[104:107], v[16:31]
    v_mfma_f32_32x32x16_bf16 v[32:47], a[136:139], a[108:111], v[32:47]
    s_waitcnt vmcnt(8)
    s_nop 9
    v_mfma_f32_32x32x4_2b_bf16 v[48:79], a[184:185], a[132:133], 0 cbsz:1 abid:0
    v_exp_f32 v96, v16
    v_exp_f32 v97, v17
    v_exp_f32 v98, v18
    v_exp_f32 v99, v19
    v_cvt_pk_bf16_f32 v80, v96, v97
    v_cvt_pk_bf16_f32 v81, v98, v99
    v_exp_f32 v100, v20
    v_exp_f32 v101, v21
    v_exp_f32 v102, v22
    v_exp_f32 v103, v23
    s_waitcnt vmcnt(7)
    buffer_load_dwordx4 a[140:143], v136, s[12:15], s72 offen offset:2560 sc1
    v_cvt_pk_bf16_f32 v82, v100, v101
    v_cvt_pk_bf16_f32 v83, v102, v103
    v_exp_f32_e64 v96, v24
    v_exp_f32 v97, v25
    v_exp_f32 v98, v26
    v_exp_f32 v99, v27
    v_mfma_f32_32x32x16_bf16 a[0:15], a[152:155], v[80:83], 0
    s_add_u32 s72, s72, 5120
    v_cvt_pk_bf16_f32 v84, v96, v97
    v_cvt_pk_bf16_f32 v85, v98, v99
    v_exp_f32 v100, v28
    v_exp_f32 v101, v29
    v_exp_f32 v102, v30
    v_exp_f32 v103, v31
    v_mfma_f32_32x32x16_bf16 v[48:63], a[136:139], a[112:115], v[48:63]
    buffer_load_dwordx4 a[160:163], v138, s[4:7], s73 offen offset:0 sc1
    v_cvt_pk_bf16_f32 v86, v100, v101
    v_cvt_pk_bf16_f32 v87, v102, v103
    v_exp_f32 v96, v32
    v_exp_f32 v97, v33
    v_exp_f32 v98, v34
    v_exp_f32 v99, v35
    v_mfma_f32_32x32x16_bf16 v[64:79], a[136:139], a[116:119], v[64:79]
    s_waitcnt vmcnt(8)
    v_cvt_pk_bf16_f32 v88, v96, v97
    v_cvt_pk_bf16_f32 v89, v98, v99
    v_exp_f32_e64 v100, v36
    v_exp_f32 v101, v37
    v_exp_f32 v102, v38
    v_exp_f32 v103, v39
    v_mfma_f32_32x32x16_bf16 a[0:15], a[156:159], v[84:87], a[0:15]
    v_cvt_pk_bf16_f32 v90, v100, v101
    v_cvt_pk_bf16_f32 v91, v102, v103
    v_exp_f32 v96, v40
    v_exp_f32 v97, v41
    v_exp_f32 v98, v42
    v_exp_f32 v99, v43
    v_mfma_f32_32x32x16_bf16 a[16:31], a[152:155], v[88:91], 0
    s_waitcnt vmcnt(5)
    v_cvt_pk_bf16_f32 v92, v96, v97
    v_cvt_pk_bf16_f32 v93, v98, v99
    v_exp_f32_e64 v100, v44
    v_exp_f32 v101, v45
    v_exp_f32 v102, v46
    v_exp_f32 v103, v47
    v_mfma_f32_32x32x4_2b_bf16 v[16:47], a[184:185], a[134:135], 0 cbsz:1 abid:0
    v_cvt_pk_bf16_f32 v94, v100, v101
    v_cvt_pk_bf16_f32 v95, v102, v103
    v_exp_f32 v96, v48
    v_exp_f32 v97, v49
    v_exp_f32 v98, v50
    v_exp_f32 v99, v51
    v_cvt_pk_bf16_f32 v80, v96, v97
    v_cvt_pk_bf16_f32 v81, v98, v99
    v_exp_f32 v100, v52
    v_exp_f32 v101, v53
    v_exp_f32 v102, v54
    v_exp_f32 v103, v55
    v_mfma_f32_32x32x16_bf16 a[16:31], a[156:159], v[92:95], a[16:31]
    buffer_load_dwordx4 a[164:167], v138, s[4:7], s73 offen offset:2560 sc1
    v_cvt_pk_bf16_f32 v82, v100, v101
    v_cvt_pk_bf16_f32 v83, v102, v103
    v_exp_f32 v96, v56
    v_exp_f32 v97, v57
    v_exp_f32 v98, v58
    v_exp_f32 v99, v59
    v_mfma_f32_32x32x16_bf16 a[32:47], a[152:155], v[80:83], 0
    s_add_u32 s73, s73, 5120
    v_cvt_pk_bf16_f32 v84, v96, v97
    v_cvt_pk_bf16_f32 v85, v98, v99
    v_exp_f32 v100, v60
    v_exp_f32 v101, v61
    v_exp_f32 v102, v62
    v_exp_f32 v103, v63
    v_mfma_f32_32x32x16_bf16 v[16:31], a[136:139], a[120:123], v[16:31]
    buffer_load_dwordx2 a[186:187], v137, s[12:15], s74 offen sc1
    v_cvt_pk_bf16_f32 v86, v100, v101
    v_cvt_pk_bf16_f32 v87, v102, v103
    v_exp_f32 v96, v64
    v_exp_f32 v97, v65
    v_exp_f32 v98, v66
    v_exp_f32 v99, v67
    v_mfma_f32_32x32x16_bf16 v[32:47], a[136:139], a[124:127], v[32:47]
    s_add_u32 s74, s74, 5120
    v_cvt_pk_bf16_f32 v88, v96, v97
    v_cvt_pk_bf16_f32 v89, v98, v99
    v_exp_f32 v100, v68
    v_exp_f32 v101, v69
    v_exp_f32 v102, v70
    v_exp_f32 v103, v71
    v_mfma_f32_32x32x16_bf16 a[32:47], a[156:159], v[84:87], a[32:47]
    v_cvt_pk_bf16_f32 v90, v100, v101
    v_cvt_pk_bf16_f32 v91, v102, v103
    v_exp_f32 v96, v72
    v_exp_f32 v97, v73
    v_exp_f32 v98, v74
    v_exp_f32 v99, v75
    v_mfma_f32_32x32x16_bf16 a[48:63], a[152:155], v[88:91], 0
    s_waitcnt vmcnt(4)
    v_cvt_pk_bf16_f32 v92, v96, v97
    v_cvt_pk_bf16_f32 v93, v98, v99
    v_exp_f32_e64 v100, v76
    v_exp_f32 v101, v77
    v_exp_f32 v102, v78
    v_exp_f32 v103, v79
    v_mfma_f32_32x32x4_2b_bf16 v[48:79], a[184:185], a[128:129], 0 cbsz:1 abid:0
    v_cvt_pk_bf16_f32 v94, v100, v101
    v_cvt_pk_bf16_f32 v95, v102, v103
    v_exp_f32 v96, v16
    v_exp_f32 v97, v17
    v_exp_f32 v98, v18
    v_exp_f32 v99, v19
    v_cvt_pk_bf16_f32 v80, v96, v97
    v_cvt_pk_bf16_f32 v81, v98, v99
    v_exp_f32 v100, v20
    v_exp_f32 v101, v21
    v_exp_f32 v102, v22
    v_exp_f32 v103, v23
    v_mfma_f32_32x32x16_bf16 a[48:63], a[156:159], v[92:95], a[48:63]
    buffer_load_dwordx4 a[144:147], v136, s[12:15], s72 offen offset:0 sc1
    v_cvt_pk_bf16_f32 v82, v100, v101
    v_cvt_pk_bf16_f32 v83, v102, v103
    v_exp_f32 v96, v24
    v_exp_f32 v97, v25
    v_exp_f32 v98, v26
    v_exp_f32 v99, v27
    v_mfma_f32_32x32x16_bf16 a[64:79], a[152:155], v[80:83], 0
    v_cvt_pk_bf16_f32 v84, v96, v97
    v_cvt_pk_bf16_f32 v85, v98, v99
    v_exp_f32 v100, v28
    v_exp_f32 v101, v29
    v_exp_f32 v102, v30
    v_exp_f32 v103, v31
    v_mfma_f32_32x32x16_bf16 v[48:63], a[136:139], a[96:99], v[48:63]
    buffer_load_dwordx4 a[168:171], v138, s[4:7], s73 offen offset:0 sc1
    v_cvt_pk_bf16_f32 v86, v100, v101
    v_cvt_pk_bf16_f32 v87, v102, v103
    v_exp_f32 v96, v32
    v_exp_f32 v97, v33
    v_exp_f32 v98, v34
    v_exp_f32 v99, v35
    v_mfma_f32_32x32x16_bf16 v[64:79], a[136:139], a[100:103], v[64:79]
    v_cvt_pk_bf16_f32 v88, v96, v97
    v_cvt_pk_bf16_f32 v89, v98, v99
    v_exp_f32 v100, v36
    v_exp_f32 v101, v37
    v_exp_f32 v102, v38
    v_exp_f32 v103, v39
    v_mfma_f32_32x32x16_bf16 a[64:79], a[156:159], v[84:87], a[64:79]
    v_cvt_pk_bf16_f32 v90, v100, v101
    v_cvt_pk_bf16_f32 v91, v102, v103
    v_exp_f32 v96, v40
    v_exp_f32 v97, v41
    v_exp_f32 v98, v42
    v_exp_f32 v99, v43
    v_mfma_f32_32x32x16_bf16 a[80:95], a[152:155], v[88:91], 0
    v_cvt_pk_bf16_f32 v92, v96, v97
    v_cvt_pk_bf16_f32 v93, v98, v99
    v_exp_f32 v100, v44
    v_exp_f32 v101, v45
    v_exp_f32 v102, v46
    v_exp_f32 v103, v47
    v_mfma_f32_32x32x4_2b_bf16 v[16:47], a[184:185], a[130:131], 0 cbsz:1 abid:1
    v_cvt_pk_bf16_f32 v94, v100, v101
    v_cvt_pk_bf16_f32 v95, v102, v103
    v_exp_f32 v96, v48
    v_exp_f32 v97, v49
    v_exp_f32 v98, v50
    v_exp_f32 v99, v51
    v_cvt_pk_bf16_f32 v80, v96, v97
    v_cvt_pk_bf16_f32 v81, v98, v99
    v_exp_f32 v100, v52
    v_exp_f32 v101, v53
    v_exp_f32 v102, v54
    v_exp_f32 v103, v55
    v_mfma_f32_32x32x16_bf16 a[80:95], a[156:159], v[92:95], a[80:95]
    buffer_load_dwordx4 a[172:175], v138, s[4:7], s73 offen offset:2560 sc1
    v_cvt_pk_bf16_f32 v82, v100, v101
    v_cvt_pk_bf16_f32 v83, v102, v103
    v_exp_f32 v96, v56
    v_exp_f32 v97, v57
    v_exp_f32 v98, v58
    v_exp_f32 v99, v59
    v_mfma_f32_32x32x16_bf16 v[104:119], a[152:155], v[80:83], 0
    s_waitcnt vmcnt(6)
    v_cvt_pk_bf16_f32 v84, v96, v97
    v_cvt_pk_bf16_f32 v85, v98, v99
    v_exp_f32_e64 v100, v60
    v_exp_f32 v101, v61
    v_exp_f32 v102, v62
    v_exp_f32 v103, v63
    v_mfma_f32_32x32x16_bf16 v[16:31], a[140:143], a[104:107], v[16:31]
    s_add_u32 s73, s73, 5120
    buffer_load_dwordx4 a[148:151], v136, s[12:15], s72 offen offset:2560 sc1
    v_cvt_pk_bf16_f32 v86, v100, v101
    v_cvt_pk_bf16_f32 v87, v102, v103
    v_exp_f32 v96, v64
    v_exp_f32 v97, v65
    v_exp_f32 v98, v66
    v_exp_f32 v99, v67
    v_mfma_f32_32x32x16_bf16 v[32:47], a[140:143], a[108:111], v[32:47]
    s_add_u32 s72, s72, 5120
    v_cvt_pk_bf16_f32 v88, v96, v97
    v_cvt_pk_bf16_f32 v89, v98, v99
    v_exp_f32 v100, v68
    v_exp_f32 v101, v69
    v_exp_f32 v102, v70
    v_exp_f32 v103, v71
    v_mfma_f32_32x32x16_bf16 v[104:119], a[156:159], v[84:87], v[104:119]
    v_cvt_pk_bf16_f32 v90, v100, v101
    v_cvt_pk_bf16_f32 v91, v102, v103
    v_exp_f32 v96, v72
    v_exp_f32 v97, v73
    v_exp_f32 v98, v74
    v_exp_f32 v99, v75
    v_mfma_f32_32x32x16_bf16 v[120:135], a[152:155], v[88:91], 0
    v_cvt_pk_bf16_f32 v92, v96, v97
    v_cvt_pk_bf16_f32 v93, v98, v99
    v_exp_f32 v100, v76
    v_exp_f32 v101, v77
    v_exp_f32 v102, v78
    v_exp_f32 v103, v79
    v_mfma_f32_32x32x4_2b_bf16 v[48:79], a[184:185], a[132:133], 0 cbsz:1 abid:1
    v_cvt_pk_bf16_f32 v94, v100, v101
    v_cvt_pk_bf16_f32 v95, v102, v103
    v_exp_f32 v96, v16
    v_exp_f32 v97, v17
    v_exp_f32 v98, v18
    v_exp_f32 v99, v19
    v_cvt_pk_bf16_f32 v80, v96, v97
    v_cvt_pk_bf16_f32 v81, v98, v99
    v_exp_f32 v100, v20
    v_exp_f32 v101, v21
    v_exp_f32 v102, v22
    v_exp_f32 v103, v23
    v_mfma_f32_32x32x16_bf16 v[120:135], a[156:159], v[92:95], v[120:135]
    s_waitcnt vmcnt(6)
    buffer_load_dwordx4 a[176:179], v138, s[4:7], s73 offen offset:0 sc1
    v_cvt_pk_bf16_f32 v82, v100, v101
    v_cvt_pk_bf16_f32 v83, v102, v103
    v_exp_f32_e64 v96, v24
    v_exp_f32 v97, v25
    v_exp_f32 v98, v26
    v_exp_f32 v99, v27
    v_mfma_f32_32x32x16_bf16 a[0:15], a[160:163], v[80:83], a[0:15]
    v_cvt_pk_bf16_f32 v84, v96, v97
    v_cvt_pk_bf16_f32 v85, v98, v99
    v_exp_f32 v100, v28
    v_exp_f32 v101, v29
    v_exp_f32 v102, v30
    v_exp_f32 v103, v31
    v_mfma_f32_32x32x16_bf16 v[48:63], a[140:143], a[112:115], v[48:63]
    buffer_load_dwordx4 a[180:183], v138, s[4:7], s73 offen offset:2560 sc1
    v_cvt_pk_bf16_f32 v86, v100, v101
    v_cvt_pk_bf16_f32 v87, v102, v103
    v_exp_f32 v96, v32
    v_exp_f32 v97, v33
    v_exp_f32 v98, v34
    v_exp_f32 v99, v35
    v_mfma_f32_32x32x16_bf16 v[64:79], a[140:143], a[116:119], v[64:79]
    s_waitcnt vmcnt(7)
    v_cvt_pk_bf16_f32 v88, v96, v97
    v_cvt_pk_bf16_f32 v89, v98, v99
    v_exp_f32_e64 v100, v36
    v_exp_f32 v101, v37
    v_exp_f32 v102, v38
    v_exp_f32 v103, v39
    v_mfma_f32_32x32x16_bf16 a[0:15], a[164:167], v[84:87], a[0:15]
    s_add_u32 s73, s73, 5120
    v_cvt_pk_bf16_f32 v90, v100, v101
    v_cvt_pk_bf16_f32 v91, v102, v103
    v_exp_f32 v96, v40
    v_exp_f32 v97, v41
    v_exp_f32 v98, v42
    v_exp_f32 v99, v43
    v_mfma_f32_32x32x16_bf16 a[16:31], a[160:163], v[88:91], a[16:31]
    v_cvt_pk_bf16_f32 v92, v96, v97
    v_cvt_pk_bf16_f32 v93, v98, v99
    v_exp_f32 v100, v44
    v_exp_f32 v101, v45
    v_exp_f32 v102, v46
    v_exp_f32 v103, v47
    v_mfma_f32_32x32x4_2b_bf16 v[16:47], a[184:185], a[134:135], 0 cbsz:1 abid:1
    v_cvt_pk_bf16_f32 v94, v100, v101
sequential_preLN__softmax_full_mha__glu_gated_bilinear__prompt_kernel_pgatt0:
    s_cbranch_execz sequential_preLN__softmax_full_mha__glu_gated_bilinear__prompt_kernel_pgatt4
    v_cvt_pk_bf16_f32 v95, v102, v103
    v_exp_f32 v96, v48
    v_exp_f32 v97, v49
    v_exp_f32 v98, v50
    v_exp_f32 v99, v51
    v_cvt_pk_bf16_f32 v80, v96, v97
    v_cvt_pk_bf16_f32 v81, v98, v99
    v_exp_f32 v100, v52
    v_exp_f32 v101, v53
    v_exp_f32 v102, v54
    v_exp_f32 v103, v55
    v_mfma_f32_32x32x16_bf16 a[16:31], a[164:167], v[92:95], a[16:31]
    buffer_load_dwordx4 a[136:139], v136, s[12:15], s72 offen offset:0 sc1
    v_cvt_pk_bf16_f32 v82, v100, v101
    v_cvt_pk_bf16_f32 v83, v102, v103
    v_exp_f32 v96, v56
    v_exp_f32 v97, v57
    v_exp_f32 v98, v58
    v_exp_f32 v99, v59
    v_mfma_f32_32x32x16_bf16 a[32:47], a[160:163], v[80:83], a[32:47]
    s_add_u32 m0, s71, 0
    v_cvt_pk_bf16_f32 v84, v96, v97
    v_cvt_pk_bf16_f32 v85, v98, v99
    v_exp_f32_e64 v100, v60
    v_exp_f32 v101, v61
    v_exp_f32 v102, v62
    v_exp_f32 v103, v63
    v_mfma_f32_32x32x16_bf16 v[16:31], a[140:143], a[120:123], v[16:31]
    s_add_u32 s64, s64, 0
    buffer_load_dwordx4 v201, s[16:19], s64 offen lds
    v_cvt_pk_bf16_f32 v86, v100, v101
    v_cvt_pk_bf16_f32 v87, v102, v103
    v_exp_f32_e64 v96, v64
    v_exp_f32 v97, v65
    v_exp_f32 v98, v66
    v_exp_f32 v99, v67
    v_mfma_f32_32x32x16_bf16 v[32:47], a[140:143], a[124:127], v[32:47]
    v_cvt_pk_bf16_f32 v88, v96, v97
    v_cvt_pk_bf16_f32 v89, v98, v99
    v_exp_f32 v100, v68
    v_exp_f32 v101, v69
    v_exp_f32 v102, v70
    v_exp_f32 v103, v71
    v_mfma_f32_32x32x16_bf16 a[32:47], a[164:167], v[84:87], a[32:47]
    v_cvt_pk_bf16_f32 v90, v100, v101
    v_cvt_pk_bf16_f32 v91, v102, v103
    v_exp_f32 v96, v72
    v_exp_f32 v97, v73
    v_exp_f32 v98, v74
    v_exp_f32 v99, v75
    v_mfma_f32_32x32x16_bf16 a[48:63], a[160:163], v[88:91], a[48:63]
    v_cvt_pk_bf16_f32 v92, v96, v97
    v_cvt_pk_bf16_f32 v93, v98, v99
    v_exp_f32 v100, v76
    v_exp_f32 v101, v77
    v_exp_f32 v102, v78
    v_exp_f32 v103, v79
    v_mfma_f32_32x32x4_2b_bf16 v[48:79], a[184:185], a[128:129], 0 cbsz:1 abid:1
    v_cvt_pk_bf16_f32 v94, v100, v101
    v_cvt_pk_bf16_f32 v95, v102, v103
    v_exp_f32 v96, v16
    v_exp_f32 v97, v17
    v_exp_f32 v98, v18
    v_exp_f32 v99, v19
    v_cvt_pk_bf16_f32 v80, v96, v97
    v_cvt_pk_bf16_f32 v81, v98, v99
    v_exp_f32 v100, v20
    v_exp_f32 v101, v21
    v_exp_f32 v102, v22
    v_exp_f32 v103, v23
    v_mfma_f32_32x32x16_bf16 a[48:63], a[164:167], v[92:95], a[48:63]
    buffer_load_dwordx4 a[152:155], v138, s[4:7], s73 offen offset:0 sc1
    v_cvt_pk_bf16_f32 v82, v100, v101
    v_cvt_pk_bf16_f32 v83, v102, v103
    v_exp_f32 v96, v24
    v_exp_f32 v97, v25
    v_exp_f32 v98, v26
    v_exp_f32 v99, v27
    v_mfma_f32_32x32x16_bf16 a[64:79], a[160:163], v[80:83], a[64:79]
    v_cvt_pk_bf16_f32 v84, v96, v97
    v_cvt_pk_bf16_f32 v85, v98, v99
    v_exp_f32 v100, v28
    v_exp_f32 v101, v29
    v_exp_f32 v102, v30
    v_exp_f32 v103, v31
    v_mfma_f32_32x32x16_bf16 v[48:63], a[140:143], a[96:99], v[48:63]
    buffer_load_dwordx2 a[184:185], v137, s[12:15], s74 offen sc1
    v_cvt_pk_bf16_f32 v86, v100, v101
    v_cvt_pk_bf16_f32 v87, v102, v103
    v_exp_f32 v96, v32
    v_exp_f32 v97, v33
    v_exp_f32 v98, v34
    v_exp_f32 v99, v35
    v_mfma_f32_32x32x16_bf16 v[64:79], a[140:143], a[100:103], v[64:79]
    s_add_u32 s74, s74, 5120
    v_cvt_pk_bf16_f32 v88, v96, v97
    v_cvt_pk_bf16_f32 v89, v98, v99
    v_exp_f32 v100, v36
    v_exp_f32 v101, v37
    v_exp_f32 v102, v38
    v_exp_f32 v103, v39
    v_mfma_f32_32x32x16_bf16 a[64:79], a[164:167], v[84:87], a[64:79]
    s_add_u32 m0, s71, 1024
    v_cvt_pk_bf16_f32 v90, v100, v101
    v_cvt_pk_bf16_f32 v91, v102, v103
    v_exp_f32 v96, v40
    v_exp_f32 v97, v41
    v_exp_f32 v98, v42
    v_exp_f32 v99, v43
    v_mfma_f32_32x32x16_bf16 a[80:95], a[160:163], v[88:91], a[80:95]
    s_waitcnt vmcnt(10)
    s_add_u32 s64, s64, s65
    buffer_load_dwordx4 v201, s[16:19], s64 offen lds
    v_cvt_pk_bf16_f32 v92, v96, v97
    v_cvt_pk_bf16_f32 v93, v98, v99
    v_exp_f32 v100, v44
    v_exp_f32 v101, v45
    v_exp_f32 v102, v46
    v_exp_f32 v103, v47
    v_mfma_f32_32x32x4_2b_bf16 v[16:47], a[186:187], a[130:131], 0 cbsz:1 abid:0
    v_cvt_pk_bf16_f32 v94, v100, v101
    v_cvt_pk_bf16_f32 v95, v102, v103
    v_exp_f32 v96, v48
    v_exp_f32 v97, v49
    v_exp_f32 v98, v50
    v_exp_f32 v99, v51
    v_cvt_pk_bf16_f32 v80, v96, v97
    v_cvt_pk_bf16_f32 v81, v98, v99
    v_exp_f32 v100, v52
    v_exp_f32 v101, v53
    v_exp_f32 v102, v54
    v_exp_f32 v103, v55
    v_mfma_f32_32x32x16_bf16 a[80:95], a[164:167], v[92:95], a[80:95]
    buffer_load_dwordx4 a[156:159], v138, s[4:7], s73 offen offset:2560 sc1
    v_cvt_pk_bf16_f32 v82, v100, v101
    v_cvt_pk_bf16_f32 v83, v102, v103
    v_exp_f32 v96, v56
    v_exp_f32 v97, v57
    v_exp_f32 v98, v58
    v_exp_f32 v99, v59
    v_mfma_f32_32x32x16_bf16 v[104:119], a[160:163], v[80:83], v[104:119]
    s_waitcnt vmcnt(11)
    v_cvt_pk_bf16_f32 v84, v96, v97
    v_cvt_pk_bf16_f32 v85, v98, v99
    v_exp_f32_e64 v100, v60
    v_exp_f32 v101, v61
    v_exp_f32 v102, v62
    v_exp_f32 v103, v63
    v_mfma_f32_32x32x16_bf16 v[16:31], a[144:147], a[104:107], v[16:31]
    s_add_u32 s73, s73, 5120
    buffer_load_dwordx4 a[140:143], v136, s[12:15], s72 offen offset:2560 sc1
    v_cvt_pk_bf16_f32 v86, v100, v101
    v_cvt_pk_bf16_f32 v87, v102, v103
    v_exp_f32 v96, v64
    v_exp_f32 v97, v65
    v_exp_f32 v98, v66
    v_exp_f32 v99, v67
    v_mfma_f32_32x32x16_bf16 v[32:47], a[144:147], a[108:111], v[32:47]
    s_add_u32 s72, s72, 5120
    v_cvt_pk_bf16_f32 v88, v96, v97
    v_cvt_pk_bf16_f32 v89, v98, v99
    v_exp_f32 v100, v68
    v_exp_f32 v101, v69
    v_exp_f32 v102, v70
    v_exp_f32 v103, v71
    v_mfma_f32_32x32x16_bf16 v[104:119], a[164:167], v[84:87], v[104:119]
    s_add_u32 m0, s71, 2048
    v_cvt_pk_bf16_f32 v90, v100, v101
    v_cvt_pk_bf16_f32 v91, v102, v103
    v_exp_f32 v96, v72
    v_exp_f32 v97, v73
    v_exp_f32 v98, v74
    v_exp_f32 v99, v75
    v_mfma_f32_32x32x16_bf16 v[120:135], a[160:163], v[88:91], v[120:135]
    s_add_u32 s64, s64, s66
    buffer_load_dwordx4 v201, s[16:19], s64 offen lds
    v_cvt_pk_bf16_f32 v92, v96, v97
    v_cvt_pk_bf16_f32 v93, v98, v99
    v_exp_f32_e64 v100, v76
    v_exp_f32 v101, v77
    v_exp_f32 v102, v78
    v_exp_f32 v103, v79
    v_mfma_f32_32x32x4_2b_bf16 v[48:79], a[186:187], a[132:133], 0 cbsz:1 abid:0
    v_cvt_pk_bf16_f32 v94, v100, v101
    v_cvt_pk_bf16_f32 v95, v102, v103
    v_exp_f32 v96, v16
    v_exp_f32 v97, v17
    v_exp_f32 v98, v18
    v_exp_f32 v99, v19
    v_cvt_pk_bf16_f32 v80, v96, v97
    v_cvt_pk_bf16_f32 v81, v98, v99
    v_exp_f32 v100, v20
    v_exp_f32 v101, v21
    v_exp_f32 v102, v22
    v_exp_f32 v103, v23
    v_mfma_f32_32x32x16_bf16 v[120:135], a[164:167], v[92:95], v[120:135]
    s_waitcnt vmcnt(12)
    buffer_load_dwordx4 a[160:163], v138, s[4:7], s73 offen offset:0 sc1
    v_cvt_pk_bf16_f32 v82, v100, v101
    v_cvt_pk_bf16_f32 v83, v102, v103
    v_exp_f32_e64 v96, v24
    v_exp_f32 v97, v25
    v_exp_f32 v98, v26
    v_exp_f32 v99, v27
    v_mfma_f32_32x32x16_bf16 a[0:15], a[168:171], v[80:83], a[0:15]
    s_add_u32 m0, s71, 3072
    v_cvt_pk_bf16_f32 v84, v96, v97
    v_cvt_pk_bf16_f32 v85, v98, v99
    v_exp_f32 v100, v28
    v_exp_f32 v101, v29
    v_exp_f32 v102, v30
    v_exp_f32 v103, v31
    v_mfma_f32_32x32x16_bf16 v[48:63], a[144:147], a[112:115], v[48:63]
    s_add_u32 s64, s64, s65
    buffer_load_dwordx4 v201, s[16:19], s64 offen lds
    v_cvt_pk_bf16_f32 v86, v100, v101
    v_cvt_pk_bf16_f32 v87, v102, v103
    v_exp_f32_e64 v96, v32
    v_exp_f32 v97, v33
    v_exp_f32 v98, v34
    v_exp_f32 v99, v35
    v_mfma_f32_32x32x16_bf16 v[64:79], a[144:147], a[116:119], v[64:79]
    s_waitcnt vmcnt(13)
    v_cvt_pk_bf16_f32 v88, v96, v97
    v_cvt_pk_bf16_f32 v89, v98, v99
    v_exp_f32_e64 v100, v36
    v_exp_f32 v101, v37
    v_exp_f32 v102, v38
    v_exp_f32 v103, v39
    v_mfma_f32_32x32x16_bf16 a[0:15], a[172:175], v[84:87], a[0:15]
    v_cvt_pk_bf16_f32 v90, v100, v101
    v_cvt_pk_bf16_f32 v91, v102, v103
    v_exp_f32 v96, v40
    v_exp_f32 v97, v41
    v_exp_f32 v98, v42
    v_exp_f32 v99, v43
    v_mfma_f32_32x32x16_bf16 a[16:31], a[168:171], v[88:91], a[16:31]
    v_cvt_pk_bf16_f32 v92, v96, v97
    v_cvt_pk_bf16_f32 v93, v98, v99
    v_exp_f32 v100, v44
    v_exp_f32 v101, v45
    v_exp_f32 v102, v46
    v_exp_f32 v103, v47
    v_mfma_f32_32x32x4_2b_bf16 v[16:47], a[186:187], a[134:135], 0 cbsz:1 abid:0
    v_cvt_pk_bf16_f32 v94, v100, v101
    v_cvt_pk_bf16_f32 v95, v102, v103
    v_exp_f32 v96, v48
    v_exp_f32 v97, v49
    v_exp_f32 v98, v50
    v_exp_f32 v99, v51
    v_cvt_pk_bf16_f32 v80, v96, v97
    v_cvt_pk_bf16_f32 v81, v98, v99
    v_exp_f32 v100, v52
    v_exp_f32 v101, v53
    v_exp_f32 v102, v54
    v_exp_f32 v103, v55
    v_mfma_f32_32x32x16_bf16 a[16:31], a[172:175], v[92:95], a[16:31]
    buffer_load_dwordx4 a[164:167], v138, s[4:7], s73 offen offset:2560 sc1
    v_cvt_pk_bf16_f32 v82, v100, v101
    v_cvt_pk_bf16_f32 v83, v102, v103
    v_exp_f32 v96, v56
    v_exp_f32 v97, v57
    v_exp_f32 v98, v58
    v_exp_f32 v99, v59
    v_mfma_f32_32x32x16_bf16 a[32:47], a[168:171], v[80:83], a[32:47]
    s_add_u32 s73, s73, 5120
    v_cvt_pk_bf16_f32 v84, v96, v97
    v_cvt_pk_bf16_f32 v85, v98, v99
    v_exp_f32 v100, v60
    v_exp_f32 v101, v61
    v_exp_f32 v102, v62
    v_exp_f32 v103, v63
    v_mfma_f32_32x32x16_bf16 v[16:31], a[144:147], a[120:123], v[16:31]
    s_add_u32 m0, s71, 4096
    v_cvt_pk_bf16_f32 v86, v100, v101
    v_cvt_pk_bf16_f32 v87, v102, v103
    v_exp_f32 v96, v64
    v_exp_f32 v97, v65
    v_exp_f32 v98, v66
    v_exp_f32 v99, v67
    v_mfma_f32_32x32x16_bf16 v[32:47], a[144:147], a[124:127], v[32:47]
    s_add_u32 s64, s64, s66
    v_cvt_pk_bf16_f32 v88, v96, v97
    v_cvt_pk_bf16_f32 v89, v98, v99
    v_exp_f32_e64 v100, v68
    v_exp_f32 v101, v69
    v_exp_f32 v102, v70
    v_exp_f32 v103, v71
    v_mfma_f32_32x32x16_bf16 a[32:47], a[172:175], v[84:87], a[32:47]
    buffer_load_dwordx4 v201, s[16:19], s64 offen lds
    v_cvt_pk_bf16_f32 v90, v100, v101
    v_cvt_pk_bf16_f32 v91, v102, v103
    v_exp_f32 v96, v72
    v_exp_f32 v97, v73
    v_exp_f32 v98, v74
    v_exp_f32 v99, v75
    v_mfma_f32_32x32x16_bf16 a[48:63], a[168:171], v[88:91], a[48:63]
    v_cvt_pk_bf16_f32 v92, v96, v97
    v_cvt_pk_bf16_f32 v93, v98, v99
    v_exp_f32 v100, v76
    v_exp_f32 v101, v77
    v_exp_f32 v102, v78
    v_exp_f32 v103, v79
    v_mfma_f32_32x32x4_2b_bf16 v[48:79], a[186:187], a[128:129], 0 cbsz:1 abid:0
    v_cvt_pk_bf16_f32 v94, v100, v101
    v_cvt_pk_bf16_f32 v95, v102, v103
    v_exp_f32 v96, v16
    v_exp_f32 v97, v17
    v_exp_f32 v98, v18
    v_exp_f32 v99, v19
    v_cvt_pk_bf16_f32 v80, v96, v97
    v_cvt_pk_bf16_f32 v81, v98, v99
    v_exp_f32 v100, v20
    v_exp_f32 v101, v21
    v_exp_f32 v102, v22
    v_exp_f32 v103, v23
    v_mfma_f32_32x32x16_bf16 a[48:63], a[172:175], v[92:95], a[48:63]
    global_load_dword v248, v247, s[20:21] sc1
    v_cvt_pk_bf16_f32 v82, v100, v101
    v_cvt_pk_bf16_f32 v83, v102, v103
    v_exp_f32 v96, v24
    v_exp_f32 v97, v25
    v_exp_f32 v98, v26
    v_exp_f32 v99, v27
    v_mfma_f32_32x32x16_bf16 a[64:79], a[168:171], v[80:83], a[64:79]
    s_add_u32 m0, s71, 5120
    v_cvt_pk_bf16_f32 v84, v96, v97
    v_cvt_pk_bf16_f32 v85, v98, v99
    v_exp_f32 v100, v28
    v_exp_f32 v101, v29
    v_exp_f32 v102, v30
    v_exp_f32 v103, v31
    v_mfma_f32_32x32x16_bf16 v[48:63], a[144:147], a[96:99], v[48:63]
    s_add_u32 s64, s64, s65
    buffer_load_dwordx4 v201, s[16:19], s64 offen lds
    v_cvt_pk_bf16_f32 v86, v100, v101
    v_cvt_pk_bf16_f32 v87, v102, v103
    v_exp_f32_e64 v96, v32
    v_exp_f32 v97, v33
    v_exp_f32 v98, v34
    v_exp_f32 v99, v35
    v_mfma_f32_32x32x16_bf16 v[64:79], a[144:147], a[100:103], v[64:79]
    v_cvt_pk_bf16_f32 v88, v96, v97
    v_cvt_pk_bf16_f32 v89, v98, v99
    v_exp_f32 v100, v36
    v_exp_f32 v101, v37
    v_exp_f32 v102, v38
    v_exp_f32 v103, v39
    v_mfma_f32_32x32x16_bf16 a[64:79], a[172:175], v[84:87], a[64:79]
    v_cvt_pk_bf16_f32 v90, v100, v101
    v_cvt_pk_bf16_f32 v91, v102, v103
    v_exp_f32 v96, v40
    v_exp_f32 v97, v41
    v_exp_f32 v98, v42
    v_exp_f32 v99, v43
    v_mfma_f32_32x32x16_bf16 a[80:95], a[168:171], v[88:91], a[80:95]
    v_cvt_pk_bf16_f32 v92, v96, v97
    v_cvt_pk_bf16_f32 v93, v98, v99
    v_exp_f32 v100, v44
    v_exp_f32 v101, v45
    v_exp_f32 v102, v46
    v_exp_f32 v103, v47
    v_mfma_f32_32x32x4_2b_bf16 v[16:47], a[186:187], a[130:131], 0 cbsz:1 abid:1
    v_cvt_pk_bf16_f32 v94, v100, v101
    v_cvt_pk_bf16_f32 v95, v102, v103
    v_exp_f32 v96, v48
    v_exp_f32 v97, v49
    v_exp_f32 v98, v50
    v_exp_f32 v99, v51
    v_cvt_pk_bf16_f32 v80, v96, v97
    v_cvt_pk_bf16_f32 v81, v98, v99
    v_exp_f32 v100, v52
    v_exp_f32 v101, v53
    v_exp_f32 v102, v54
    v_exp_f32 v103, v55
    v_mfma_f32_32x32x16_bf16 a[80:95], a[172:175], v[92:95], a[80:95]
    buffer_load_dwordx4 a[144:147], v136, s[12:15], s72 offen offset:0 sc1
    v_cvt_pk_bf16_f32 v82, v100, v101
    v_cvt_pk_bf16_f32 v83, v102, v103
    v_exp_f32 v96, v56
    v_exp_f32 v97, v57
    v_exp_f32 v98, v58
    v_exp_f32 v99, v59
    v_mfma_f32_32x32x16_bf16 v[104:119], a[168:171], v[80:83], v[104:119]
    s_waitcnt vmcnt(17)
    v_cvt_pk_bf16_f32 v84, v96, v97
    v_cvt_pk_bf16_f32 v85, v98, v99
    v_exp_f32_e64 v100, v60
    v_exp_f32 v101, v61
    v_exp_f32 v102, v62
    v_exp_f32 v103, v63
    v_mfma_f32_32x32x16_bf16 v[16:31], a[148:151], a[104:107], v[16:31]
    s_add_u32 m0, s71, 6144
    v_cvt_pk_bf16_f32 v86, v100, v101
    v_cvt_pk_bf16_f32 v87, v102, v103
    v_exp_f32 v96, v64
    v_exp_f32 v97, v65
    v_exp_f32 v98, v66
    v_exp_f32 v99, v67
    v_mfma_f32_32x32x16_bf16 v[32:47], a[148:151], a[108:111], v[32:47]
    s_add_u32 s64, s64, s66
    v_cvt_pk_bf16_f32 v88, v96, v97
    v_cvt_pk_bf16_f32 v89, v98, v99
    v_exp_f32_e64 v100, v68
    v_exp_f32 v101, v69
    v_exp_f32 v102, v70
    v_exp_f32 v103, v71
    v_mfma_f32_32x32x16_bf16 v[104:119], a[172:175], v[84:87], v[104:119]
    buffer_load_dwordx4 v201, s[16:19], s64 offen lds
    v_cvt_pk_bf16_f32 v90, v100, v101
    v_cvt_pk_bf16_f32 v91, v102, v103
    v_exp_f32 v96, v72
    v_exp_f32 v97, v73
    v_exp_f32 v98, v74
    v_exp_f32 v99, v75
    v_mfma_f32_32x32x16_bf16 v[120:135], a[168:171], v[88:91], v[120:135]
    v_cvt_pk_bf16_f32 v92, v96, v97
    v_cvt_pk_bf16_f32 v93, v98, v99
    v_exp_f32 v100, v76
    v_exp_f32 v101, v77
    v_exp_f32 v102, v78
    v_exp_f32 v103, v79
    v_mfma_f32_32x32x4_2b_bf16 v[48:79], a[186:187], a[132:133], 0 cbsz:1 abid:1
    v_cvt_pk_bf16_f32 v94, v100, v101
    v_cvt_pk_bf16_f32 v95, v102, v103
    v_exp_f32 v96, v16
    v_exp_f32 v97, v17
    v_exp_f32 v98, v18
    v_exp_f32 v99, v19
    v_cvt_pk_bf16_f32 v80, v96, v97
    v_cvt_pk_bf16_f32 v81, v98, v99
    v_exp_f32 v100, v20
    v_exp_f32 v101, v21
    v_exp_f32 v102, v22
    v_exp_f32 v103, v23
    v_mfma_f32_32x32x16_bf16 v[120:135], a[172:175], v[92:95], v[120:135]
    s_waitcnt vmcnt(17)
    buffer_load_dwordx4 a[168:171], v138, s[4:7], s73 offen offset:0 sc1
    v_cvt_pk_bf16_f32 v82, v100, v101
    v_cvt_pk_bf16_f32 v83, v102, v103
    v_exp_f32_e64 v96, v24
    v_exp_f32 v97, v25
    v_exp_f32 v98, v26
    v_exp_f32 v99, v27
    v_mfma_f32_32x32x16_bf16 a[0:15], a[176:179], v[80:83], a[0:15]
    s_add_u32 m0, s71, 7168
    v_cvt_pk_bf16_f32 v84, v96, v97
    v_cvt_pk_bf16_f32 v85, v98, v99
    v_exp_f32 v100, v28
    v_exp_f32 v101, v29
    v_exp_f32 v102, v30
    v_exp_f32 v103, v31
    v_mfma_f32_32x32x16_bf16 v[48:63], a[148:151], a[112:115], v[48:63]
    s_add_u32 s64, s64, s65
    buffer_load_dwordx4 v201, s[16:19], s64 offen lds
    v_cvt_pk_bf16_f32 v86, v100, v101
    v_cvt_pk_bf16_f32 v87, v102, v103
    v_exp_f32_e64 v96, v32
    v_exp_f32 v97, v33
    v_exp_f32 v98, v34
    v_exp_f32 v99, v35
    v_mfma_f32_32x32x16_bf16 v[64:79], a[148:151], a[116:119], v[64:79]
    s_waitcnt vmcnt(18)
    v_cvt_pk_bf16_f32 v88, v96, v97
    v_cvt_pk_bf16_f32 v89, v98, v99
    v_exp_f32_e64 v100, v36
    v_exp_f32 v101, v37
    v_exp_f32 v102, v38
    v_exp_f32 v103, v39
    v_mfma_f32_32x32x16_bf16 a[0:15], a[180:183], v[84:87], a[0:15]
    v_cvt_pk_bf16_f32 v90, v100, v101
    v_cvt_pk_bf16_f32 v91, v102, v103
    v_exp_f32 v96, v40
    v_exp_f32 v97, v41
    v_exp_f32 v98, v42
    v_exp_f32 v99, v43
    v_mfma_f32_32x32x16_bf16 a[16:31], a[176:179], v[88:91], a[16:31]
    v_cvt_pk_bf16_f32 v92, v96, v97
    v_cvt_pk_bf16_f32 v93, v98, v99
    v_exp_f32 v100, v44
    v_exp_f32 v101, v45
    v_exp_f32 v102, v46
    v_exp_f32 v103, v47
    v_mfma_f32_32x32x4_2b_bf16 v[16:47], a[186:187], a[134:135], 0 cbsz:1 abid:1
    v_cvt_pk_bf16_f32 v94, v100, v101
    v_cvt_pk_bf16_f32 v95, v102, v103
    v_exp_f32 v96, v48
    v_exp_f32 v97, v49
    v_exp_f32 v98, v50
    v_exp_f32 v99, v51
    v_cvt_pk_bf16_f32 v80, v96, v97
    v_cvt_pk_bf16_f32 v81, v98, v99
    v_exp_f32 v100, v52
    v_exp_f32 v101, v53
    v_exp_f32 v102, v54
    v_exp_f32 v103, v55
    v_mfma_f32_32x32x16_bf16 a[16:31], a[180:183], v[92:95], a[16:31]
    buffer_load_dwordx4 a[172:175], v138, s[4:7], s73 offen offset:2560 sc1
    v_cvt_pk_bf16_f32 v82, v100, v101
    v_cvt_pk_bf16_f32 v83, v102, v103
    v_exp_f32 v96, v56
    v_exp_f32 v97, v57
    v_exp_f32 v98, v58
    v_exp_f32 v99, v59
    v_mfma_f32_32x32x16_bf16 a[32:47], a[176:179], v[80:83], a[32:47]
    s_add_u32 s73, s73, 5120
    v_cvt_pk_bf16_f32 v84, v96, v97
    v_cvt_pk_bf16_f32 v85, v98, v99
    v_exp_f32 v100, v60
    v_exp_f32 v101, v61
    v_exp_f32 v102, v62
    v_exp_f32 v103, v63
    v_mfma_f32_32x32x16_bf16 v[16:31], a[148:151], a[120:123], v[16:31]
    s_add_u32 m0, s71, 8192
    v_cvt_pk_bf16_f32 v86, v100, v101
    v_cvt_pk_bf16_f32 v87, v102, v103
    v_exp_f32 v96, v64
    v_exp_f32 v97, v65
    v_exp_f32 v98, v66
    v_exp_f32 v99, v67
    v_mfma_f32_32x32x16_bf16 v[32:47], a[148:151], a[124:127], v[32:47]
    s_add_u32 s64, s64, s66
    v_cvt_pk_bf16_f32 v88, v96, v97
    v_cvt_pk_bf16_f32 v89, v98, v99
    v_exp_f32_e64 v100, v68
    v_exp_f32 v101, v69
    v_exp_f32 v102, v70
    v_exp_f32 v103, v71
    v_mfma_f32_32x32x16_bf16 a[32:47], a[180:183], v[84:87], a[32:47]
    buffer_load_dwordx4 v201, s[16:19], s64 offen lds
    v_cvt_pk_bf16_f32 v90, v100, v101
    v_cvt_pk_bf16_f32 v91, v102, v103
    v_exp_f32 v96, v72
    v_exp_f32 v97, v73
    v_exp_f32 v98, v74
    v_exp_f32 v99, v75
    v_mfma_f32_32x32x16_bf16 a[48:63], a[176:179], v[88:91], a[48:63]
    v_cvt_pk_bf16_f32 v92, v96, v97
    v_cvt_pk_bf16_f32 v93, v98, v99
    v_exp_f32 v100, v76
    v_exp_f32 v101, v77
    v_exp_f32 v102, v78
    v_exp_f32 v103, v79
    v_mfma_f32_32x32x4_2b_bf16 v[48:79], a[186:187], a[128:129], 0 cbsz:1 abid:1
    v_cvt_pk_bf16_f32 v94, v100, v101
    v_cvt_pk_bf16_f32 v95, v102, v103
    v_exp_f32 v96, v16
    v_exp_f32 v97, v17
    v_exp_f32 v98, v18
    v_exp_f32 v99, v19
    v_cvt_pk_bf16_f32 v80, v96, v97
    v_cvt_pk_bf16_f32 v81, v98, v99
    v_exp_f32 v100, v20
    v_exp_f32 v101, v21
    v_exp_f32 v102, v22
    v_exp_f32 v103, v23
    v_mfma_f32_32x32x16_bf16 a[48:63], a[180:183], v[92:95], a[48:63]
    buffer_load_dwordx2 a[186:187], v137, s[12:15], s74 offen sc1
    v_cvt_pk_bf16_f32 v82, v100, v101
    v_cvt_pk_bf16_f32 v83, v102, v103
    v_exp_f32 v96, v24
    v_exp_f32 v97, v25
    v_exp_f32 v98, v26
    v_exp_f32 v99, v27
    v_mfma_f32_32x32x16_bf16 a[64:79], a[176:179], v[80:83], a[64:79]
    s_add_u32 s74, s74, 5120
    v_cvt_pk_bf16_f32 v84, v96, v97
    v_cvt_pk_bf16_f32 v85, v98, v99
    v_exp_f32 v100, v28
    v_exp_f32 v101, v29
    v_exp_f32 v102, v30
    v_exp_f32 v103, v31
    v_mfma_f32_32x32x16_bf16 v[48:63], a[148:151], a[96:99], v[48:63]
    s_add_u32 m0, s71, 9216
    v_cvt_pk_bf16_f32 v86, v100, v101
    v_cvt_pk_bf16_f32 v87, v102, v103
    v_exp_f32 v96, v32
    v_exp_f32 v97, v33
    v_exp_f32 v98, v34
    v_exp_f32 v99, v35
    v_mfma_f32_32x32x16_bf16 v[64:79], a[148:151], a[100:103], v[64:79]
    s_add_u32 s64, s64, s65
    v_cvt_pk_bf16_f32 v88, v96, v97
    v_cvt_pk_bf16_f32 v89, v98, v99
    v_exp_f32_e64 v100, v36
    v_exp_f32 v101, v37
    v_exp_f32 v102, v38
    v_exp_f32 v103, v39
    v_mfma_f32_32x32x16_bf16 a[64:79], a[180:183], v[84:87], a[64:79]
    buffer_load_dwordx4 v201, s[16:19], s64 offen lds
    v_cvt_pk_bf16_f32 v90, v100, v101
    v_cvt_pk_bf16_f32 v91, v102, v103
    v_exp_f32 v96, v40
    v_exp_f32 v97, v41
    v_exp_f32 v98, v42
    v_exp_f32 v99, v43
    v_mfma_f32_32x32x16_bf16 a[80:95], a[176:179], v[88:91], a[80:95]
    s_waitcnt vmcnt(18)
    v_cvt_pk_bf16_f32 v92, v96, v97
    v_cvt_pk_bf16_f32 v93, v98, v99
    v_exp_f32_e64 v100, v44
    v_exp_f32 v101, v45
    v_exp_f32 v102, v46
    v_exp_f32 v103, v47
    v_mfma_f32_32x32x4_2b_bf16 v[16:47], a[184:185], a[130:131], 0 cbsz:1 abid:0
    v_cvt_pk_bf16_f32 v94, v100, v101
    v_cvt_pk_bf16_f32 v95, v102, v103
    v_exp_f32 v96, v48
    v_exp_f32 v97, v49
    v_exp_f32 v98, v50
    v_exp_f32 v99, v51
    v_cvt_pk_bf16_f32 v80, v96, v97
    v_cvt_pk_bf16_f32 v81, v98, v99
    v_exp_f32 v100, v52
    v_exp_f32 v101, v53
    v_exp_f32 v102, v54
    v_exp_f32 v103, v55
    v_mfma_f32_32x32x16_bf16 a[80:95], a[180:183], v[92:95], a[80:95]
    buffer_load_dwordx4 a[148:151], v136, s[12:15], s72 offen offset:2560 sc1
    v_cvt_pk_bf16_f32 v82, v100, v101
    v_cvt_pk_bf16_f32 v83, v102, v103
    v_exp_f32 v96, v56
    v_exp_f32 v97, v57
    v_exp_f32 v98, v58
    v_exp_f32 v99, v59
    v_mfma_f32_32x32x16_bf16 v[104:119], a[176:179], v[80:83], v[104:119]
    s_add_u32 s72, s72, 5120
    v_cvt_pk_bf16_f32 v84, v96, v97
    v_cvt_pk_bf16_f32 v85, v98, v99
    v_exp_f32 v100, v60
    v_exp_f32 v101, v61
    v_exp_f32 v102, v62
    v_exp_f32 v103, v63
    v_mfma_f32_32x32x16_bf16 v[16:31], a[136:139], a[104:107], v[16:31]
    v_cvt_pk_bf16_f32 v86, v100, v101
    v_cvt_pk_bf16_f32 v87, v102, v103
    v_exp_f32 v96, v64
    v_exp_f32 v97, v65
    v_exp_f32 v98, v66
    v_exp_f32 v99, v67
    v_mfma_f32_32x32x16_bf16 v[32:47], a[136:139], a[108:111], v[32:47]
    v_cvt_pk_bf16_f32 v88, v96, v97
    v_cvt_pk_bf16_f32 v89, v98, v99
    v_exp_f32 v100, v68
    v_exp_f32 v101, v69
    v_exp_f32 v102, v70
    v_exp_f32 v103, v71
    v_mfma_f32_32x32x16_bf16 v[104:119], a[180:183], v[84:87], v[104:119]
    v_cvt_pk_bf16_f32 v90, v100, v101
    v_cvt_pk_bf16_f32 v91, v102, v103
    v_exp_f32 v96, v72
    v_exp_f32 v97, v73
    v_exp_f32 v98, v74
    v_exp_f32 v99, v75
    v_mfma_f32_32x32x16_bf16 v[120:135], a[176:179], v[88:91], v[120:135]
    v_cvt_pk_bf16_f32 v92, v96, v97
    v_cvt_pk_bf16_f32 v93, v98, v99
    v_exp_f32 v100, v76
    v_exp_f32 v101, v77
    v_exp_f32 v102, v78
    v_exp_f32 v103, v79
    v_mfma_f32_32x32x4_2b_bf16 v[48:79], a[184:185], a[132:133], 0 cbsz:1 abid:0
    v_cvt_pk_bf16_f32 v94, v100, v101
    v_cvt_pk_bf16_f32 v95, v102, v103
    v_exp_f32 v96, v16
    v_exp_f32 v97, v17
    v_exp_f32 v98, v18
    v_exp_f32 v99, v19
    v_cvt_pk_bf16_f32 v80, v96, v97
    v_cvt_pk_bf16_f32 v81, v98, v99
    v_exp_f32 v100, v20
    v_exp_f32 v101, v21
    v_exp_f32 v102, v22
    v_exp_f32 v103, v23
    v_mfma_f32_32x32x16_bf16 v[120:135], a[180:183], v[92:95], v[120:135]
    buffer_load_dwordx4 a[176:179], v138, s[4:7], s73 offen offset:0 sc1
    v_cvt_pk_bf16_f32 v82, v100, v101
    v_cvt_pk_bf16_f32 v83, v102, v103
    v_exp_f32 v96, v24
    v_exp_f32 v97, v25
    v_exp_f32 v98, v26
    v_exp_f32 v99, v27
    v_mfma_f32_32x32x16_bf16 a[0:15], a[152:155], v[80:83], a[0:15]
    s_waitcnt vmcnt(19)
    ds_read_b64_tr_b16 v[216:217], v202 offset:0
    v_cvt_pk_bf16_f32 v84, v96, v97
    v_cvt_pk_bf16_f32 v85, v98, v99
    v_exp_f32_e64 v100, v28
    v_exp_f32 v101, v29
    v_exp_f32 v102, v30
    v_exp_f32 v103, v31
    v_mfma_f32_32x32x16_bf16 v[48:63], a[136:139], a[112:115], v[48:63]
    ds_read_b64_tr_b16 v[218:219], v202 offset:256
    v_cvt_pk_bf16_f32 v86, v100, v101
    v_cvt_pk_bf16_f32 v87, v102, v103
    v_exp_f32 v96, v32
    v_exp_f32 v97, v33
    v_exp_f32 v98, v34
    v_exp_f32 v99, v35
    v_mfma_f32_32x32x16_bf16 v[64:79], a[136:139], a[116:119], v[64:79]
sequential_preLN__softmax_full_mha__glu_gated_bilinear__prompt_kernel_pgatt1:
    s_cbranch_execz sequential_preLN__softmax_full_mha__glu_gated_bilinear__prompt_kernel_pgatt5
    s_waitcnt vmcnt(18)
    ds_read_b64_tr_b16 v[220:221], v202 offset:8
    v_cvt_pk_bf16_f32 v88, v96, v97
    v_cvt_pk_bf16_f32 v89, v98, v99
    v_exp_f32_e64 v100, v36
    v_exp_f32 v101, v37
    v_exp_f32 v102, v38
    v_exp_f32 v103, v39
    v_mfma_f32_32x32x16_bf16 a[0:15], a[156:159], v[84:87], a[0:15]
    ds_read_b64_tr_b16 v[222:223], v202 offset:264
    v_cvt_pk_bf16_f32 v90, v100, v101
    v_cvt_pk_bf16_f32 v91, v102, v103
    v_exp_f32 v96, v40
    v_exp_f32 v97, v41
    v_exp_f32 v98, v42
    v_exp_f32 v99, v43
    v_mfma_f32_32x32x16_bf16 a[16:31], a[152:155], v[88:91], a[16:31]
    v_cvt_pk_bf16_f32 v92, v96, v97
    v_cvt_pk_bf16_f32 v93, v98, v99
    v_exp_f32 v100, v44
    v_exp_f32 v101, v45
    v_exp_f32 v102, v46
    v_exp_f32 v103, v47
    v_mfma_f32_32x32x4_2b_bf16 v[16:47], a[184:185], a[134:135], 0 cbsz:1 abid:0
    v_cvt_pk_bf16_f32 v94, v100, v101
    v_cvt_pk_bf16_f32 v95, v102, v103
    v_exp_f32 v96, v48
    v_exp_f32 v97, v49
    v_exp_f32 v98, v50
    v_exp_f32 v99, v51
    v_cvt_pk_bf16_f32 v80, v96, v97
    v_cvt_pk_bf16_f32 v81, v98, v99
    v_exp_f32 v100, v52
    v_exp_f32 v101, v53
    v_exp_f32 v102, v54
    v_exp_f32 v103, v55
    v_mfma_f32_32x32x16_bf16 a[16:31], a[156:159], v[92:95], a[16:31]
    buffer_load_dwordx4 a[180:183], v138, s[4:7], s73 offen offset:2560 sc1
    v_cvt_pk_bf16_f32 v82, v100, v101
    v_cvt_pk_bf16_f32 v83, v102, v103
    v_exp_f32 v96, v56
    v_exp_f32 v97, v57
    v_exp_f32 v98, v58
    v_exp_f32 v99, v59
    v_mfma_f32_32x32x16_bf16 a[32:47], a[152:155], v[80:83], a[32:47]
    s_add_u32 s73, s73, 5120
    v_cvt_pk_bf16_f32 v84, v96, v97
    v_cvt_pk_bf16_f32 v85, v98, v99
    v_exp_f32 v100, v60
    v_exp_f32 v101, v61
    v_exp_f32 v102, v62
    v_exp_f32 v103, v63
    v_mfma_f32_32x32x16_bf16 v[16:31], a[136:139], a[120:123], v[16:31]
    s_waitcnt lgkmcnt(0)
    buffer_store_dwordx4 v[216:219], v253, s[4:7], s67 offen sc1
    v_cvt_pk_bf16_f32 v86, v100, v101
    v_cvt_pk_bf16_f32 v87, v102, v103
    v_exp_f32_e64 v96, v64
    v_exp_f32 v97, v65
    v_mfma_f32_16x16x32_bf16 v[204:207], v[212:215], v[216:219], 0
    v_exp_f32 v98, v66
    v_exp_f32 v99, v67
    v_mfma_f32_32x32x16_bf16 v[32:47], a[136:139], a[124:127], v[32:47]
    s_add_u32 s67, s67, s68
    v_cvt_pk_bf16_f32 v88, v96, v97
    v_cvt_pk_bf16_f32 v89, v98, v99
    v_exp_f32_e64 v100, v68
    v_exp_f32 v101, v69
    v_mfma_f32_16x16x32_bf16 v[208:211], v[212:215], v[220:223], 0
    v_exp_f32 v102, v70
    v_exp_f32 v103, v71
    v_mfma_f32_32x32x16_bf16 a[32:47], a[156:159], v[84:87], a[32:47]
    v_cvt_pk_bf16_f32 v90, v100, v101
    v_cvt_pk_bf16_f32 v91, v102, v103
    v_exp_f32 v96, v72
    v_exp_f32 v97, v73
    v_exp_f32 v98, v74
    v_exp_f32 v99, v75
    v_mfma_f32_32x32x16_bf16 a[48:63], a[152:155], v[88:91], a[48:63]
    v_cvt_pk_bf16_f32 v92, v96, v97
    v_cvt_pk_bf16_f32 v93, v98, v99
    v_exp_f32 v100, v76
    v_exp_f32 v101, v77
    v_exp_f32 v102, v78
    v_exp_f32 v103, v79
    v_mfma_f32_32x32x4_2b_bf16 v[48:79], a[184:185], a[128:129], 0 cbsz:1 abid:0
    v_cvt_pk_bf16_f32 v94, v100, v101
    v_cvt_pk_bf16_f32 v95, v102, v103
    v_exp_f32 v96, v16
    v_exp_f32 v97, v17
    v_exp_f32 v98, v18
    v_exp_f32 v99, v19
    v_cvt_pk_bf16_f32 v80, v96, v97
    v_cvt_pk_bf16_f32 v81, v98, v99
    v_exp_f32 v100, v20
    v_exp_f32 v101, v21
    v_exp_f32 v102, v22
    v_exp_f32 v103, v23
    v_mfma_f32_32x32x16_bf16 a[48:63], a[156:159], v[92:95], a[48:63]
    buffer_store_dwordx4 v[220:223], v253, s[4:7], s67 offen sc1
    v_cvt_pk_bf16_f32 v82, v100, v101
    v_cvt_pk_bf16_f32 v83, v102, v103
    v_exp_f32 v96, v24
    v_exp_f32 v97, v25
    v_exp_f32 v98, v26
    v_exp_f32 v99, v27
    v_mfma_f32_32x32x16_bf16 a[64:79], a[152:155], v[80:83], a[64:79]
    s_add_u32 s67, s67, s69
    v_cvt_pk_bf16_f32 v84, v96, v97
    v_cvt_pk_bf16_f32 v85, v98, v99
    v_exp_f32_e64 v100, v28
    v_exp_f32 v101, v29
    v_exp_f32 v102, v30
    v_exp_f32 v103, v31
    v_mfma_f32_32x32x16_bf16 v[48:63], a[136:139], a[96:99], v[48:63]
    s_waitcnt vmcnt(17)
    ds_read_b64_tr_b16 v[224:225], v202 offset:2048
    v_cvt_pk_bf16_f32 v86, v100, v101
    v_cvt_pk_bf16_f32 v87, v102, v103
    v_exp_f32_e64 v96, v32
    v_exp_f32 v97, v33
    v_exp_f32 v98, v34
    v_exp_f32 v99, v35
    v_mfma_f32_32x32x16_bf16 v[64:79], a[136:139], a[100:103], v[64:79]
    ds_read_b64_tr_b16 v[226:227], v202 offset:2304
    v_cvt_pk_bf16_f32 v88, v96, v97
    v_cvt_pk_bf16_f32 v89, v98, v99
    v_exp_f32 v100, v36
    v_exp_f32 v101, v37
    v_exp_f32 v102, v38
    v_exp_f32 v103, v39
    v_mfma_f32_32x32x16_bf16 a[64:79], a[156:159], v[84:87], a[64:79]
    ds_read_b64_tr_b16 v[228:229], v202 offset:2056
    v_cvt_pk_bf16_f32 v90, v100, v101
    v_cvt_pk_bf16_f32 v91, v102, v103
    v_exp_f32 v96, v40
    v_exp_f32 v97, v41
    v_exp_f32 v98, v42
    v_exp_f32 v99, v43
    v_mfma_f32_32x32x16_bf16 a[80:95], a[152:155], v[88:91], a[80:95]
    ds_read_b64_tr_b16 v[230:231], v202 offset:2312
    v_cvt_pk_bf16_f32 v92, v96, v97
    v_cvt_pk_bf16_f32 v93, v98, v99
    v_exp_f32 v100, v44
    v_exp_f32 v101, v45
    v_exp_f32 v102, v46
    v_exp_f32 v103, v47
    v_mfma_f32_32x32x4_2b_bf16 v[16:47], a[184:185], a[130:131], 0 cbsz:1 abid:1
    v_cvt_pk_bf16_f32 v94, v100, v101
    v_cvt_pk_bf16_f32 v95, v102, v103
    v_exp_f32 v96, v48
    v_exp_f32 v97, v49
    v_exp_f32 v98, v50
    v_exp_f32 v99, v51
    v_cvt_pk_bf16_f32 v80, v96, v97
    v_cvt_pk_bf16_f32 v81, v98, v99
    v_exp_f32 v100, v52
    v_exp_f32 v101, v53
    v_exp_f32 v102, v54
    v_exp_f32 v103, v55
    v_mfma_f32_32x32x16_bf16 a[80:95], a[156:159], v[92:95], a[80:95]
    buffer_load_dwordx4 a[136:139], v136, s[12:15], s72 offen offset:0 sc1
    v_cvt_pk_bf16_f32 v82, v100, v101
    v_cvt_pk_bf16_f32 v83, v102, v103
    v_exp_f32 v96, v56
    v_exp_f32 v97, v57
    v_exp_f32 v98, v58
    v_exp_f32 v99, v59
    v_mfma_f32_32x32x16_bf16 v[104:119], a[152:155], v[80:83], v[104:119]
    s_waitcnt lgkmcnt(0)
    v_cvt_pk_bf16_f32 v84, v96, v97
    v_cvt_pk_bf16_f32 v85, v98, v99
    v_exp_f32_e64 v100, v60
    v_exp_f32 v101, v61
    v_mfma_f32_16x16x32_bf16 v[204:207], v[212:215], v[224:227], v[204:207]
    v_exp_f32 v102, v62
    v_exp_f32 v103, v63
    v_mfma_f32_32x32x16_bf16 v[16:31], a[140:143], a[104:107], v[16:31]
    buffer_store_dwordx4 v[224:227], v253, s[4:7], s67 offen sc1
    v_cvt_pk_bf16_f32 v86, v100, v101
    v_cvt_pk_bf16_f32 v87, v102, v103
    v_exp_f32 v96, v64
    v_exp_f32 v97, v65
    v_mfma_f32_16x16x32_bf16 v[208:211], v[212:215], v[228:231], v[208:211]
    v_exp_f32 v98, v66
    v_exp_f32 v99, v67
    v_mfma_f32_32x32x16_bf16 v[32:47], a[140:143], a[108:111], v[32:47]
    s_add_u32 s67, s67, s68
    v_cvt_pk_bf16_f32 v88, v96, v97
    v_cvt_pk_bf16_f32 v89, v98, v99
    v_exp_f32_e64 v100, v68
    v_exp_f32 v101, v69
    v_exp_f32 v102, v70
    v_exp_f32 v103, v71
    v_mfma_f32_32x32x16_bf16 v[104:119], a[156:159], v[84:87], v[104:119]
    v_cvt_pk_bf16_f32 v90, v100, v101
    v_cvt_pk_bf16_f32 v91, v102, v103
    v_exp_f32 v96, v72
    v_exp_f32 v97, v73
    v_exp_f32 v98, v74
    v_exp_f32 v99, v75
    v_mfma_f32_32x32x16_bf16 v[120:135], a[152:155], v[88:91], v[120:135]
    v_cvt_pk_bf16_f32 v92, v96, v97
    v_cvt_pk_bf16_f32 v93, v98, v99
    v_exp_f32 v100, v76
    v_exp_f32 v101, v77
    v_exp_f32 v102, v78
    v_exp_f32 v103, v79
    v_mfma_f32_32x32x4_2b_bf16 v[48:79], a[184:185], a[132:133], 0 cbsz:1 abid:1
    v_cvt_pk_bf16_f32 v94, v100, v101
    v_cvt_pk_bf16_f32 v95, v102, v103
    v_exp_f32 v96, v16
    v_exp_f32 v97, v17
    v_exp_f32 v98, v18
    v_exp_f32 v99, v19
    v_cvt_pk_bf16_f32 v80, v96, v97
    v_cvt_pk_bf16_f32 v81, v98, v99
    v_exp_f32 v100, v20
    v_exp_f32 v101, v21
    v_exp_f32 v102, v22
    v_exp_f32 v103, v23
    v_mfma_f32_32x32x16_bf16 v[120:135], a[156:159], v[92:95], v[120:135]
    buffer_load_dwordx4 a[152:155], v138, s[4:7], s73 offen offset:0 sc1
    v_cvt_pk_bf16_f32 v82, v100, v101
    v_cvt_pk_bf16_f32 v83, v102, v103
    v_exp_f32 v96, v24
    v_exp_f32 v97, v25
    v_exp_f32 v98, v26
    v_exp_f32 v99, v27
    v_mfma_f32_32x32x16_bf16 a[0:15], a[160:163], v[80:83], a[0:15]
    buffer_store_dwordx4 v[228:231], v253, s[4:7], s67 offen sc1
    v_cvt_pk_bf16_f32 v84, v96, v97
    v_cvt_pk_bf16_f32 v85, v98, v99
    v_exp_f32 v100, v28
    v_exp_f32 v101, v29
    v_exp_f32 v102, v30
    v_exp_f32 v103, v31
    v_mfma_f32_32x32x16_bf16 v[48:63], a[140:143], a[112:115], v[48:63]
    s_add_u32 s67, s67, s69
    v_cvt_pk_bf16_f32 v86, v100, v101
    v_cvt_pk_bf16_f32 v87, v102, v103
    v_exp_f32_e64 v96, v32
    v_exp_f32 v97, v33
    v_exp_f32 v98, v34
    v_exp_f32 v99, v35
    v_mfma_f32_32x32x16_bf16 v[64:79], a[140:143], a[116:119], v[64:79]
    s_waitcnt vmcnt(20)
    v_cvt_pk_bf16_f32 v88, v96, v97
    v_cvt_pk_bf16_f32 v89, v98, v99
    v_exp_f32_e64 v100, v36
    v_exp_f32 v101, v37
    v_exp_f32 v102, v38
    v_exp_f32 v103, v39
    v_mfma_f32_32x32x16_bf16 a[0:15], a[164:167], v[84:87], a[0:15]
    s_waitcnt vmcnt(17)
    ds_read_b64_tr_b16 v[216:217], v12 offset:4096
    ds_read_b64_tr_b16 v[218:219], v12 offset:4352
    v_cvt_pk_bf16_f32 v90, v100, v101
    v_cvt_pk_bf16_f32 v91, v102, v103
    v_exp_f32_e64 v96, v40
    v_exp_f32 v97, v41
    v_exp_f32 v98, v42
    v_exp_f32 v99, v43
    v_mfma_f32_32x32x16_bf16 a[16:31], a[160:163], v[88:91], a[16:31]
    ds_read_b64_tr_b16 v[220:221], v13 offset:4104
    ds_read_b64_tr_b16 v[222:223], v13 offset:4360
    v_cvt_pk_bf16_f32 v92, v96, v97
    v_cvt_pk_bf16_f32 v93, v98, v99
    v_exp_f32 v100, v44
    v_exp_f32 v101, v45
    v_exp_f32 v102, v46
    v_exp_f32 v103, v47
    v_mfma_f32_32x32x4_2b_bf16 v[16:47], a[184:185], a[134:135], 0 cbsz:1 abid:1
    v_cvt_pk_bf16_f32 v94, v100, v101
    v_cvt_pk_bf16_f32 v95, v102, v103
    v_exp_f32 v96, v48
    v_exp_f32 v97, v49
    v_exp_f32 v98, v50
    v_exp_f32 v99, v51
    v_cvt_pk_bf16_f32 v80, v96, v97
    v_cvt_pk_bf16_f32 v81, v98, v99
    v_exp_f32 v100, v52
    v_exp_f32 v101, v53
    v_exp_f32 v102, v54
    v_exp_f32 v103, v55
    v_mfma_f32_32x32x16_bf16 a[16:31], a[164:167], v[92:95], a[16:31]
    buffer_load_dwordx4 a[156:159], v138, s[4:7], s73 offen offset:2560 sc1
    v_cvt_pk_bf16_f32 v82, v100, v101
    v_cvt_pk_bf16_f32 v83, v102, v103
    v_exp_f32 v96, v56
    v_exp_f32 v97, v57
    v_exp_f32 v98, v58
    v_exp_f32 v99, v59
    v_mfma_f32_32x32x16_bf16 a[32:47], a[160:163], v[80:83], a[32:47]
    s_add_u32 s73, s73, 5120
    v_cvt_pk_bf16_f32 v84, v96, v97
    v_cvt_pk_bf16_f32 v85, v98, v99
    v_exp_f32 v100, v60
    v_exp_f32 v101, v61
    v_exp_f32 v102, v62
    v_exp_f32 v103, v63
    v_mfma_f32_32x32x16_bf16 v[16:31], a[140:143], a[120:123], v[16:31]
    s_waitcnt lgkmcnt(0)
    buffer_store_dwordx4 v[216:219], v253, s[4:7], s67 offen sc1
    v_cvt_pk_bf16_f32 v86, v100, v101
    v_cvt_pk_bf16_f32 v87, v102, v103
    v_exp_f32_e64 v96, v64
    v_exp_f32 v97, v65
    v_mfma_f32_16x16x32_bf16 v[204:207], v[212:215], v[216:219], v[204:207]
    v_exp_f32 v98, v66
    v_exp_f32 v99, v67
    v_mfma_f32_32x32x16_bf16 v[32:47], a[140:143], a[124:127], v[32:47]
    s_add_u32 s67, s67, s68
    v_cvt_pk_bf16_f32 v88, v96, v97
    v_cvt_pk_bf16_f32 v89, v98, v99
    v_exp_f32_e64 v100, v68
    v_exp_f32 v101, v69
    v_mfma_f32_16x16x32_bf16 v[208:211], v[212:215], v[220:223], v[208:211]
    v_exp_f32 v102, v70
    v_exp_f32 v103, v71
    v_mfma_f32_32x32x16_bf16 a[32:47], a[164:167], v[84:87], a[32:47]
    v_cvt_pk_bf16_f32 v90, v100, v101
    v_cvt_pk_bf16_f32 v91, v102, v103
    v_exp_f32 v96, v72
    v_exp_f32 v97, v73
    v_exp_f32 v98, v74
    v_exp_f32 v99, v75
    v_mfma_f32_32x32x16_bf16 a[48:63], a[160:163], v[88:91], a[48:63]
    v_cvt_pk_bf16_f32 v92, v96, v97
    v_cvt_pk_bf16_f32 v93, v98, v99
    v_exp_f32 v100, v76
    v_exp_f32 v101, v77
    v_exp_f32 v102, v78
    v_exp_f32 v103, v79
    v_mfma_f32_32x32x4_2b_bf16 v[48:79], a[184:185], a[128:129], 0 cbsz:1 abid:1
    v_cvt_pk_bf16_f32 v94, v100, v101
    v_cvt_pk_bf16_f32 v95, v102, v103
    v_exp_f32 v96, v16
    v_exp_f32 v97, v17
    v_exp_f32 v98, v18
    v_exp_f32 v99, v19
    v_cvt_pk_bf16_f32 v80, v96, v97
    v_cvt_pk_bf16_f32 v81, v98, v99
    v_exp_f32 v100, v20
    v_exp_f32 v101, v21
    v_exp_f32 v102, v22
    v_exp_f32 v103, v23
    v_mfma_f32_32x32x16_bf16 a[48:63], a[164:167], v[92:95], a[48:63]
    buffer_load_dwordx2 a[184:185], v137, s[12:15], s74 offen sc1
    v_cvt_pk_bf16_f32 v82, v100, v101
    v_cvt_pk_bf16_f32 v83, v102, v103
    v_exp_f32 v96, v24
    v_exp_f32 v97, v25
    v_exp_f32 v98, v26
    v_exp_f32 v99, v27
    v_mfma_f32_32x32x16_bf16 a[64:79], a[160:163], v[80:83], a[64:79]
    s_add_u32 s74, s74, 5120
    buffer_store_dwordx4 v[220:223], v253, s[4:7], s67 offen sc1
    v_cvt_pk_bf16_f32 v84, v96, v97
    v_cvt_pk_bf16_f32 v85, v98, v99
    v_exp_f32 v100, v28
    v_exp_f32 v101, v29
    v_exp_f32 v102, v30
    v_exp_f32 v103, v31
    v_mfma_f32_32x32x16_bf16 v[48:63], a[140:143], a[96:99], v[48:63]
    s_add_u32 s67, s67, s69
    v_cvt_pk_bf16_f32 v86, v100, v101
    v_cvt_pk_bf16_f32 v87, v102, v103
    v_exp_f32_e64 v96, v32
    v_exp_f32 v97, v33
    v_exp_f32 v98, v34
    v_exp_f32 v99, v35
    v_mfma_f32_32x32x16_bf16 v[64:79], a[140:143], a[100:103], v[64:79]
    s_waitcnt vmcnt(17)
    ds_read_b64_tr_b16 v[224:225], v202 offset:6144
    ds_read_b64_tr_b16 v[226:227], v202 offset:6400
    v_cvt_pk_bf16_f32 v88, v96, v97
    v_cvt_pk_bf16_f32 v89, v98, v99
    v_exp_f32_e64 v100, v36
    v_exp_f32 v101, v37
    v_exp_f32 v102, v38
    v_exp_f32 v103, v39
    v_mfma_f32_32x32x16_bf16 a[64:79], a[164:167], v[84:87], a[64:79]
    ds_read_b64_tr_b16 v[228:229], v202 offset:6152
    v_cvt_pk_bf16_f32 v90, v100, v101
    v_cvt_pk_bf16_f32 v91, v102, v103
    v_exp_f32 v96, v40
    v_exp_f32 v97, v41
    v_exp_f32 v98, v42
    v_exp_f32 v99, v43
    v_mfma_f32_32x32x16_bf16 a[80:95], a[160:163], v[88:91], a[80:95]
    s_waitcnt vmcnt(14)
    ds_read_b64_tr_b16 v[230:231], v202 offset:6408
    v_cvt_pk_bf16_f32 v92, v96, v97
    v_cvt_pk_bf16_f32 v93, v98, v99
    v_exp_f32_e64 v100, v44
    v_exp_f32 v101, v45
    v_exp_f32 v102, v46
    v_exp_f32 v103, v47
    v_mfma_f32_32x32x4_2b_bf16 v[16:47], a[186:187], a[130:131], 0 cbsz:1 abid:0
    v_cvt_pk_bf16_f32 v94, v100, v101
    v_cvt_pk_bf16_f32 v95, v102, v103
    v_exp_f32 v96, v48
    v_exp_f32 v97, v49
    v_exp_f32 v98, v50
    v_exp_f32 v99, v51
    v_cvt_pk_bf16_f32 v80, v96, v97
    v_cvt_pk_bf16_f32 v81, v98, v99
    v_exp_f32 v100, v52
    v_exp_f32 v101, v53
    v_exp_f32 v102, v54
    v_exp_f32 v103, v55
    v_mfma_f32_32x32x16_bf16 a[80:95], a[164:167], v[92:95], a[80:95]
    buffer_load_dwordx4 a[140:143], v136, s[12:15], s72 offen offset:2560 sc1
    v_cvt_pk_bf16_f32 v82, v100, v101
    v_cvt_pk_bf16_f32 v83, v102, v103
    v_exp_f32 v96, v56
    v_exp_f32 v97, v57
    v_exp_f32 v98, v58
    v_exp_f32 v99, v59
    v_mfma_f32_32x32x16_bf16 v[104:119], a[160:163], v[80:83], v[104:119]
    s_add_u32 s72, s72, 5120
    v_cvt_pk_bf16_f32 v84, v96, v97
    v_cvt_pk_bf16_f32 v85, v98, v99
    v_exp_f32 v100, v60
    v_exp_f32 v101, v61
    v_exp_f32 v102, v62
    v_exp_f32 v103, v63
    v_mfma_f32_32x32x16_bf16 v[16:31], a[144:147], a[104:107], v[16:31]
    s_waitcnt lgkmcnt(0)
    buffer_store_dwordx4 v[224:227], v253, s[4:7], s67 offen sc1
    v_cvt_pk_bf16_f32 v86, v100, v101
    v_cvt_pk_bf16_f32 v87, v102, v103
    v_exp_f32_e64 v96, v64
    v_exp_f32 v97, v65
    v_mfma_f32_16x16x32_bf16 v[204:207], v[212:215], v[224:227], v[204:207]
    v_exp_f32 v98, v66
    v_exp_f32 v99, v67
    v_mfma_f32_32x32x16_bf16 v[32:47], a[144:147], a[108:111], v[32:47]
    s_add_u32 s67, s67, s68
    v_cvt_pk_bf16_f32 v88, v96, v97
    v_cvt_pk_bf16_f32 v89, v98, v99
    v_exp_f32_e64 v100, v68
    v_exp_f32 v101, v69
    v_mfma_f32_16x16x32_bf16 v[208:211], v[212:215], v[228:231], v[208:211]
    v_exp_f32 v102, v70
    v_exp_f32 v103, v71
    v_mfma_f32_32x32x16_bf16 v[104:119], a[164:167], v[84:87], v[104:119]
    v_cvt_pk_bf16_f32 v90, v100, v101
    v_cvt_pk_bf16_f32 v91, v102, v103
    v_exp_f32 v96, v72
    v_exp_f32 v97, v73
    v_exp_f32 v98, v74
    v_exp_f32 v99, v75
    v_mfma_f32_32x32x16_bf16 v[120:135], a[160:163], v[88:91], v[120:135]
    v_cvt_pk_bf16_f32 v92, v96, v97
    v_cvt_pk_bf16_f32 v93, v98, v99
    v_exp_f32 v100, v76
    v_exp_f32 v101, v77
    v_exp_f32 v102, v78
    v_exp_f32 v103, v79
    v_mfma_f32_32x32x4_2b_bf16 v[48:79], a[186:187], a[132:133], 0 cbsz:1 abid:0
    v_cvt_pk_bf16_f32 v94, v100, v101
    v_cvt_pk_bf16_f32 v95, v102, v103
    v_exp_f32 v96, v16
    v_exp_f32 v97, v17
    v_exp_f32 v98, v18
    v_exp_f32 v99, v19
    v_cvt_pk_bf16_f32 v80, v96, v97
    v_cvt_pk_bf16_f32 v81, v98, v99
    v_exp_f32 v100, v20
    v_exp_f32 v101, v21
    v_exp_f32 v102, v22
    v_exp_f32 v103, v23
    v_mfma_f32_32x32x16_bf16 v[120:135], a[164:167], v[92:95], v[120:135]
    buffer_load_dwordx4 a[160:163], v138, s[4:7], s73 offen offset:0 sc1
    v_cvt_pk_bf16_f32 v82, v100, v101
    v_cvt_pk_bf16_f32 v83, v102, v103
    v_exp_f32 v96, v24
    v_exp_f32 v97, v25
    v_exp_f32 v98, v26
    v_exp_f32 v99, v27
    v_mfma_f32_32x32x16_bf16 a[0:15], a[168:171], v[80:83], a[0:15]
    buffer_store_dwordx4 v[228:231], v253, s[4:7], s67 offen sc1
    v_cvt_pk_bf16_f32 v84, v96, v97
    v_cvt_pk_bf16_f32 v85, v98, v99
    v_exp_f32 v100, v28
    v_exp_f32 v101, v29
    v_exp_f32 v102, v30
    v_exp_f32 v103, v31
    v_mfma_f32_32x32x16_bf16 v[48:63], a[144:147], a[112:115], v[48:63]
    s_add_u32 s67, s67, s69
    v_cvt_pk_bf16_f32 v86, v100, v101
    v_cvt_pk_bf16_f32 v87, v102, v103
    v_exp_f32_e64 v96, v32
    v_exp_f32 v97, v33
    v_exp_f32 v98, v34
    v_exp_f32 v99, v35
    v_mfma_f32_32x32x16_bf16 v[64:79], a[144:147], a[116:119], v[64:79]
    s_waitcnt vmcnt(17)
    ds_read_b64_tr_b16 v[216:217], v202 offset:8192
    ds_read_b64_tr_b16 v[218:219], v202 offset:8448
    v_cvt_pk_bf16_f32 v88, v96, v97
    v_cvt_pk_bf16_f32 v89, v98, v99
    v_exp_f32_e64 v100, v36
    v_exp_f32 v101, v37
    v_exp_f32 v102, v38
    v_exp_f32 v103, v39
    v_mfma_f32_32x32x16_bf16 a[0:15], a[172:175], v[84:87], a[0:15]
    ds_read_b64_tr_b16 v[220:221], v202 offset:8200
    v_cvt_pk_bf16_f32 v90, v100, v101
    v_cvt_pk_bf16_f32 v91, v102, v103
    v_exp_f32 v96, v40
    v_exp_f32 v97, v41
    v_exp_f32 v98, v42
    v_exp_f32 v99, v43
    v_mfma_f32_32x32x16_bf16 a[16:31], a[168:171], v[88:91], a[16:31]
    ds_read_b64_tr_b16 v[222:223], v202 offset:8456
    v_cvt_pk_bf16_f32 v92, v96, v97
    v_cvt_pk_bf16_f32 v93, v98, v99
    v_exp_f32 v100, v44
    v_exp_f32 v101, v45
    v_exp_f32 v102, v46
    v_exp_f32 v103, v47
    v_mfma_f32_32x32x4_2b_bf16 v[16:47], a[186:187], a[134:135], 0 cbsz:1 abid:0
    v_cvt_pk_bf16_f32 v94, v100, v101
    v_cvt_pk_bf16_f32 v95, v102, v103
    v_exp_f32 v96, v48
    v_exp_f32 v97, v49
    v_exp_f32 v98, v50
    v_exp_f32 v99, v51
    v_cvt_pk_bf16_f32 v80, v96, v97
    v_cvt_pk_bf16_f32 v81, v98, v99
    v_exp_f32 v100, v52
    v_exp_f32 v101, v53
    v_exp_f32 v102, v54
    v_exp_f32 v103, v55
    v_mfma_f32_32x32x16_bf16 a[16:31], a[172:175], v[92:95], a[16:31]
    buffer_load_dwordx4 a[164:167], v138, s[4:7], s73 offen offset:2560 sc1
    v_cvt_pk_bf16_f32 v82, v100, v101
    v_cvt_pk_bf16_f32 v83, v102, v103
    v_exp_f32 v96, v56
    v_exp_f32 v97, v57
    v_exp_f32 v98, v58
    v_exp_f32 v99, v59
    v_mfma_f32_32x32x16_bf16 a[32:47], a[168:171], v[80:83], a[32:47]
    s_add_u32 s73, s73, 5120
    v_cvt_pk_bf16_f32 v84, v96, v97
    v_cvt_pk_bf16_f32 v85, v98, v99
    v_exp_f32 v100, v60
    v_exp_f32 v101, v61
    v_exp_f32 v102, v62
    v_exp_f32 v103, v63
    v_mfma_f32_32x32x16_bf16 v[16:31], a[144:147], a[120:123], v[16:31]
    s_waitcnt lgkmcnt(0)
    buffer_store_dwordx4 v[216:219], v253, s[4:7], s67 offen sc1
    v_cvt_pk_bf16_f32 v86, v100, v101
    v_cvt_pk_bf16_f32 v87, v102, v103
    v_exp_f32_e64 v96, v64
    v_exp_f32 v97, v65
    v_mfma_f32_16x16x32_bf16 v[204:207], v[212:215], v[216:219], v[204:207]
    v_exp_f32 v98, v66
    v_exp_f32 v99, v67
    v_mfma_f32_32x32x16_bf16 v[32:47], a[144:147], a[124:127], v[32:47]
    s_add_u32 s67, s67, s68
    v_cvt_pk_bf16_f32 v88, v96, v97
    v_cvt_pk_bf16_f32 v89, v98, v99
    v_exp_f32_e64 v100, v68
    v_exp_f32 v101, v69
    v_mfma_f32_16x16x32_bf16 v[208:211], v[212:215], v[220:223], v[208:211]
    v_exp_f32 v102, v70
    v_exp_f32 v103, v71
    v_mfma_f32_32x32x16_bf16 a[32:47], a[172:175], v[84:87], a[32:47]
    v_cvt_pk_bf16_f32 v90, v100, v101
    v_cvt_pk_bf16_f32 v91, v102, v103
    v_exp_f32 v96, v72
    v_exp_f32 v97, v73
    v_exp_f32 v98, v74
    v_exp_f32 v99, v75
    v_mfma_f32_32x32x16_bf16 a[48:63], a[168:171], v[88:91], a[48:63]
    v_cvt_pk_bf16_f32 v92, v96, v97
    v_cvt_pk_bf16_f32 v93, v98, v99
    v_exp_f32 v100, v76
    v_exp_f32 v101, v77
    v_exp_f32 v102, v78
    v_exp_f32 v103, v79
    v_mfma_f32_32x32x4_2b_bf16 v[48:79], a[186:187], a[128:129], 0 cbsz:1 abid:0
    v_cvt_pk_bf16_f32 v94, v100, v101
    v_cvt_pk_bf16_f32 v95, v102, v103
    v_exp_f32 v96, v16
    v_exp_f32 v97, v17
    v_exp_f32 v98, v18
    v_exp_f32 v99, v19
    v_cvt_pk_bf16_f32 v80, v96, v97
    v_cvt_pk_bf16_f32 v81, v98, v99
    v_exp_f32 v100, v20
    v_exp_f32 v101, v21
    v_exp_f32 v102, v22
    v_exp_f32 v103, v23
    v_mfma_f32_32x32x16_bf16 a[48:63], a[172:175], v[92:95], a[48:63]
    global_load_dword v248, v247, s[20:21] sc1
    v_cvt_pk_bf16_f32 v82, v100, v101
    v_cvt_pk_bf16_f32 v83, v102, v103
    v_exp_f32 v96, v24
    v_exp_f32 v97, v25
    v_exp_f32 v98, v26
    v_exp_f32 v99, v27
    v_mfma_f32_32x32x16_bf16 a[64:79], a[168:171], v[80:83], a[64:79]
    buffer_store_dwordx4 v[220:223], v253, s[4:7], s67 offen sc1
    v_cvt_pk_bf16_f32 v84, v96, v97
    v_cvt_pk_bf16_f32 v85, v98, v99
    v_exp_f32 v100, v28
    v_exp_f32 v101, v29
    v_exp_f32 v102, v30
    v_exp_f32 v103, v31
    v_mfma_f32_32x32x16_bf16 v[48:63], a[144:147], a[96:99], v[48:63]
    s_add_u32 s67, s67, s69
    buffer_store_dword v204, v203, s[4:7], s70 offen offset:0 sc1
    v_cvt_pk_bf16_f32 v86, v100, v101
    v_cvt_pk_bf16_f32 v87, v102, v103
    v_exp_f32_e64 v96, v32
    v_exp_f32 v97, v33
    v_exp_f32 v98, v34
    v_exp_f32 v99, v35
    v_mfma_f32_32x32x16_bf16 v[64:79], a[144:147], a[100:103], v[64:79]
    v_cvt_pk_bf16_f32 v88, v96, v97
    v_cvt_pk_bf16_f32 v89, v98, v99
    v_exp_f32 v100, v36
    v_exp_f32 v101, v37
    v_exp_f32 v102, v38
    v_exp_f32 v103, v39
    v_mfma_f32_32x32x16_bf16 a[64:79], a[172:175], v[84:87], a[64:79]
    buffer_store_dword v208, v203, s[4:7], s70 offen offset:128 sc1
    v_cvt_pk_bf16_f32 v90, v100, v101
    v_cvt_pk_bf16_f32 v91, v102, v103
    v_exp_f32 v96, v40
    v_exp_f32 v97, v41
    v_exp_f32 v98, v42
    v_exp_f32 v99, v43
    v_mfma_f32_32x32x16_bf16 a[80:95], a[168:171], v[88:91], a[80:95]
    v_cvt_pk_bf16_f32 v92, v96, v97
    v_cvt_pk_bf16_f32 v93, v98, v99
    v_exp_f32 v100, v44
    v_exp_f32 v101, v45
    v_exp_f32 v102, v46
    v_exp_f32 v103, v47
    v_mfma_f32_32x32x4_2b_bf16 v[16:47], a[186:187], a[130:131], 0 cbsz:1 abid:1
    v_cvt_pk_bf16_f32 v94, v100, v101
    v_cvt_pk_bf16_f32 v95, v102, v103
    v_exp_f32 v96, v48
    v_exp_f32 v97, v49
    v_exp_f32 v98, v50
    v_exp_f32 v99, v51
    v_cvt_pk_bf16_f32 v80, v96, v97
    v_cvt_pk_bf16_f32 v81, v98, v99
    v_exp_f32 v100, v52
    v_exp_f32 v101, v53
    v_exp_f32 v102, v54
    v_exp_f32 v103, v55
    v_mfma_f32_32x32x16_bf16 a[80:95], a[172:175], v[92:95], a[80:95]
    buffer_load_dwordx4 a[144:147], v136, s[12:15], s72 offen offset:0 sc1
    v_cvt_pk_bf16_f32 v82, v100, v101
    v_cvt_pk_bf16_f32 v83, v102, v103
    v_exp_f32 v96, v56
    v_exp_f32 v97, v57
    v_exp_f32 v98, v58
    v_exp_f32 v99, v59
    v_mfma_f32_32x32x16_bf16 v[104:119], a[168:171], v[80:83], v[104:119]
    s_waitcnt vmcnt(23)
    v_cvt_pk_bf16_f32 v84, v96, v97
    v_cvt_pk_bf16_f32 v85, v98, v99
    v_exp_f32_e64 v100, v60
    v_exp_f32 v101, v61
    v_exp_f32 v102, v62
    v_exp_f32 v103, v63
    v_mfma_f32_32x32x16_bf16 v[16:31], a[148:151], a[104:107], v[16:31]
    v_cvt_pk_bf16_f32 v86, v100, v101
    v_cvt_pk_bf16_f32 v87, v102, v103
    v_exp_f32 v96, v64
    v_exp_f32 v97, v65
    v_exp_f32 v98, v66
    v_exp_f32 v99, v67
    v_mfma_f32_32x32x16_bf16 v[32:47], a[148:151], a[108:111], v[32:47]
    v_cvt_pk_bf16_f32 v88, v96, v97
    v_cvt_pk_bf16_f32 v89, v98, v99
    v_exp_f32 v100, v68
    v_exp_f32 v101, v69
    v_exp_f32 v102, v70
    v_exp_f32 v103, v71
    v_mfma_f32_32x32x16_bf16 v[104:119], a[172:175], v[84:87], v[104:119]
sequential_preLN__softmax_full_mha__glu_gated_bilinear__prompt_kernel_pgatt2:
    s_cbranch_execz sequential_preLN__softmax_full_mha__glu_gated_bilinear__prompt_kernel_wratt
    v_cvt_pk_bf16_f32 v90, v100, v101
    v_cvt_pk_bf16_f32 v91, v102, v103
    v_exp_f32 v96, v72
    v_exp_f32 v97, v73
    v_exp_f32 v98, v74
    v_exp_f32 v99, v75
    v_mfma_f32_32x32x16_bf16 v[120:135], a[168:171], v[88:91], v[120:135]
    v_cvt_pk_bf16_f32 v92, v96, v97
    v_cvt_pk_bf16_f32 v93, v98, v99
    v_exp_f32 v100, v76
    v_exp_f32 v101, v77
    v_exp_f32 v102, v78
    v_exp_f32 v103, v79
    v_mfma_f32_32x32x4_2b_bf16 v[48:79], a[186:187], a[132:133], 0 cbsz:1 abid:1
    v_cvt_pk_bf16_f32 v94, v100, v101
    v_cvt_pk_bf16_f32 v95, v102, v103
    v_exp_f32 v96, v16
    v_exp_f32 v97, v17
    v_exp_f32 v98, v18
    v_exp_f32 v99, v19
    v_cvt_pk_bf16_f32 v80, v96, v97
    v_cvt_pk_bf16_f32 v81, v98, v99
    v_exp_f32 v100, v20
    v_exp_f32 v101, v21
    v_exp_f32 v102, v22
    v_exp_f32 v103, v23
    v_mfma_f32_32x32x16_bf16 v[120:135], a[172:175], v[92:95], v[120:135]
    s_waitcnt vmcnt(22)
    buffer_load_dwordx4 a[168:171], v138, s[4:7], s73 offen offset:0 sc1
    v_cvt_pk_bf16_f32 v82, v100, v101
    v_cvt_pk_bf16_f32 v83, v102, v103
    v_exp_f32_e64 v96, v24
    v_exp_f32 v97, v25
    v_exp_f32 v98, v26
    v_exp_f32 v99, v27
    v_mfma_f32_32x32x16_bf16 a[0:15], a[176:179], v[80:83], a[0:15]
    v_cvt_pk_bf16_f32 v84, v96, v97
    v_cvt_pk_bf16_f32 v85, v98, v99
    v_exp_f32 v100, v28
    v_exp_f32 v101, v29
    v_exp_f32 v102, v30
    v_exp_f32 v103, v31
    v_mfma_f32_32x32x16_bf16 v[48:63], a[148:151], a[112:115], v[48:63]
    v_cvt_pk_bf16_f32 v86, v100, v101
    v_cvt_pk_bf16_f32 v87, v102, v103
    v_exp_f32 v96, v32
    v_exp_f32 v97, v33
    v_exp_f32 v98, v34
    v_exp_f32 v99, v35
    v_mfma_f32_32x32x16_bf16 v[64:79], a[148:151], a[116:119], v[64:79]
    s_waitcnt vmcnt(22)
    v_cvt_pk_bf16_f32 v88, v96, v97
    v_cvt_pk_bf16_f32 v89, v98, v99
    v_exp_f32_e64 v100, v36
    v_exp_f32 v101, v37
    v_exp_f32 v102, v38
    v_exp_f32 v103, v39
    v_mfma_f32_32x32x16_bf16 a[0:15], a[180:183], v[84:87], a[0:15]
    v_cvt_pk_bf16_f32 v90, v100, v101
    v_cvt_pk_bf16_f32 v91, v102, v103
    v_exp_f32 v96, v40
    v_exp_f32 v97, v41
    v_exp_f32 v98, v42
    v_exp_f32 v99, v43
    v_mfma_f32_32x32x16_bf16 a[16:31], a[176:179], v[88:91], a[16:31]
    v_cvt_pk_bf16_f32 v92, v96, v97
    v_cvt_pk_bf16_f32 v93, v98, v99
    v_exp_f32 v100, v44
    v_exp_f32 v101, v45
    v_exp_f32 v102, v46
    v_exp_f32 v103, v47
    v_mfma_f32_32x32x4_2b_bf16 v[16:47], a[186:187], a[134:135], 0 cbsz:1 abid:1
    v_cvt_pk_bf16_f32 v94, v100, v101
    v_cvt_pk_bf16_f32 v95, v102, v103
    v_exp_f32 v96, v48
    v_exp_f32 v97, v49
    v_exp_f32 v98, v50
    v_exp_f32 v99, v51
    v_cvt_pk_bf16_f32 v80, v96, v97
    v_cvt_pk_bf16_f32 v81, v98, v99
    v_exp_f32 v100, v52
    v_exp_f32 v101, v53
    v_exp_f32 v102, v54
    v_exp_f32 v103, v55
    v_mfma_f32_32x32x16_bf16 a[16:31], a[180:183], v[92:95], a[16:31]
    buffer_load_dwordx4 a[172:175], v138, s[4:7], s73 offen offset:2560 sc1
    v_cvt_pk_bf16_f32 v82, v100, v101
    v_cvt_pk_bf16_f32 v83, v102, v103
    v_exp_f32 v96, v56
    v_exp_f32 v97, v57
    v_exp_f32 v98, v58
    v_exp_f32 v99, v59
    v_mfma_f32_32x32x16_bf16 a[32:47], a[176:179], v[80:83], a[32:47]
    s_add_u32 s73, s73, 5120
    v_cvt_pk_bf16_f32 v84, v96, v97
    v_cvt_pk_bf16_f32 v85, v98, v99
    v_exp_f32 v100, v60
    v_exp_f32 v101, v61
    v_exp_f32 v102, v62
    v_exp_f32 v103, v63
    v_mfma_f32_32x32x16_bf16 v[16:31], a[148:151], a[120:123], v[16:31]
    v_cvt_pk_bf16_f32 v86, v100, v101
    v_cvt_pk_bf16_f32 v87, v102, v103
    v_exp_f32 v96, v64
    v_exp_f32 v97, v65
    v_exp_f32 v98, v66
    v_exp_f32 v99, v67
    v_mfma_f32_32x32x16_bf16 v[32:47], a[148:151], a[124:127], v[32:47]
    v_cvt_pk_bf16_f32 v88, v96, v97
    v_cvt_pk_bf16_f32 v89, v98, v99
    v_exp_f32 v100, v68
    v_exp_f32 v101, v69
    v_exp_f32 v102, v70
    v_exp_f32 v103, v71
    v_mfma_f32_32x32x16_bf16 a[32:47], a[180:183], v[84:87], a[32:47]
    v_cvt_pk_bf16_f32 v90, v100, v101
    v_cvt_pk_bf16_f32 v91, v102, v103
    v_exp_f32 v96, v72
    v_exp_f32 v97, v73
    v_exp_f32 v98, v74
    v_exp_f32 v99, v75
    v_mfma_f32_32x32x16_bf16 a[48:63], a[176:179], v[88:91], a[48:63]
    v_cvt_pk_bf16_f32 v92, v96, v97
    v_cvt_pk_bf16_f32 v93, v98, v99
    v_exp_f32 v100, v76
    v_exp_f32 v101, v77
    v_exp_f32 v102, v78
    v_exp_f32 v103, v79
    v_mfma_f32_32x32x4_2b_bf16 v[48:79], a[186:187], a[128:129], 0 cbsz:1 abid:1
    v_cvt_pk_bf16_f32 v94, v100, v101
    v_cvt_pk_bf16_f32 v95, v102, v103
    v_exp_f32 v96, v16
    v_exp_f32 v97, v17
    v_exp_f32 v98, v18
    v_exp_f32 v99, v19
    v_cvt_pk_bf16_f32 v80, v96, v97
    v_cvt_pk_bf16_f32 v81, v98, v99
    v_exp_f32 v100, v20
    v_exp_f32 v101, v21
    v_exp_f32 v102, v22
    v_exp_f32 v103, v23
    v_mfma_f32_32x32x16_bf16 a[48:63], a[180:183], v[92:95], a[48:63]
    buffer_load_dwordx2 a[186:187], v137, s[12:15], s74 offen sc1
    v_cvt_pk_bf16_f32 v82, v100, v101
    v_cvt_pk_bf16_f32 v83, v102, v103
    v_exp_f32 v96, v24
    v_exp_f32 v97, v25
    v_exp_f32 v98, v26
    v_exp_f32 v99, v27
    v_mfma_f32_32x32x16_bf16 a[64:79], a[176:179], v[80:83], a[64:79]
    s_add_u32 s74, s74, 5120
    v_cvt_pk_bf16_f32 v84, v96, v97
    v_cvt_pk_bf16_f32 v85, v98, v99
    v_exp_f32 v100, v28
    v_exp_f32 v101, v29
    v_exp_f32 v102, v30
    v_exp_f32 v103, v31
    v_mfma_f32_32x32x16_bf16 v[48:63], a[148:151], a[96:99], v[48:63]
    s_waitcnt vmcnt(4)
    buffer_store_dword v7, off, s[4:7], s34 sc1
    v_cvt_pk_bf16_f32 v86, v100, v101
    v_cvt_pk_bf16_f32 v87, v102, v103
    v_exp_f32_e64 v96, v32
    v_exp_f32 v97, v33
    v_exp_f32 v98, v34
    v_exp_f32 v99, v35
    v_mfma_f32_32x32x16_bf16 v[64:79], a[148:151], a[100:103], v[64:79]
    v_cvt_pk_bf16_f32 v88, v96, v97
    v_cvt_pk_bf16_f32 v89, v98, v99
    v_exp_f32 v100, v36
    v_exp_f32 v101, v37
    v_exp_f32 v102, v38
    v_exp_f32 v103, v39
    v_mfma_f32_32x32x16_bf16 a[64:79], a[180:183], v[84:87], a[64:79]
    v_cvt_pk_bf16_f32 v90, v100, v101
    v_cvt_pk_bf16_f32 v91, v102, v103
    v_exp_f32 v96, v40
    v_exp_f32 v97, v41
    v_exp_f32 v98, v42
    v_exp_f32 v99, v43
    v_mfma_f32_32x32x16_bf16 a[80:95], a[176:179], v[88:91], a[80:95]
    v_cvt_pk_bf16_f32 v92, v96, v97
    v_cvt_pk_bf16_f32 v93, v98, v99
    v_exp_f32 v100, v44
    v_exp_f32 v101, v45
    v_exp_f32 v102, v46
    v_exp_f32 v103, v47
    v_mfma_f32_32x32x4_2b_bf16 v[16:47], a[184:185], a[130:131], 0 cbsz:1 abid:0
    v_cvt_pk_bf16_f32 v94, v100, v101
    v_cvt_pk_bf16_f32 v95, v102, v103
    v_exp_f32 v96, v48
    v_exp_f32 v97, v49
    v_exp_f32 v98, v50
    v_exp_f32 v99, v51
    v_cvt_pk_bf16_f32 v80, v96, v97
    v_cvt_pk_bf16_f32 v81, v98, v99
    v_exp_f32 v100, v52
    v_exp_f32 v101, v53
    v_exp_f32 v102, v54
    v_exp_f32 v103, v55
    v_mfma_f32_32x32x16_bf16 a[80:95], a[180:183], v[92:95], a[80:95]
    buffer_load_dwordx4 a[148:151], v136, s[12:15], s72 offen offset:2560 sc1
    v_cvt_pk_bf16_f32 v82, v100, v101
    v_cvt_pk_bf16_f32 v83, v102, v103
    v_exp_f32 v96, v56
    v_exp_f32 v97, v57
    v_exp_f32 v98, v58
    v_exp_f32 v99, v59
    v_mfma_f32_32x32x16_bf16 v[104:119], a[176:179], v[80:83], v[104:119]
    s_add_u32 s72, s72, 5120
    v_cvt_pk_bf16_f32 v84, v96, v97
    v_cvt_pk_bf16_f32 v85, v98, v99
    v_exp_f32 v100, v60
    v_exp_f32 v101, v61
    v_exp_f32 v102, v62
    v_exp_f32 v103, v63
    v_mfma_f32_32x32x16_bf16 v[16:31], a[136:139], a[104:107], v[16:31]
    v_cvt_pk_bf16_f32 v86, v100, v101
    v_cvt_pk_bf16_f32 v87, v102, v103
    v_exp_f32 v96, v64
    v_exp_f32 v97, v65
    v_exp_f32 v98, v66
    v_exp_f32 v99, v67
    v_mfma_f32_32x32x16_bf16 v[32:47], a[136:139], a[108:111], v[32:47]
    v_cvt_pk_bf16_f32 v88, v96, v97
    v_cvt_pk_bf16_f32 v89, v98, v99
    v_exp_f32 v100, v68
    v_exp_f32 v101, v69
    v_exp_f32 v102, v70
    v_exp_f32 v103, v71
    v_mfma_f32_32x32x16_bf16 v[104:119], a[180:183], v[84:87], v[104:119]
    v_cvt_pk_bf16_f32 v90, v100, v101
    v_cvt_pk_bf16_f32 v91, v102, v103
    v_exp_f32 v96, v72
    v_exp_f32 v97, v73
    v_exp_f32 v98, v74
    v_exp_f32 v99, v75
    v_mfma_f32_32x32x16_bf16 v[120:135], a[176:179], v[88:91], v[120:135]
    v_cvt_pk_bf16_f32 v92, v96, v97
    v_cvt_pk_bf16_f32 v93, v98, v99
    v_exp_f32 v100, v76
    v_exp_f32 v101, v77
    v_exp_f32 v102, v78
    v_exp_f32 v103, v79
    v_mfma_f32_32x32x4_2b_bf16 v[48:79], a[184:185], a[132:133], 0 cbsz:1 abid:0
    v_cvt_pk_bf16_f32 v94, v100, v101
    v_cvt_pk_bf16_f32 v95, v102, v103
    v_exp_f32 v96, v16
    v_exp_f32 v97, v17
    v_exp_f32 v98, v18
    v_exp_f32 v99, v19
    v_cvt_pk_bf16_f32 v80, v96, v97
    v_cvt_pk_bf16_f32 v81, v98, v99
    v_exp_f32 v100, v20
    v_exp_f32 v101, v21
    v_exp_f32 v102, v22
    v_exp_f32 v103, v23
    v_mfma_f32_32x32x16_bf16 v[120:135], a[180:183], v[92:95], v[120:135]
    buffer_load_dwordx4 a[176:179], v138, s[4:7], s73 offen offset:0 sc1
    v_cvt_pk_bf16_f32 v82, v100, v101
    v_cvt_pk_bf16_f32 v83, v102, v103
    v_exp_f32 v96, v24
    v_exp_f32 v97, v25
    v_exp_f32 v98, v26
    v_exp_f32 v99, v27
    v_mfma_f32_32x32x16_bf16 a[0:15], a[152:155], v[80:83], a[0:15]
    v_cvt_pk_bf16_f32 v84, v96, v97
    v_cvt_pk_bf16_f32 v85, v98, v99
    v_exp_f32 v100, v28
    v_exp_f32 v101, v29
    v_exp_f32 v102, v30
    v_exp_f32 v103, v31
    v_mfma_f32_32x32x16_bf16 v[48:63], a[136:139], a[112:115], v[48:63]
    v_cvt_pk_bf16_f32 v86, v100, v101
    v_cvt_pk_bf16_f32 v87, v102, v103
    v_exp_f32 v96, v32
    v_exp_f32 v97, v33
    v_exp_f32 v98, v34
    v_exp_f32 v99, v35
    v_mfma_f32_32x32x16_bf16 v[64:79], a[136:139], a[116:119], v[64:79]
    v_cvt_pk_bf16_f32 v88, v96, v97
    v_cvt_pk_bf16_f32 v89, v98, v99
    v_exp_f32 v100, v36
    v_exp_f32 v101, v37
    v_exp_f32 v102, v38
    v_exp_f32 v103, v39
    v_mfma_f32_32x32x16_bf16 a[0:15], a[156:159], v[84:87], a[0:15]
    v_cvt_pk_bf16_f32 v90, v100, v101
    v_cvt_pk_bf16_f32 v91, v102, v103
    v_exp_f32 v96, v40
    v_exp_f32 v97, v41
    v_exp_f32 v98, v42
    v_exp_f32 v99, v43
    v_mfma_f32_32x32x16_bf16 a[16:31], a[152:155], v[88:91], a[16:31]
    v_cvt_pk_bf16_f32 v92, v96, v97
    v_cvt_pk_bf16_f32 v93, v98, v99
    v_exp_f32 v100, v44
    v_exp_f32 v101, v45
    v_exp_f32 v102, v46
    v_exp_f32 v103, v47
    v_mfma_f32_32x32x4_2b_bf16 v[16:47], a[184:185], a[134:135], 0 cbsz:1 abid:0
    v_cvt_pk_bf16_f32 v94, v100, v101
    v_cvt_pk_bf16_f32 v95, v102, v103
    v_exp_f32 v96, v48
    v_exp_f32 v97, v49
    v_exp_f32 v98, v50
    v_exp_f32 v99, v51
    v_cvt_pk_bf16_f32 v80, v96, v97
    v_cvt_pk_bf16_f32 v81, v98, v99
    v_exp_f32 v100, v52
    v_exp_f32 v101, v53
    v_exp_f32 v102, v54
    v_exp_f32 v103, v55
    v_mfma_f32_32x32x16_bf16 a[16:31], a[156:159], v[92:95], a[16:31]
    buffer_load_dwordx4 a[180:183], v138, s[4:7], s73 offen offset:2560 sc1
    v_cvt_pk_bf16_f32 v82, v100, v101
    v_cvt_pk_bf16_f32 v83, v102, v103
    v_exp_f32 v96, v56
    v_exp_f32 v97, v57
    v_exp_f32 v98, v58
    v_exp_f32 v99, v59
    v_mfma_f32_32x32x16_bf16 a[32:47], a[152:155], v[80:83], a[32:47]
    s_add_u32 s73, s73, 5120
    v_cvt_pk_bf16_f32 v84, v96, v97
    v_cvt_pk_bf16_f32 v85, v98, v99
    v_exp_f32 v100, v60
    v_exp_f32 v101, v61
    v_exp_f32 v102, v62
    v_exp_f32 v103, v63
    v_mfma_f32_32x32x16_bf16 v[16:31], a[136:139], a[120:123], v[16:31]
    v_cvt_pk_bf16_f32 v86, v100, v101
    v_cvt_pk_bf16_f32 v87, v102, v103
    v_exp_f32 v96, v64
    v_exp_f32 v97, v65
    v_exp_f32 v98, v66
    v_exp_f32 v99, v67
    v_mfma_f32_32x32x16_bf16 v[32:47], a[136:139], a[124:127], v[32:47]
    v_cvt_pk_bf16_f32 v88, v96, v97
    v_cvt_pk_bf16_f32 v89, v98, v99
    v_exp_f32 v100, v68
    v_exp_f32 v101, v69
    v_exp_f32 v102, v70
    v_exp_f32 v103, v71
    v_mfma_f32_32x32x16_bf16 a[32:47], a[156:159], v[84:87], a[32:47]
    v_cvt_pk_bf16_f32 v90, v100, v101
    v_cvt_pk_bf16_f32 v91, v102, v103
    v_exp_f32 v96, v72
    v_exp_f32 v97, v73
    v_exp_f32 v98, v74
    v_exp_f32 v99, v75
    v_mfma_f32_32x32x16_bf16 a[48:63], a[152:155], v[88:91], a[48:63]
    v_cvt_pk_bf16_f32 v92, v96, v97
    v_cvt_pk_bf16_f32 v93, v98, v99
    v_exp_f32 v100, v76
    v_exp_f32 v101, v77
    v_exp_f32 v102, v78
    v_exp_f32 v103, v79
    v_mfma_f32_32x32x4_2b_bf16 v[48:79], a[184:185], a[128:129], 0 cbsz:1 abid:0
    v_cvt_pk_bf16_f32 v94, v100, v101
    v_cvt_pk_bf16_f32 v95, v102, v103
    v_exp_f32 v96, v16
    v_exp_f32 v97, v17
    v_exp_f32 v98, v18
    v_exp_f32 v99, v19
    v_cvt_pk_bf16_f32 v80, v96, v97
    v_cvt_pk_bf16_f32 v81, v98, v99
    v_exp_f32 v100, v20
    v_exp_f32 v101, v21
    v_exp_f32 v102, v22
    v_exp_f32 v103, v23
    v_mfma_f32_32x32x16_bf16 a[48:63], a[156:159], v[92:95], a[48:63]
    v_cvt_pk_bf16_f32 v82, v100, v101
    v_cvt_pk_bf16_f32 v83, v102, v103
    v_exp_f32 v96, v24
    v_exp_f32 v97, v25
    v_exp_f32 v98, v26
    v_exp_f32 v99, v27
    v_mfma_f32_32x32x16_bf16 a[64:79], a[152:155], v[80:83], a[64:79]
    v_cvt_pk_bf16_f32 v84, v96, v97
    v_cvt_pk_bf16_f32 v85, v98, v99
    v_exp_f32 v100, v28
    v_exp_f32 v101, v29
    v_exp_f32 v102, v30
    v_exp_f32 v103, v31
    v_mfma_f32_32x32x16_bf16 v[48:63], a[136:139], a[96:99], v[48:63]
    v_cvt_pk_bf16_f32 v86, v100, v101
    v_cvt_pk_bf16_f32 v87, v102, v103
    v_exp_f32 v96, v32
    v_exp_f32 v97, v33
    v_exp_f32 v98, v34
    v_exp_f32 v99, v35
    v_mfma_f32_32x32x16_bf16 v[64:79], a[136:139], a[100:103], v[64:79]
    v_cvt_pk_bf16_f32 v88, v96, v97
    v_cvt_pk_bf16_f32 v89, v98, v99
    v_exp_f32 v100, v36
    v_exp_f32 v101, v37
    v_exp_f32 v102, v38
    v_exp_f32 v103, v39
    v_mfma_f32_32x32x16_bf16 a[64:79], a[156:159], v[84:87], a[64:79]
    v_cvt_pk_bf16_f32 v90, v100, v101
    v_cvt_pk_bf16_f32 v91, v102, v103
    v_exp_f32 v96, v40
    v_exp_f32 v97, v41
    v_exp_f32 v98, v42
    v_exp_f32 v99, v43
    v_mfma_f32_32x32x16_bf16 a[80:95], a[152:155], v[88:91], a[80:95]
    v_cvt_pk_bf16_f32 v92, v96, v97
    v_cvt_pk_bf16_f32 v93, v98, v99
    v_exp_f32 v100, v44
    v_exp_f32 v101, v45
    v_exp_f32 v102, v46
    v_exp_f32 v103, v47
    v_mfma_f32_32x32x4_2b_bf16 v[16:47], a[184:185], a[130:131], 0 cbsz:1 abid:1
    v_cvt_pk_bf16_f32 v94, v100, v101
    v_cvt_pk_bf16_f32 v95, v102, v103
    v_exp_f32 v96, v48
    v_exp_f32 v97, v49
    v_exp_f32 v98, v50
    v_exp_f32 v99, v51
    v_cvt_pk_bf16_f32 v80, v96, v97
    v_cvt_pk_bf16_f32 v81, v98, v99
    v_exp_f32 v100, v52
    v_exp_f32 v101, v53
    v_exp_f32 v102, v54
    v_exp_f32 v103, v55
    v_mfma_f32_32x32x16_bf16 a[80:95], a[156:159], v[92:95], a[80:95]
    buffer_load_dwordx4 a[136:139], v136, s[12:15], s72 offen offset:0 sc1
    v_cvt_pk_bf16_f32 v82, v100, v101
    v_cvt_pk_bf16_f32 v83, v102, v103
    v_exp_f32 v96, v56
    v_exp_f32 v97, v57
    v_exp_f32 v98, v58
    v_exp_f32 v99, v59
    v_mfma_f32_32x32x16_bf16 v[104:119], a[152:155], v[80:83], v[104:119]
    v_cvt_pk_bf16_f32 v84, v96, v97
    v_cvt_pk_bf16_f32 v85, v98, v99
    v_exp_f32 v100, v60
    v_exp_f32 v101, v61
    v_exp_f32 v102, v62
    v_exp_f32 v103, v63
    v_mfma_f32_32x32x16_bf16 v[16:31], a[140:143], a[104:107], v[16:31]
    buffer_load_dwordx4 v[216:219], v11, s[4:7], s101 offen sc1
    v_cvt_pk_bf16_f32 v86, v100, v101
    v_cvt_pk_bf16_f32 v87, v102, v103
    v_exp_f32 v96, v64
    v_exp_f32 v97, v65
    v_exp_f32 v98, v66
    v_exp_f32 v99, v67
    v_mfma_f32_32x32x16_bf16 v[32:47], a[140:143], a[108:111], v[32:47]
    v_cvt_pk_bf16_f32 v88, v96, v97
    v_cvt_pk_bf16_f32 v89, v98, v99
    v_exp_f32 v100, v68
    v_exp_f32 v101, v69
    v_exp_f32 v102, v70
    v_exp_f32 v103, v71
    v_mfma_f32_32x32x16_bf16 v[104:119], a[156:159], v[84:87], v[104:119]
    v_cvt_pk_bf16_f32 v90, v100, v101
    v_cvt_pk_bf16_f32 v91, v102, v103
    v_exp_f32 v96, v72
    v_exp_f32 v97, v73
    v_exp_f32 v98, v74
    v_exp_f32 v99, v75
    v_mfma_f32_32x32x16_bf16 v[120:135], a[152:155], v[88:91], v[120:135]
    v_cvt_pk_bf16_f32 v92, v96, v97
    v_cvt_pk_bf16_f32 v93, v98, v99
    v_exp_f32 v100, v76
    v_exp_f32 v101, v77
    v_exp_f32 v102, v78
    v_exp_f32 v103, v79
    v_mfma_f32_32x32x4_2b_bf16 v[48:79], a[184:185], a[132:133], 0 cbsz:1 abid:1
    v_cvt_pk_bf16_f32 v94, v100, v101
    v_cvt_pk_bf16_f32 v95, v102, v103
    v_exp_f32 v96, v16
    v_exp_f32 v97, v17
    v_exp_f32 v98, v18
    v_exp_f32 v99, v19
    v_cvt_pk_bf16_f32 v80, v96, v97
    v_cvt_pk_bf16_f32 v81, v98, v99
    v_exp_f32 v100, v20
    v_exp_f32 v101, v21
    v_exp_f32 v102, v22
    v_exp_f32 v103, v23
    v_mfma_f32_32x32x16_bf16 v[120:135], a[156:159], v[92:95], v[120:135]
    buffer_load_dwordx4 a[152:155], v138, s[4:7], s73 offen offset:0 sc1
    v_cvt_pk_bf16_f32 v82, v100, v101
    v_cvt_pk_bf16_f32 v83, v102, v103
    v_exp_f32 v96, v24
    v_exp_f32 v97, v25
    v_exp_f32 v98, v26
    v_exp_f32 v99, v27
    v_mfma_f32_32x32x16_bf16 a[0:15], a[160:163], v[80:83], a[0:15]
    v_cvt_pk_bf16_f32 v84, v96, v97
    v_cvt_pk_bf16_f32 v85, v98, v99
    v_exp_f32 v100, v28
    v_exp_f32 v101, v29
    v_exp_f32 v102, v30
    v_exp_f32 v103, v31
    v_mfma_f32_32x32x16_bf16 v[48:63], a[140:143], a[112:115], v[48:63]
    v_cvt_pk_bf16_f32 v86, v100, v101
    v_cvt_pk_bf16_f32 v87, v102, v103
    v_exp_f32 v96, v32
    v_exp_f32 v97, v33
    v_exp_f32 v98, v34
    v_exp_f32 v99, v35
    v_mfma_f32_32x32x16_bf16 v[64:79], a[140:143], a[116:119], v[64:79]
    v_cvt_pk_bf16_f32 v88, v96, v97
    v_cvt_pk_bf16_f32 v89, v98, v99
    v_exp_f32 v100, v36
    v_exp_f32 v101, v37
    v_exp_f32 v102, v38
    v_exp_f32 v103, v39
    v_mfma_f32_32x32x16_bf16 a[0:15], a[164:167], v[84:87], a[0:15]
    v_cvt_pk_bf16_f32 v90, v100, v101
    v_cvt_pk_bf16_f32 v91, v102, v103
    v_exp_f32 v96, v40
    v_exp_f32 v97, v41
    v_exp_f32 v98, v42
    v_exp_f32 v99, v43
    v_mfma_f32_32x32x16_bf16 a[16:31], a[160:163], v[88:91], a[16:31]
    v_cvt_pk_bf16_f32 v92, v96, v97
    v_cvt_pk_bf16_f32 v93, v98, v99
    v_exp_f32 v100, v44
    v_exp_f32 v101, v45
    v_exp_f32 v102, v46
    v_exp_f32 v103, v47
    v_mfma_f32_32x32x4_2b_bf16 v[16:47], a[184:185], a[134:135], 0 cbsz:1 abid:1
    v_cvt_pk_bf16_f32 v94, v100, v101
    v_cvt_pk_bf16_f32 v95, v102, v103
    v_exp_f32 v96, v48
    v_exp_f32 v97, v49
    v_exp_f32 v98, v50
    v_exp_f32 v99, v51
    v_cvt_pk_bf16_f32 v80, v96, v97
    v_cvt_pk_bf16_f32 v81, v98, v99
    v_exp_f32 v100, v52
    v_exp_f32 v101, v53
    v_exp_f32 v102, v54
    v_exp_f32 v103, v55
    v_mfma_f32_32x32x16_bf16 a[16:31], a[164:167], v[92:95], a[16:31]
    buffer_load_dwordx4 a[156:159], v138, s[4:7], s73 offen offset:2560 sc1
    v_cvt_pk_bf16_f32 v82, v100, v101
    v_cvt_pk_bf16_f32 v83, v102, v103
    v_exp_f32 v96, v56
    v_exp_f32 v97, v57
    v_exp_f32 v98, v58
    v_exp_f32 v99, v59
    v_mfma_f32_32x32x16_bf16 a[32:47], a[160:163], v[80:83], a[32:47]
    s_add_u32 s73, s73, 5120
    v_cvt_pk_bf16_f32 v84, v96, v97
    v_cvt_pk_bf16_f32 v85, v98, v99
    v_exp_f32 v100, v60
    v_exp_f32 v101, v61
    v_exp_f32 v102, v62
    v_exp_f32 v103, v63
    v_mfma_f32_32x32x16_bf16 v[16:31], a[140:143], a[120:123], v[16:31]
    v_cvt_pk_bf16_f32 v86, v100, v101
    v_cvt_pk_bf16_f32 v87, v102, v103
    v_exp_f32 v96, v64
    v_exp_f32 v97, v65
    v_exp_f32 v98, v66
    v_exp_f32 v99, v67
    v_mfma_f32_32x32x16_bf16 v[32:47], a[140:143], a[124:127], v[32:47]
    v_cvt_pk_bf16_f32 v88, v96, v97
    v_cvt_pk_bf16_f32 v89, v98, v99
    v_exp_f32 v100, v68
    v_exp_f32 v101, v69
    v_exp_f32 v102, v70
    v_exp_f32 v103, v71
    v_mfma_f32_32x32x16_bf16 a[32:47], a[164:167], v[84:87], a[32:47]
    v_cvt_pk_bf16_f32 v90, v100, v101
    v_cvt_pk_bf16_f32 v91, v102, v103
    v_exp_f32 v96, v72
    v_exp_f32 v97, v73
    v_exp_f32 v98, v74
    v_exp_f32 v99, v75
    v_mfma_f32_32x32x16_bf16 a[48:63], a[160:163], v[88:91], a[48:63]
    v_cvt_pk_bf16_f32 v92, v96, v97
    v_cvt_pk_bf16_f32 v93, v98, v99
    v_exp_f32 v100, v76
    v_exp_f32 v101, v77
    v_exp_f32 v102, v78
    v_exp_f32 v103, v79
    v_mfma_f32_32x32x4_2b_bf16 v[48:79], a[184:185], a[128:129], 0 cbsz:1 abid:1
    v_cvt_pk_bf16_f32 v94, v100, v101
    v_cvt_pk_bf16_f32 v95, v102, v103
    v_exp_f32 v96, v16
    v_exp_f32 v97, v17
    v_exp_f32 v98, v18
    v_exp_f32 v99, v19
    v_cvt_pk_bf16_f32 v80, v96, v97
    v_cvt_pk_bf16_f32 v81, v98, v99
    v_exp_f32 v100, v20
    v_exp_f32 v101, v21
    v_exp_f32 v102, v22
    v_exp_f32 v103, v23
    v_mfma_f32_32x32x16_bf16 a[48:63], a[164:167], v[92:95], a[48:63]
    buffer_load_dwordx2 a[184:185], v137, s[12:15], s74 offen sc1
    v_cvt_pk_bf16_f32 v82, v100, v101
    v_cvt_pk_bf16_f32 v83, v102, v103
    v_exp_f32 v96, v24
    v_exp_f32 v97, v25
    v_exp_f32 v98, v26
    v_exp_f32 v99, v27
    v_mfma_f32_32x32x16_bf16 a[64:79], a[160:163], v[80:83], a[64:79]
    s_add_u32 s74, s74, 5120
    v_cvt_pk_bf16_f32 v84, v96, v97
    v_cvt_pk_bf16_f32 v85, v98, v99
    v_exp_f32 v100, v28
    v_exp_f32 v101, v29
    v_exp_f32 v102, v30
    v_exp_f32 v103, v31
    v_mfma_f32_32x32x16_bf16 v[48:63], a[140:143], a[96:99], v[48:63]
    s_waitcnt vmcnt(3)
    v_min3_u32 v216, v216, v217, v218
    v_min_u32 v216, v216, v219
    v_cmp_eq_u32 vcc, 0, v216
    v_cvt_pk_bf16_f32 v86, v100, v101
    v_cvt_pk_bf16_f32 v87, v102, v103
    v_exp_f32_e64 v96, v32
    v_exp_f32 v97, v33
    v_exp_f32 v98, v34
    v_exp_f32 v99, v35
    v_mfma_f32_32x32x16_bf16 v[64:79], a[140:143], a[100:103], v[64:79]
    s_nop 0
    v_cvt_pk_bf16_f32 v88, v96, v97
    v_cvt_pk_bf16_f32 v89, v98, v99
    v_exp_f32_e64 v100, v36
    v_exp_f32 v101, v37
    v_exp_f32 v102, v38
    v_exp_f32 v103, v39
    v_mfma_f32_32x32x16_bf16 a[64:79], a[164:167], v[84:87], a[64:79]
    s_cbranch_vccnz sequential_preLN__softmax_full_mha__glu_gated_bilinear__prompt_kernel_frspin
sequential_preLN__softmax_full_mha__glu_gated_bilinear__prompt_kernel_frok:
    v_cvt_pk_bf16_f32 v90, v100, v101
    v_cvt_pk_bf16_f32 v91, v102, v103
    v_exp_f32_e64 v96, v40
    v_exp_f32 v97, v41
    v_exp_f32 v98, v42
    v_exp_f32 v99, v43
    v_mfma_f32_32x32x16_bf16 a[80:95], a[160:163], v[88:91], a[80:95]
    s_barrier
    v_cvt_pk_bf16_f32 v92, v96, v97
    v_cvt_pk_bf16_f32 v93, v98, v99
    v_exp_f32_e64 v100, v44
    v_exp_f32 v101, v45
    v_exp_f32 v102, v46
    v_exp_f32 v103, v47
    v_mfma_f32_32x32x4_2b_bf16 v[16:47], a[186:187], a[130:131], 0 cbsz:1 abid:0
    v_cvt_pk_bf16_f32 v94, v100, v101
    v_cvt_pk_bf16_f32 v95, v102, v103
    v_exp_f32 v96, v48
    v_exp_f32 v97, v49
    v_exp_f32 v98, v50
    v_exp_f32 v99, v51
    v_cvt_pk_bf16_f32 v80, v96, v97
    v_cvt_pk_bf16_f32 v81, v98, v99
    v_exp_f32 v100, v52
    v_exp_f32 v101, v53
    v_exp_f32 v102, v54
    v_exp_f32 v103, v55
    v_mfma_f32_32x32x16_bf16 a[80:95], a[164:167], v[92:95], a[80:95]
    buffer_load_dwordx4 a[140:143], v136, s[12:15], s72 offen offset:2560 sc1
    v_cvt_pk_bf16_f32 v82, v100, v101
    v_cvt_pk_bf16_f32 v83, v102, v103
    v_exp_f32 v96, v56
    v_exp_f32 v97, v57
    v_exp_f32 v98, v58
    v_exp_f32 v99, v59
    v_mfma_f32_32x32x16_bf16 v[104:119], a[160:163], v[80:83], v[104:119]
    s_add_u32 s72, s72, 5120
    buffer_load_dword v9, v8, s[4:7], s77 offen sc1
    v_cvt_pk_bf16_f32 v84, v96, v97
    v_cvt_pk_bf16_f32 v85, v98, v99
    v_exp_f32 v100, v60
    v_exp_f32 v101, v61
    v_exp_f32 v102, v62
    v_exp_f32 v103, v63
    v_mfma_f32_32x32x16_bf16 v[16:31], a[144:147], a[104:107], v[16:31]
    s_add_u32 m0, s47, 0
    v_cvt_pk_bf16_f32 v86, v100, v101
    v_cvt_pk_bf16_f32 v87, v102, v103
    v_exp_f32_e64 v96, v64
    v_exp_f32 v97, v65
    v_exp_f32 v98, v66
    v_exp_f32 v99, v67
    v_mfma_f32_32x32x16_bf16 v[32:47], a[144:147], a[108:111], v[32:47]
    s_add_u32 s46, s45, 4096
    buffer_load_dwordx4 v253, s[4:7], s45 offen offset:0 sc1 lds
    buffer_load_dwordx4 v253, s[4:7], s45 offen offset:1024 sc1 lds
    v_cvt_pk_bf16_f32 v88, v96, v97
    v_cvt_pk_bf16_f32 v89, v98, v99
    v_exp_f32 v100, v68
    v_exp_f32 v101, v69
    v_exp_f32 v102, v70
    v_exp_f32 v103, v71
    v_mfma_f32_32x32x16_bf16 v[104:119], a[164:167], v[84:87], v[104:119]
    buffer_load_dwordx4 v253, s[4:7], s45 offen offset:2048 sc1 lds
    v_cvt_pk_bf16_f32 v90, v100, v101
    v_cvt_pk_bf16_f32 v91, v102, v103
    v_exp_f32 v96, v72
    v_exp_f32 v97, v73
    v_exp_f32 v98, v74
    v_exp_f32 v99, v75
    v_mfma_f32_32x32x16_bf16 v[120:135], a[160:163], v[88:91], v[120:135]
    buffer_load_dwordx4 v253, s[4:7], s45 offen offset:3072 sc1 lds
    v_cvt_pk_bf16_f32 v92, v96, v97
    v_cvt_pk_bf16_f32 v93, v98, v99
    v_exp_f32 v100, v76
    v_exp_f32 v101, v77
    v_exp_f32 v102, v78
    v_exp_f32 v103, v79
    v_mfma_f32_32x32x4_2b_bf16 v[48:79], a[186:187], a[132:133], 0 cbsz:1 abid:0
sequential_preLN__softmax_full_mha__glu_gated_bilinear__prompt_kernel_pgatt3:
    s_cbranch_execz sequential_preLN__softmax_full_mha__glu_gated_bilinear__prompt_kernel_wratt
    v_cvt_pk_bf16_f32 v94, v100, v101
    v_cvt_pk_bf16_f32 v95, v102, v103
    v_exp_f32 v96, v16
    v_exp_f32 v97, v17
    v_exp_f32 v98, v18
    v_exp_f32 v99, v19
    v_cvt_pk_bf16_f32 v80, v96, v97
    v_cvt_pk_bf16_f32 v81, v98, v99
    v_exp_f32 v100, v20
    v_exp_f32 v101, v21
    v_exp_f32 v102, v22
    v_exp_f32 v103, v23
    v_mfma_f32_32x32x16_bf16 v[120:135], a[164:167], v[92:95], v[120:135]
    buffer_load_dwordx4 a[160:163], v138, s[4:7], s73 offen offset:0 sc1
    v_cvt_pk_bf16_f32 v82, v100, v101
    v_cvt_pk_bf16_f32 v83, v102, v103
    v_exp_f32 v96, v24
    v_exp_f32 v97, v25
    v_exp_f32 v98, v26
    v_exp_f32 v99, v27
    v_mfma_f32_32x32x16_bf16 a[0:15], a[168:171], v[80:83], a[0:15]
    s_add_u32 m0, s47, 4096
    v_cvt_pk_bf16_f32 v84, v96, v97
    v_cvt_pk_bf16_f32 v85, v98, v99
    v_exp_f32 v100, v28
    v_exp_f32 v101, v29
    v_exp_f32 v102, v30
    v_exp_f32 v103, v31
    v_mfma_f32_32x32x16_bf16 v[48:63], a[144:147], a[112:115], v[48:63]
    s_add_u32 s45, s45, 442368
    buffer_load_dwordx4 v253, s[4:7], s46 offen offset:0 sc1 lds
    v_cvt_pk_bf16_f32 v86, v100, v101
    v_cvt_pk_bf16_f32 v87, v102, v103
    v_exp_f32 v96, v32
    v_exp_f32 v97, v33
    v_exp_f32 v98, v34
    v_exp_f32 v99, v35
    v_mfma_f32_32x32x16_bf16 v[64:79], a[144:147], a[116:119], v[64:79]
    buffer_load_dwordx4 v253, s[4:7], s46 offen offset:1024 sc1 lds
    v_cvt_pk_bf16_f32 v88, v96, v97
    v_cvt_pk_bf16_f32 v89, v98, v99
    v_exp_f32 v100, v36
    v_exp_f32 v101, v37
    v_exp_f32 v102, v38
    v_exp_f32 v103, v39
    v_mfma_f32_32x32x16_bf16 a[0:15], a[172:175], v[84:87], a[0:15]
    buffer_load_dwordx4 v253, s[4:7], s46 offen offset:2048 sc1 lds
    s_add_u32 m0, s47, 28672
    v_cvt_pk_bf16_f32 v90, v100, v101
    v_cvt_pk_bf16_f32 v91, v102, v103
    v_exp_f32 v96, v40
    v_exp_f32 v97, v41
    v_exp_f32 v98, v42
    v_exp_f32 v99, v43
    v_mfma_f32_32x32x16_bf16 a[16:31], a[168:171], v[88:91], a[16:31]
    s_add_u32 s46, s45, 4096
    buffer_load_dwordx4 v253, s[4:7], s45 offen offset:0 sc1 lds
    v_cvt_pk_bf16_f32 v92, v96, v97
    v_cvt_pk_bf16_f32 v93, v98, v99
    v_exp_f32 v100, v44
    v_exp_f32 v101, v45
    v_exp_f32 v102, v46
    v_exp_f32 v103, v47
    v_mfma_f32_32x32x4_2b_bf16 v[16:47], a[186:187], a[134:135], 0 cbsz:1 abid:0
    v_cvt_pk_bf16_f32 v94, v100, v101
    v_cvt_pk_bf16_f32 v95, v102, v103
    v_exp_f32 v96, v48
    v_exp_f32 v97, v49
    v_exp_f32 v98, v50
    v_exp_f32 v99, v51
    v_cvt_pk_bf16_f32 v80, v96, v97
    v_cvt_pk_bf16_f32 v81, v98, v99
    v_exp_f32 v100, v52
    v_exp_f32 v101, v53
    v_exp_f32 v102, v54
    v_exp_f32 v103, v55
    v_mfma_f32_32x32x16_bf16 a[16:31], a[172:175], v[92:95], a[16:31]
    buffer_load_dwordx4 a[164:167], v138, s[4:7], s73 offen offset:2560 sc1
    v_cvt_pk_bf16_f32 v82, v100, v101
    v_cvt_pk_bf16_f32 v83, v102, v103
    v_exp_f32 v96, v56
    v_exp_f32 v97, v57
    v_exp_f32 v98, v58
    v_exp_f32 v99, v59
    v_mfma_f32_32x32x16_bf16 a[32:47], a[168:171], v[80:83], a[32:47]
    s_add_u32 s73, s73, 5120
    buffer_load_dwordx4 v253, s[4:7], s45 offen offset:1024 sc1 lds
    v_cvt_pk_bf16_f32 v84, v96, v97
    v_cvt_pk_bf16_f32 v85, v98, v99
    v_exp_f32 v100, v60
    v_exp_f32 v101, v61
    v_exp_f32 v102, v62
    v_exp_f32 v103, v63
    v_mfma_f32_32x32x16_bf16 v[16:31], a[144:147], a[120:123], v[16:31]
    buffer_load_dwordx4 v253, s[4:7], s45 offen offset:2048 sc1 lds
    v_cvt_pk_bf16_f32 v86, v100, v101
    v_cvt_pk_bf16_f32 v87, v102, v103
    v_exp_f32 v96, v64
    v_exp_f32 v97, v65
    v_exp_f32 v98, v66
    v_exp_f32 v99, v67
    v_mfma_f32_32x32x16_bf16 v[32:47], a[144:147], a[124:127], v[32:47]
    v_cvt_pk_bf16_f32 v88, v96, v97
    v_cvt_pk_bf16_f32 v89, v98, v99
    v_exp_f32 v100, v68
    v_exp_f32 v101, v69
    v_exp_f32 v102, v70
    v_exp_f32 v103, v71
    v_mfma_f32_32x32x16_bf16 a[32:47], a[172:175], v[84:87], a[32:47]
    buffer_load_dwordx4 v253, s[4:7], s45 offen offset:3072 sc1 lds
    v_cvt_pk_bf16_f32 v90, v100, v101
    v_cvt_pk_bf16_f32 v91, v102, v103
    v_exp_f32 v96, v72
    v_exp_f32 v97, v73
    v_exp_f32 v98, v74
    v_exp_f32 v99, v75
    v_mfma_f32_32x32x16_bf16 a[48:63], a[168:171], v[88:91], a[48:63]
    v_cvt_pk_bf16_f32 v92, v96, v97
    v_cvt_pk_bf16_f32 v93, v98, v99
    v_exp_f32 v100, v76
    v_exp_f32 v101, v77
    v_exp_f32 v102, v78
    v_exp_f32 v103, v79
    v_mfma_f32_32x32x4_2b_bf16 v[48:79], a[186:187], a[128:129], 0 cbsz:1 abid:0
    v_cvt_pk_bf16_f32 v94, v100, v101
    v_cvt_pk_bf16_f32 v95, v102, v103
    v_exp_f32 v96, v16
    v_exp_f32 v97, v17
    v_exp_f32 v98, v18
    v_exp_f32 v99, v19
    v_cvt_pk_bf16_f32 v80, v96, v97
    v_cvt_pk_bf16_f32 v81, v98, v99
    v_exp_f32 v100, v20
    v_exp_f32 v101, v21
    v_exp_f32 v102, v22
    v_exp_f32 v103, v23
    v_mfma_f32_32x32x16_bf16 a[48:63], a[172:175], v[92:95], a[48:63]
    global_load_dword v248, v247, s[20:21] sc1
    v_cvt_pk_bf16_f32 v82, v100, v101
    v_cvt_pk_bf16_f32 v83, v102, v103
    v_exp_f32 v96, v24
    v_exp_f32 v97, v25
    v_exp_f32 v98, v26
    v_exp_f32 v99, v27
    v_mfma_f32_32x32x16_bf16 a[64:79], a[168:171], v[80:83], a[64:79]
    s_add_u32 m0, s47, 32768
    v_cvt_pk_bf16_f32 v84, v96, v97
    v_cvt_pk_bf16_f32 v85, v98, v99
    v_exp_f32 v100, v28
    v_exp_f32 v101, v29
    v_exp_f32 v102, v30
    v_exp_f32 v103, v31
    v_mfma_f32_32x32x16_bf16 v[48:63], a[144:147], a[96:99], v[48:63]
    s_add_u32 s45, s45, 442368
    buffer_load_dwordx4 v253, s[4:7], s46 offen offset:0 sc1 lds
    v_cvt_pk_bf16_f32 v86, v100, v101
    v_cvt_pk_bf16_f32 v87, v102, v103
    v_exp_f32 v96, v32
    v_exp_f32 v97, v33
    v_exp_f32 v98, v34
    v_exp_f32 v99, v35
    v_mfma_f32_32x32x16_bf16 v[64:79], a[144:147], a[100:103], v[64:79]
    buffer_load_dwordx4 v253, s[4:7], s46 offen offset:1024 sc1 lds
    v_cvt_pk_bf16_f32 v88, v96, v97
    v_cvt_pk_bf16_f32 v89, v98, v99
    v_exp_f32 v100, v36
    v_exp_f32 v101, v37
    v_exp_f32 v102, v38
    v_exp_f32 v103, v39
    v_mfma_f32_32x32x16_bf16 a[64:79], a[172:175], v[84:87], a[64:79]
    buffer_load_dwordx4 v253, s[4:7], s46 offen offset:2048 sc1 lds
    v_cvt_pk_bf16_f32 v90, v100, v101
    v_cvt_pk_bf16_f32 v91, v102, v103
    v_exp_f32 v96, v40
    v_exp_f32 v97, v41
    v_exp_f32 v98, v42
    v_exp_f32 v99, v43
    v_mfma_f32_32x32x16_bf16 a[80:95], a[168:171], v[88:91], a[80:95]
    v_cvt_pk_bf16_f32 v92, v96, v97
    v_cvt_pk_bf16_f32 v93, v98, v99
    v_exp_f32 v100, v44
    v_exp_f32 v101, v45
    v_exp_f32 v102, v46
    v_exp_f32 v103, v47
    v_mfma_f32_32x32x4_2b_bf16 v[16:47], a[186:187], a[130:131], 0 cbsz:1 abid:1
    v_cvt_pk_bf16_f32 v94, v100, v101
    v_cvt_pk_bf16_f32 v95, v102, v103
    v_exp_f32 v96, v48
    v_exp_f32 v97, v49
    v_exp_f32 v98, v50
    v_exp_f32 v99, v51
    v_cvt_pk_bf16_f32 v80, v96, v97
    v_cvt_pk_bf16_f32 v81, v98, v99
    v_exp_f32 v100, v52
    v_exp_f32 v101, v53
    v_exp_f32 v102, v54
    v_exp_f32 v103, v55
    v_mfma_f32_32x32x16_bf16 a[80:95], a[172:175], v[92:95], a[80:95]
    buffer_load_dwordx4 a[144:147], v136, s[12:15], s72 offen offset:0 sc1
    v_cvt_pk_bf16_f32 v82, v100, v101
    v_cvt_pk_bf16_f32 v83, v102, v103
    v_exp_f32 v96, v56
    v_exp_f32 v97, v57
    v_exp_f32 v98, v58
    v_exp_f32 v99, v59
    v_mfma_f32_32x32x16_bf16 v[104:119], a[168:171], v[80:83], v[104:119]
    s_waitcnt vmcnt(18)
    v_cmp_ne_u32 vcc, v7, v9
    v_cvt_pk_bf16_f32 v84, v96, v97
    v_cvt_pk_bf16_f32 v85, v98, v99
    v_exp_f32 v100, v60
    v_exp_f32 v101, v61
    v_exp_f32 v102, v62
    v_exp_f32 v103, v63
    v_mfma_f32_32x32x16_bf16 v[16:31], a[148:151], a[104:107], v[16:31]
    s_nop 0
    v_cvt_pk_bf16_f32 v86, v100, v101
    v_cvt_pk_bf16_f32 v87, v102, v103
    v_exp_f32_e64 v96, v64
    v_exp_f32 v97, v65
    v_exp_f32 v98, v66
    v_exp_f32 v99, v67
    v_mfma_f32_32x32x16_bf16 v[32:47], a[148:151], a[108:111], v[32:47]
    s_cmp_eq_u64 vcc, 0
    v_cvt_pk_bf16_f32 v88, v96, v97
    v_cvt_pk_bf16_f32 v89, v98, v99
    v_exp_f32_e64 v100, v68
    v_exp_f32 v101, v69
    v_exp_f32 v102, v70
    v_exp_f32 v103, v71
    v_mfma_f32_32x32x16_bf16 v[104:119], a[172:175], v[84:87], v[104:119]
    s_cselect_b32 s26, 1, 0
    v_cvt_pk_bf16_f32 v90, v100, v101
    v_cvt_pk_bf16_f32 v91, v102, v103
    v_exp_f32_e64 v96, v72
    v_exp_f32 v97, v73
    v_exp_f32 v98, v74
    v_exp_f32 v99, v75
    v_mfma_f32_32x32x16_bf16 v[120:135], a[168:171], v[88:91], v[120:135]
    v_cvt_pk_bf16_f32 v92, v96, v97
    v_cvt_pk_bf16_f32 v93, v98, v99
    v_exp_f32 v100, v76
    v_exp_f32 v101, v77
    v_exp_f32 v102, v78
    v_exp_f32 v103, v79
    v_mfma_f32_32x32x4_2b_bf16 v[48:79], a[186:187], a[132:133], 0 cbsz:1 abid:1
    v_cvt_pk_bf16_f32 v94, v100, v101
    v_cvt_pk_bf16_f32 v95, v102, v103
    v_exp_f32 v96, v16
    v_exp_f32 v97, v17
    v_exp_f32 v98, v18
    v_exp_f32 v99, v19
    v_cvt_pk_bf16_f32 v80, v96, v97
    v_cvt_pk_bf16_f32 v81, v98, v99
    v_exp_f32 v100, v20
    v_exp_f32 v101, v21
    v_exp_f32 v102, v22
    v_exp_f32 v103, v23
    v_mfma_f32_32x32x16_bf16 v[120:135], a[172:175], v[92:95], v[120:135]
    buffer_load_dwordx4 a[168:171], v138, s[4:7], s73 offen offset:0 sc1
    v_cvt_pk_bf16_f32 v82, v100, v101
    v_cvt_pk_bf16_f32 v83, v102, v103
    v_exp_f32 v96, v24
    v_exp_f32 v97, v25
    v_exp_f32 v98, v26
    v_exp_f32 v99, v27
    v_mfma_f32_32x32x16_bf16 a[0:15], a[176:179], v[80:83], a[0:15]
    s_cmp_eq_u32 s26, 0
    v_cvt_pk_bf16_f32 v84, v96, v97
    v_cvt_pk_bf16_f32 v85, v98, v99
    v_exp_f32_e64 v100, v28
    v_exp_f32 v101, v29
    v_exp_f32 v102, v30
    v_exp_f32 v103, v31
    v_mfma_f32_32x32x16_bf16 v[48:63], a[148:151], a[112:115], v[48:63]
    s_cselect_b32 s35, 1073741824, 0
    v_cvt_pk_bf16_f32 v86, v100, v101
    v_cvt_pk_bf16_f32 v87, v102, v103
    v_exp_f32 v96, v32
    v_exp_f32 v97, v33
    v_exp_f32 v98, v34
    v_exp_f32 v99, v35
    v_mfma_f32_32x32x16_bf16 v[64:79], a[148:151], a[116:119], v[64:79]
    s_add_u32 s76, s76, s35
    v_cvt_pk_bf16_f32 v88, v96, v97
    v_cvt_pk_bf16_f32 v89, v98, v99
    v_exp_f32_e64 v100, v36
    v_exp_f32 v101, v37
    v_exp_f32 v102, v38
    v_exp_f32 v103, v39
    v_mfma_f32_32x32x16_bf16 a[0:15], a[180:183], v[84:87], a[0:15]
    s_add_u32 s90, s90, s35
    v_cvt_pk_bf16_f32 v90, v100, v101
    v_cvt_pk_bf16_f32 v91, v102, v103
    v_exp_f32_e64 v96, v40
    v_exp_f32 v97, v41
    v_exp_f32 v98, v42
    v_exp_f32 v99, v43
    v_mfma_f32_32x32x16_bf16 a[16:31], a[176:179], v[88:91], a[16:31]
    s_add_u32 s93, s93, s35
    v_cvt_pk_bf16_f32 v92, v96, v97
    v_cvt_pk_bf16_f32 v93, v98, v99
    v_exp_f32_e64 v100, v44
    v_exp_f32 v101, v45
    v_exp_f32 v102, v46
    v_exp_f32 v103, v47
    v_mfma_f32_32x32x4_2b_bf16 v[16:47], a[186:187], a[134:135], 0 cbsz:1 abid:1
    v_cvt_pk_bf16_f32 v94, v100, v101
    v_cvt_pk_bf16_f32 v95, v102, v103
    v_exp_f32 v96, v48
    v_exp_f32 v97, v49
    v_exp_f32 v98, v50
    v_exp_f32 v99, v51
    v_cvt_pk_bf16_f32 v80, v96, v97
    v_cvt_pk_bf16_f32 v81, v98, v99
    v_exp_f32 v100, v52
    v_exp_f32 v101, v53
    v_exp_f32 v102, v54
    v_exp_f32 v103, v55
    v_mfma_f32_32x32x16_bf16 a[16:31], a[180:183], v[92:95], a[16:31]
    buffer_load_dwordx4 a[172:175], v138, s[4:7], s73 offen offset:2560 sc1
    v_cvt_pk_bf16_f32 v82, v100, v101
    v_cvt_pk_bf16_f32 v83, v102, v103
    v_exp_f32 v96, v56
    v_exp_f32 v97, v57
    v_exp_f32 v98, v58
    v_exp_f32 v99, v59
    v_mfma_f32_32x32x16_bf16 a[32:47], a[176:179], v[80:83], a[32:47]
    s_add_u32 s73, s73, 5120
    v_cvt_pk_bf16_f32 v84, v96, v97
    v_cvt_pk_bf16_f32 v85, v98, v99
    v_exp_f32 v100, v60
    v_exp_f32 v101, v61
    v_exp_f32 v102, v62
    v_exp_f32 v103, v63
    v_mfma_f32_32x32x16_bf16 v[16:31], a[148:151], a[120:123], v[16:31]
    s_add_u32 m0, s47, 57344
    v_cvt_pk_bf16_f32 v86, v100, v101
    v_cvt_pk_bf16_f32 v87, v102, v103
    v_exp_f32 v96, v64
    v_exp_f32 v97, v65
    v_exp_f32 v98, v66
    v_exp_f32 v99, v67
    v_mfma_f32_32x32x16_bf16 v[32:47], a[148:151], a[124:127], v[32:47]
    s_add_u32 s46, s45, 4096
    buffer_load_dwordx4 v253, s[4:7], s45 offen offset:0 sc1 lds
    v_cvt_pk_bf16_f32 v88, v96, v97
    v_cvt_pk_bf16_f32 v89, v98, v99
    v_exp_f32 v100, v68
    v_exp_f32 v101, v69
    v_exp_f32 v102, v70
    v_exp_f32 v103, v71
    v_mfma_f32_32x32x16_bf16 a[32:47], a[180:183], v[84:87], a[32:47]
    buffer_load_dwordx4 v253, s[4:7], s45 offen offset:1024 sc1 lds
    v_cvt_pk_bf16_f32 v90, v100, v101
    v_cvt_pk_bf16_f32 v91, v102, v103
    v_exp_f32 v96, v72
    v_exp_f32 v97, v73
    v_exp_f32 v98, v74
    v_exp_f32 v99, v75
    v_mfma_f32_32x32x16_bf16 a[48:63], a[176:179], v[88:91], a[48:63]
    buffer_load_dwordx4 v253, s[4:7], s45 offen offset:2048 sc1 lds
    v_cvt_pk_bf16_f32 v92, v96, v97
    v_cvt_pk_bf16_f32 v93, v98, v99
    v_exp_f32 v100, v76
    v_exp_f32 v101, v77
    v_exp_f32 v102, v78
    v_exp_f32 v103, v79
    v_mfma_f32_32x32x4_2b_bf16 v[48:79], a[186:187], a[128:129], 0 cbsz:1 abid:1
    v_cvt_pk_bf16_f32 v94, v100, v101
    v_cvt_pk_bf16_f32 v95, v102, v103
    v_exp_f32 v96, v16
    v_exp_f32 v97, v17
    v_exp_f32 v98, v18
    v_exp_f32 v99, v19
    v_cvt_pk_bf16_f32 v80, v96, v97
    v_cvt_pk_bf16_f32 v81, v98, v99
    v_exp_f32 v100, v20
    v_exp_f32 v101, v21
    v_exp_f32 v102, v22
    v_exp_f32 v103, v23
    v_mfma_f32_32x32x16_bf16 a[48:63], a[180:183], v[92:95], a[48:63]
    buffer_load_dwordx2 a[186:187], v137, s[12:15], s74 offen sc1
    v_cvt_pk_bf16_f32 v82, v100, v101
    v_cvt_pk_bf16_f32 v83, v102, v103
    v_exp_f32 v96, v24
    v_exp_f32 v97, v25
    v_exp_f32 v98, v26
    v_exp_f32 v99, v27
    v_mfma_f32_32x32x16_bf16 a[64:79], a[176:179], v[80:83], a[64:79]
    s_add_u32 s74, s74, 5120
    buffer_load_dwordx4 v253, s[4:7], s45 offen offset:3072 sc1 lds
    v_cvt_pk_bf16_f32 v84, v96, v97
    v_cvt_pk_bf16_f32 v85, v98, v99
    v_exp_f32 v100, v28
    v_exp_f32 v101, v29
    v_exp_f32 v102, v30
    v_exp_f32 v103, v31
    v_mfma_f32_32x32x16_bf16 v[48:63], a[148:151], a[96:99], v[48:63]
    s_add_u32 m0, s47, 61440
    v_cvt_pk_bf16_f32 v86, v100, v101
    v_cvt_pk_bf16_f32 v87, v102, v103
    v_exp_f32 v96, v32
    v_exp_f32 v97, v33
    v_exp_f32 v98, v34
    v_exp_f32 v99, v35
    v_mfma_f32_32x32x16_bf16 v[64:79], a[148:151], a[100:103], v[64:79]
    s_add_u32 s45, s45, 442368
    buffer_load_dwordx4 v253, s[4:7], s46 offen offset:0 sc1 lds
    v_cvt_pk_bf16_f32 v88, v96, v97
    v_cvt_pk_bf16_f32 v89, v98, v99
    v_exp_f32 v100, v36
    v_exp_f32 v101, v37
    v_exp_f32 v102, v38
    v_exp_f32 v103, v39
    v_mfma_f32_32x32x16_bf16 a[64:79], a[180:183], v[84:87], a[64:79]
    buffer_load_dwordx4 v253, s[4:7], s46 offen offset:1024 sc1 lds
    v_cvt_pk_bf16_f32 v90, v100, v101
    v_cvt_pk_bf16_f32 v91, v102, v103
    v_exp_f32 v96, v40
    v_exp_f32 v97, v41
    v_exp_f32 v98, v42
    v_exp_f32 v99, v43
    v_mfma_f32_32x32x16_bf16 a[80:95], a[176:179], v[88:91], a[80:95]
    v_cvt_pk_bf16_f32 v92, v96, v97
    v_cvt_pk_bf16_f32 v93, v98, v99
    v_exp_f32 v100, v44
    v_exp_f32 v101, v45
    v_exp_f32 v102, v46
    v_exp_f32 v103, v47
    v_mfma_f32_32x32x4_2b_bf16 v[16:47], a[184:185], a[130:131], 0 cbsz:1 abid:0
    v_cvt_pk_bf16_f32 v94, v100, v101
    v_cvt_pk_bf16_f32 v95, v102, v103
    v_exp_f32 v96, v48
    v_exp_f32 v97, v49
    v_exp_f32 v98, v50
    v_exp_f32 v99, v51
    v_cvt_pk_bf16_f32 v80, v96, v97
    v_cvt_pk_bf16_f32 v81, v98, v99
    v_exp_f32 v100, v52
    v_exp_f32 v101, v53
    v_exp_f32 v102, v54
    v_exp_f32 v103, v55
    v_mfma_f32_32x32x16_bf16 a[80:95], a[180:183], v[92:95], a[80:95]
    buffer_load_dwordx4 a[148:151], v136, s[12:15], s72 offen offset:2560 sc1
    v_cvt_pk_bf16_f32 v82, v100, v101
    v_cvt_pk_bf16_f32 v83, v102, v103
    v_exp_f32 v96, v56
    v_exp_f32 v97, v57
    v_exp_f32 v98, v58
    v_exp_f32 v99, v59
    v_mfma_f32_32x32x16_bf16 v[104:119], a[176:179], v[80:83], v[104:119]
    s_add_u32 s72, s72, 5120
    buffer_load_dwordx4 v253, s[4:7], s46 offen offset:2048 sc1 lds
    v_cvt_pk_bf16_f32 v84, v96, v97
    v_cvt_pk_bf16_f32 v85, v98, v99
    v_exp_f32 v100, v60
    v_exp_f32 v101, v61
    v_exp_f32 v102, v62
    v_exp_f32 v103, v63
    v_mfma_f32_32x32x16_bf16 v[16:31], a[136:139], a[104:107], v[16:31]
    buffer_load_dword v194, v146, s[4:7], s75 offen sc1
    v_cvt_pk_bf16_f32 v86, v100, v101
    v_cvt_pk_bf16_f32 v87, v102, v103
    v_exp_f32 v96, v64
    v_exp_f32 v97, v65
    v_exp_f32 v98, v66
    v_exp_f32 v99, v67
    v_mfma_f32_32x32x16_bf16 v[32:47], a[136:139], a[108:111], v[32:47]
    s_add_u32 s75, s75, 13824
    v_cvt_pk_bf16_f32 v88, v96, v97
    v_cvt_pk_bf16_f32 v89, v98, v99
    v_exp_f32 v100, v68
    v_exp_f32 v101, v69
    v_exp_f32 v102, v70
    v_exp_f32 v103, v71
    v_mfma_f32_32x32x16_bf16 v[104:119], a[180:183], v[84:87], v[104:119]
    buffer_load_dword v195, v146, s[4:7], s75 offen sc1
    v_cvt_pk_bf16_f32 v90, v100, v101
    v_cvt_pk_bf16_f32 v91, v102, v103
    v_exp_f32 v96, v72
    v_exp_f32 v97, v73
    v_exp_f32 v98, v74
    v_exp_f32 v99, v75
    v_mfma_f32_32x32x16_bf16 v[120:135], a[176:179], v[88:91], v[120:135]
    v_cvt_pk_bf16_f32 v92, v96, v97
    v_cvt_pk_bf16_f32 v93, v98, v99
    v_exp_f32 v100, v76
    v_exp_f32 v101, v77
    v_exp_f32 v102, v78
    v_exp_f32 v103, v79
    v_mfma_f32_32x32x4_2b_bf16 v[48:79], a[184:185], a[132:133], 0 cbsz:1 abid:0
    v_cvt_pk_bf16_f32 v94, v100, v101
    v_cvt_pk_bf16_f32 v95, v102, v103
    v_exp_f32 v96, v16
    v_exp_f32 v97, v17
    v_exp_f32 v98, v18
    v_exp_f32 v99, v19
    v_cvt_pk_bf16_f32 v80, v96, v97
    v_cvt_pk_bf16_f32 v81, v98, v99
    v_exp_f32 v100, v20
    v_exp_f32 v101, v21
    v_exp_f32 v102, v22
    v_exp_f32 v103, v23
    v_mfma_f32_32x32x16_bf16 v[120:135], a[180:183], v[92:95], v[120:135]
    buffer_load_dwordx4 a[176:179], v138, s[4:7], s73 offen offset:0 sc1
    v_cvt_pk_bf16_f32 v82, v100, v101
    v_cvt_pk_bf16_f32 v83, v102, v103
    v_exp_f32 v96, v24
    v_exp_f32 v97, v25
    v_exp_f32 v98, v26
    v_exp_f32 v99, v27
    v_mfma_f32_32x32x16_bf16 a[0:15], a[152:155], v[80:83], a[0:15]
    s_add_u32 s75, s75, 13824
    buffer_load_dword v196, v146, s[4:7], s75 offen sc1
    v_cvt_pk_bf16_f32 v84, v96, v97
    v_cvt_pk_bf16_f32 v85, v98, v99
    v_exp_f32 v100, v28
    v_exp_f32 v101, v29
    v_exp_f32 v102, v30
    v_exp_f32 v103, v31
    v_mfma_f32_32x32x16_bf16 v[48:63], a[136:139], a[112:115], v[48:63]
    s_add_u32 s75, s75, 13824
    buffer_load_dword v197, v146, s[4:7], s75 offen sc1
    v_cvt_pk_bf16_f32 v86, v100, v101
    v_cvt_pk_bf16_f32 v87, v102, v103
    v_exp_f32 v96, v32
    v_exp_f32 v97, v33
    v_exp_f32 v98, v34
    v_exp_f32 v99, v35
    v_mfma_f32_32x32x16_bf16 v[64:79], a[136:139], a[116:119], v[64:79]
    s_add_u32 s75, s75, 13824
    v_cvt_pk_bf16_f32 v88, v96, v97
    v_cvt_pk_bf16_f32 v89, v98, v99
    v_exp_f32 v100, v36
    v_exp_f32 v101, v37
    v_exp_f32 v102, v38
    v_exp_f32 v103, v39
    v_mfma_f32_32x32x16_bf16 a[0:15], a[156:159], v[84:87], a[0:15]
    buffer_load_dwordx4 v[184:187], v246, s[8:11], s51 offen
    v_cvt_pk_bf16_f32 v90, v100, v101
    v_cvt_pk_bf16_f32 v91, v102, v103
    v_exp_f32 v96, v40
    v_exp_f32 v97, v41
    v_exp_f32 v98, v42
    v_exp_f32 v99, v43
    v_mfma_f32_32x32x16_bf16 a[16:31], a[152:155], v[88:91], a[16:31]
    v_cvt_pk_bf16_f32 v92, v96, v97
    v_cvt_pk_bf16_f32 v93, v98, v99
    v_exp_f32 v100, v44
    v_exp_f32 v101, v45
    v_exp_f32 v102, v46
    v_exp_f32 v103, v47
    v_mfma_f32_32x32x4_2b_bf16 v[16:47], a[184:185], a[134:135], 0 cbsz:1 abid:0
    v_cvt_pk_bf16_f32 v94, v100, v101
    v_cvt_pk_bf16_f32 v95, v102, v103
    v_exp_f32 v96, v48
    v_exp_f32 v97, v49
    v_exp_f32 v98, v50
    v_exp_f32 v99, v51
    v_cvt_pk_bf16_f32 v80, v96, v97
    v_cvt_pk_bf16_f32 v81, v98, v99
    v_exp_f32 v100, v52
    v_exp_f32 v101, v53
    v_exp_f32 v102, v54
    v_exp_f32 v103, v55
    v_mfma_f32_32x32x16_bf16 a[16:31], a[156:159], v[92:95], a[16:31]
    buffer_load_dwordx4 a[180:183], v138, s[4:7], s73 offen offset:2560 sc1
    v_cvt_pk_bf16_f32 v82, v100, v101
    v_cvt_pk_bf16_f32 v83, v102, v103
    v_exp_f32 v96, v56
    v_exp_f32 v97, v57
    v_exp_f32 v98, v58
    v_exp_f32 v99, v59
    v_mfma_f32_32x32x16_bf16 a[32:47], a[152:155], v[80:83], a[32:47]
    s_add_u32 s73, s73, 5120
    buffer_load_dwordx4 v[188:191], v246, s[8:11], s51 offen offset:64
    v_cvt_pk_bf16_f32 v84, v96, v97
    v_cvt_pk_bf16_f32 v85, v98, v99
    v_exp_f32 v100, v60
    v_exp_f32 v101, v61
    v_exp_f32 v102, v62
    v_exp_f32 v103, v63
    v_mfma_f32_32x32x16_bf16 v[16:31], a[136:139], a[120:123], v[16:31]
    buffer_load_dwordx2 v[192:193], v198, s[8:11], s61 offen
    v_cvt_pk_bf16_f32 v86, v100, v101
    v_cvt_pk_bf16_f32 v87, v102, v103
    v_exp_f32 v96, v64
    v_exp_f32 v97, v65
    v_exp_f32 v98, v66
    v_exp_f32 v99, v67
    v_mfma_f32_32x32x16_bf16 v[32:47], a[136:139], a[124:127], v[32:47]
    v_cvt_pk_bf16_f32 v88, v96, v97
    v_cvt_pk_bf16_f32 v89, v98, v99
    v_exp_f32 v100, v68
    v_exp_f32 v101, v69
    v_exp_f32 v102, v70
    v_exp_f32 v103, v71
    v_mfma_f32_32x32x16_bf16 a[32:47], a[156:159], v[84:87], a[32:47]
    buffer_load_dwordx4 a[192:195], v250, s[4:7], s44 offen offset:0 sc1
    v_cvt_pk_bf16_f32 v90, v100, v101
    v_cvt_pk_bf16_f32 v91, v102, v103
    v_exp_f32 v96, v72
    v_exp_f32 v97, v73
    v_exp_f32 v98, v74
    v_exp_f32 v99, v75
    v_mfma_f32_32x32x16_bf16 a[48:63], a[152:155], v[88:91], a[48:63]
    v_cvt_pk_bf16_f32 v92, v96, v97
    v_cvt_pk_bf16_f32 v93, v98, v99
    v_exp_f32 v100, v76
    v_exp_f32 v101, v77
    v_exp_f32 v102, v78
    v_exp_f32 v103, v79
    v_mfma_f32_32x32x4_2b_bf16 v[48:79], a[184:185], a[128:129], 0 cbsz:1 abid:0
    v_cvt_pk_bf16_f32 v94, v100, v101
    v_cvt_pk_bf16_f32 v95, v102, v103
    v_exp_f32 v96, v16
    v_exp_f32 v97, v17
    v_exp_f32 v98, v18
    v_exp_f32 v99, v19
    v_cvt_pk_bf16_f32 v80, v96, v97
    v_cvt_pk_bf16_f32 v81, v98, v99
    v_exp_f32 v100, v20
    v_exp_f32 v101, v21
    v_exp_f32 v102, v22
    v_exp_f32 v103, v23
    v_mfma_f32_32x32x16_bf16 a[48:63], a[156:159], v[92:95], a[48:63]
    s_add_u32 s91, s93, 28491776
    buffer_load_dword v248, off, s[4:7], s91  sc1
    v_cvt_pk_bf16_f32 v82, v100, v101
    v_cvt_pk_bf16_f32 v83, v102, v103
    v_exp_f32 v96, v24
    v_exp_f32 v97, v25
    v_exp_f32 v98, v26
    v_exp_f32 v99, v27
    v_mfma_f32_32x32x16_bf16 a[64:79], a[152:155], v[80:83], a[64:79]
    buffer_load_dwordx4 a[196:199], v250, s[4:7], s44 offen offset:1024 sc1
    v_cvt_pk_bf16_f32 v84, v96, v97
    v_cvt_pk_bf16_f32 v85, v98, v99
    v_exp_f32 v100, v28
    v_exp_f32 v101, v29
    v_exp_f32 v102, v30
    v_exp_f32 v103, v31
    v_mfma_f32_32x32x16_bf16 v[48:63], a[136:139], a[96:99], v[48:63]
    buffer_load_dwordx4 a[200:203], v250, s[4:7], s44 offen offset:2048 sc1
    v_cvt_pk_bf16_f32 v86, v100, v101
    v_cvt_pk_bf16_f32 v87, v102, v103
    v_exp_f32 v96, v32
    v_exp_f32 v97, v33
    v_exp_f32 v98, v34
    v_exp_f32 v99, v35
    v_mfma_f32_32x32x16_bf16 v[64:79], a[136:139], a[100:103], v[64:79]
    v_cvt_pk_bf16_f32 v88, v96, v97
    v_cvt_pk_bf16_f32 v89, v98, v99
    v_exp_f32 v100, v36
    v_exp_f32 v101, v37
    v_exp_f32 v102, v38
    v_exp_f32 v103, v39
    v_mfma_f32_32x32x16_bf16 a[64:79], a[156:159], v[84:87], a[64:79]
    buffer_load_dwordx4 a[204:207], v250, s[4:7], s44 offen offset:3072 sc1
    v_cvt_pk_bf16_f32 v90, v100, v101
    v_cvt_pk_bf16_f32 v91, v102, v103
    v_exp_f32 v96, v40
    v_exp_f32 v97, v41
    v_exp_f32 v98, v42
    v_exp_f32 v99, v43
    v_mfma_f32_32x32x16_bf16 a[80:95], a[152:155], v[88:91], a[80:95]
    v_cvt_pk_bf16_f32 v92, v96, v97
    v_cvt_pk_bf16_f32 v93, v98, v99
    v_exp_f32 v100, v44
    v_exp_f32 v101, v45
    v_exp_f32 v102, v46
    v_exp_f32 v103, v47
    v_mfma_f32_32x32x4_2b_bf16 v[16:47], a[184:185], a[130:131], 0 cbsz:1 abid:1
    v_cvt_pk_bf16_f32 v94, v100, v101
    v_cvt_pk_bf16_f32 v95, v102, v103
    v_exp_f32 v96, v48
    v_exp_f32 v97, v49
    v_exp_f32 v98, v50
    v_exp_f32 v99, v51
    v_cvt_pk_bf16_f32 v80, v96, v97
    v_cvt_pk_bf16_f32 v81, v98, v99
    v_exp_f32 v100, v52
    v_exp_f32 v101, v53
    v_exp_f32 v102, v54
    v_exp_f32 v103, v55
    v_mfma_f32_32x32x16_bf16 a[80:95], a[156:159], v[92:95], a[80:95]
    buffer_load_dwordx4 a[208:211], v251, s[4:7], s44 offen offset:0 sc1
    v_cvt_pk_bf16_f32 v82, v100, v101
    v_cvt_pk_bf16_f32 v83, v102, v103
    v_exp_f32 v96, v56
    v_exp_f32 v97, v57
    v_exp_f32 v98, v58
    v_exp_f32 v99, v59
    v_mfma_f32_32x32x16_bf16 v[104:119], a[152:155], v[80:83], v[104:119]
sequential_preLN__softmax_full_mha__glu_gated_bilinear__prompt_kernel_pgatt4:
    s_cbranch_execz sequential_preLN__softmax_full_mha__glu_gated_bilinear__prompt_kernel_wratt
    s_add_u32 s44, s44, 40960
    v_cvt_pk_bf16_f32 v84, v96, v97
    v_cvt_pk_bf16_f32 v85, v98, v99
    v_exp_f32 v100, v60
    v_exp_f32 v101, v61
    v_exp_f32 v102, v62
    v_exp_f32 v103, v63
    v_mfma_f32_32x32x16_bf16 v[16:31], a[140:143], a[104:107], v[16:31]
    buffer_load_dwordx4 a[212:215], v250, s[4:7], s44 offen offset:0 sc1
    v_cvt_pk_bf16_f32 v86, v100, v101
    v_cvt_pk_bf16_f32 v87, v102, v103
    v_exp_f32 v96, v64
    v_exp_f32 v97, v65
    v_exp_f32 v98, v66
    v_exp_f32 v99, v67
    v_mfma_f32_32x32x16_bf16 v[32:47], a[140:143], a[108:111], v[32:47]
    v_cvt_pk_bf16_f32 v88, v96, v97
    v_cvt_pk_bf16_f32 v89, v98, v99
    v_exp_f32 v100, v68
    v_exp_f32 v101, v69
    v_exp_f32 v102, v70
    v_exp_f32 v103, v71
    v_mfma_f32_32x32x16_bf16 v[104:119], a[156:159], v[84:87], v[104:119]
    buffer_load_dwordx4 a[216:219], v250, s[4:7], s44 offen offset:1024 sc1
    v_cvt_pk_bf16_f32 v90, v100, v101
    v_cvt_pk_bf16_f32 v91, v102, v103
    v_exp_f32 v96, v72
    v_exp_f32 v97, v73
    v_exp_f32 v98, v74
    v_exp_f32 v99, v75
    v_mfma_f32_32x32x16_bf16 v[120:135], a[152:155], v[88:91], v[120:135]
    s_waitcnt vmcnt(22)
    v_cvt_pk_bf16_f32 v92, v96, v97
    v_cvt_pk_bf16_f32 v93, v98, v99
    v_exp_f32_e64 v100, v76
    v_exp_f32 v101, v77
    v_exp_f32 v102, v78
    v_exp_f32 v103, v79
    v_mfma_f32_32x32x4_2b_bf16 v[48:79], a[186:187], a[130:131], 0 cbsz:1 abid:0
    v_cvt_pk_bf16_f32 v94, v100, v101
    v_cvt_pk_bf16_f32 v95, v102, v103
    v_exp_f32 v96, v16
    v_exp_f32 v97, v17
    v_exp_f32 v98, v18
    v_exp_f32 v99, v19
    v_cvt_pk_bf16_f32 v80, v96, v97
    v_cvt_pk_bf16_f32 v81, v98, v99
    v_exp_f32 v100, v20
    v_exp_f32 v101, v21
    v_exp_f32 v102, v22
    v_exp_f32 v103, v23
    v_mfma_f32_32x32x16_bf16 v[120:135], a[156:159], v[92:95], v[120:135]
    buffer_load_dwordx4 a[220:223], v250, s[4:7], s44 offen offset:2048 sc1
    v_cvt_pk_bf16_f32 v82, v100, v101
    v_cvt_pk_bf16_f32 v83, v102, v103
    v_exp_f32 v96, v24
    v_exp_f32 v97, v25
    v_exp_f32 v98, v26
    v_exp_f32 v99, v27
    v_mfma_f32_32x32x16_bf16 a[0:15], a[160:163], v[80:83], a[0:15]
    v_cvt_pk_bf16_f32 v84, v96, v97
    v_cvt_pk_bf16_f32 v85, v98, v99
    v_exp_f32 v100, v28
    v_exp_f32 v101, v29
    v_exp_f32 v102, v30
    v_exp_f32 v103, v31
    v_mfma_f32_32x32x16_bf16 v[48:63], a[144:147], a[104:107], v[48:63]
    buffer_load_dwordx4 a[224:227], v250, s[4:7], s44 offen offset:3072 sc1
    v_cvt_pk_bf16_f32 v86, v100, v101
    v_cvt_pk_bf16_f32 v87, v102, v103
    v_exp_f32 v96, v32
    v_exp_f32 v97, v33
    v_exp_f32 v98, v34
    v_exp_f32 v99, v35
    v_mfma_f32_32x32x16_bf16 v[64:79], a[144:147], a[108:111], v[64:79]
    v_cvt_pk_bf16_f32 v88, v96, v97
    v_cvt_pk_bf16_f32 v89, v98, v99
    v_exp_f32 v100, v36
    v_exp_f32 v101, v37
    v_exp_f32 v102, v38
    v_exp_f32 v103, v39
    v_mfma_f32_32x32x16_bf16 a[0:15], a[164:167], v[84:87], a[0:15]
    buffer_load_dwordx4 a[228:231], v251, s[4:7], s44 offen offset:0 sc1
    v_cvt_pk_bf16_f32 v90, v100, v101
    v_cvt_pk_bf16_f32 v91, v102, v103
    v_exp_f32 v96, v40
    v_exp_f32 v97, v41
    v_exp_f32 v98, v42
    v_exp_f32 v99, v43
    v_mfma_f32_32x32x16_bf16 a[16:31], a[160:163], v[88:91], a[16:31]
    v_cvt_pk_bf16_f32 v92, v96, v97
    v_cvt_pk_bf16_f32 v93, v98, v99
    v_exp_f32 v100, v44
    v_exp_f32 v101, v45
    v_exp_f32 v102, v46
    v_exp_f32 v103, v47
    v_mfma_f32_32x32x4_2b_bf16 v[16:47], a[186:187], a[130:131], 0 cbsz:1 abid:1
    v_cvt_pk_bf16_f32 v94, v100, v101
    v_cvt_pk_bf16_f32 v95, v102, v103
    v_exp_f32 v96, v48
    v_exp_f32 v97, v49
    v_exp_f32 v98, v50
    v_exp_f32 v99, v51
    v_cvt_pk_bf16_f32 v80, v96, v97
    v_cvt_pk_bf16_f32 v81, v98, v99
    v_exp_f32 v100, v52
    v_exp_f32 v101, v53
    v_exp_f32 v102, v54
    v_exp_f32 v103, v55
    v_mfma_f32_32x32x16_bf16 a[16:31], a[164:167], v[92:95], a[16:31]
    s_add_u32 s44, s44, 40960
    buffer_load_dwordx4 a[232:235], v250, s[4:7], s44 offen offset:0 sc1
    v_cvt_pk_bf16_f32 v82, v100, v101
    v_cvt_pk_bf16_f32 v83, v102, v103
    v_exp_f32 v96, v56
    v_exp_f32 v97, v57
    v_exp_f32 v98, v58
    v_exp_f32 v99, v59
    v_mfma_f32_32x32x16_bf16 a[0:15], a[168:171], v[80:83], a[0:15]
    s_waitcnt vmcnt(22)
    v_cvt_pk_bf16_f32 v84, v96, v97
    v_cvt_pk_bf16_f32 v85, v98, v99
    v_exp_f32_e64 v100, v60
    v_exp_f32 v101, v61
    v_exp_f32 v102, v62
    v_exp_f32 v103, v63
    v_mfma_f32_32x32x16_bf16 v[16:31], a[148:151], a[104:107], v[16:31]
    buffer_load_dwordx4 a[236:239], v250, s[4:7], s44 offen offset:1024 sc1
    v_cvt_pk_bf16_f32 v86, v100, v101
    v_cvt_pk_bf16_f32 v87, v102, v103
    v_exp_f32 v96, v64
    v_exp_f32 v97, v65
    v_exp_f32 v98, v66
    v_exp_f32 v99, v67
    v_mfma_f32_32x32x16_bf16 v[32:47], a[148:151], a[108:111], v[32:47]
    v_cvt_pk_bf16_f32 v88, v96, v97
    v_cvt_pk_bf16_f32 v89, v98, v99
    v_exp_f32 v100, v68
    v_exp_f32 v101, v69
    v_exp_f32 v102, v70
    v_exp_f32 v103, v71
    v_mfma_f32_32x32x16_bf16 a[0:15], a[172:175], v[84:87], a[0:15]
    buffer_load_dwordx4 a[240:243], v250, s[4:7], s44 offen offset:2048 sc1
    v_cvt_pk_bf16_f32 v90, v100, v101
    v_cvt_pk_bf16_f32 v91, v102, v103
    v_exp_f32 v96, v72
    v_exp_f32 v97, v73
    v_exp_f32 v98, v74
    v_exp_f32 v99, v75
    v_mfma_f32_32x32x16_bf16 a[16:31], a[168:171], v[88:91], a[16:31]
    v_cvt_pk_bf16_f32 v92, v96, v97
    v_cvt_pk_bf16_f32 v93, v98, v99
    v_exp_f32 v100, v76
    v_exp_f32 v101, v77
    v_exp_f32 v102, v78
    v_exp_f32 v103, v79
    v_mfma_f32_32x32x4_2b_bf16 v[48:79], a[184:185], a[132:133], 0 cbsz:1 abid:1
    v_cvt_pk_bf16_f32 v94, v100, v101
    v_cvt_pk_bf16_f32 v95, v102, v103
    v_exp_f32 v96, v16
    v_exp_f32 v97, v17
    v_exp_f32 v98, v18
    v_exp_f32 v99, v19
    v_cvt_pk_bf16_f32 v80, v96, v97
    v_cvt_pk_bf16_f32 v81, v98, v99
    v_exp_f32 v100, v20
    v_exp_f32 v101, v21
    v_exp_f32 v102, v22
    v_exp_f32 v103, v23
    v_mfma_f32_32x32x16_bf16 a[16:31], a[172:175], v[92:95], a[16:31]
    s_waitcnt vmcnt(20)
    global_load_dword v248, v247, s[20:21] sc1
    v_cvt_pk_bf16_f32 v82, v100, v101
    v_cvt_pk_bf16_f32 v83, v102, v103
    v_exp_f32_e64 v96, v24
    v_exp_f32 v97, v25
    v_exp_f32 v98, v26
    v_exp_f32 v99, v27
    v_mfma_f32_32x32x16_bf16 a[0:15], a[176:179], v[80:83], a[0:15]
    s_add_u32 s91, s90, 0
    buffer_load_dword v248, v147, s[4:7], s91 offen sc1
    v_cvt_pk_bf16_f32 v84, v96, v97
    v_cvt_pk_bf16_f32 v85, v98, v99
    v_exp_f32_e64 v100, v28
    v_exp_f32 v101, v29
    v_exp_f32 v102, v30
    v_exp_f32 v103, v31
    v_mfma_f32_32x32x16_bf16 v[48:63], a[140:143], a[112:115], v[48:63]
    buffer_load_dwordx4 a[244:247], v250, s[4:7], s44 offen offset:3072 sc1
    v_cvt_pk_bf16_f32 v86, v100, v101
    v_cvt_pk_bf16_f32 v87, v102, v103
    v_exp_f32 v96, v32
    v_exp_f32 v97, v33
    v_exp_f32 v98, v34
    v_exp_f32 v99, v35
    v_mfma_f32_32x32x16_bf16 v[64:79], a[140:143], a[116:119], v[64:79]
    s_waitcnt vmcnt(19)
    buffer_load_dwordx4 a[248:251], v251, s[4:7], s44 offen offset:0 sc1
    v_cvt_pk_bf16_f32 v88, v96, v97
    v_cvt_pk_bf16_f32 v89, v98, v99
    v_exp_f32_e64 v100, v36
    v_exp_f32 v101, v37
    v_exp_f32 v102, v38
    v_exp_f32 v103, v39
    v_mfma_f32_32x32x16_bf16 a[0:15], a[180:183], v[84:87], a[0:15]
    s_add_u32 s44, s44, 40960
    buffer_load_dwordx4 a[252:255], v250, s[4:7], s44 offen offset:0 sc1
    v_cvt_pk_bf16_f32 v90, v100, v101
    v_cvt_pk_bf16_f32 v91, v102, v103
    v_exp_f32 v96, v40
    v_exp_f32 v97, v41
    v_exp_f32 v98, v42
    v_exp_f32 v99, v43
    v_mfma_f32_32x32x16_bf16 a[16:31], a[176:179], v[88:91], a[16:31]
    v_cvt_pk_bf16_f32 v92, v96, v97
    v_cvt_pk_bf16_f32 v93, v98, v99
    v_exp_f32 v100, v44
    v_exp_f32 v101, v45
    v_exp_f32 v102, v46
    v_exp_f32 v103, v47
    v_mfma_f32_32x32x4_2b_bf16 v[16:47], a[186:187], a[132:133], 0 cbsz:1 abid:0
    v_cvt_pk_bf16_f32 v94, v100, v101
    v_cvt_pk_bf16_f32 v95, v102, v103
    v_exp_f32 v96, v48
    v_exp_f32 v97, v49
    v_exp_f32 v98, v50
    v_exp_f32 v99, v51
    v_cvt_pk_bf16_f32 v80, v96, v97
    v_cvt_pk_bf16_f32 v81, v98, v99
    v_exp_f32 v100, v52
    v_exp_f32 v101, v53
    v_exp_f32 v102, v54
    v_exp_f32 v103, v55
    v_mfma_f32_32x32x16_bf16 a[16:31], a[180:183], v[92:95], a[16:31]
    buffer_load_dwordx4 v[148:151], v250, s[4:7], s44 offen offset:1024 sc1
    v_cvt_pk_bf16_f32 v82, v100, v101
    v_cvt_pk_bf16_f32 v83, v102, v103
    v_exp_f32 v96, v56
    v_exp_f32 v97, v57
    v_exp_f32 v98, v58
    v_exp_f32 v99, v59
    v_mfma_f32_32x32x16_bf16 a[32:47], a[160:163], v[80:83], a[32:47]
    ds_write_b128 v141, a[0:3] offset:0
    v_cvt_pk_bf16_f32 v84, v96, v97
    v_cvt_pk_bf16_f32 v85, v98, v99
    v_exp_f32 v100, v60
    v_exp_f32 v101, v61
    v_exp_f32 v102, v62
    v_exp_f32 v103, v63
    v_mfma_f32_32x32x16_bf16 v[16:31], a[144:147], a[112:115], v[16:31]
    buffer_load_dwordx4 v[152:155], v250, s[4:7], s44 offen offset:2048 sc1
    v_cvt_pk_bf16_f32 v86, v100, v101
    v_cvt_pk_bf16_f32 v87, v102, v103
    v_exp_f32 v96, v64
    v_exp_f32 v97, v65
    v_exp_f32 v98, v66
    v_exp_f32 v99, v67
    v_mfma_f32_32x32x16_bf16 v[32:47], a[144:147], a[116:119], v[32:47]
    ds_write_b128 v141, a[4:7] offset:1024
    v_cvt_pk_bf16_f32 v88, v96, v97
    v_cvt_pk_bf16_f32 v89, v98, v99
    v_exp_f32 v100, v68
    v_exp_f32 v101, v69
    v_exp_f32 v102, v70
    v_exp_f32 v103, v71
    v_mfma_f32_32x32x16_bf16 a[32:47], a[164:167], v[84:87], a[32:47]
    buffer_load_dwordx4 v[156:159], v250, s[4:7], s44 offen offset:3072 sc1
    v_cvt_pk_bf16_f32 v90, v100, v101
    v_cvt_pk_bf16_f32 v91, v102, v103
    v_exp_f32 v96, v72
    v_exp_f32 v97, v73
    v_exp_f32 v98, v74
    v_exp_f32 v99, v75
    v_mfma_f32_32x32x16_bf16 a[48:63], a[160:163], v[88:91], a[48:63]
    ds_write_b128 v141, a[8:11] offset:2048
    v_cvt_pk_bf16_f32 v92, v96, v97
    v_cvt_pk_bf16_f32 v93, v98, v99
    v_exp_f32 v100, v76
    v_exp_f32 v101, v77
    v_exp_f32 v102, v78
    v_exp_f32 v103, v79
    v_mfma_f32_32x32x4_2b_bf16 v[48:79], a[186:187], a[132:133], 0 cbsz:1 abid:1
    v_cvt_pk_bf16_f32 v94, v100, v101
    v_cvt_pk_bf16_f32 v95, v102, v103
    v_exp_f32 v96, v16
    v_exp_f32 v97, v17
    v_exp_f32 v98, v18
    v_exp_f32 v99, v19
    v_cvt_pk_bf16_f32 v80, v96, v97
    v_cvt_pk_bf16_f32 v81, v98, v99
    v_exp_f32 v100, v20
    v_exp_f32 v101, v21
    v_exp_f32 v102, v22
    v_exp_f32 v103, v23
    v_mfma_f32_32x32x16_bf16 a[48:63], a[164:167], v[92:95], a[48:63]
    buffer_load_dwordx4 v[160:163], v251, s[4:7], s44 offen offset:0 sc1
    v_cvt_pk_bf16_f32 v82, v100, v101
    v_cvt_pk_bf16_f32 v83, v102, v103
    v_exp_f32 v96, v24
    v_exp_f32 v97, v25
    v_exp_f32 v98, v26
    v_exp_f32 v99, v27
    v_mfma_f32_32x32x16_bf16 a[32:47], a[168:171], v[80:83], a[32:47]
    ds_write_b128 v141, a[16:19] offset:3072
    v_cvt_pk_bf16_f32 v84, v96, v97
    v_cvt_pk_bf16_f32 v85, v98, v99
    v_exp_f32 v100, v28
    v_exp_f32 v101, v29
    v_exp_f32 v102, v30
    v_exp_f32 v103, v31
    v_mfma_f32_32x32x16_bf16 v[48:63], a[148:151], a[112:115], v[48:63]
    s_mov_b32 s44, s78
    buffer_load_dwordx4 v[164:167], v250, s[4:7], s44 offen offset:0 sc1
    v_cvt_pk_bf16_f32 v86, v100, v101
    v_cvt_pk_bf16_f32 v87, v102, v103
    v_exp_f32_e64 v96, v32
    v_exp_f32 v97, v33
    v_exp_f32 v98, v34
    v_exp_f32 v99, v35
    v_mfma_f32_32x32x16_bf16 v[64:79], a[148:151], a[116:119], v[64:79]
    ds_write_b128 v141, a[20:23] offset:4096
    v_cvt_pk_bf16_f32 v88, v96, v97
    v_cvt_pk_bf16_f32 v89, v98, v99
    v_exp_f32 v100, v36
    v_exp_f32 v101, v37
    v_exp_f32 v102, v38
    v_exp_f32 v103, v39
    v_mfma_f32_32x32x16_bf16 a[32:47], a[172:175], v[84:87], a[32:47]
    buffer_load_dwordx4 v[168:171], v250, s[4:7], s44 offen offset:1024 sc1
    v_cvt_pk_bf16_f32 v90, v100, v101
    v_cvt_pk_bf16_f32 v91, v102, v103
    v_exp_f32 v96, v40
    v_exp_f32 v97, v41
    v_exp_f32 v98, v42
    v_exp_f32 v99, v43
    v_mfma_f32_32x32x16_bf16 a[48:63], a[168:171], v[88:91], a[48:63]
    ds_write_b128 v141, a[24:27] offset:5120
    v_cvt_pk_bf16_f32 v92, v96, v97
    v_cvt_pk_bf16_f32 v93, v98, v99
    v_exp_f32 v100, v44
    v_exp_f32 v101, v45
    v_exp_f32 v102, v46
    v_exp_f32 v103, v47
    v_mfma_f32_32x32x4_2b_bf16 v[16:47], a[184:185], a[134:135], 0 cbsz:1 abid:1
    v_cvt_pk_bf16_f32 v94, v100, v101
    v_cvt_pk_bf16_f32 v95, v102, v103
    v_exp_f32 v96, v48
    v_exp_f32 v97, v49
    v_exp_f32 v98, v50
    v_exp_f32 v99, v51
    v_cvt_pk_bf16_f32 v80, v96, v97
    v_cvt_pk_bf16_f32 v81, v98, v99
    v_exp_f32 v100, v52
    v_exp_f32 v101, v53
    v_exp_f32 v102, v54
    v_exp_f32 v103, v55
    v_mfma_f32_32x32x16_bf16 a[48:63], a[172:175], v[92:95], a[48:63]
    s_waitcnt lgkmcnt(0)
    buffer_load_dwordx4 v[172:175], v250, s[4:7], s44 offen offset:2048 sc1
    v_cvt_pk_bf16_f32 v82, v100, v101
    v_cvt_pk_bf16_f32 v83, v102, v103
    v_exp_f32_e64 v96, v56
    v_exp_f32 v97, v57
    v_exp_f32 v98, v58
    v_exp_f32 v99, v59
    v_mfma_f32_32x32x16_bf16 a[32:47], a[176:179], v[80:83], a[32:47]
    buffer_load_dwordx4 v[176:179], v250, s[4:7], s44 offen offset:3072 sc1
    v_cvt_pk_bf16_f32 v84, v96, v97
    v_cvt_pk_bf16_f32 v85, v98, v99
    v_exp_f32 v100, v60
    v_exp_f32 v101, v61
    v_exp_f32 v102, v62
    v_exp_f32 v103, v63
    v_mfma_f32_32x32x16_bf16 v[16:31], a[140:143], a[120:123], v[16:31]
    buffer_load_dwordx4 v[180:183], v251, s[4:7], s44 offen offset:0 sc1
    v_cvt_pk_bf16_f32 v86, v100, v101
    v_cvt_pk_bf16_f32 v87, v102, v103
    v_exp_f32 v96, v64
    v_exp_f32 v97, v65
    v_exp_f32 v98, v66
    v_exp_f32 v99, v67
    v_mfma_f32_32x32x16_bf16 v[32:47], a[140:143], a[124:127], v[32:47]
    buffer_load_dwordx4 a[0:3], v250, s[4:7], s100 offen offset:0 sc1
    v_cvt_pk_bf16_f32 v88, v96, v97
    v_cvt_pk_bf16_f32 v89, v98, v99
    v_exp_f32 v100, v68
    v_exp_f32 v101, v69
    v_exp_f32 v102, v70
    v_exp_f32 v103, v71
    v_mfma_f32_32x32x16_bf16 a[32:47], a[180:183], v[84:87], a[32:47]
    buffer_load_dwordx4 a[4:7], v250, s[4:7], s100 offen offset:1024 sc1
    v_cvt_pk_bf16_f32 v90, v100, v101
    v_cvt_pk_bf16_f32 v91, v102, v103
    v_exp_f32 v96, v72
    v_exp_f32 v97, v73
    v_exp_f32 v98, v74
    v_exp_f32 v99, v75
    v_mfma_f32_32x32x16_bf16 a[48:63], a[176:179], v[88:91], a[48:63]
    buffer_load_dwordx4 a[8:11], v250, s[4:7], s100 offen offset:2048 sc1
    v_cvt_pk_bf16_f32 v92, v96, v97
    v_cvt_pk_bf16_f32 v93, v98, v99
    v_exp_f32 v100, v76
    v_exp_f32 v101, v77
    v_exp_f32 v102, v78
    v_exp_f32 v103, v79
    v_mfma_f32_32x32x4_2b_bf16 v[48:79], a[186:187], a[134:135], 0 cbsz:1 abid:0
    v_cvt_pk_bf16_f32 v94, v100, v101
    v_cvt_pk_bf16_f32 v95, v102, v103
    v_exp_f32 v96, v16
    v_exp_f32 v97, v17
    v_exp_f32 v98, v18
    v_exp_f32 v99, v19
    v_cvt_pk_bf16_f32 v80, v96, v97
    v_cvt_pk_bf16_f32 v81, v98, v99
    v_exp_f32 v100, v20
    v_exp_f32 v101, v21
    v_exp_f32 v102, v22
    v_exp_f32 v103, v23
    v_mfma_f32_32x32x16_bf16 a[48:63], a[180:183], v[92:95], a[48:63]
    buffer_load_dwordx4 a[12:15], v250, s[4:7], s100 offen offset:3072 sc1
    v_cvt_pk_bf16_f32 v82, v100, v101
    v_cvt_pk_bf16_f32 v83, v102, v103
    v_exp_f32 v96, v24
    v_exp_f32 v97, v25
    v_exp_f32 v98, v26
    v_exp_f32 v99, v27
    v_mfma_f32_32x32x16_bf16 a[64:79], a[160:163], v[80:83], a[64:79]
    ds_write_b128 v142, a[32:35] offset:0
    v_cvt_pk_bf16_f32 v84, v96, v97
    v_cvt_pk_bf16_f32 v85, v98, v99
    v_exp_f32 v100, v28
    v_exp_f32 v101, v29
    v_exp_f32 v102, v30
    v_exp_f32 v103, v31
    v_mfma_f32_32x32x16_bf16 v[48:63], a[144:147], a[120:123], v[48:63]
    buffer_load_dwordx4 a[16:19], v251, s[4:7], s100 offen offset:0 sc1
    v_cvt_pk_bf16_f32 v86, v100, v101
    v_cvt_pk_bf16_f32 v87, v102, v103
    v_exp_f32 v96, v32
    v_exp_f32 v97, v33
    v_exp_f32 v98, v34
    v_exp_f32 v99, v35
    v_mfma_f32_32x32x16_bf16 v[64:79], a[144:147], a[124:127], v[64:79]
    ds_write_b128 v142, a[36:39] offset:1024
    v_cvt_pk_bf16_f32 v88, v96, v97
    v_cvt_pk_bf16_f32 v89, v98, v99
    v_exp_f32 v100, v36
    v_exp_f32 v101, v37
    v_exp_f32 v102, v38
    v_exp_f32 v103, v39
    v_mfma_f32_32x32x16_bf16 a[64:79], a[164:167], v[84:87], a[64:79]
    s_add_u32 s100, s100, 40960
    buffer_load_dwordx4 a[20:23], v250, s[4:7], s100 offen offset:0 sc1
    v_cvt_pk_bf16_f32 v90, v100, v101
    v_cvt_pk_bf16_f32 v91, v102, v103
    v_exp_f32 v96, v40
    v_exp_f32 v97, v41
    v_exp_f32 v98, v42
    v_exp_f32 v99, v43
    v_mfma_f32_32x32x16_bf16 a[80:95], a[160:163], v[88:91], a[80:95]
    ds_write_b128 v142, a[40:43] offset:2048
    v_cvt_pk_bf16_f32 v92, v96, v97
    v_cvt_pk_bf16_f32 v93, v98, v99
    v_exp_f32 v100, v44
    v_exp_f32 v101, v45
    v_exp_f32 v102, v46
    v_exp_f32 v103, v47
    v_mfma_f32_32x32x4_2b_bf16 v[16:47], a[186:187], a[134:135], 0 cbsz:1 abid:1
    v_cvt_pk_bf16_f32 v94, v100, v101
    v_cvt_pk_bf16_f32 v95, v102, v103
    v_exp_f32 v96, v48
    v_exp_f32 v97, v49
    v_exp_f32 v98, v50
    v_exp_f32 v99, v51
    v_cvt_pk_bf16_f32 v80, v96, v97
    v_cvt_pk_bf16_f32 v81, v98, v99
    v_exp_f32 v100, v52
    v_exp_f32 v101, v53
    v_exp_f32 v102, v54
    v_exp_f32 v103, v55
    v_mfma_f32_32x32x16_bf16 a[80:95], a[164:167], v[92:95], a[80:95]
    buffer_load_dwordx4 a[24:27], v250, s[4:7], s100 offen offset:1024 sc1
    v_cvt_pk_bf16_f32 v82, v100, v101
    v_cvt_pk_bf16_f32 v83, v102, v103
    v_exp_f32 v96, v56
    v_exp_f32 v97, v57
    v_exp_f32 v98, v58
    v_exp_f32 v99, v59
    v_mfma_f32_32x32x16_bf16 a[64:79], a[168:171], v[80:83], a[64:79]
    ds_write_b128 v142, a[48:51] offset:3072
    v_cvt_pk_bf16_f32 v84, v96, v97
    v_cvt_pk_bf16_f32 v85, v98, v99
    v_exp_f32 v100, v60
    v_exp_f32 v101, v61
    v_exp_f32 v102, v62
    v_exp_f32 v103, v63
    v_mfma_f32_32x32x16_bf16 v[16:31], a[148:151], a[120:123], v[16:31]
    buffer_load_dwordx4 a[28:31], v250, s[4:7], s100 offen offset:2048 sc1
    v_cvt_pk_bf16_f32 v86, v100, v101
    v_cvt_pk_bf16_f32 v87, v102, v103
    v_exp_f32 v96, v64
    v_exp_f32 v97, v65
    v_exp_f32 v98, v66
    v_exp_f32 v99, v67
    v_mfma_f32_32x32x16_bf16 v[32:47], a[148:151], a[124:127], v[32:47]
    ds_write_b128 v142, a[52:55] offset:4096
    v_cvt_pk_bf16_f32 v88, v96, v97
    v_cvt_pk_bf16_f32 v89, v98, v99
    v_exp_f32 v100, v68
    v_exp_f32 v101, v69
    v_exp_f32 v102, v70
    v_exp_f32 v103, v71
    v_mfma_f32_32x32x16_bf16 a[64:79], a[172:175], v[84:87], a[64:79]
    v_cvt_pk_bf16_f32 v90, v100, v101
    v_cvt_pk_bf16_f32 v91, v102, v103
    v_exp_f32 v96, v72
    v_exp_f32 v97, v73
    v_exp_f32 v98, v74
    v_exp_f32 v99, v75
    v_mfma_f32_32x32x16_bf16 a[80:95], a[168:171], v[88:91], a[80:95]
    ds_write_b128 v142, a[56:59] offset:5120
    v_cvt_pk_bf16_f32 v92, v96, v97
    v_cvt_pk_bf16_f32 v93, v98, v99
    v_exp_f32 v100, v76
    v_exp_f32 v101, v77
    v_exp_f32 v102, v78
    v_exp_f32 v103, v79
    v_mfma_f32_32x32x4_2b_bf16 v[48:79], a[184:185], a[128:129], 0 cbsz:1 abid:1
    v_cvt_pk_bf16_f32 v94, v100, v101
    v_cvt_pk_bf16_f32 v95, v102, v103
    v_exp_f32 v96, v16
    v_exp_f32 v97, v17
    v_exp_f32 v98, v18
    v_exp_f32 v99, v19
    v_cvt_pk_bf16_f32 v80, v96, v97
    v_cvt_pk_bf16_f32 v81, v98, v99
    v_exp_f32 v100, v20
    v_exp_f32 v101, v21
    v_exp_f32 v102, v22
    v_exp_f32 v103, v23
    v_mfma_f32_32x32x16_bf16 a[80:95], a[172:175], v[92:95], a[80:95]
    s_waitcnt lgkmcnt(0)
    buffer_load_dwordx4 a[32:35], v250, s[4:7], s100 offen offset:3072 sc1
    v_cvt_pk_bf16_f32 v82, v100, v101
    v_cvt_pk_bf16_f32 v83, v102, v103
    v_exp_f32_e64 v96, v24
    v_exp_f32 v97, v25
    v_exp_f32 v98, v26
    v_exp_f32 v99, v27
    v_mfma_f32_32x32x16_bf16 a[64:79], a[176:179], v[80:83], a[64:79]
    v_cvt_pk_bf16_f32 v84, v96, v97
    v_cvt_pk_bf16_f32 v85, v98, v99
    v_exp_f32 v100, v28
    v_exp_f32 v101, v29
    v_exp_f32 v102, v30
    v_exp_f32 v103, v31
    v_mfma_f32_32x32x16_bf16 v[48:63], a[140:143], a[96:99], v[48:63]
    buffer_load_dwordx4 a[36:39], v251, s[4:7], s100 offen offset:0 sc1
    v_cvt_pk_bf16_f32 v86, v100, v101
    v_cvt_pk_bf16_f32 v87, v102, v103
    v_exp_f32 v96, v32
    v_exp_f32 v97, v33
    v_exp_f32 v98, v34
    v_exp_f32 v99, v35
    v_mfma_f32_32x32x16_bf16 v[64:79], a[140:143], a[100:103], v[64:79]
    s_add_u32 s100, s100, 40960
    v_cvt_pk_bf16_f32 v88, v96, v97
    v_cvt_pk_bf16_f32 v89, v98, v99
    v_exp_f32 v100, v36
    v_exp_f32 v101, v37
    v_exp_f32 v102, v38
    v_exp_f32 v103, v39
    v_mfma_f32_32x32x16_bf16 a[64:79], a[180:183], v[84:87], a[64:79]
    buffer_load_dwordx4 a[40:43], v250, s[4:7], s100 offen offset:0 sc1
    v_cvt_pk_bf16_f32 v90, v100, v101
    v_cvt_pk_bf16_f32 v91, v102, v103
    v_exp_f32 v96, v40
    v_exp_f32 v97, v41
    v_exp_f32 v98, v42
    v_exp_f32 v99, v43
    v_mfma_f32_32x32x16_bf16 a[80:95], a[176:179], v[88:91], a[80:95]
    v_cvt_pk_bf16_f32 v92, v96, v97
    v_cvt_pk_bf16_f32 v93, v98, v99
    v_exp_f32 v100, v44
    v_exp_f32 v101, v45
    v_exp_f32 v102, v46
    v_exp_f32 v103, v47
    v_mfma_f32_32x32x4_2b_bf16 v[16:47], a[186:187], a[128:129], 0 cbsz:1 abid:0
    v_cvt_pk_bf16_f32 v94, v100, v101
    v_cvt_pk_bf16_f32 v95, v102, v103
    v_exp_f32 v96, v48
    v_exp_f32 v97, v49
    v_exp_f32 v98, v50
    v_exp_f32 v99, v51
    v_cvt_pk_bf16_f32 v80, v96, v97
    v_cvt_pk_bf16_f32 v81, v98, v99
    v_exp_f32 v100, v52
    v_exp_f32 v101, v53
    v_exp_f32 v102, v54
    v_exp_f32 v103, v55
    v_mfma_f32_32x32x16_bf16 a[80:95], a[180:183], v[92:95], a[80:95]
    buffer_load_dwordx4 a[44:47], v250, s[4:7], s100 offen offset:1024 sc1
    v_cvt_pk_bf16_f32 v82, v100, v101
    v_cvt_pk_bf16_f32 v83, v102, v103
    v_exp_f32 v96, v56
    v_exp_f32 v97, v57
    v_exp_f32 v98, v58
    v_exp_f32 v99, v59
    v_mfma_f32_32x32x16_bf16 v[104:119], a[160:163], v[80:83], v[104:119]
    ds_write_b128 v143, a[64:67] offset:0
    v_cvt_pk_bf16_f32 v84, v96, v97
    v_cvt_pk_bf16_f32 v85, v98, v99
    v_exp_f32 v100, v60
    v_exp_f32 v101, v61
    v_exp_f32 v102, v62
    v_exp_f32 v103, v63
    v_mfma_f32_32x32x16_bf16 v[16:31], a[144:147], a[96:99], v[16:31]
    buffer_load_dwordx4 a[48:51], v250, s[4:7], s100 offen offset:2048 sc1
    v_cvt_pk_bf16_f32 v86, v100, v101
    v_cvt_pk_bf16_f32 v87, v102, v103
    v_exp_f32 v96, v64
    v_exp_f32 v97, v65
    v_exp_f32 v98, v66
    v_exp_f32 v99, v67
    v_mfma_f32_32x32x16_bf16 v[32:47], a[144:147], a[100:103], v[32:47]
    ds_write_b128 v143, a[68:71] offset:1024
    v_cvt_pk_bf16_f32 v88, v96, v97
    v_cvt_pk_bf16_f32 v89, v98, v99
    v_exp_f32 v100, v68
    v_exp_f32 v101, v69
    v_exp_f32 v102, v70
    v_exp_f32 v103, v71
    v_mfma_f32_32x32x16_bf16 v[104:119], a[164:167], v[84:87], v[104:119]
    buffer_load_dwordx4 a[52:55], v250, s[4:7], s100 offen offset:3072 sc1
    v_cvt_pk_bf16_f32 v90, v100, v101
    v_cvt_pk_bf16_f32 v91, v102, v103
    v_exp_f32 v96, v72
    v_exp_f32 v97, v73
    v_exp_f32 v98, v74
    v_exp_f32 v99, v75
    v_mfma_f32_32x32x16_bf16 v[120:135], a[160:163], v[88:91], v[120:135]
    ds_write_b128 v143, a[72:75] offset:2048
    v_cvt_pk_bf16_f32 v92, v96, v97
    v_cvt_pk_bf16_f32 v93, v98, v99
    v_exp_f32 v100, v76
    v_exp_f32 v101, v77
    v_exp_f32 v102, v78
    v_exp_f32 v103, v79
    v_mfma_f32_32x32x4_2b_bf16 v[48:79], a[186:187], a[128:129], 0 cbsz:1 abid:1
    v_cvt_pk_bf16_f32 v94, v100, v101
    v_cvt_pk_bf16_f32 v95, v102, v103
    v_exp_f32 v96, v16
    v_exp_f32 v97, v17
    v_exp_f32 v98, v18
    v_exp_f32 v99, v19
    v_cvt_pk_bf16_f32 v80, v96, v97
    v_cvt_pk_bf16_f32 v81, v98, v99
    v_exp_f32 v100, v20
    v_exp_f32 v101, v21
    v_exp_f32 v102, v22
    v_exp_f32 v103, v23
    v_mfma_f32_32x32x16_bf16 v[120:135], a[164:167], v[92:95], v[120:135]
    buffer_load_dwordx4 a[56:59], v251, s[4:7], s100 offen offset:0 sc1
    v_cvt_pk_bf16_f32 v82, v100, v101
    v_cvt_pk_bf16_f32 v83, v102, v103
    v_exp_f32 v96, v24
    v_exp_f32 v97, v25
    v_exp_f32 v98, v26
    v_exp_f32 v99, v27
    v_mfma_f32_32x32x16_bf16 v[104:119], a[168:171], v[80:83], v[104:119]
    ds_write_b128 v143, a[80:83] offset:3072
    v_cvt_pk_bf16_f32 v84, v96, v97
    v_cvt_pk_bf16_f32 v85, v98, v99
    v_exp_f32 v100, v28
    v_exp_f32 v101, v29
    v_exp_f32 v102, v30
    v_exp_f32 v103, v31
    v_mfma_f32_32x32x16_bf16 v[48:63], a[148:151], a[96:99], v[48:63]
    s_add_u32 s100, s100, 40960
    buffer_load_dwordx4 a[60:63], v250, s[4:7], s100 offen offset:0 sc1
    v_cvt_pk_bf16_f32 v86, v100, v101
    v_cvt_pk_bf16_f32 v87, v102, v103
    v_exp_f32 v96, v32
    v_exp_f32 v97, v33
    v_exp_f32 v98, v34
    v_exp_f32 v99, v35
    v_mfma_f32_32x32x16_bf16 v[64:79], a[148:151], a[100:103], v[64:79]
sequential_preLN__softmax_full_mha__glu_gated_bilinear__prompt_kernel_pgatt5:
    s_cbranch_execz sequential_preLN__softmax_full_mha__glu_gated_bilinear__prompt_kernel_wratt
    ds_write_b128 v143, a[84:87] offset:4096
    v_cvt_pk_bf16_f32 v88, v96, v97
    v_cvt_pk_bf16_f32 v89, v98, v99
    v_exp_f32 v100, v36
    v_exp_f32 v101, v37
    v_exp_f32 v102, v38
    v_exp_f32 v103, v39
    v_mfma_f32_32x32x16_bf16 v[104:119], a[172:175], v[84:87], v[104:119]
    v_cvt_pk_bf16_f32 v90, v100, v101
    v_cvt_pk_bf16_f32 v91, v102, v103
    v_exp_f32 v96, v40
    v_exp_f32 v97, v41
    v_exp_f32 v98, v42
    v_exp_f32 v99, v43
    v_mfma_f32_32x32x16_bf16 v[120:135], a[168:171], v[88:91], v[120:135]
    ds_write_b128 v143, a[88:91] offset:5120
    v_cvt_pk_bf16_f32 v92, v96, v97
    v_cvt_pk_bf16_f32 v93, v98, v99
    v_exp_f32 v100, v44
    v_exp_f32 v101, v45
    v_exp_f32 v102, v46
    v_exp_f32 v103, v47
    v_cvt_pk_bf16_f32 v94, v100, v101
    v_cvt_pk_bf16_f32 v95, v102, v103
    v_exp_f32 v96, v48
    v_exp_f32 v97, v49
    v_exp_f32 v98, v50
    v_exp_f32 v99, v51
    v_cvt_pk_bf16_f32 v80, v96, v97
    v_cvt_pk_bf16_f32 v81, v98, v99
    v_exp_f32 v100, v52
    v_exp_f32 v101, v53
    v_exp_f32 v102, v54
    v_exp_f32 v103, v55
    v_mfma_f32_32x32x16_bf16 v[120:135], a[172:175], v[92:95], v[120:135]
    s_waitcnt lgkmcnt(0)
    s_barrier
    ds_read_b128 v[204:207], v144 offset:0
    ds_read_b128 v[208:211], v144 offset:1024
    ds_read_b128 v[212:215], v144 offset:2048
    ds_read_b128 v[216:219], v144 offset:3072
    ds_read_b128 v[220:223], v144 offset:4096
    ds_read_b128 v[224:227], v144 offset:5120
    v_cvt_pk_bf16_f32 v82, v100, v101
    v_cvt_pk_bf16_f32 v83, v102, v103
    v_exp_f32 v96, v56
    v_exp_f32 v97, v57
    v_exp_f32 v98, v58
    v_exp_f32 v99, v59
    v_mfma_f32_32x32x16_bf16 v[104:119], a[176:179], v[80:83], v[104:119]
    ds_read_b128 v[16:19], v144 offset:6144
    ds_read_b128 v[20:23], v144 offset:7168
    ds_read_b128 v[24:27], v144 offset:8192
    ds_read_b128 v[28:31], v144 offset:9216
    ds_read_b128 v[32:35], v144 offset:10240
    ds_read_b128 v[36:39], v144 offset:11264
    v_cvt_pk_bf16_f32 v84, v96, v97
    v_cvt_pk_bf16_f32 v85, v98, v99
    v_exp_f32 v100, v60
    v_exp_f32 v101, v61
    v_exp_f32 v102, v62
    v_exp_f32 v103, v63
    s_add_u32 s91, s85, 122880
    buffer_load_dword v248, v140, s[4:7], s91 offen sc1
    v_cvt_pk_bf16_f32 v86, v100, v101
    v_cvt_pk_bf16_f32 v87, v102, v103
    v_exp_f32 v96, v64
    v_exp_f32 v97, v65
    v_exp_f32 v98, v66
    v_exp_f32 v99, v67
    v_cvt_pk_bf16_f32 v88, v96, v97
    v_cvt_pk_bf16_f32 v89, v98, v99
    v_exp_f32 v100, v68
    v_exp_f32 v101, v69
    v_exp_f32 v102, v70
    v_exp_f32 v103, v71
    v_mfma_f32_32x32x16_bf16 v[104:119], a[180:183], v[84:87], v[104:119]
    ds_read_b128 v[228:231], v144 offset:12288
    ds_read_b128 v[232:235], v144 offset:13312
    ds_read_b128 v[236:239], v144 offset:14336
    ds_read_b128 v[200:203], v144 offset:15360
    ds_read_b128 v[40:43], v144 offset:16384
    ds_read_b128 v[44:47], v144 offset:17408
    v_cvt_pk_bf16_f32 v90, v100, v101
    v_cvt_pk_bf16_f32 v91, v102, v103
    v_exp_f32 v96, v72
    v_exp_f32 v97, v73
    v_exp_f32 v98, v74
    v_exp_f32 v99, v75
    v_mfma_f32_32x32x16_bf16 v[120:135], a[176:179], v[88:91], v[120:135]
    v_cvt_pk_bf16_f32 v92, v96, v97
    v_cvt_pk_bf16_f32 v93, v98, v99
    v_exp_f32 v100, v76
    v_exp_f32 v101, v77
    v_exp_f32 v102, v78
    v_exp_f32 v103, v79
    v_cvt_pk_bf16_f32 v94, v100, v101
    v_cvt_pk_bf16_f32 v95, v102, v103
    s_waitcnt lgkmcnt(0)
    s_nop 0
    v_mfma_f32_32x32x16_bf16 v[120:135], a[180:183], v[92:95], v[120:135]
    v_add_f32 v204, v204, v16
    v_add_f32 v205, v205, v17
    v_add_f32 v206, v206, v18
    v_add_f32 v207, v207, v19
    v_add_f32 v208, v208, v20
    v_add_f32 v209, v209, v21
    v_add_f32 v210, v210, v22
    v_add_f32 v211, v211, v23
    v_pk_add_f32 v[212:213], v[212:213], v[24:25]
    v_pk_add_f32 v[214:215], v[214:215], v[26:27]
    v_pk_add_f32 v[216:217], v[216:217], v[28:29]
    v_pk_add_f32 v[218:219], v[218:219], v[30:31]
    v_pk_add_f32 v[220:221], v[220:221], v[32:33]
    v_pk_add_f32 v[222:223], v[222:223], v[34:35]
    v_pk_add_f32 v[224:225], v[224:225], v[36:37]
    v_pk_add_f32 v[226:227], v[226:227], v[38:39]
    v_pk_add_f32 v[104:105], v[104:105], v[204:205]
    v_pk_add_f32 v[106:107], v[106:107], v[206:207]
    v_pk_add_f32 v[108:109], v[108:109], v[208:209]
    v_pk_add_f32 v[110:111], v[110:111], v[210:211]
    v_pk_add_f32 v[112:113], v[112:113], v[212:213]
    v_pk_add_f32 v[114:115], v[114:115], v[214:215]
    v_pk_add_f32 v[120:121], v[120:121], v[216:217]
    v_pk_add_f32 v[122:123], v[122:123], v[218:219]
    v_pk_add_f32 v[124:125], v[124:125], v[220:221]
    v_pk_add_f32 v[126:127], v[126:127], v[222:223]
    v_pk_add_f32 v[128:129], v[128:129], v[224:225]
    v_pk_add_f32 v[130:131], v[130:131], v[226:227]
    v_pk_add_f32 v[104:105], v[104:105], v[228:229]
    v_pk_add_f32 v[106:107], v[106:107], v[230:231]
    v_pk_add_f32 v[108:109], v[108:109], v[232:233]
    v_pk_add_f32 v[110:111], v[110:111], v[234:235]
    v_pk_add_f32 v[112:113], v[112:113], v[236:237]
    v_pk_add_f32 v[114:115], v[114:115], v[238:239]
    v_pk_add_f32 v[120:121], v[120:121], v[200:201]
    v_pk_add_f32 v[122:123], v[122:123], v[202:203]
    v_pk_add_f32 v[124:125], v[124:125], v[40:41]
    v_pk_add_f32 v[126:127], v[126:127], v[42:43]
    v_pk_add_f32 v[128:129], v[128:129], v[44:45]
    v_pk_add_f32 v[130:131], v[130:131], v[46:47]
sequential_preLN__softmax_full_mha__glu_gated_bilinear__prompt_kernel_anorm:
    v_mov_b32 v12, v112
    v_mov_b32 v13, v112
    v_mov_b32 v14, v128
    v_mov_b32 v15, v128
    s_mov_b32 s36, 0x5d800000
    s_mov_b32 s37, 0x21800000
    v_permlane32_swap_b32 v12, v13
    v_permlane32_swap_b32 v14, v15
    s_nop 1
    v_rcp_f32 v12, v13
    v_rcp_f32 v14, v15
    v_cmp_nlt_f32_e64 vcc, v13, s36
    v_cmp_nlt_f32_e64 s[40:41], v15, s36
    v_cmp_ngt_f32_e64 s[42:43], v13, s37
    v_cmp_ngt_f32_e64 s[56:57], v15, s37
    s_or_b64 vcc, vcc, s[40:41]
    s_or_b64 vcc, vcc, s[42:43]
    s_or_b64 vcc, vcc, s[56:57]
    s_cbranch_scc1 sequential_preLN__softmax_full_mha__glu_gated_bilinear__prompt_kernel_aslow
sequential_preLN__softmax_full_mha__glu_gated_bilinear__prompt_kernel_afin:
    s_mov_b64 exec, 1
    buffer_atomic_or v10, off, s[4:7], s38 sc1
    s_mov_b64 exec, -1
    v_pk_mul_f32 v[104:105], v[104:105], v[12:13] op_sel_hi:[1,0]
    v_pk_mul_f32 v[106:107], v[106:107], v[12:13] op_sel_hi:[1,0]
    v_pk_mul_f32 v[108:109], v[108:109], v[12:13] op_sel_hi:[1,0]
    v_pk_mul_f32 v[110:111], v[110:111], v[12:13] op_sel_hi:[1,0]
    v_pk_mul_f32 v[112:113], v[112:113], v[12:13] op_sel_hi:[1,0]
    v_pk_mul_f32 v[114:115], v[114:115], v[12:13] op_sel_hi:[1,0]
    v_cvt_pk_bf16_f32 v16, v104, v105
    v_cvt_pk_bf16_f32 v17, v106, v107
    v_cvt_pk_bf16_f32 v18, v108, v109
    v_cvt_pk_bf16_f32 v19, v110, v111
    v_cvt_pk_bf16_f32 v24, v112, v113
    v_cvt_pk_bf16_f32 v25, v114, v115
    v_pk_mul_f32 v[120:121], v[120:121], v[14:15] op_sel_hi:[1,0]
    v_pk_mul_f32 v[122:123], v[122:123], v[14:15] op_sel_hi:[1,0]
    v_pk_mul_f32 v[124:125], v[124:125], v[14:15] op_sel_hi:[1,0]
    v_pk_mul_f32 v[126:127], v[126:127], v[14:15] op_sel_hi:[1,0]
    v_pk_mul_f32 v[128:129], v[128:129], v[14:15] op_sel_hi:[1,0]
    v_pk_mul_f32 v[130:131], v[130:131], v[14:15] op_sel_hi:[1,0]
    v_cvt_pk_bf16_f32 v20, v120, v121
    v_cvt_pk_bf16_f32 v21, v122, v123
    v_cvt_pk_bf16_f32 v22, v124, v125
    v_cvt_pk_bf16_f32 v23, v126, v127
    v_cvt_pk_bf16_f32 v26, v128, v129
    v_cvt_pk_bf16_f32 v27, v130, v131
    buffer_store_dwordx4 v[16:19], v139, s[4:7], s33 offen sc1
    buffer_store_dwordx4 v[20:23], v139, s[4:7], s39 offen sc1
    s_mov_b32 exec_hi, 0
    buffer_store_dwordx4 v[24:27], v253, s[4:7], s63 offen sc1
    s_mov_b64 exec, -1
    s_waitcnt vmcnt(20)
    s_barrier
    v_lshlrev_b32 v16, 16, v184
    v_and_b32 v17, 0xffff0000, v184
    v_lshlrev_b32 v18, 16, v185
    v_and_b32 v19, 0xffff0000, v185
    v_lshlrev_b32 v20, 16, v186
    v_and_b32 v21, 0xffff0000, v186
    v_lshlrev_b32 v22, 16, v187
    v_and_b32 v23, 0xffff0000, v187
    v_lshlrev_b32 v24, 16, v188
    v_and_b32 v25, 0xffff0000, v188
    v_lshlrev_b32 v26, 16, v189
    v_and_b32 v27, 0xffff0000, v189
    v_lshlrev_b32 v28, 16, v190
    v_and_b32 v29, 0xffff0000, v190
    v_lshlrev_b32 v30, 16, v191
    v_and_b32 v31, 0xffff0000, v191
    v_lshlrev_b32 v32, 16, v192
    v_and_b32 v33, 0xffff0000, v192
    v_lshlrev_b32 v34, 16, v193
    v_and_b32 v35, 0xffff0000, v193
    v_add_f32 v194, v194, v195
    v_add_f32 v196, v196, v197
    v_add_f32 v194, v194, v196
    v_add_u32 v146, 147456, v146
    ds_write_b32 v146, v194
    s_mov_b64 exec, 0xff
    s_mov_b32 s58, 200000
    v_mov_b32 v2, 0
    buffer_atomic_or v2, v241, s[4:7], s84 offen sc0 sc1
    s_mov_b64 exec, 0
    s_cmp_eq_u32 s3, 1
    s_cbranch_scc1 sequential_preLN__softmax_full_mha__glu_gated_bilinear__prompt_kernel_pglate1
    s_cmp_eq_u32 s3, 2
    s_cbranch_scc1 sequential_preLN__softmax_full_mha__glu_gated_bilinear__prompt_kernel_pglate2
    s_cmp_eq_u32 s3, 3
    s_cbranch_scc1 sequential_preLN__softmax_full_mha__glu_gated_bilinear__prompt_kernel_pglate3
    s_branch sequential_preLN__softmax_full_mha__glu_gated_bilinear__prompt_kernel_pglate0
sequential_preLN__softmax_full_mha__glu_gated_bilinear__prompt_kernel_wrlate:
    s_mov_b64 exec, -1
    s_mov_b64 exec, 0xff
    s_branch L_poll_19w
L_poll_19:
    v_mov_b32 v2, 0
    buffer_atomic_or v2, v241, s[4:7], s84 offen sc0 sc1
L_poll_19w:
    s_waitcnt vmcnt(0)
    v_cmp_eq_u32 vcc, 0, v2
    s_sub_u32 s58, s58, 1
    s_cbranch_scc1 L_pollout_20
    s_cbranch_vccnz L_poll_19
L_pollout_20:
    s_mov_b64 exec, -1
    buffer_load_dwordx2 v[112:113], v252, s[4:7], s53 offen offset:0 sc1
    buffer_load_dwordx2 v[114:115], v252, s[4:7], s53 offen offset:512 sc1
    buffer_load_dwordx4 v[96:99], v253, s[4:7], s81 offen offset:0 sc1
    buffer_load_dwordx4 v[100:103], v253, s[4:7], s81 offen offset:1024 sc1
    buffer_load_dwordx4 v[104:107], v253, s[4:7], s81 offen offset:2048 sc1
    buffer_load_dwordx4 v[108:111], v253, s[4:7], s81 offen offset:3072 sc1
    s_and_b32 s57, s49, 12
    s_mul_i32 s57, s57, 55296
    s_lshl_b32 s37, s31, 10
    s_add_u32 s57, s57, s37
    s_add_u32 s57, s57, s23
    s_add_u32 s57, s57, 327680
    s_add_u32 s36, s3, 0
    s_and_b32 s36, s36, 3
    s_mul_i32 s37, s36, 55296
    s_add_u32 s72, s57, s37
    s_add_u32 s36, s3, 1
    s_and_b32 s36, s36, 3
    s_mul_i32 s37, s36, 55296
    s_add_u32 s73, s57, s37
    s_add_u32 s36, s3, 2
    s_and_b32 s36, s36, 3
    s_mul_i32 s37, s36, 55296
    s_add_u32 s74, s57, s37
    s_add_u32 s36, s3, 3
    s_and_b32 s36, s36, 3
    s_mul_i32 s37, s36, 55296
    s_add_u32 s75, s57, s37
    s_lshr_b32 s37, s25, 2
    s_lshl_b32 s36, s49, 3
    s_add_u32 s36, s36, s37
    s_lshl_b32 s36, s36, 7
    s_add_u32 s65, s36, 28491776
    s_lshr_b32 s36, s49, 1
    s_lshl_b32 s36, s36, 5
    s_lshl_b32 s37, s37, 1
    s_add_u32 s36, s36, s37
    s_and_b32 s37, s49, 1
    s_add_u32 s36, s36, s37
    s_lshl_b32 s36, s36, 2
    s_add_u32 s66, s36, 28663808
    s_lshr_b32 s36, s49, 2
    s_lshl_b32 s36, s36, 4
    s_add_u32 s36, s36, s3
    s_lshl_b32 s36, s36, 4
    s_add_u32 s70, s36, 28672000
    s_and_b32 s36, s25, 1
    s_lshl_b32 s37, s24, 1
    s_add_u32 s36, s36, s37
    s_lshl_b32 s36, s36, 2
    s_add_u32 s36, s36, s3
    s_and_b32 s56, s36, 7
    s_mul_i32 s28, s56, 40960
    s_add_u32 s28, s28, s23
    s_add_u32 s28, s28, 0
    s_lshl_b32 s37, s36, 7
    buffer_load_dwordx2 v[132:133], v252, s[4:7], s54 offen offset:0 sc1
    buffer_load_dwordx2 v[134:135], v252, s[4:7], s54 offen offset:512 sc1
    buffer_load_dwordx4 v[116:119], v253, s[4:7], s82 offen offset:0 sc1
    buffer_load_dwordx4 v[120:123], v253, s[4:7], s82 offen offset:1024 sc1
    buffer_load_dwordx4 v[124:127], v253, s[4:7], s82 offen offset:2048 sc1
    buffer_load_dwordx4 v[128:131], v253, s[4:7], s82 offen offset:3072 sc1
    s_add_u32 s67, s37, 28663808
    s_lshr_b32 s39, s25, 1
    s_lshl_b32 s39, s39, 2
    s_add_u32 s37, s37, s39
    s_add_u32 s69, s37, 28672000
    s_lshl_b32 s37, s36, 11
    s_add_u32 s68, s37, 28491776
    s_lshl_b32 s37, s24, 10
    s_add_u32 s71, s37, 28663808
    s_and_b32 s57, s48, 1
    s_mul_i32 s29, s56, 110592
    s_add_u32 s29, s29, s23
    s_add_u32 s29, s29, 327680
    s_lshr_b32 s37, s48, 1
    s_lshl_b32 s37, s37, 10
    s_add_u32 s29, s29, s37
    s_cmp_eq_u32 s57, 0
    s_cselect_b32 s37, 3072, 8
    s_cselect_b32 s39, 12288, 0
    s_cselect_b32 s56, 768, 0
    s_add_u32 s30, s29, s37
    s_lshl_b32 s37, s57, 10
    s_add_u32 s29, s29, s37
    s_lshl_b32 s36, s57, 11
    s_mov_b32 s33, s29
    s_cmp_ge_u32 s25, 30
    s_cselect_b32 s29, 1073741824, s29
    v_add_u32 v4, s36, v253
    v_add_u32 v7, s39, v253
    s_add_u32 s36, s36, 57344
    s_add_u32 s39, s39, 57344
    v_add_u32 v5, s36, v253
    v_add_u32 v8, s39, v253
    s_add_u32 s36, s36, 57344
    s_add_u32 s39, s39, 57344
    v_add_u32 v6, s36, v253
    v_add_u32 v9, s39, v253
    s_add_u32 s36, s36, 57344
    s_add_u32 s39, s39, 57344
    v_add_u32 v11, 20480, v253
    v_lshrrev_b32 v2, 4, v1
    v_and_b32 v3, 15, v1
    v_lshlrev_b32 v12, 8, v2
    v_lshl_add_u32 v12, v3, 3, v12
    s_lshl_b32 s36, s57, 7
    s_add_u32 s36, s36, 147456
    v_lshl_add_u32 v13, v2, 4, s36
    s_add_u32 s56, s56, 147456
    v_lshl_add_u32 v14, v2, 4, s56
    v_lshrrev_b32 v2, 3, v1
    v_and_b32 v3, 7, v1
    v_lshlrev_b32 v2, 7, v2
    v_lshl_add_u32 v15, v3, 3, v2
    s_mul_i32 s36, s3, 3072
    s_add_u32 s36, s36, 148480
    v_add_u32 v0, s36, v253
    s_xor_b32 s88, s3, 3
    s_xor_b32 s36, s25, 31
    s_or_b32 s88, s88, s36
    s_mov_b32 s12, s86
    s_mov_b32 s13, s87
    s_mov_b32 s14, 2621440
    s_mov_b32 s15, 0x20000
    v_mov_b32 v240, 2
    s_waitcnt vmcnt(6)
    v_max3_u32 v2, v96, v97, v98
    v_max3_u32 v2, v2, v99, v100
    v_max3_u32 v2, v2, v101, v102
    v_max3_u32 v2, v2, v103, v104
    v_max3_u32 v2, v2, v105, v106
    v_max3_u32 v2, v2, v107, v108
    v_max3_u32 v2, v2, v109, v110
    v_max3_u32 v2, v2, v111, v112
    v_max3_u32 v2, v2, v113, v114
    v_max_u32 v2, v2, v115
    v_cmp_eq_u32 vcc, -1, v2
    s_nop 0
    s_cbranch_vccnz sequential_preLN__softmax_full_mha__glu_gated_bilinear__prompt_kernel_ospin0
sequential_preLN__softmax_full_mha__glu_gated_bilinear__prompt_kernel_ook0:
    v_mfma_f32_16x16x32_bf16 v[36:39], a[192:195], v[96:99], 0
    buffer_load_dwordx2 v[216:217], v252, s[4:7], s55 offen offset:0 sc1
    v_mfma_f32_16x16x32_bf16 v[36:39], a[212:215], v[100:103], v[36:39]
    v_mfma_f32_16x16x32_bf16 v[36:39], a[232:235], v[104:107], v[36:39]
    buffer_load_dwordx2 v[218:219], v252, s[4:7], s55 offen offset:512 sc1
    v_mfma_f32_16x16x32_bf16 v[36:39], a[252:255], v[108:111], v[36:39]
    v_mfma_f32_16x16x32_bf16 v[36:39], v[164:167], v[112:115], v[36:39]
    buffer_load_dwordx4 v[200:203], v253, s[4:7], s83 offen offset:0 sc1
    v_mfma_f32_16x16x32_bf16 v[40:43], a[196:199], v[96:99], 0
    v_mfma_f32_16x16x32_bf16 v[40:43], a[216:219], v[100:103], v[40:43]
    buffer_load_dwordx4 v[204:207], v253, s[4:7], s83 offen offset:1024 sc1
    v_mfma_f32_16x16x32_bf16 v[40:43], a[236:239], v[104:107], v[40:43]
    v_mfma_f32_16x16x32_bf16 v[40:43], v[148:151], v[108:111], v[40:43]
    buffer_load_dwordx4 v[208:211], v253, s[4:7], s83 offen offset:2048 sc1
    v_mfma_f32_16x16x32_bf16 v[40:43], v[168:171], v[112:115], v[40:43]
    v_mfma_f32_16x16x32_bf16 v[44:47], a[200:203], v[96:99], 0
    buffer_load_dwordx4 v[212:215], v253, s[4:7], s83 offen offset:3072 sc1
    v_mfma_f32_16x16x32_bf16 v[44:47], a[220:223], v[100:103], v[44:47]
    v_mfma_f32_16x16x32_bf16 v[44:47], a[240:243], v[104:107], v[44:47]
    buffer_load_dwordx2 v[236:237], v252, s[4:7], s52 offen offset:0 sc1
    v_mfma_f32_16x16x32_bf16 v[44:47], v[152:155], v[108:111], v[44:47]
    ds_write_b128 v242, v[36:39] offset:0
    v_mfma_f32_16x16x32_bf16 v[44:47], v[172:175], v[112:115], v[44:47]
    buffer_load_dwordx2 v[238:239], v252, s[4:7], s52 offen offset:512 sc1
    v_mfma_f32_16x16x32_bf16 v[48:51], a[204:207], v[96:99], 0
    v_mfma_f32_16x16x32_bf16 v[48:51], a[224:227], v[100:103], v[48:51]
    s_waitcnt vmcnt(8)
    buffer_load_dwordx4 v[220:223], v253, s[4:7], s80 offen offset:0 sc1
    v_mfma_f32_16x16x32_bf16 v[48:51], a[244:247], v[104:107], v[48:51]
    v_max3_u32 v2, v116, v117, v118
    v_max3_u32 v2, v2, v119, v120
    v_max3_u32 v2, v2, v121, v122
    v_mfma_f32_16x16x32_bf16 v[48:51], v[156:159], v[108:111], v[48:51]
    buffer_load_dwordx4 v[224:227], v253, s[4:7], s80 offen offset:1024 sc1
    ds_write_b128 v242, v[40:43] offset:1024
    v_mfma_f32_16x16x32_bf16 v[48:51], v[176:179], v[112:115], v[48:51]
    v_max3_u32 v2, v2, v123, v124
    v_max3_u32 v2, v2, v125, v126
    v_max3_u32 v2, v2, v127, v128
    v_mfma_f32_16x16x32_bf16 v[52:55], a[208:211], v[96:99], 0
    buffer_load_dwordx4 v[228:231], v253, s[4:7], s80 offen offset:2048 sc1
    v_max3_u32 v2, v2, v129, v130
    v_mfma_f32_16x16x32_bf16 v[52:55], a[228:231], v[100:103], v[52:55]
    v_max3_u32 v2, v2, v131, v132
    v_max3_u32 v2, v2, v133, v134
    v_max_u32 v2, v2, v135
    v_mfma_f32_16x16x32_bf16 v[52:55], a[248:251], v[104:107], v[52:55]
    buffer_load_dwordx4 v[232:235], v253, s[4:7], s80 offen offset:3072 sc1
    v_mfma_f32_16x16x32_bf16 v[52:55], v[160:163], v[108:111], v[52:55]
    ds_write_b128 v242, v[44:47] offset:2048
    v_cmp_eq_u32 vcc, -1, v2
    v_mfma_f32_16x16x32_bf16 v[52:55], v[180:183], v[112:115], v[52:55]
    s_cbranch_vccnz sequential_preLN__softmax_full_mha__glu_gated_bilinear__prompt_kernel_ospin1
sequential_preLN__softmax_full_mha__glu_gated_bilinear__prompt_kernel_ook1:
    v_mfma_f32_16x16x32_bf16 v[56:59], a[192:195], v[116:119], 0
    buffer_load_dwordx4 a[64:67], v250, s[4:7], s100 offen offset:1024 sc1
    v_mfma_f32_16x16x32_bf16 v[56:59], a[212:215], v[120:123], v[56:59]
    v_mfma_f32_16x16x32_bf16 v[56:59], a[232:235], v[124:127], v[56:59]
    v_mfma_f32_16x16x32_bf16 v[56:59], a[252:255], v[128:131], v[56:59]
    buffer_load_dwordx4 a[68:71], v250, s[4:7], s100 offen offset:2048 sc1
    ds_write_b128 v242, v[48:51] offset:3072
    v_mfma_f32_16x16x32_bf16 v[56:59], v[164:167], v[132:135], v[56:59]
    v_mfma_f32_16x16x32_bf16 v[60:63], a[196:199], v[116:119], 0
    v_mfma_f32_16x16x32_bf16 v[60:63], a[216:219], v[120:123], v[60:63]
    v_mfma_f32_16x16x32_bf16 v[60:63], a[236:239], v[124:127], v[60:63]
    buffer_load_dwordx4 a[72:75], v250, s[4:7], s100 offen offset:3072 sc1
    v_mfma_f32_16x16x32_bf16 v[60:63], v[148:151], v[128:131], v[60:63]
    ds_write_b128 v242, v[52:55] offset:4096
    v_mfma_f32_16x16x32_bf16 v[60:63], v[168:171], v[132:135], v[60:63]
    v_mfma_f32_16x16x32_bf16 v[64:67], a[200:203], v[116:119], 0
    buffer_load_dwordx4 a[76:79], v251, s[4:7], s100 offen offset:0 sc1
    v_mfma_f32_16x16x32_bf16 v[64:67], a[220:223], v[120:123], v[64:67]
    s_add_u32 s100, s100, 40960
    v_mfma_f32_16x16x32_bf16 v[64:67], a[240:243], v[124:127], v[64:67]
    v_mfma_f32_16x16x32_bf16 v[64:67], v[152:155], v[128:131], v[64:67]
    ds_write_b128 v243, v[56:59] offset:0
    v_mfma_f32_16x16x32_bf16 v[64:67], v[172:175], v[132:135], v[64:67]
    buffer_load_dwordx4 a[80:83], v250, s[4:7], s100 offen offset:0 sc1
    v_mfma_f32_16x16x32_bf16 v[68:71], a[204:207], v[116:119], 0
    v_mfma_f32_16x16x32_bf16 v[68:71], a[224:227], v[120:123], v[68:71]
    s_waitcnt vmcnt(11)
    v_mfma_f32_16x16x32_bf16 v[68:71], a[244:247], v[124:127], v[68:71]
    buffer_load_dwordx4 a[84:87], v250, s[4:7], s100 offen offset:1024 sc1
    v_max3_u32 v2, v200, v201, v202
    v_mfma_f32_16x16x32_bf16 v[68:71], v[156:159], v[128:131], v[68:71]
    ds_write_b128 v243, v[60:63] offset:1024
    v_max3_u32 v2, v2, v203, v204
    v_max3_u32 v2, v2, v205, v206
    v_mfma_f32_16x16x32_bf16 v[68:71], v[176:179], v[132:135], v[68:71]
    v_max3_u32 v2, v2, v207, v208
    v_max3_u32 v2, v2, v209, v210
    v_max3_u32 v2, v2, v211, v212
    v_mfma_f32_16x16x32_bf16 v[72:75], a[208:211], v[116:119], 0
    v_max3_u32 v2, v2, v213, v214
    v_max3_u32 v2, v2, v215, v216
    v_mfma_f32_16x16x32_bf16 v[72:75], a[228:231], v[120:123], v[72:75]
    buffer_load_dwordx4 a[88:91], v250, s[4:7], s100 offen offset:2048 sc1
    v_mfma_f32_16x16x32_bf16 v[72:75], a[248:251], v[124:127], v[72:75]
    v_max3_u32 v2, v2, v217, v218
    v_max_u32 v2, v2, v219
    v_mfma_f32_16x16x32_bf16 v[72:75], v[160:163], v[128:131], v[72:75]
    ds_write_b128 v243, v[64:67] offset:2048
    v_cmp_eq_u32 vcc, -1, v2
    v_mfma_f32_16x16x32_bf16 v[72:75], v[180:183], v[132:135], v[72:75]
    buffer_load_dwordx4 a[92:95], v250, s[4:7], s100 offen offset:3072 sc1
    s_cbranch_vccnz sequential_preLN__softmax_full_mha__glu_gated_bilinear__prompt_kernel_ospin2
sequential_preLN__softmax_full_mha__glu_gated_bilinear__prompt_kernel_ook2:
    v_mfma_f32_16x16x32_bf16 v[76:79], a[192:195], v[200:203], 0
    v_mfma_f32_16x16x32_bf16 v[76:79], a[212:215], v[204:207], v[76:79]
    v_mfma_f32_16x16x32_bf16 v[76:79], a[232:235], v[208:211], v[76:79]
    v_mfma_f32_16x16x32_bf16 v[76:79], a[252:255], v[212:215], v[76:79]
    buffer_load_dwordx4 a[96:99], v251, s[4:7], s100 offen offset:0 sc1
    ds_write_b128 v243, v[68:71] offset:3072
    v_mfma_f32_16x16x32_bf16 v[76:79], v[164:167], v[216:219], v[76:79]
    s_add_u32 s100, s100, 40960
    v_mfma_f32_16x16x32_bf16 v[80:83], a[196:199], v[200:203], 0
    v_mfma_f32_16x16x32_bf16 v[80:83], a[216:219], v[204:207], v[80:83]
    buffer_load_dwordx4 a[100:103], v250, s[4:7], s100 offen offset:0 sc1
    v_mfma_f32_16x16x32_bf16 v[80:83], a[236:239], v[208:211], v[80:83]
    v_mfma_f32_16x16x32_bf16 v[80:83], v[148:151], v[212:215], v[80:83]
    ds_write_b128 v243, v[72:75] offset:4096
    v_mfma_f32_16x16x32_bf16 v[80:83], v[168:171], v[216:219], v[80:83]
    v_mfma_f32_16x16x32_bf16 v[84:87], a[200:203], v[200:203], 0
    buffer_load_dwordx4 a[104:107], v250, s[4:7], s100 offen offset:1024 sc1
    v_mfma_f32_16x16x32_bf16 v[84:87], a[220:223], v[204:207], v[84:87]
    v_mfma_f32_16x16x32_bf16 v[84:87], a[240:243], v[208:211], v[84:87]
    v_mfma_f32_16x16x32_bf16 v[84:87], v[152:155], v[212:215], v[84:87]
    buffer_load_dwordx4 a[108:111], v250, s[4:7], s100 offen offset:2048 sc1
    ds_write_b128 v244, v[76:79] offset:0
    v_mfma_f32_16x16x32_bf16 v[84:87], v[172:175], v[216:219], v[84:87]
    v_mfma_f32_16x16x32_bf16 v[88:91], a[204:207], v[200:203], 0
    s_waitcnt lgkmcnt(1)
    s_barrier
    v_mfma_f32_16x16x32_bf16 v[88:91], a[224:227], v[204:207], v[88:91]
    s_waitcnt vmcnt(12)
    ds_read_b128 v[36:39], v245 offset:0
    v_mfma_f32_16x16x32_bf16 v[88:91], a[244:247], v[208:211], v[88:91]
    buffer_load_dwordx4 a[112:115], v250, s[4:7], s100 offen offset:3072 sc1
    v_max3_u32 v2, v220, v221, v222
    v_mfma_f32_16x16x32_bf16 v[88:91], v[156:159], v[212:215], v[88:91]
    ds_write_b128 v244, v[80:83] offset:1024
    v_max3_u32 v2, v2, v223, v224
    v_max3_u32 v2, v2, v225, v226
    v_mfma_f32_16x16x32_bf16 v[88:91], v[176:179], v[216:219], v[88:91]
    ds_read_b128 v[40:43], v245 offset:1024
    v_max3_u32 v2, v2, v227, v228
    v_max3_u32 v2, v2, v229, v230
    v_mfma_f32_16x16x32_bf16 v[92:95], a[208:211], v[200:203], 0
    buffer_load_dwordx4 a[116:119], v251, s[4:7], s100 offen offset:0 sc1
    v_max3_u32 v2, v2, v231, v232
    v_mfma_f32_16x16x32_bf16 v[92:95], a[228:231], v[204:207], v[92:95]
    s_add_u32 s100, s100, 40960
    ds_read_b128 v[44:47], v245 offset:2048
    v_max3_u32 v2, v2, v233, v234
    v_max3_u32 v2, v2, v235, v236
    v_mfma_f32_16x16x32_bf16 v[92:95], a[248:251], v[208:211], v[92:95]
    ds_read_b128 v[48:51], v245 offset:3072
    v_max3_u32 v2, v2, v237, v238
    v_max_u32 v2, v2, v239
    v_mfma_f32_16x16x32_bf16 v[92:95], v[160:163], v[212:215], v[92:95]
    ds_write_b128 v244, v[84:87] offset:2048
    v_cmp_eq_u32 vcc, -1, v2
    v_mfma_f32_16x16x32_bf16 v[92:95], v[180:183], v[216:219], v[92:95]
    buffer_load_dwordx4 a[120:123], v250, s[4:7], s100 offen offset:0 sc1
    s_cbranch_vccnz sequential_preLN__softmax_full_mha__glu_gated_bilinear__prompt_kernel_ospin3
sequential_preLN__softmax_full_mha__glu_gated_bilinear__prompt_kernel_ook3:
    s_mov_b32 vcc_lo, s26
    s_mov_b32 vcc_hi, 0
    v_mfma_f32_16x16x32_bf16 v[16:19], a[192:195], v[220:223], v[16:19]
    ds_read_b128 v[52:55], v245 offset:4096
    v_mfma_f32_16x16x32_bf16 v[16:19], a[212:215], v[224:227], v[16:19]
    ds_read_b128 v[56:59], v245 offset:5120
    v_mfma_f32_16x16x32_bf16 v[16:19], a[232:235], v[228:231], v[16:19]
    buffer_load_dwordx4 a[124:127], v250, s[4:7], s100 offen offset:1024 sc1
    v_mfma_f32_16x16x32_bf16 v[16:19], a[252:255], v[232:235], v[16:19]
    ds_write_b128 v244, v[88:91] offset:3072
    v_mfma_f32_16x16x32_bf16 v[16:19], v[164:167], v[236:239], v[16:19]
    ds_read_b128 v[60:63], v245 offset:6144
    v_mfma_f32_16x16x32_bf16 v[20:23], a[196:199], v[220:223], v[20:23]
    ds_read_b128 v[64:67], v245 offset:7168
    v_mfma_f32_16x16x32_bf16 v[20:23], a[216:219], v[224:227], v[20:23]
    buffer_load_dwordx4 a[128:131], v250, s[4:7], s100 offen offset:2048 sc1
    v_mfma_f32_16x16x32_bf16 v[20:23], a[236:239], v[228:231], v[20:23]
    ds_read_b128 v[68:71], v245 offset:8192
    v_mfma_f32_16x16x32_bf16 v[20:23], v[148:151], v[232:235], v[20:23]
    ds_write_b128 v244, v[92:95] offset:4096
    v_mfma_f32_16x16x32_bf16 v[20:23], v[168:171], v[236:239], v[20:23]
    buffer_load_dwordx4 a[132:135], v250, s[4:7], s100 offen offset:3072 sc1
    v_mfma_f32_16x16x32_bf16 v[24:27], a[200:203], v[220:223], v[24:27]
    ds_read_b128 v[72:75], v245 offset:9216
    v_mfma_f32_16x16x32_bf16 v[24:27], a[220:223], v[224:227], v[24:27]
    v_mfma_f32_16x16x32_bf16 v[24:27], a[240:243], v[228:231], v[24:27]
    s_waitcnt lgkmcnt(0)
    s_barrier
    v_mfma_f32_16x16x32_bf16 v[24:27], v[152:155], v[232:235], v[24:27]
    buffer_load_dwordx4 a[136:139], v251, s[4:7], s100 offen offset:0 sc1
    v_add_f32 v36, v36, v56
    v_mfma_f32_16x16x32_bf16 v[24:27], v[172:175], v[236:239], v[24:27]
    s_add_u32 s100, s100, 40960
    ds_read_b128 v[76:79], v245 offset:10240
    v_add_f32 v37, v37, v57
    v_add_f32 v38, v38, v58
    v_mfma_f32_16x16x32_bf16 v[28:31], a[204:207], v[220:223], v[28:31]
    ds_read_b128 v[80:83], v245 offset:11264
    v_add_f32 v39, v39, v59
    v_add_f32 v40, v40, v60
    v_mfma_f32_16x16x32_bf16 v[28:31], a[224:227], v[224:227], v[28:31]
    buffer_load_dwordx4 a[140:143], v250, s[4:7], s100 offen offset:0 sc1
    v_add_f32 v41, v41, v61
    v_mfma_f32_16x16x32_bf16 v[28:31], a[244:247], v[228:231], v[28:31]
    ds_read_b128 v[84:87], v245 offset:12288
    v_add_f32 v42, v42, v62
    v_add_f32 v43, v43, v63
    v_mfma_f32_16x16x32_bf16 v[28:31], v[156:159], v[232:235], v[28:31]
    ds_read_b128 v[88:91], v245 offset:13312
    v_add_f32 v44, v44, v64
    v_mfma_f32_16x16x32_bf16 v[28:31], v[176:179], v[236:239], v[28:31]
    ds_read_b128 v[92:95], v245 offset:14336
    v_add_f32 v45, v45, v65
    v_mfma_f32_16x16x32_bf16 v[32:35], a[208:211], v[220:223], v[32:35]
    v_add_f32 v46, v46, v66
    v_add_f32 v47, v47, v67
    v_mfma_f32_16x16x32_bf16 v[32:35], a[228:231], v[224:227], v[32:35]
    v_add_f32 v48, v48, v68
    v_add_f32 v49, v49, v69
    v_mfma_f32_16x16x32_bf16 v[32:35], a[248:251], v[228:231], v[32:35]
    v_add_f32 v50, v50, v70
    v_add_f32 v51, v51, v71
    v_mfma_f32_16x16x32_bf16 v[32:35], v[160:163], v[232:235], v[32:35]
    v_add_f32 v52, v52, v72
    v_add_f32 v53, v53, v73
    v_mfma_f32_16x16x32_bf16 v[32:35], v[180:183], v[236:239], v[32:35]
    v_add_f32 v54, v54, v74
    v_add_f32 v55, v55, v75
    s_waitcnt lgkmcnt(0)
    v_pk_add_f32 v[36:37], v[36:37], v[76:77]
    v_pk_add_f32 v[38:39], v[38:39], v[78:79]
    v_pk_add_f32 v[40:41], v[40:41], v[80:81]
    v_pk_add_f32 v[42:43], v[42:43], v[82:83]
    v_pk_add_f32 v[44:45], v[44:45], v[84:85]
    v_pk_add_f32 v[46:47], v[46:47], v[86:87]
    v_pk_add_f32 v[48:49], v[48:49], v[88:89]
    v_pk_add_f32 v[50:51], v[50:51], v[90:91]
    v_pk_add_f32 v[52:53], v[52:53], v[92:93]
    v_pk_add_f32 v[54:55], v[54:55], v[94:95]
    v_pk_add_f32 v[16:17], v[16:17], v[36:37]
    v_pk_add_f32 v[18:19], v[18:19], v[38:39]
sequential_preLN__softmax_full_mha__glu_gated_bilinear__prompt_kernel_pglate0:
    s_cbranch_execz sequential_preLN__softmax_full_mha__glu_gated_bilinear__prompt_kernel_wrlate
    v_pk_add_f32 v[20:21], v[20:21], v[40:41]
    v_pk_add_f32 v[22:23], v[22:23], v[42:43]
    v_pk_add_f32 v[24:25], v[24:25], v[44:45]
    v_pk_add_f32 v[26:27], v[26:27], v[46:47]
    v_pk_add_f32 v[28:29], v[28:29], v[48:49]
    v_pk_add_f32 v[30:31], v[30:31], v[50:51]
    v_pk_add_f32 v[32:33], v[32:33], v[52:53]
    v_pk_add_f32 v[34:35], v[34:35], v[54:55]
    v_cvt_pk_bf16_f32 v184, v16, v17
    v_cvt_pk_bf16_f32 v185, v18, v19
    v_cvt_pk_bf16_f32 v186, v20, v21
    v_cvt_pk_bf16_f32 v187, v22, v23
    v_cvt_pk_bf16_f32 v188, v24, v25
    v_cvt_pk_bf16_f32 v189, v26, v27
    v_cvt_pk_bf16_f32 v190, v28, v29
    v_cvt_pk_bf16_f32 v191, v30, v31
    v_cvt_pk_bf16_f32 v192, v32, v33
    v_cvt_pk_bf16_f32 v193, v34, v35
    s_cbranch_vccz L_wt_21
    buffer_store_dwordx4 v[184:187], v253, s[4:7], s50 offen
    buffer_store_dwordx4 v[188:191], v253, s[4:7], s50 offen offset:1024
    buffer_store_dwordx2 v[192:193], v199, s[4:7], s60 offen
L_wb_22:
    ds_write_b128 v0, v[184:187] offset:0
    ds_write_b128 v0, v[188:191] offset:1024
    ds_write_b64 v0, v[192:193] offset:2048
    v_pk_mul_f32 v[114:115], v[16:17], v[16:17]
    v_pk_add_f32 v[112:113], v[16:17], v[18:19]
    v_pk_fma_f32 v[114:115], v[18:19], v[18:19], v[114:115]
    v_pk_fma_f32 v[114:115], v[20:21], v[20:21], v[114:115]
    v_pk_add_f32 v[112:113], v[112:113], v[20:21]
    v_pk_fma_f32 v[114:115], v[22:23], v[22:23], v[114:115]
    v_pk_add_f32 v[112:113], v[112:113], v[22:23]
    v_pk_fma_f32 v[114:115], v[24:25], v[24:25], v[114:115]
    v_pk_add_f32 v[112:113], v[112:113], v[24:25]
    v_pk_fma_f32 v[114:115], v[26:27], v[26:27], v[114:115]
    v_pk_add_f32 v[112:113], v[112:113], v[26:27]
    v_pk_fma_f32 v[114:115], v[28:29], v[28:29], v[114:115]
    v_pk_add_f32 v[112:113], v[112:113], v[28:29]
    v_pk_fma_f32 v[114:115], v[30:31], v[30:31], v[114:115]
    v_pk_add_f32 v[112:113], v[112:113], v[30:31]
    v_pk_fma_f32 v[114:115], v[32:33], v[32:33], v[114:115]
    v_pk_add_f32 v[112:113], v[112:113], v[32:33]
    v_pk_fma_f32 v[114:115], v[34:35], v[34:35], v[114:115]
    v_pk_add_f32 v[112:113], v[112:113], v[34:35]
    v_add_f32 v112, v112, v113
    v_add_f32 v113, v114, v115
    v_mov_b32 v114, v112
    v_mov_b32 v115, v113
    s_nop 1
    v_permlane32_swap_b32 v112, v114
    v_permlane32_swap_b32 v113, v115
    s_nop 1
    v_add_f32 v112, v112, v114
    v_add_f32 v113, v113, v115
    v_mov_b32 v114, v112
    v_mov_b32 v115, v113
    s_nop 1
    v_permlane16_swap_b32 v112, v114
    v_permlane16_swap_b32 v113, v115
    s_nop 1
    v_add_f32 v112, v112, v114
    v_add_f32 v113, v113, v115
    s_mov_b64 exec, 0xffff
    s_cbranch_vccz L_wt_23
    buffer_store_dwordx2 v[112:113], v12, s[4:7], s65 offen
L_wb_24:
    s_mov_b64 exec, -1
    v_mov_b32 v252, v147
    ds_read_b128 v[80:83], v4 offset:0
    ds_read_b128 v[84:87], v4 offset:14336
    ds_read_b128 v[88:91], v4 offset:1024
    ds_read_b128 v[92:95], v4 offset:15360
    ds_read_b128 v[208:211], v4 offset:2048
    ds_read_b128 v[212:215], v4 offset:16384
    s_barrier
    s_waitcnt vmcnt(1)
    s_cbranch_vccz L_wt_25
    buffer_store_dword v10, off, s[4:7], s66
L_wb_26:
    s_mov_b64 exec, 0xffff
    s_mov_b32 s58, 200000
L_poll_27:
    buffer_load_dword v2, v241, s[4:7], s67 offen sc1
L_poll_27w:
    s_waitcnt vmcnt(0)
    v_cmp_eq_u32 vcc, 0, v2
    s_sub_u32 s58, s58, 1
    s_cbranch_scc1 L_pollout_28
    s_cbranch_vccnz L_poll_27
L_pollout_28:
    s_mov_b64 exec, -1
    buffer_load_dwordx4 v[16:19], v253, s[4:7], s28 offen offset:0 sc1
    buffer_load_dwordx4 v[20:23], v253, s[4:7], s28 offen offset:1024 sc1
    buffer_load_dwordx4 v[24:27], v11, s[4:7], s28 offen offset:0 sc1
    buffer_load_dwordx4 v[28:31], v11, s[4:7], s28 offen offset:1024 sc1
    s_add_u32 s28, s28, 2048
    buffer_load_dwordx4 v[32:35], v253, s[4:7], s28 offen offset:0 sc1
    buffer_load_dwordx4 v[36:39], v253, s[4:7], s28 offen offset:1024 sc1
    buffer_load_dwordx4 v[40:43], v11, s[4:7], s28 offen offset:0 sc1
    buffer_load_dwordx4 v[44:47], v11, s[4:7], s28 offen offset:1024 sc1
    s_add_u32 s28, s28, 2048
    s_mov_b32 vcc_lo, s26
    s_mov_b32 vcc_hi, 0
    s_cbranch_vccz L_wt_29
    buffer_store_dword v240, off, s[4:7], s66
L_wb_30:
    s_waitcnt lgkmcnt(4)
    s_waitcnt vmcnt(5)
    v_mfma_f32_16x16x32_bf16 v[96:99], v[80:83], v[16:19], 0
    v_mfma_f32_16x16x32_bf16 v[96:99], v[84:87], v[20:23], v[96:99]
    ds_read_b128 v[216:219], v4 offset:3072
    v_mfma_f32_16x16x32_bf16 v[100:103], v[80:83], v[24:27], 0
    ds_read_b128 v[220:223], v4 offset:17408
    v_mfma_f32_16x16x32_bf16 v[100:103], v[84:87], v[28:31], v[100:103]
    s_waitcnt lgkmcnt(4)
    buffer_load_dwordx4 v[48:51], v253, s[4:7], s28 offen offset:0 sc1
    v_mfma_f32_16x16x32_bf16 v[104:107], v[88:91], v[16:19], 0
    v_mfma_f32_16x16x32_bf16 v[104:107], v[92:95], v[20:23], v[104:107]
    ds_read_b128 v[80:83], v4 offset:4096
    v_mfma_f32_16x16x32_bf16 v[108:111], v[88:91], v[24:27], 0
    ds_read_b128 v[84:87], v4 offset:18432
    v_mfma_f32_16x16x32_bf16 v[108:111], v[92:95], v[28:31], v[108:111]
    s_waitcnt lgkmcnt(4)
    buffer_load_dwordx4 v[52:55], v253, s[4:7], s28 offen offset:1024 sc1
    v_mfma_f32_16x16x32_bf16 v[112:115], v[208:211], v[16:19], 0
    v_mfma_f32_16x16x32_bf16 v[112:115], v[212:215], v[20:23], v[112:115]
    ds_read_b128 v[88:91], v4 offset:5120
    v_mfma_f32_16x16x32_bf16 v[116:119], v[208:211], v[24:27], 0
    ds_read_b128 v[92:95], v4 offset:19456
    v_mfma_f32_16x16x32_bf16 v[116:119], v[212:215], v[28:31], v[116:119]
    s_waitcnt lgkmcnt(4)
    buffer_load_dwordx4 v[56:59], v11, s[4:7], s28 offen offset:0 sc1
    v_mfma_f32_16x16x32_bf16 v[120:123], v[216:219], v[16:19], 0
    v_mfma_f32_16x16x32_bf16 v[120:123], v[220:223], v[20:23], v[120:123]
    ds_read_b128 v[208:211], v4 offset:6144
    v_mfma_f32_16x16x32_bf16 v[124:127], v[216:219], v[24:27], 0
    ds_read_b128 v[212:215], v4 offset:20480
    v_mfma_f32_16x16x32_bf16 v[124:127], v[220:223], v[28:31], v[124:127]
    s_waitcnt lgkmcnt(4)
    buffer_load_dwordx4 v[60:63], v11, s[4:7], s28 offen offset:1024 sc1
    v_mfma_f32_16x16x32_bf16 v[128:131], v[80:83], v[16:19], 0
    s_add_u32 s28, s28, 2048
    v_mfma_f32_16x16x32_bf16 v[128:131], v[84:87], v[20:23], v[128:131]
    ds_read_b128 v[216:219], v4 offset:7168
    v_mfma_f32_16x16x32_bf16 v[132:135], v[80:83], v[24:27], 0
    s_add_u32 m0, s47, 86016
    ds_read_b128 v[220:223], v4 offset:21504
    v_mfma_f32_16x16x32_bf16 v[132:135], v[84:87], v[28:31], v[132:135]
    s_waitcnt lgkmcnt(4)
    s_add_u32 s46, s45, 4096
    v_mfma_f32_16x16x32_bf16 v[136:139], v[88:91], v[16:19], 0
    buffer_load_dwordx4 v253, s[4:7], s45 offen offset:0 sc1 lds
    v_mfma_f32_16x16x32_bf16 v[136:139], v[92:95], v[20:23], v[136:139]
    ds_read_b128 v[80:83], v4 offset:8192
    v_mfma_f32_16x16x32_bf16 v[140:143], v[88:91], v[24:27], 0
    ds_read_b128 v[84:87], v4 offset:22528
    v_mfma_f32_16x16x32_bf16 v[140:143], v[92:95], v[28:31], v[140:143]
    s_waitcnt lgkmcnt(4)
    v_mfma_f32_16x16x32_bf16 v[144:147], v[208:211], v[16:19], 0
    buffer_load_dwordx4 v253, s[4:7], s45 offen offset:1024 sc1 lds
    v_mfma_f32_16x16x32_bf16 v[144:147], v[212:215], v[20:23], v[144:147]
    ds_read_b128 v[88:91], v4 offset:9216
    v_mfma_f32_16x16x32_bf16 v[148:151], v[208:211], v[24:27], 0
    ds_read_b128 v[92:95], v4 offset:23552
    v_mfma_f32_16x16x32_bf16 v[148:151], v[212:215], v[28:31], v[148:151]
    s_waitcnt lgkmcnt(4)
    v_mfma_f32_16x16x32_bf16 v[152:155], v[216:219], v[16:19], 0
    buffer_load_dwordx4 v253, s[4:7], s45 offen offset:2048 sc1 lds
    v_mfma_f32_16x16x32_bf16 v[152:155], v[220:223], v[20:23], v[152:155]
    ds_read_b128 v[208:211], v4 offset:10240
    v_mfma_f32_16x16x32_bf16 v[156:159], v[216:219], v[24:27], 0
    ds_read_b128 v[212:215], v4 offset:24576
    v_mfma_f32_16x16x32_bf16 v[156:159], v[220:223], v[28:31], v[156:159]
    s_waitcnt lgkmcnt(4)
    v_mfma_f32_16x16x32_bf16 v[160:163], v[80:83], v[16:19], 0
    buffer_load_dwordx4 v253, s[4:7], s45 offen offset:3072 sc1 lds
    v_mfma_f32_16x16x32_bf16 v[160:163], v[84:87], v[20:23], v[160:163]
    s_add_u32 m0, s47, 90112
    ds_read_b128 v[216:219], v4 offset:11264
    v_mfma_f32_16x16x32_bf16 v[164:167], v[80:83], v[24:27], 0
    s_add_u32 s45, s45, 442368
    ds_read_b128 v[220:223], v4 offset:25600
    v_mfma_f32_16x16x32_bf16 v[164:167], v[84:87], v[28:31], v[164:167]
    s_waitcnt lgkmcnt(4)
    v_mfma_f32_16x16x32_bf16 v[168:171], v[88:91], v[16:19], 0
    v_mfma_f32_16x16x32_bf16 v[168:171], v[92:95], v[20:23], v[168:171]
    ds_read_b128 v[80:83], v7 offset:0
    v_mfma_f32_16x16x32_bf16 v[172:175], v[88:91], v[24:27], 0
    ds_read_b128 v[84:87], v7 offset:14336
    v_mfma_f32_16x16x32_bf16 v[172:175], v[92:95], v[28:31], v[172:175]
    s_waitcnt lgkmcnt(4)
    buffer_load_dwordx4 v253, s[4:7], s46 offen offset:0 sc1 lds
    v_mfma_f32_16x16x32_bf16 v[176:179], v[208:211], v[16:19], 0
    v_mfma_f32_16x16x32_bf16 v[176:179], v[212:215], v[20:23], v[176:179]
    ds_read_b128 v[88:91], v7 offset:1024
    v_mfma_f32_16x16x32_bf16 v[180:183], v[208:211], v[24:27], 0
    ds_read_b128 v[92:95], v7 offset:15360
    v_mfma_f32_16x16x32_bf16 v[180:183], v[212:215], v[28:31], v[180:183]
    s_waitcnt lgkmcnt(4)
    buffer_load_dwordx4 v253, s[4:7], s46 offen offset:1024 sc1 lds
    v_mfma_f32_16x16x32_bf16 v[184:187], v[216:219], v[16:19], 0
    v_mfma_f32_16x16x32_bf16 v[184:187], v[220:223], v[20:23], v[184:187]
    ds_read_b128 v[208:211], v4 offset:28672
    v_mfma_f32_16x16x32_bf16 v[188:191], v[216:219], v[24:27], 0
    ds_read_b128 v[212:215], v4 offset:43008
    v_mfma_f32_16x16x32_bf16 v[188:191], v[220:223], v[28:31], v[188:191]
    s_waitcnt lgkmcnt(4)
    buffer_load_dwordx4 v253, s[4:7], s46 offen offset:2048 sc1 lds
    v_mfma_f32_16x16x32_bf16 v[192:195], v[80:83], v[16:19], 0
    v_mfma_f32_16x16x32_bf16 v[192:195], v[84:87], v[20:23], v[192:195]
    ds_read_b128 v[216:219], v4 offset:29696
    v_mfma_f32_16x16x32_bf16 v[196:199], v[80:83], v[24:27], 0
    ds_read_b128 v[220:223], v4 offset:44032
    v_mfma_f32_16x16x32_bf16 v[196:199], v[84:87], v[28:31], v[196:199]
    s_waitcnt lgkmcnt(4)
    buffer_load_dwordx4 v[64:67], v253, s[4:7], s28 offen offset:0 sc1
    v_mfma_f32_16x16x32_bf16 v[200:203], v[88:91], v[16:19], 0
    v_mfma_f32_16x16x32_bf16 v[200:203], v[92:95], v[20:23], v[200:203]
    ds_read_b128 v[80:83], v4 offset:30720
    v_mfma_f32_16x16x32_bf16 v[204:207], v[88:91], v[24:27], 0
    ds_read_b128 v[84:87], v4 offset:45056
    v_mfma_f32_16x16x32_bf16 v[204:207], v[92:95], v[28:31], v[204:207]
    s_waitcnt lgkmcnt(4)
    s_waitcnt vmcnt(13)
    buffer_load_dwordx4 v[68:71], v253, s[4:7], s28 offen offset:1024 sc1
    v_mfma_f32_16x16x32_bf16 v[96:99], v[208:211], v[32:35], v[96:99]
    v_mfma_f32_16x16x32_bf16 v[96:99], v[212:215], v[36:39], v[96:99]
    ds_read_b128 v[88:91], v4 offset:31744
    v_mfma_f32_16x16x32_bf16 v[100:103], v[208:211], v[40:43], v[100:103]
    ds_read_b128 v[92:95], v4 offset:46080
    v_mfma_f32_16x16x32_bf16 v[100:103], v[212:215], v[44:47], v[100:103]
    s_waitcnt lgkmcnt(4)
    buffer_load_dwordx4 v[72:75], v11, s[4:7], s28 offen offset:0 sc1
    v_mfma_f32_16x16x32_bf16 v[104:107], v[216:219], v[32:35], v[104:107]
    v_mfma_f32_16x16x32_bf16 v[104:107], v[220:223], v[36:39], v[104:107]
    ds_read_b128 v[208:211], v4 offset:32768
    v_mfma_f32_16x16x32_bf16 v[108:111], v[216:219], v[40:43], v[108:111]
    ds_read_b128 v[212:215], v4 offset:47104
    v_mfma_f32_16x16x32_bf16 v[108:111], v[220:223], v[44:47], v[108:111]
    s_waitcnt lgkmcnt(4)
    buffer_load_dwordx4 v[76:79], v11, s[4:7], s28 offen offset:1024 sc1
    v_mfma_f32_16x16x32_bf16 v[112:115], v[80:83], v[32:35], v[112:115]
    s_add_u32 s28, s28, 2048
    v_mfma_f32_16x16x32_bf16 v[112:115], v[84:87], v[36:39], v[112:115]
    s_add_u32 m0, s47, 114688
    ds_read_b128 v[216:219], v4 offset:33792
    v_mfma_f32_16x16x32_bf16 v[116:119], v[80:83], v[40:43], v[116:119]
    s_add_u32 s46, s45, 4096
    ds_read_b128 v[220:223], v4 offset:48128
    v_mfma_f32_16x16x32_bf16 v[116:119], v[84:87], v[44:47], v[116:119]
    s_waitcnt lgkmcnt(4)
    buffer_load_dwordx4 v253, s[4:7], s45 offen offset:0 sc1 lds
    v_mfma_f32_16x16x32_bf16 v[120:123], v[88:91], v[32:35], v[120:123]
    v_mfma_f32_16x16x32_bf16 v[120:123], v[92:95], v[36:39], v[120:123]
    ds_read_b128 v[80:83], v4 offset:34816
    v_mfma_f32_16x16x32_bf16 v[124:127], v[88:91], v[40:43], v[124:127]
    ds_read_b128 v[84:87], v4 offset:49152
    v_mfma_f32_16x16x32_bf16 v[124:127], v[92:95], v[44:47], v[124:127]
    s_waitcnt lgkmcnt(4)
    buffer_load_dwordx4 v253, s[4:7], s45 offen offset:1024 sc1 lds
    v_mfma_f32_16x16x32_bf16 v[128:131], v[208:211], v[32:35], v[128:131]
    v_mfma_f32_16x16x32_bf16 v[128:131], v[212:215], v[36:39], v[128:131]
    ds_read_b128 v[88:91], v4 offset:35840
    v_mfma_f32_16x16x32_bf16 v[132:135], v[208:211], v[40:43], v[132:135]
    ds_read_b128 v[92:95], v4 offset:50176
    v_mfma_f32_16x16x32_bf16 v[132:135], v[212:215], v[44:47], v[132:135]
    s_waitcnt lgkmcnt(4)
    buffer_load_dwordx4 v253, s[4:7], s45 offen offset:2048 sc1 lds
    v_mfma_f32_16x16x32_bf16 v[136:139], v[216:219], v[32:35], v[136:139]
    v_mfma_f32_16x16x32_bf16 v[136:139], v[220:223], v[36:39], v[136:139]
    ds_read_b128 v[208:211], v4 offset:36864
    v_mfma_f32_16x16x32_bf16 v[140:143], v[216:219], v[40:43], v[140:143]
    ds_read_b128 v[212:215], v4 offset:51200
    v_mfma_f32_16x16x32_bf16 v[140:143], v[220:223], v[44:47], v[140:143]
    s_waitcnt lgkmcnt(4)
    buffer_load_dwordx4 v253, s[4:7], s45 offen offset:3072 sc1 lds
    v_mfma_f32_16x16x32_bf16 v[144:147], v[80:83], v[32:35], v[144:147]
    s_add_u32 m0, s47, 118784
    v_mfma_f32_16x16x32_bf16 v[144:147], v[84:87], v[36:39], v[144:147]
    s_add_u32 s45, s45, 442368
    ds_read_b128 v[216:219], v4 offset:37888
    v_mfma_f32_16x16x32_bf16 v[148:151], v[80:83], v[40:43], v[148:151]
    ds_read_b128 v[220:223], v4 offset:52224
    v_mfma_f32_16x16x32_bf16 v[148:151], v[84:87], v[44:47], v[148:151]
    s_waitcnt lgkmcnt(4)
    buffer_load_dwordx4 v253, s[4:7], s46 offen offset:0 sc1 lds
    v_mfma_f32_16x16x32_bf16 v[152:155], v[88:91], v[32:35], v[152:155]
    v_mfma_f32_16x16x32_bf16 v[152:155], v[92:95], v[36:39], v[152:155]
    ds_read_b128 v[80:83], v4 offset:38912
    v_mfma_f32_16x16x32_bf16 v[156:159], v[88:91], v[40:43], v[156:159]
    ds_read_b128 v[84:87], v4 offset:53248
    v_mfma_f32_16x16x32_bf16 v[156:159], v[92:95], v[44:47], v[156:159]
    s_waitcnt lgkmcnt(4)
    v_mfma_f32_16x16x32_bf16 v[160:163], v[208:211], v[32:35], v[160:163]
    buffer_load_dwordx4 v253, s[4:7], s46 offen offset:1024 sc1 lds
    v_mfma_f32_16x16x32_bf16 v[160:163], v[212:215], v[36:39], v[160:163]
    ds_read_b128 v[88:91], v4 offset:39936
    v_mfma_f32_16x16x32_bf16 v[164:167], v[208:211], v[40:43], v[164:167]
    ds_read_b128 v[92:95], v4 offset:54272
    v_mfma_f32_16x16x32_bf16 v[164:167], v[212:215], v[44:47], v[164:167]
    s_waitcnt lgkmcnt(4)
    v_mfma_f32_16x16x32_bf16 v[168:171], v[216:219], v[32:35], v[168:171]
    buffer_load_dwordx4 v253, s[4:7], s46 offen offset:2048 sc1 lds
    v_mfma_f32_16x16x32_bf16 v[168:171], v[220:223], v[36:39], v[168:171]
    ds_read_b128 v[208:211], v7 offset:28672
    v_mfma_f32_16x16x32_bf16 v[172:175], v[216:219], v[40:43], v[172:175]
    ds_read_b128 v[212:215], v7 offset:43008
    v_mfma_f32_16x16x32_bf16 v[172:175], v[220:223], v[44:47], v[172:175]
    s_waitcnt lgkmcnt(4)
    v_mfma_f32_16x16x32_bf16 v[176:179], v[80:83], v[32:35], v[176:179]
    buffer_load_dwordx2 v[2:3], v15, s[4:7], s71 offen sc1
    v_mfma_f32_16x16x32_bf16 v[176:179], v[84:87], v[36:39], v[176:179]
    ds_read_b128 v[216:219], v7 offset:29696
    v_mfma_f32_16x16x32_bf16 v[180:183], v[80:83], v[40:43], v[180:183]
    ds_read_b128 v[220:223], v7 offset:44032
    v_mfma_f32_16x16x32_bf16 v[180:183], v[84:87], v[44:47], v[180:183]
    s_waitcnt lgkmcnt(4)
    v_mfma_f32_16x16x32_bf16 v[184:187], v[88:91], v[32:35], v[184:187]
    buffer_load_dwordx4 v[16:19], v253, s[4:7], s28 offen offset:0 sc1
    v_mfma_f32_16x16x32_bf16 v[184:187], v[92:95], v[36:39], v[184:187]
    ds_read_b128 v[80:83], v5 offset:0
    v_mfma_f32_16x16x32_bf16 v[188:191], v[88:91], v[40:43], v[188:191]
    ds_read_b128 v[84:87], v5 offset:14336
    v_mfma_f32_16x16x32_bf16 v[188:191], v[92:95], v[44:47], v[188:191]
    s_waitcnt lgkmcnt(4)
    v_mfma_f32_16x16x32_bf16 v[192:195], v[208:211], v[32:35], v[192:195]
    v_mfma_f32_16x16x32_bf16 v[192:195], v[212:215], v[36:39], v[192:195]
    ds_read_b128 v[88:91], v5 offset:1024
    v_mfma_f32_16x16x32_bf16 v[196:199], v[208:211], v[40:43], v[196:199]
    ds_read_b128 v[92:95], v5 offset:15360
    v_mfma_f32_16x16x32_bf16 v[196:199], v[212:215], v[44:47], v[196:199]
    s_waitcnt lgkmcnt(4)
    buffer_load_dwordx4 v[20:23], v253, s[4:7], s28 offen offset:1024 sc1
    v_mfma_f32_16x16x32_bf16 v[200:203], v[216:219], v[32:35], v[200:203]
    v_mfma_f32_16x16x32_bf16 v[200:203], v[220:223], v[36:39], v[200:203]
    ds_read_b128 v[208:211], v5 offset:2048
    v_mfma_f32_16x16x32_bf16 v[204:207], v[216:219], v[40:43], v[204:207]
    ds_read_b128 v[212:215], v5 offset:16384
    v_mfma_f32_16x16x32_bf16 v[204:207], v[220:223], v[44:47], v[204:207]
    s_waitcnt lgkmcnt(4)
    s_waitcnt vmcnt(21)
    buffer_load_dwordx4 v[24:27], v11, s[4:7], s28 offen offset:0 sc1
    v_mfma_f32_16x16x32_bf16 v[96:99], v[80:83], v[48:51], v[96:99]
    v_mfma_f32_16x16x32_bf16 v[96:99], v[84:87], v[52:55], v[96:99]
    ds_read_b128 v[216:219], v5 offset:3072
    v_mfma_f32_16x16x32_bf16 v[100:103], v[80:83], v[56:59], v[100:103]
    ds_read_b128 v[220:223], v5 offset:17408
    v_mfma_f32_16x16x32_bf16 v[100:103], v[84:87], v[60:63], v[100:103]
    s_waitcnt lgkmcnt(4)
    buffer_load_dwordx4 v[28:31], v11, s[4:7], s28 offen offset:1024 sc1
    v_mfma_f32_16x16x32_bf16 v[104:107], v[88:91], v[48:51], v[104:107]
    s_add_u32 s28, s28, 2048
    v_mfma_f32_16x16x32_bf16 v[104:107], v[92:95], v[52:55], v[104:107]
    ds_read_b128 v[80:83], v5 offset:4096
    v_mfma_f32_16x16x32_bf16 v[108:111], v[88:91], v[56:59], v[108:111]
    ds_read_b128 v[84:87], v5 offset:18432
    v_mfma_f32_16x16x32_bf16 v[108:111], v[92:95], v[60:63], v[108:111]
    s_waitcnt lgkmcnt(4)
    buffer_load_dwordx4 v[32:35], v253, s[4:7], s28 offen offset:0 sc1
    v_mfma_f32_16x16x32_bf16 v[112:115], v[208:211], v[48:51], v[112:115]
    v_mfma_f32_16x16x32_bf16 v[112:115], v[212:215], v[52:55], v[112:115]
    ds_read_b128 v[88:91], v5 offset:5120
    v_mfma_f32_16x16x32_bf16 v[116:119], v[208:211], v[56:59], v[116:119]
    ds_read_b128 v[92:95], v5 offset:19456
    v_mfma_f32_16x16x32_bf16 v[116:119], v[212:215], v[60:63], v[116:119]
    s_waitcnt lgkmcnt(4)
    buffer_load_dwordx4 v[36:39], v253, s[4:7], s28 offen offset:1024 sc1
    v_mfma_f32_16x16x32_bf16 v[120:123], v[216:219], v[48:51], v[120:123]
    v_mfma_f32_16x16x32_bf16 v[120:123], v[220:223], v[52:55], v[120:123]
    ds_read_b128 v[208:211], v5 offset:6144
    v_mfma_f32_16x16x32_bf16 v[124:127], v[216:219], v[56:59], v[124:127]
    ds_read_b128 v[212:215], v5 offset:20480
    v_mfma_f32_16x16x32_bf16 v[124:127], v[220:223], v[60:63], v[124:127]
    s_waitcnt lgkmcnt(4)
    buffer_load_dwordx4 v[40:43], v11, s[4:7], s28 offen offset:0 sc1
    v_mfma_f32_16x16x32_bf16 v[128:131], v[80:83], v[48:51], v[128:131]
    v_mfma_f32_16x16x32_bf16 v[128:131], v[84:87], v[52:55], v[128:131]
    ds_read_b128 v[216:219], v5 offset:7168
    v_mfma_f32_16x16x32_bf16 v[132:135], v[80:83], v[56:59], v[132:135]
    ds_read_b128 v[220:223], v5 offset:21504
    v_mfma_f32_16x16x32_bf16 v[132:135], v[84:87], v[60:63], v[132:135]
    s_waitcnt lgkmcnt(4)
    buffer_load_dwordx4 v[44:47], v11, s[4:7], s28 offen offset:1024 sc1
    v_mfma_f32_16x16x32_bf16 v[136:139], v[88:91], v[48:51], v[136:139]
    s_add_u32 s28, s28, 2048
    v_mfma_f32_16x16x32_bf16 v[136:139], v[92:95], v[52:55], v[136:139]
    ds_read_b128 v[80:83], v5 offset:8192
    v_mfma_f32_16x16x32_bf16 v[140:143], v[88:91], v[56:59], v[140:143]
    ds_read_b128 v[84:87], v5 offset:22528
    v_mfma_f32_16x16x32_bf16 v[140:143], v[92:95], v[60:63], v[140:143]
    s_waitcnt lgkmcnt(4)
    buffer_load_dwordx4 a[144:147], v250, s[4:7], s100 offen offset:1024 sc1
    v_mfma_f32_16x16x32_bf16 v[144:147], v[208:211], v[48:51], v[144:147]
    v_mfma_f32_16x16x32_bf16 v[144:147], v[212:215], v[52:55], v[144:147]
    ds_read_b128 v[88:91], v5 offset:9216
    v_mfma_f32_16x16x32_bf16 v[148:151], v[208:211], v[56:59], v[148:151]
    ds_read_b128 v[92:95], v5 offset:23552
    v_mfma_f32_16x16x32_bf16 v[148:151], v[212:215], v[60:63], v[148:151]
    s_waitcnt lgkmcnt(4)
    buffer_load_dwordx4 a[148:151], v250, s[4:7], s100 offen offset:2048 sc1
    v_mfma_f32_16x16x32_bf16 v[152:155], v[216:219], v[48:51], v[152:155]
    v_mfma_f32_16x16x32_bf16 v[152:155], v[220:223], v[52:55], v[152:155]
    ds_read_b128 v[208:211], v5 offset:10240
    v_mfma_f32_16x16x32_bf16 v[156:159], v[216:219], v[56:59], v[156:159]
    ds_read_b128 v[212:215], v5 offset:24576
    v_mfma_f32_16x16x32_bf16 v[156:159], v[220:223], v[60:63], v[156:159]
    s_waitcnt lgkmcnt(4)
    buffer_load_dwordx4 a[152:155], v250, s[4:7], s100 offen offset:3072 sc1
    v_mfma_f32_16x16x32_bf16 v[160:163], v[80:83], v[48:51], v[160:163]
    v_mfma_f32_16x16x32_bf16 v[160:163], v[84:87], v[52:55], v[160:163]
    ds_read_b128 v[216:219], v5 offset:11264
    v_mfma_f32_16x16x32_bf16 v[164:167], v[80:83], v[56:59], v[164:167]
    ds_read_b128 v[220:223], v5 offset:25600
    v_mfma_f32_16x16x32_bf16 v[164:167], v[84:87], v[60:63], v[164:167]
    s_waitcnt lgkmcnt(4)
    buffer_load_dwordx4 a[156:159], v251, s[4:7], s100 offen offset:0 sc1
    v_mfma_f32_16x16x32_bf16 v[168:171], v[88:91], v[48:51], v[168:171]
    s_add_u32 s100, s100, 40960
    v_mfma_f32_16x16x32_bf16 v[168:171], v[92:95], v[52:55], v[168:171]
    ds_read_b128 v[80:83], v8 offset:0
    v_mfma_f32_16x16x32_bf16 v[172:175], v[88:91], v[56:59], v[172:175]
    ds_read_b128 v[84:87], v8 offset:14336
    v_mfma_f32_16x16x32_bf16 v[172:175], v[92:95], v[60:63], v[172:175]
    s_waitcnt lgkmcnt(4)
    v_mfma_f32_16x16x32_bf16 v[176:179], v[208:211], v[48:51], v[176:179]
    buffer_load_dwordx4 a[160:163], v250, s[4:7], s100 offen offset:0 sc1
    v_mfma_f32_16x16x32_bf16 v[176:179], v[212:215], v[52:55], v[176:179]
    ds_read_b128 v[88:91], v8 offset:1024
    v_mfma_f32_16x16x32_bf16 v[180:183], v[208:211], v[56:59], v[180:183]
    ds_read_b128 v[92:95], v8 offset:15360
    v_mfma_f32_16x16x32_bf16 v[180:183], v[212:215], v[60:63], v[180:183]
    s_waitcnt lgkmcnt(4)
    s_waitcnt vmcnt(25)
    s_barrier
    v_mfma_f32_16x16x32_bf16 v[184:187], v[216:219], v[48:51], v[184:187]
    v_mfma_f32_16x16x32_bf16 v[184:187], v[220:223], v[52:55], v[184:187]
    s_add_u32 m0, s47, 0
    ds_read_b128 v[208:211], v5 offset:28672
    v_mfma_f32_16x16x32_bf16 v[188:191], v[216:219], v[56:59], v[188:191]
    s_add_u32 s46, s45, 4096
    ds_read_b128 v[212:215], v5 offset:43008
    v_mfma_f32_16x16x32_bf16 v[188:191], v[220:223], v[60:63], v[188:191]
    s_waitcnt lgkmcnt(4)
    buffer_load_dwordx4 v253, s[4:7], s45 offen offset:0 sc1 lds
    v_mfma_f32_16x16x32_bf16 v[192:195], v[80:83], v[48:51], v[192:195]
    v_mfma_f32_16x16x32_bf16 v[192:195], v[84:87], v[52:55], v[192:195]
    ds_read_b128 v[216:219], v5 offset:29696
    v_mfma_f32_16x16x32_bf16 v[196:199], v[80:83], v[56:59], v[196:199]
    ds_read_b128 v[220:223], v5 offset:44032
    v_mfma_f32_16x16x32_bf16 v[196:199], v[84:87], v[60:63], v[196:199]
    s_waitcnt lgkmcnt(4)
    buffer_load_dwordx4 v253, s[4:7], s45 offen offset:1024 sc1 lds
    v_mfma_f32_16x16x32_bf16 v[200:203], v[88:91], v[48:51], v[200:203]
    v_mfma_f32_16x16x32_bf16 v[200:203], v[92:95], v[52:55], v[200:203]
    ds_read_b128 v[80:83], v5 offset:30720
    v_mfma_f32_16x16x32_bf16 v[204:207], v[88:91], v[56:59], v[204:207]
    ds_read_b128 v[84:87], v5 offset:45056
    v_mfma_f32_16x16x32_bf16 v[204:207], v[92:95], v[60:63], v[204:207]
    s_waitcnt lgkmcnt(4)
    s_waitcnt vmcnt(23)
    s_waitcnt vmcnt(15)
    buffer_load_dwordx4 v253, s[4:7], s45 offen offset:2048 sc1 lds
    v_min_u32 v2, v2, v3
    v_cmp_gt_u32 vcc, 2, v2
    s_nop 1
    s_cbranch_vccnz sequential_preLN__softmax_full_mha__glu_gated_bilinear__prompt_kernel_f3spin
sequential_preLN__softmax_full_mha__glu_gated_bilinear__prompt_kernel_f3ok:
    v_mfma_f32_16x16x32_bf16 v[96:99], v[208:211], v[64:67], v[96:99]
    v_mfma_f32_16x16x32_bf16 v[96:99], v[212:215], v[68:71], v[96:99]
    ds_read_b128 v[88:91], v5 offset:31744
    v_mfma_f32_16x16x32_bf16 v[100:103], v[208:211], v[72:75], v[100:103]
    ds_read_b128 v[92:95], v5 offset:46080
    v_mfma_f32_16x16x32_bf16 v[100:103], v[212:215], v[76:79], v[100:103]
    s_waitcnt lgkmcnt(4)
    buffer_load_dwordx4 v253, s[4:7], s45 offen offset:3072 sc1 lds
    v_mfma_f32_16x16x32_bf16 v[104:107], v[216:219], v[64:67], v[104:107]
    s_add_u32 m0, s47, 4096
    v_mfma_f32_16x16x32_bf16 v[104:107], v[220:223], v[68:71], v[104:107]
    s_add_u32 s45, s45, 442368
    ds_read_b128 v[208:211], v5 offset:32768
    v_mfma_f32_16x16x32_bf16 v[108:111], v[216:219], v[72:75], v[108:111]
    ds_read_b128 v[212:215], v5 offset:47104
    v_mfma_f32_16x16x32_bf16 v[108:111], v[220:223], v[76:79], v[108:111]
    s_waitcnt lgkmcnt(4)
    v_mfma_f32_16x16x32_bf16 v[112:115], v[80:83], v[64:67], v[112:115]
    buffer_load_dwordx4 v253, s[4:7], s46 offen offset:0 sc1 lds
    v_mfma_f32_16x16x32_bf16 v[112:115], v[84:87], v[68:71], v[112:115]
    ds_read_b128 v[216:219], v5 offset:33792
    v_mfma_f32_16x16x32_bf16 v[116:119], v[80:83], v[72:75], v[116:119]
    ds_read_b128 v[220:223], v5 offset:48128
    v_mfma_f32_16x16x32_bf16 v[116:119], v[84:87], v[76:79], v[116:119]
    s_waitcnt lgkmcnt(4)
    v_mfma_f32_16x16x32_bf16 v[120:123], v[88:91], v[64:67], v[120:123]
    buffer_load_dwordx4 v253, s[4:7], s46 offen offset:1024 sc1 lds
    v_mfma_f32_16x16x32_bf16 v[120:123], v[92:95], v[68:71], v[120:123]
    ds_read_b128 v[80:83], v5 offset:34816
    v_mfma_f32_16x16x32_bf16 v[124:127], v[88:91], v[72:75], v[124:127]
    ds_read_b128 v[84:87], v5 offset:49152
    v_mfma_f32_16x16x32_bf16 v[124:127], v[92:95], v[76:79], v[124:127]
    s_waitcnt lgkmcnt(4)
    v_mfma_f32_16x16x32_bf16 v[128:131], v[208:211], v[64:67], v[128:131]
    buffer_load_dwordx4 v253, s[4:7], s46 offen offset:2048 sc1 lds
    v_mfma_f32_16x16x32_bf16 v[128:131], v[212:215], v[68:71], v[128:131]
    ds_read_b128 v[88:91], v5 offset:35840
    v_mfma_f32_16x16x32_bf16 v[132:135], v[208:211], v[72:75], v[132:135]
    ds_read_b128 v[92:95], v5 offset:50176
    v_mfma_f32_16x16x32_bf16 v[132:135], v[212:215], v[76:79], v[132:135]
    s_waitcnt lgkmcnt(4)
    v_mfma_f32_16x16x32_bf16 v[136:139], v[216:219], v[64:67], v[136:139]
    buffer_load_dwordx2 v[232:233], v12, s[4:7], s68 offen offset:0 sc1
    v_mfma_f32_16x16x32_bf16 v[136:139], v[220:223], v[68:71], v[136:139]
    ds_read_b128 v[208:211], v5 offset:36864
    v_mfma_f32_16x16x32_bf16 v[140:143], v[216:219], v[72:75], v[140:143]
    ds_read_b128 v[212:215], v5 offset:51200
    v_mfma_f32_16x16x32_bf16 v[140:143], v[220:223], v[76:79], v[140:143]
    s_waitcnt lgkmcnt(4)
    v_mfma_f32_16x16x32_bf16 v[144:147], v[80:83], v[64:67], v[144:147]
    v_mfma_f32_16x16x32_bf16 v[144:147], v[84:87], v[68:71], v[144:147]
    ds_read_b128 v[216:219], v5 offset:37888
    v_mfma_f32_16x16x32_bf16 v[148:151], v[80:83], v[72:75], v[148:151]
    ds_read_b128 v[220:223], v5 offset:52224
    v_mfma_f32_16x16x32_bf16 v[148:151], v[84:87], v[76:79], v[148:151]
    s_waitcnt lgkmcnt(4)
    buffer_load_dwordx2 v[234:235], v12, s[4:7], s68 offen offset:128 sc1
    v_mfma_f32_16x16x32_bf16 v[152:155], v[88:91], v[64:67], v[152:155]
    v_mfma_f32_16x16x32_bf16 v[152:155], v[92:95], v[68:71], v[152:155]
    ds_read_b128 v[80:83], v5 offset:38912
    v_mfma_f32_16x16x32_bf16 v[156:159], v[88:91], v[72:75], v[156:159]
    ds_read_b128 v[84:87], v5 offset:53248
    v_mfma_f32_16x16x32_bf16 v[156:159], v[92:95], v[76:79], v[156:159]
    s_waitcnt lgkmcnt(4)
    buffer_load_dwordx2 v[236:237], v12, s[4:7], s68 offen offset:1024 sc1
    v_mfma_f32_16x16x32_bf16 v[160:163], v[208:211], v[64:67], v[160:163]
    v_mfma_f32_16x16x32_bf16 v[160:163], v[212:215], v[68:71], v[160:163]
    ds_read_b128 v[88:91], v5 offset:39936
    v_mfma_f32_16x16x32_bf16 v[164:167], v[208:211], v[72:75], v[164:167]
    ds_read_b128 v[92:95], v5 offset:54272
    v_mfma_f32_16x16x32_bf16 v[164:167], v[212:215], v[76:79], v[164:167]
    s_waitcnt lgkmcnt(4)
    buffer_load_dwordx2 v[238:239], v12, s[4:7], s68 offen offset:1152 sc1
    v_mfma_f32_16x16x32_bf16 v[168:171], v[216:219], v[64:67], v[168:171]
    s_add_u32 m0, s47, 28672
    v_mfma_f32_16x16x32_bf16 v[168:171], v[220:223], v[68:71], v[168:171]
    s_add_u32 s46, s45, 4096
    ds_read_b128 v[208:211], v8 offset:28672
    v_mfma_f32_16x16x32_bf16 v[172:175], v[216:219], v[72:75], v[172:175]
    ds_read_b128 v[212:215], v8 offset:43008
    v_mfma_f32_16x16x32_bf16 v[172:175], v[220:223], v[76:79], v[172:175]
    s_waitcnt lgkmcnt(4)
    buffer_load_dwordx4 v253, s[4:7], s45 offen offset:0 sc1 lds
    v_mfma_f32_16x16x32_bf16 v[176:179], v[80:83], v[64:67], v[176:179]
    v_mfma_f32_16x16x32_bf16 v[176:179], v[84:87], v[68:71], v[176:179]
    ds_read_b128 v[216:219], v8 offset:29696
    v_mfma_f32_16x16x32_bf16 v[180:183], v[80:83], v[72:75], v[180:183]
    ds_read_b128 v[220:223], v8 offset:44032
    v_mfma_f32_16x16x32_bf16 v[180:183], v[84:87], v[76:79], v[180:183]
    s_waitcnt lgkmcnt(4)
    buffer_load_dwordx4 v253, s[4:7], s45 offen offset:1024 sc1 lds
    s_barrier
    v_mfma_f32_16x16x32_bf16 v[184:187], v[88:91], v[64:67], v[184:187]
    v_mfma_f32_16x16x32_bf16 v[184:187], v[92:95], v[68:71], v[184:187]
    ds_read_b128 v[80:83], v6 offset:0
    v_mfma_f32_16x16x32_bf16 v[188:191], v[88:91], v[72:75], v[188:191]
    ds_read_b128 v[84:87], v6 offset:14336
    v_mfma_f32_16x16x32_bf16 v[188:191], v[92:95], v[76:79], v[188:191]
    s_waitcnt lgkmcnt(4)
    buffer_load_dwordx4 v253, s[4:7], s45 offen offset:2048 sc1 lds
    v_mfma_f32_16x16x32_bf16 v[192:195], v[208:211], v[64:67], v[192:195]
    v_mfma_f32_16x16x32_bf16 v[192:195], v[212:215], v[68:71], v[192:195]
sequential_preLN__softmax_full_mha__glu_gated_bilinear__prompt_kernel_pglate1:
    s_cbranch_execz sequential_preLN__softmax_full_mha__glu_gated_bilinear__prompt_kernel_wrlate
    ds_read_b128 v[88:91], v6 offset:1024
    v_mfma_f32_16x16x32_bf16 v[196:199], v[208:211], v[72:75], v[196:199]
    ds_read_b128 v[92:95], v6 offset:15360
    v_mfma_f32_16x16x32_bf16 v[196:199], v[212:215], v[76:79], v[196:199]
    s_waitcnt lgkmcnt(4)
    buffer_load_dwordx4 v253, s[4:7], s45 offen offset:3072 sc1 lds
    v_mfma_f32_16x16x32_bf16 v[200:203], v[216:219], v[64:67], v[200:203]
    s_add_u32 m0, s47, 32768
    v_mfma_f32_16x16x32_bf16 v[200:203], v[220:223], v[68:71], v[200:203]
    s_add_u32 s45, s45, 442368
    ds_read_b128 v[208:211], v6 offset:2048
    v_mfma_f32_16x16x32_bf16 v[204:207], v[216:219], v[72:75], v[204:207]
    ds_read_b128 v[212:215], v6 offset:16384
    v_mfma_f32_16x16x32_bf16 v[204:207], v[220:223], v[76:79], v[204:207]
    s_waitcnt lgkmcnt(4)
    s_waitcnt vmcnt(24)
    buffer_load_dwordx4 v253, s[4:7], s46 offen offset:0 sc1 lds
    v_mfma_f32_16x16x32_bf16 v[96:99], v[80:83], v[16:19], v[96:99]
    v_mfma_f32_16x16x32_bf16 v[96:99], v[84:87], v[20:23], v[96:99]
    ds_read_b128 v[216:219], v6 offset:3072
    v_mfma_f32_16x16x32_bf16 v[100:103], v[80:83], v[24:27], v[100:103]
    ds_read_b128 v[220:223], v6 offset:17408
    v_mfma_f32_16x16x32_bf16 v[100:103], v[84:87], v[28:31], v[100:103]
    s_waitcnt lgkmcnt(4)
    buffer_load_dwordx4 v253, s[4:7], s46 offen offset:1024 sc1 lds
    v_mfma_f32_16x16x32_bf16 v[104:107], v[88:91], v[16:19], v[104:107]
    v_mfma_f32_16x16x32_bf16 v[104:107], v[92:95], v[20:23], v[104:107]
    ds_read_b128 v[80:83], v6 offset:4096
    v_mfma_f32_16x16x32_bf16 v[108:111], v[88:91], v[24:27], v[108:111]
    ds_read_b128 v[84:87], v6 offset:18432
    v_mfma_f32_16x16x32_bf16 v[108:111], v[92:95], v[28:31], v[108:111]
    s_waitcnt lgkmcnt(4)
    buffer_load_dwordx4 v253, s[4:7], s46 offen offset:2048 sc1 lds
    v_mfma_f32_16x16x32_bf16 v[112:115], v[208:211], v[16:19], v[112:115]
    v_mfma_f32_16x16x32_bf16 v[112:115], v[212:215], v[20:23], v[112:115]
    ds_read_b128 v[88:91], v6 offset:5120
    v_mfma_f32_16x16x32_bf16 v[116:119], v[208:211], v[24:27], v[116:119]
    ds_read_b128 v[92:95], v6 offset:19456
    v_mfma_f32_16x16x32_bf16 v[116:119], v[212:215], v[28:31], v[116:119]
    s_waitcnt lgkmcnt(4)
    buffer_load_dwordx4 v[48:51], v253, s[4:7], s28 offen offset:0 sc1
    v_mfma_f32_16x16x32_bf16 v[120:123], v[216:219], v[16:19], v[120:123]
    v_mfma_f32_16x16x32_bf16 v[120:123], v[220:223], v[20:23], v[120:123]
    ds_read_b128 v[208:211], v6 offset:6144
    v_mfma_f32_16x16x32_bf16 v[124:127], v[216:219], v[24:27], v[124:127]
    ds_read_b128 v[212:215], v6 offset:20480
    v_mfma_f32_16x16x32_bf16 v[124:127], v[220:223], v[28:31], v[124:127]
    s_waitcnt lgkmcnt(4)
    buffer_load_dwordx4 v[52:55], v253, s[4:7], s28 offen offset:1024 sc1
    v_mfma_f32_16x16x32_bf16 v[128:131], v[80:83], v[16:19], v[128:131]
    v_mfma_f32_16x16x32_bf16 v[128:131], v[84:87], v[20:23], v[128:131]
    ds_read_b128 v[216:219], v6 offset:7168
    v_mfma_f32_16x16x32_bf16 v[132:135], v[80:83], v[24:27], v[132:135]
    ds_read_b128 v[220:223], v6 offset:21504
    v_mfma_f32_16x16x32_bf16 v[132:135], v[84:87], v[28:31], v[132:135]
    s_waitcnt lgkmcnt(4)
    s_waitcnt vmcnt(9)
    v_mfma_f32_16x16x32_bf16 v[136:139], v[88:91], v[16:19], v[136:139]
    buffer_load_dwordx4 v[56:59], v11, s[4:7], s28 offen offset:0 sc1
    v_mfma_f32_16x16x32_bf16 v[136:139], v[92:95], v[20:23], v[136:139]
    ds_read_b128 v[80:83], v6 offset:8192
    v_add_f32 v232, v232, v234
    v_mfma_f32_16x16x32_bf16 v[140:143], v[88:91], v[24:27], v[140:143]
    ds_read_b128 v[84:87], v6 offset:22528
    v_add_f32 v233, v233, v235
    v_mfma_f32_16x16x32_bf16 v[140:143], v[92:95], v[28:31], v[140:143]
    s_waitcnt lgkmcnt(4)
    v_add_f32 v236, v236, v238
    v_mfma_f32_16x16x32_bf16 v[144:147], v[208:211], v[16:19], v[144:147]
    buffer_load_dwordx4 v[60:63], v11, s[4:7], s28 offen offset:1024 sc1
    v_mfma_f32_16x16x32_bf16 v[144:147], v[212:215], v[20:23], v[144:147]
    s_add_u32 s28, s28, 2048
    ds_read_b128 v[88:91], v6 offset:9216
    v_add_f32 v237, v237, v239
    v_mfma_f32_16x16x32_bf16 v[148:151], v[208:211], v[24:27], v[148:151]
    s_add_u32 m0, s47, 57344
    ds_read_b128 v[92:95], v6 offset:23552
    v_mov_b32 v234, v232
    v_mfma_f32_16x16x32_bf16 v[148:151], v[212:215], v[28:31], v[148:151]
    s_waitcnt lgkmcnt(4)
    s_add_u32 s46, s45, 4096
    v_mfma_f32_16x16x32_bf16 v[152:155], v[216:219], v[16:19], v[152:155]
    buffer_load_dwordx4 v253, s[4:7], s45 offen offset:0 sc1 lds
    v_mfma_f32_16x16x32_bf16 v[152:155], v[220:223], v[20:23], v[152:155]
    ds_read_b128 v[208:211], v6 offset:10240
    v_mov_b32 v235, v233
    v_mfma_f32_16x16x32_bf16 v[156:159], v[216:219], v[24:27], v[156:159]
    ds_read_b128 v[212:215], v6 offset:24576
    v_mfma_f32_16x16x32_bf16 v[156:159], v[220:223], v[28:31], v[156:159]
    s_waitcnt lgkmcnt(4)
    v_mov_b32 v238, v236
    v_mfma_f32_16x16x32_bf16 v[160:163], v[80:83], v[16:19], v[160:163]
    buffer_load_dwordx4 v253, s[4:7], s45 offen offset:1024 sc1 lds
    v_mfma_f32_16x16x32_bf16 v[160:163], v[84:87], v[20:23], v[160:163]
    ds_read_b128 v[216:219], v6 offset:11264
    v_mov_b32 v239, v237
    v_mfma_f32_16x16x32_bf16 v[164:167], v[80:83], v[24:27], v[164:167]
    ds_read_b128 v[220:223], v6 offset:25600
    v_mfma_f32_16x16x32_bf16 v[164:167], v[84:87], v[28:31], v[164:167]
    s_waitcnt lgkmcnt(4)
    v_permlane32_swap_b32 v232, v234
    v_mfma_f32_16x16x32_bf16 v[168:171], v[88:91], v[16:19], v[168:171]
    v_mfma_f32_16x16x32_bf16 v[168:171], v[92:95], v[20:23], v[168:171]
    ds_read_b128 v[80:83], v9 offset:0
    v_permlane32_swap_b32 v233, v235
    v_mfma_f32_16x16x32_bf16 v[172:175], v[88:91], v[24:27], v[172:175]
    ds_read_b128 v[84:87], v9 offset:14336
    v_mfma_f32_16x16x32_bf16 v[172:175], v[92:95], v[28:31], v[172:175]
    s_waitcnt lgkmcnt(4)
    buffer_load_dwordx4 v253, s[4:7], s45 offen offset:2048 sc1 lds
    v_mfma_f32_16x16x32_bf16 v[176:179], v[208:211], v[16:19], v[176:179]
    v_permlane32_swap_b32 v236, v238
    v_mfma_f32_16x16x32_bf16 v[176:179], v[212:215], v[20:23], v[176:179]
    ds_read_b128 v[88:91], v9 offset:1024
    v_mfma_f32_16x16x32_bf16 v[180:183], v[208:211], v[24:27], v[180:183]
    ds_read_b128 v[92:95], v9 offset:15360
    v_permlane32_swap_b32 v237, v239
    v_mfma_f32_16x16x32_bf16 v[180:183], v[212:215], v[28:31], v[180:183]
    s_waitcnt lgkmcnt(4)
    buffer_load_dwordx4 v253, s[4:7], s45 offen offset:3072 sc1 lds
    s_barrier
    v_mfma_f32_16x16x32_bf16 v[184:187], v[216:219], v[16:19], v[184:187]
    s_add_u32 m0, s47, 61440
    v_add_f32 v232, v232, v234
    v_mfma_f32_16x16x32_bf16 v[184:187], v[220:223], v[20:23], v[184:187]
    s_add_u32 s45, s45, 442368
    ds_read_b128 v[208:211], v4 offset:0
    v_add_f32 v233, v233, v235
    v_mfma_f32_16x16x32_bf16 v[188:191], v[216:219], v[24:27], v[188:191]
    ds_read_b128 v[212:215], v4 offset:14336
    v_add_f32 v236, v236, v238
    v_mfma_f32_16x16x32_bf16 v[188:191], v[220:223], v[28:31], v[188:191]
    s_waitcnt lgkmcnt(4)
    buffer_load_dwordx4 v253, s[4:7], s46 offen offset:0 sc1 lds
    v_mfma_f32_16x16x32_bf16 v[192:195], v[80:83], v[16:19], v[192:195]
    v_add_f32 v237, v237, v239
    v_mfma_f32_16x16x32_bf16 v[192:195], v[84:87], v[20:23], v[192:195]
    ds_read_b128 v[216:219], v4 offset:1024
    v_mov_b32 v234, v232
    v_mfma_f32_16x16x32_bf16 v[196:199], v[80:83], v[24:27], v[196:199]
    ds_read_b128 v[220:223], v4 offset:15360
    v_mfma_f32_16x16x32_bf16 v[196:199], v[84:87], v[28:31], v[196:199]
    s_waitcnt lgkmcnt(4)
    buffer_load_dwordx4 v253, s[4:7], s46 offen offset:1024 sc1 lds
    v_mfma_f32_16x16x32_bf16 v[200:203], v[88:91], v[16:19], v[200:203]
    v_mov_b32 v235, v233
    v_mfma_f32_16x16x32_bf16 v[200:203], v[92:95], v[20:23], v[200:203]
    ds_read_b128 v[80:83], v4 offset:2048
    v_mfma_f32_16x16x32_bf16 v[204:207], v[88:91], v[24:27], v[204:207]
    ds_read_b128 v[84:87], v4 offset:16384
    v_mov_b32 v238, v236
    v_mfma_f32_16x16x32_bf16 v[204:207], v[92:95], v[28:31], v[204:207]
    s_waitcnt lgkmcnt(4)
    buffer_load_dwordx4 v253, s[4:7], s46 offen offset:2048 sc1 lds
    v_mfma_f32_16x16x32_bf16 v[96:99], v[208:211], v[32:35], v[96:99]
    s_add_u32 m0, s47, 86016
    v_mov_b32 v239, v237
    v_mfma_f32_16x16x32_bf16 v[96:99], v[212:215], v[36:39], v[96:99]
    s_add_u32 s46, s45, 4096
    ds_read_b128 v[88:91], v4 offset:3072
    v_mfma_f32_16x16x32_bf16 v[100:103], v[208:211], v[40:43], v[100:103]
    ds_read_b128 v[92:95], v4 offset:17408
    v_permlane16_swap_b32 v232, v234
    v_mfma_f32_16x16x32_bf16 v[100:103], v[212:215], v[44:47], v[100:103]
    s_waitcnt lgkmcnt(4)
    buffer_load_dwordx4 v253, s[4:7], s45 offen offset:0 sc1 lds
    v_mfma_f32_16x16x32_bf16 v[104:107], v[216:219], v[32:35], v[104:107]
    v_permlane16_swap_b32 v233, v235
    v_mfma_f32_16x16x32_bf16 v[104:107], v[220:223], v[36:39], v[104:107]
    ds_read_b128 v[208:211], v4 offset:4096
    v_mfma_f32_16x16x32_bf16 v[108:111], v[216:219], v[40:43], v[108:111]
    ds_read_b128 v[212:215], v4 offset:18432
    v_permlane16_swap_b32 v236, v238
    v_mfma_f32_16x16x32_bf16 v[108:111], v[220:223], v[44:47], v[108:111]
    s_waitcnt lgkmcnt(4)
    buffer_load_dwordx4 v253, s[4:7], s45 offen offset:1024 sc1 lds
    v_mfma_f32_16x16x32_bf16 v[112:115], v[80:83], v[32:35], v[112:115]
    v_permlane16_swap_b32 v237, v239
    v_mfma_f32_16x16x32_bf16 v[112:115], v[84:87], v[36:39], v[112:115]
    ds_read_b128 v[216:219], v4 offset:5120
    v_mfma_f32_16x16x32_bf16 v[116:119], v[80:83], v[40:43], v[116:119]
    ds_read_b128 v[220:223], v4 offset:19456
    v_add_f32 v232, v232, v234
    v_mfma_f32_16x16x32_bf16 v[116:119], v[84:87], v[44:47], v[116:119]
    s_waitcnt lgkmcnt(4)
    buffer_load_dwordx4 v253, s[4:7], s45 offen offset:2048 sc1 lds
    v_mfma_f32_16x16x32_bf16 v[120:123], v[88:91], v[32:35], v[120:123]
    v_add_f32 v233, v233, v235
    v_mfma_f32_16x16x32_bf16 v[120:123], v[92:95], v[36:39], v[120:123]
    ds_read_b128 v[80:83], v4 offset:6144
    v_add_f32 v236, v236, v238
    v_mfma_f32_16x16x32_bf16 v[124:127], v[88:91], v[40:43], v[124:127]
    ds_read_b128 v[84:87], v4 offset:20480
    v_add_f32 v237, v237, v239
    v_mfma_f32_16x16x32_bf16 v[124:127], v[92:95], v[44:47], v[124:127]
    s_waitcnt lgkmcnt(4)
    buffer_load_dwordx4 v253, s[4:7], s45 offen offset:3072 sc1 lds
    v_mfma_f32_16x16x32_bf16 v[128:131], v[208:211], v[32:35], v[128:131]
    s_add_u32 m0, s47, 90112
    v_mul_f32 v232, 0xbacccccd, v232
    v_mfma_f32_16x16x32_bf16 v[128:131], v[212:215], v[36:39], v[128:131]
    s_add_u32 s45, s45, 442368
    ds_read_b128 v[88:91], v4 offset:7168
    v_mul_f32 v234, 0x3acccccd, v233
    v_mfma_f32_16x16x32_bf16 v[132:135], v[208:211], v[40:43], v[132:135]
    ds_read_b128 v[92:95], v4 offset:21504
    v_fma_f32 v234, -v232, v232, v234
    v_mfma_f32_16x16x32_bf16 v[132:135], v[212:215], v[44:47], v[132:135]
    s_waitcnt lgkmcnt(4)
    buffer_load_dwordx4 v253, s[4:7], s46 offen offset:0 sc1 lds
    v_mfma_f32_16x16x32_bf16 v[136:139], v[216:219], v[32:35], v[136:139]
    v_max_f32 v234, 0, v234
    v_mfma_f32_16x16x32_bf16 v[136:139], v[220:223], v[36:39], v[136:139]
    ds_read_b128 v[208:211], v4 offset:8192
    v_add_f32 v234, 0x3727c5ac, v234
    v_mfma_f32_16x16x32_bf16 v[140:143], v[216:219], v[40:43], v[140:143]
    ds_read_b128 v[212:215], v4 offset:22528
    v_rcp_f32 v234, v234
    v_mfma_f32_16x16x32_bf16 v[140:143], v[220:223], v[44:47], v[140:143]
    s_waitcnt lgkmcnt(4)
    buffer_load_dwordx4 v253, s[4:7], s46 offen offset:1024 sc1 lds
    v_mfma_f32_16x16x32_bf16 v[144:147], v[80:83], v[32:35], v[144:147]
    v_mul_f32 v236, 0xbacccccd, v236
    v_mfma_f32_16x16x32_bf16 v[144:147], v[84:87], v[36:39], v[144:147]
    ds_read_b128 v[216:219], v4 offset:9216
    v_mul_f32 v238, 0x3acccccd, v237
    v_mfma_f32_16x16x32_bf16 v[148:151], v[80:83], v[40:43], v[148:151]
    ds_read_b128 v[220:223], v4 offset:23552
    v_fma_f32 v238, -v236, v236, v238
    v_mfma_f32_16x16x32_bf16 v[148:151], v[84:87], v[44:47], v[148:151]
    s_waitcnt lgkmcnt(4)
    v_max_f32 v238, 0, v238
    v_mfma_f32_16x16x32_bf16 v[152:155], v[88:91], v[32:35], v[152:155]
    buffer_load_dwordx4 v253, s[4:7], s46 offen offset:2048 sc1 lds
    v_mfma_f32_16x16x32_bf16 v[152:155], v[92:95], v[36:39], v[152:155]
    ds_read_b128 v[80:83], v4 offset:10240
    v_add_f32 v238, 0x3727c5ac, v238
    v_mfma_f32_16x16x32_bf16 v[156:159], v[88:91], v[40:43], v[156:159]
    ds_read_b128 v[84:87], v4 offset:24576
    v_rcp_f32 v238, v238
    v_mfma_f32_16x16x32_bf16 v[156:159], v[92:95], v[44:47], v[156:159]
    s_waitcnt lgkmcnt(4)
    v_mfma_f32_16x16x32_bf16 v[160:163], v[208:211], v[32:35], v[160:163]
    buffer_load_dwordx4 v[64:67], v253, s[4:7], s28 offen offset:0 sc1
    v_mfma_f32_16x16x32_bf16 v[160:163], v[212:215], v[36:39], v[160:163]
    ds_read_b128 v[88:91], v4 offset:11264
    v_mfma_f32_16x16x32_bf16 v[164:167], v[208:211], v[40:43], v[164:167]
    ds_read_b128 v[92:95], v4 offset:25600
    v_mfma_f32_16x16x32_bf16 v[164:167], v[212:215], v[44:47], v[164:167]
    s_waitcnt lgkmcnt(4)
    v_mfma_f32_16x16x32_bf16 v[168:171], v[216:219], v[32:35], v[168:171]
    buffer_load_dwordx4 v[68:71], v253, s[4:7], s28 offen offset:1024 sc1
    v_mfma_f32_16x16x32_bf16 v[168:171], v[220:223], v[36:39], v[168:171]
    ds_read_b128 v[208:211], v7 offset:0
    v_mfma_f32_16x16x32_bf16 v[172:175], v[216:219], v[40:43], v[172:175]
    ds_read_b128 v[212:215], v7 offset:14336
    v_mfma_f32_16x16x32_bf16 v[172:175], v[220:223], v[44:47], v[172:175]
    s_waitcnt lgkmcnt(4)
    v_mfma_f32_16x16x32_bf16 v[176:179], v[80:83], v[32:35], v[176:179]
    buffer_load_dwordx4 v[72:75], v11, s[4:7], s28 offen offset:0 sc1
    v_mfma_f32_16x16x32_bf16 v[176:179], v[84:87], v[36:39], v[176:179]
    ds_read_b128 v[216:219], v7 offset:1024
    v_mfma_f32_16x16x32_bf16 v[180:183], v[80:83], v[40:43], v[180:183]
    ds_read_b128 v[220:223], v7 offset:15360
    v_mfma_f32_16x16x32_bf16 v[180:183], v[84:87], v[44:47], v[180:183]
    s_waitcnt lgkmcnt(4)
    s_waitcnt vmcnt(21)
    s_barrier
    v_mfma_f32_16x16x32_bf16 v[184:187], v[88:91], v[32:35], v[184:187]
    v_mfma_f32_16x16x32_bf16 v[184:187], v[92:95], v[36:39], v[184:187]
    ds_read_b128 v[80:83], v4 offset:28672
    v_mfma_f32_16x16x32_bf16 v[188:191], v[88:91], v[40:43], v[188:191]
    ds_read_b128 v[84:87], v4 offset:43008
    v_mfma_f32_16x16x32_bf16 v[188:191], v[92:95], v[44:47], v[188:191]
    s_waitcnt lgkmcnt(4)
    buffer_load_dwordx4 v[76:79], v11, s[4:7], s28 offen offset:1024 sc1
    v_mfma_f32_16x16x32_bf16 v[192:195], v[208:211], v[32:35], v[192:195]
    s_add_u32 s28, s28, 2048
    ds_read_b128 v[224:227], v13 offset:384
    v_mfma_f32_16x16x32_bf16 v[192:195], v[212:215], v[36:39], v[192:195]
    s_add_u32 m0, s47, 114688
    ds_read_b128 v[88:91], v4 offset:29696
    v_mfma_f32_16x16x32_bf16 v[196:199], v[208:211], v[40:43], v[196:199]
    s_add_u32 s46, s45, 4096
    ds_read_b128 v[92:95], v4 offset:44032
    v_mfma_f32_16x16x32_bf16 v[196:199], v[212:215], v[44:47], v[196:199]
    s_waitcnt lgkmcnt(5)
    buffer_load_dwordx4 v253, s[4:7], s45 offen offset:0 sc1 lds
    v_mfma_f32_16x16x32_bf16 v[200:203], v[216:219], v[32:35], v[200:203]
    v_mfma_f32_16x16x32_bf16 v[200:203], v[220:223], v[36:39], v[200:203]
    ds_read_b128 v[208:211], v4 offset:30720
    v_mfma_f32_16x16x32_bf16 v[204:207], v[216:219], v[40:43], v[204:207]
    ds_read_b128 v[212:215], v4 offset:45056
    v_mfma_f32_16x16x32_bf16 v[204:207], v[220:223], v[44:47], v[204:207]
    s_waitcnt lgkmcnt(4)
    s_waitcnt vmcnt(19)
    buffer_load_dwordx4 v253, s[4:7], s45 offen offset:1024 sc1 lds
    v_mfma_f32_16x16x32_bf16 v[96:99], v[80:83], v[48:51], v[96:99]
    ds_read_b128 v[228:231], v13 offset:512
    v_fmac_f32 v144, v224, v232
    v_fmac_f32 v145, v225, v232
    v_mfma_f32_16x16x32_bf16 v[96:99], v[84:87], v[52:55], v[96:99]
    ds_read_b128 v[216:219], v4 offset:31744
    v_fmac_f32 v146, v226, v232
    v_mfma_f32_16x16x32_bf16 v[100:103], v[80:83], v[56:59], v[100:103]
    ds_read_b128 v[220:223], v4 offset:46080
    v_fmac_f32 v147, v227, v232
    v_mfma_f32_16x16x32_bf16 v[100:103], v[84:87], v[60:63], v[100:103]
    s_waitcnt lgkmcnt(5)
    buffer_load_dwordx4 v253, s[4:7], s45 offen offset:2048 sc1 lds
    v_mfma_f32_16x16x32_bf16 v[104:107], v[88:91], v[48:51], v[104:107]
    v_fmac_f32 v148, v224, v236
    v_fmac_f32 v149, v225, v236
    v_mfma_f32_16x16x32_bf16 v[104:107], v[92:95], v[52:55], v[104:107]
    ds_read_b128 v[80:83], v4 offset:32768
    v_fmac_f32 v150, v226, v236
    v_mfma_f32_16x16x32_bf16 v[108:111], v[88:91], v[56:59], v[108:111]
    ds_read_b128 v[84:87], v4 offset:47104
    v_fmac_f32 v151, v227, v236
    v_mfma_f32_16x16x32_bf16 v[108:111], v[92:95], v[60:63], v[108:111]
    s_waitcnt lgkmcnt(4)
    buffer_load_dwordx4 v253, s[4:7], s45 offen offset:3072 sc1 lds
    v_mfma_f32_16x16x32_bf16 v[112:115], v[208:211], v[48:51], v[112:115]
    s_add_u32 m0, s47, 118784
    ds_read_b128 v[224:227], v13 offset:640
    v_fmac_f32 v160, v228, v232
    v_fmac_f32 v161, v229, v232
    v_mfma_f32_16x16x32_bf16 v[112:115], v[212:215], v[52:55], v[112:115]
    s_add_u32 s45, s45, 442368
    ds_read_b128 v[88:91], v4 offset:33792
    v_fmac_f32 v162, v230, v232
    v_mfma_f32_16x16x32_bf16 v[116:119], v[208:211], v[56:59], v[116:119]
    ds_read_b128 v[92:95], v4 offset:48128
    v_fmac_f32 v163, v231, v232
    v_mfma_f32_16x16x32_bf16 v[116:119], v[212:215], v[60:63], v[116:119]
    s_waitcnt lgkmcnt(5)
    buffer_load_dwordx4 v253, s[4:7], s46 offen offset:0 sc1 lds
    v_mfma_f32_16x16x32_bf16 v[120:123], v[216:219], v[48:51], v[120:123]
    v_fmac_f32 v164, v228, v236
    v_fmac_f32 v165, v229, v236
    v_mfma_f32_16x16x32_bf16 v[120:123], v[220:223], v[52:55], v[120:123]
    ds_read_b128 v[208:211], v4 offset:34816
    v_fmac_f32 v166, v230, v236
    v_mfma_f32_16x16x32_bf16 v[124:127], v[216:219], v[56:59], v[124:127]
    ds_read_b128 v[212:215], v4 offset:49152
    v_fmac_f32 v167, v231, v236
    v_mfma_f32_16x16x32_bf16 v[124:127], v[220:223], v[60:63], v[124:127]
    s_waitcnt lgkmcnt(4)
    buffer_load_dwordx4 v253, s[4:7], s46 offen offset:1024 sc1 lds
    v_mfma_f32_16x16x32_bf16 v[128:131], v[80:83], v[48:51], v[128:131]
    ds_read_b128 v[228:231], v14 offset:0
    v_fmac_f32 v176, v224, v232
    v_fmac_f32 v177, v225, v232
    v_mfma_f32_16x16x32_bf16 v[128:131], v[84:87], v[52:55], v[128:131]
    ds_read_b128 v[216:219], v4 offset:35840
    v_fmac_f32 v178, v226, v232
    v_mfma_f32_16x16x32_bf16 v[132:135], v[80:83], v[56:59], v[132:135]
    ds_read_b128 v[220:223], v4 offset:50176
    v_fmac_f32 v179, v227, v232
    v_mfma_f32_16x16x32_bf16 v[132:135], v[84:87], v[60:63], v[132:135]
    s_waitcnt lgkmcnt(5)
    buffer_load_dwordx4 v253, s[4:7], s46 offen offset:2048 sc1 lds
    v_mfma_f32_16x16x32_bf16 v[136:139], v[88:91], v[48:51], v[136:139]
    v_fmac_f32 v180, v224, v236
    v_fmac_f32 v181, v225, v236
    v_mfma_f32_16x16x32_bf16 v[136:139], v[92:95], v[52:55], v[136:139]
    ds_read_b128 v[80:83], v4 offset:36864
    v_fmac_f32 v182, v226, v236
    v_mfma_f32_16x16x32_bf16 v[140:143], v[88:91], v[56:59], v[140:143]
    ds_read_b128 v[84:87], v4 offset:51200
    v_fmac_f32 v183, v227, v236
    v_mfma_f32_16x16x32_bf16 v[140:143], v[92:95], v[60:63], v[140:143]
    s_waitcnt lgkmcnt(4)
    buffer_load_dwordx4 v[16:19], v253, s[4:7], s28 offen offset:0 sc1
    v_mfma_f32_16x16x32_bf16 v[144:147], v[208:211], v[48:51], v[144:147]
    ds_read_b128 v[224:227], v13 offset:0
    v_fmac_f32 v192, v228, v232
    v_fmac_f32 v193, v229, v232
    v_mfma_f32_16x16x32_bf16 v[144:147], v[212:215], v[52:55], v[144:147]
    ds_read_b128 v[88:91], v4 offset:37888
    v_fmac_f32 v194, v230, v232
    v_mfma_f32_16x16x32_bf16 v[148:151], v[208:211], v[56:59], v[148:151]
    ds_read_b128 v[92:95], v4 offset:52224
    v_fmac_f32 v195, v231, v232
    v_mfma_f32_16x16x32_bf16 v[148:151], v[212:215], v[60:63], v[148:151]
    s_waitcnt lgkmcnt(5)
    buffer_load_dwordx4 v[20:23], v253, s[4:7], s28 offen offset:1024 sc1
    v_mfma_f32_16x16x32_bf16 v[152:155], v[216:219], v[48:51], v[152:155]
    v_fmac_f32 v196, v228, v236
    v_fmac_f32 v197, v229, v236
    v_mfma_f32_16x16x32_bf16 v[152:155], v[220:223], v[52:55], v[152:155]
    ds_read_b128 v[208:211], v4 offset:38912
    v_fmac_f32 v198, v230, v236
    v_mfma_f32_16x16x32_bf16 v[156:159], v[216:219], v[56:59], v[156:159]
    ds_read_b128 v[212:215], v4 offset:53248
    v_fmac_f32 v199, v231, v236
    v_mfma_f32_16x16x32_bf16 v[156:159], v[220:223], v[60:63], v[156:159]
    s_waitcnt lgkmcnt(4)
    buffer_load_dwordx4 v[24:27], v11, s[4:7], s28 offen offset:0 sc1
    v_mfma_f32_16x16x32_bf16 v[160:163], v[80:83], v[48:51], v[160:163]
    ds_read_b128 v[228:231], v13 offset:128
    v_fmac_f32 v96, v224, v232
    v_mfma_f32_16x16x32_bf16 v[160:163], v[84:87], v[52:55], v[160:163]
    ds_read_b128 v[216:219], v4 offset:39936
    v_fmac_f32 v97, v225, v232
    v_mfma_f32_16x16x32_bf16 v[164:167], v[80:83], v[56:59], v[164:167]
    ds_read_b128 v[220:223], v4 offset:54272
    v_fmac_f32 v98, v226, v232
    v_mfma_f32_16x16x32_bf16 v[164:167], v[84:87], v[60:63], v[164:167]
    s_waitcnt lgkmcnt(5)
    buffer_load_dwordx4 v[28:31], v11, s[4:7], s28 offen offset:1024 sc1
    v_mfma_f32_16x16x32_bf16 v[168:171], v[88:91], v[48:51], v[168:171]
    s_add_u32 s28, s28, 2048
    v_fmac_f32 v99, v227, v232
    v_fmac_f32 v100, v224, v236
    v_mfma_f32_16x16x32_bf16 v[168:171], v[92:95], v[52:55], v[168:171]
    ds_read_b128 v[80:83], v7 offset:28672
    v_fmac_f32 v101, v225, v236
    v_mfma_f32_16x16x32_bf16 v[172:175], v[88:91], v[56:59], v[172:175]
    ds_read_b128 v[84:87], v7 offset:43008
    v_fmac_f32 v102, v226, v236
    v_mfma_f32_16x16x32_bf16 v[172:175], v[92:95], v[60:63], v[172:175]
    s_waitcnt lgkmcnt(4)
    v_fmac_f32 v103, v227, v236
    v_mfma_f32_16x16x32_bf16 v[176:179], v[208:211], v[48:51], v[176:179]
    ds_read_b128 v[224:227], v13 offset:256
    v_fmac_f32 v112, v228, v232
    v_fmac_f32 v113, v229, v232
    v_mfma_f32_16x16x32_bf16 v[176:179], v[212:215], v[52:55], v[176:179]
    ds_read_b128 v[88:91], v7 offset:29696
    v_fmac_f32 v114, v230, v232
    v_mfma_f32_16x16x32_bf16 v[180:183], v[208:211], v[56:59], v[180:183]
    ds_read_b128 v[92:95], v7 offset:44032
    v_fmac_f32 v115, v231, v232
    v_mfma_f32_16x16x32_bf16 v[180:183], v[212:215], v[60:63], v[180:183]
    s_waitcnt lgkmcnt(5)
    s_waitcnt vmcnt(22)
    buffer_load_dwordx4 v[32:35], v253, s[4:7], s28 offen offset:0 sc1
    s_barrier
    v_mfma_f32_16x16x32_bf16 v[184:187], v[216:219], v[48:51], v[184:187]
    buffer_load_dwordx4 v[36:39], v253, s[4:7], s28 offen offset:1024 sc1
    v_mfma_f32_16x16x32_bf16 v[184:187], v[220:223], v[52:55], v[184:187]
    ds_read_b128 v[208:211], v5 offset:0
    v_fmac_f32 v116, v228, v236
    v_mfma_f32_16x16x32_bf16 v[188:191], v[216:219], v[56:59], v[188:191]
    ds_read_b128 v[212:215], v5 offset:14336
    v_fmac_f32 v117, v229, v236
    v_mfma_f32_16x16x32_bf16 v[188:191], v[220:223], v[60:63], v[188:191]
    s_waitcnt lgkmcnt(4)
    v_fmac_f32 v118, v230, v236
    v_fmac_f32 v119, v231, v236
    v_mfma_f32_16x16x32_bf16 v[192:195], v[80:83], v[48:51], v[192:195]
    ds_read_b128 v[228:231], v13 offset:448
    v_fmac_f32 v128, v224, v232
    v_fmac_f32 v129, v225, v232
    v_mfma_f32_16x16x32_bf16 v[192:195], v[84:87], v[52:55], v[192:195]
    ds_read_b128 v[216:219], v5 offset:1024
    v_fmac_f32 v130, v226, v232
    v_mfma_f32_16x16x32_bf16 v[196:199], v[80:83], v[56:59], v[196:199]
    ds_read_b128 v[220:223], v5 offset:15360
    v_fmac_f32 v131, v227, v232
    v_mfma_f32_16x16x32_bf16 v[196:199], v[84:87], v[60:63], v[196:199]
    s_waitcnt lgkmcnt(5)
    buffer_load_dwordx4 v[40:43], v11, s[4:7], s28 offen offset:0 sc1
    v_mfma_f32_16x16x32_bf16 v[200:203], v[88:91], v[48:51], v[200:203]
    v_fmac_f32 v132, v224, v236
    v_fmac_f32 v133, v225, v236
    v_mfma_f32_16x16x32_bf16 v[200:203], v[92:95], v[52:55], v[200:203]
    ds_read_b128 v[80:83], v5 offset:2048
    v_fmac_f32 v134, v226, v236
    v_mfma_f32_16x16x32_bf16 v[204:207], v[88:91], v[56:59], v[204:207]
    ds_read_b128 v[84:87], v5 offset:16384
    v_fmac_f32 v135, v227, v236
    v_mfma_f32_16x16x32_bf16 v[204:207], v[92:95], v[60:63], v[204:207]
    s_waitcnt lgkmcnt(4)
    s_waitcnt vmcnt(14)
    buffer_load_dwordx4 v[44:47], v11, s[4:7], s28 offen offset:1024 sc1
    v_mfma_f32_16x16x32_bf16 v[96:99], v[208:211], v[64:67], v[96:99]
    s_add_u32 s28, s28, 2048
    ds_read_b128 v[224:227], v13 offset:576
    v_fmac_f32 v152, v228, v232
    v_fmac_f32 v153, v229, v232
    v_mfma_f32_16x16x32_bf16 v[96:99], v[212:215], v[68:71], v[96:99]
    ds_read_b128 v[88:91], v5 offset:3072
    v_fmac_f32 v154, v230, v232
    v_mfma_f32_16x16x32_bf16 v[100:103], v[208:211], v[72:75], v[100:103]
    ds_read_b128 v[92:95], v5 offset:17408
    v_fmac_f32 v155, v231, v232
    v_mfma_f32_16x16x32_bf16 v[100:103], v[212:215], v[76:79], v[100:103]
    s_waitcnt lgkmcnt(5)
    buffer_load_dwordx4 a[164:167], v250, s[4:7], s100 offen offset:1024 sc1
    v_mfma_f32_16x16x32_bf16 v[104:107], v[216:219], v[64:67], v[104:107]
    v_fmac_f32 v156, v228, v236
    v_fmac_f32 v157, v229, v236
    v_mfma_f32_16x16x32_bf16 v[104:107], v[220:223], v[68:71], v[104:107]
    ds_read_b128 v[208:211], v5 offset:4096
    v_fmac_f32 v158, v230, v236
    v_mfma_f32_16x16x32_bf16 v[108:111], v[216:219], v[72:75], v[108:111]
    ds_read_b128 v[212:215], v5 offset:18432
    v_fmac_f32 v159, v231, v236
    v_mfma_f32_16x16x32_bf16 v[108:111], v[220:223], v[76:79], v[108:111]
    s_waitcnt lgkmcnt(4)
    buffer_load_dwordx4 a[168:171], v250, s[4:7], s100 offen offset:2048 sc1
    v_mfma_f32_16x16x32_bf16 v[112:115], v[80:83], v[64:67], v[112:115]
    ds_read_b128 v[228:231], v13 offset:704
    v_fmac_f32 v168, v224, v232
    v_fmac_f32 v169, v225, v232
    v_mfma_f32_16x16x32_bf16 v[112:115], v[84:87], v[68:71], v[112:115]
    ds_read_b128 v[216:219], v5 offset:5120
    v_fmac_f32 v170, v226, v232
    v_mfma_f32_16x16x32_bf16 v[116:119], v[80:83], v[72:75], v[116:119]
    ds_read_b128 v[220:223], v5 offset:19456
    v_fmac_f32 v171, v227, v232
    v_mfma_f32_16x16x32_bf16 v[116:119], v[84:87], v[76:79], v[116:119]
    s_waitcnt lgkmcnt(5)
    buffer_load_dwordx4 a[172:175], v250, s[4:7], s100 offen offset:3072 sc1
    v_mfma_f32_16x16x32_bf16 v[120:123], v[88:91], v[64:67], v[120:123]
    v_fmac_f32 v172, v224, v236
    v_fmac_f32 v173, v225, v236
    v_mfma_f32_16x16x32_bf16 v[120:123], v[92:95], v[68:71], v[120:123]
    ds_read_b128 v[80:83], v5 offset:6144
    v_fmac_f32 v174, v226, v236
    v_mfma_f32_16x16x32_bf16 v[124:127], v[88:91], v[72:75], v[124:127]
    ds_read_b128 v[84:87], v5 offset:20480
    v_fmac_f32 v175, v227, v236
    v_mfma_f32_16x16x32_bf16 v[124:127], v[92:95], v[76:79], v[124:127]
    s_waitcnt lgkmcnt(4)
    buffer_load_dwordx4 a[176:179], v251, s[4:7], s100 offen offset:0 sc1
    v_mfma_f32_16x16x32_bf16 v[128:131], v[208:211], v[64:67], v[128:131]
    s_add_u32 s100, s100, 40960
    ds_read_b128 v[224:227], v14 offset:64
    v_fmac_f32 v184, v228, v232
    v_fmac_f32 v185, v229, v232
    v_mfma_f32_16x16x32_bf16 v[128:131], v[212:215], v[68:71], v[128:131]
    ds_read_b128 v[88:91], v5 offset:7168
    v_fmac_f32 v186, v230, v232
    v_mfma_f32_16x16x32_bf16 v[132:135], v[208:211], v[72:75], v[132:135]
    ds_read_b128 v[92:95], v5 offset:21504
    v_fmac_f32 v187, v231, v232
    v_mfma_f32_16x16x32_bf16 v[132:135], v[212:215], v[76:79], v[132:135]
    s_waitcnt lgkmcnt(5)
    buffer_load_dwordx4 a[180:183], v250, s[4:7], s100 offen offset:0 sc1
    v_mfma_f32_16x16x32_bf16 v[136:139], v[216:219], v[64:67], v[136:139]
    v_fmac_f32 v188, v228, v236
    v_fmac_f32 v189, v229, v236
    v_mfma_f32_16x16x32_bf16 v[136:139], v[220:223], v[68:71], v[136:139]
    ds_read_b128 v[208:211], v5 offset:8192
    v_fmac_f32 v190, v230, v236
    v_mfma_f32_16x16x32_bf16 v[140:143], v[216:219], v[72:75], v[140:143]
    ds_read_b128 v[212:215], v5 offset:22528
    v_fmac_f32 v191, v231, v236
    v_mfma_f32_16x16x32_bf16 v[140:143], v[220:223], v[76:79], v[140:143]
    s_waitcnt lgkmcnt(4)
    buffer_load_dwordx4 a[184:187], v250, s[4:7], s100 offen offset:1024 sc1
    v_mfma_f32_16x16x32_bf16 v[144:147], v[80:83], v[64:67], v[144:147]
    ds_read_b128 v[228:231], v13 offset:64
    v_fmac_f32 v200, v224, v232
    v_fmac_f32 v201, v225, v232
    v_mfma_f32_16x16x32_bf16 v[144:147], v[84:87], v[68:71], v[144:147]
    ds_read_b128 v[216:219], v5 offset:9216
    v_fmac_f32 v202, v226, v232
    v_mfma_f32_16x16x32_bf16 v[148:151], v[80:83], v[72:75], v[148:151]
    ds_read_b128 v[220:223], v5 offset:23552
    v_fmac_f32 v203, v227, v232
    v_mfma_f32_16x16x32_bf16 v[148:151], v[84:87], v[76:79], v[148:151]
    s_waitcnt lgkmcnt(5)
    buffer_load_dwordx4 a[188:191], v250, s[4:7], s100 offen offset:2048 sc1
    v_mfma_f32_16x16x32_bf16 v[152:155], v[88:91], v[64:67], v[152:155]
    v_fmac_f32 v204, v224, v236
    v_fmac_f32 v205, v225, v236
    v_mfma_f32_16x16x32_bf16 v[152:155], v[92:95], v[68:71], v[152:155]
    ds_read_b128 v[80:83], v5 offset:10240
    v_fmac_f32 v206, v226, v236
    v_mfma_f32_16x16x32_bf16 v[156:159], v[88:91], v[72:75], v[156:159]
    ds_read_b128 v[84:87], v5 offset:24576
    v_fmac_f32 v207, v227, v236
    v_mfma_f32_16x16x32_bf16 v[156:159], v[92:95], v[76:79], v[156:159]
    s_waitcnt lgkmcnt(4)
    buffer_load_dwordx4 a[192:195], v250, s[4:7], s100 offen offset:3072 sc1
    v_mfma_f32_16x16x32_bf16 v[160:163], v[208:211], v[64:67], v[160:163]
    ds_read_b128 v[224:227], v13 offset:192
    v_fmac_f32 v104, v228, v232
    v_fmac_f32 v105, v229, v232
    v_mfma_f32_16x16x32_bf16 v[160:163], v[212:215], v[68:71], v[160:163]
    ds_read_b128 v[88:91], v5 offset:11264
    v_fmac_f32 v106, v230, v232
    v_mfma_f32_16x16x32_bf16 v[164:167], v[208:211], v[72:75], v[164:167]
    ds_read_b128 v[92:95], v5 offset:25600
    v_fmac_f32 v107, v231, v232
    v_mfma_f32_16x16x32_bf16 v[164:167], v[212:215], v[76:79], v[164:167]
    s_waitcnt lgkmcnt(5)
    buffer_load_dwordx4 a[196:199], v251, s[4:7], s100 offen offset:0 sc1
    v_mfma_f32_16x16x32_bf16 v[168:171], v[216:219], v[64:67], v[168:171]
    s_add_u32 s100, s100, 40960
    v_fmac_f32 v108, v228, v236
    v_fmac_f32 v109, v229, v236
    v_mfma_f32_16x16x32_bf16 v[168:171], v[220:223], v[68:71], v[168:171]
    ds_read_b128 v[208:211], v8 offset:0
    v_fmac_f32 v110, v230, v236
    v_mfma_f32_16x16x32_bf16 v[172:175], v[216:219], v[72:75], v[172:175]
    ds_read_b128 v[212:215], v8 offset:14336
    v_fmac_f32 v111, v231, v236
    v_mfma_f32_16x16x32_bf16 v[172:175], v[220:223], v[76:79], v[172:175]
    s_waitcnt lgkmcnt(4)
    buffer_load_dwordx4 a[200:203], v250, s[4:7], s100 offen offset:0 sc1
    v_mfma_f32_16x16x32_bf16 v[176:179], v[80:83], v[64:67], v[176:179]
    ds_read_b128 v[228:231], v13 offset:320
    v_fmac_f32 v120, v224, v232
    v_fmac_f32 v121, v225, v232
    v_mfma_f32_16x16x32_bf16 v[176:179], v[84:87], v[68:71], v[176:179]
sequential_preLN__softmax_full_mha__glu_gated_bilinear__prompt_kernel_pglate2:
    s_cbranch_execz sequential_preLN__softmax_full_mha__glu_gated_bilinear__prompt_kernel_wrlate
    ds_read_b128 v[216:219], v8 offset:1024
    v_fmac_f32 v122, v226, v232
    v_mfma_f32_16x16x32_bf16 v[180:183], v[80:83], v[72:75], v[180:183]
    ds_read_b128 v[220:223], v8 offset:15360
    v_fmac_f32 v123, v227, v232
    v_mfma_f32_16x16x32_bf16 v[180:183], v[84:87], v[76:79], v[180:183]
    s_waitcnt lgkmcnt(5)
    s_waitcnt vmcnt(18)
    buffer_load_dwordx4 a[204:207], v250, s[4:7], s100 offen offset:1024 sc1
    s_barrier
    v_mfma_f32_16x16x32_bf16 v[184:187], v[88:91], v[64:67], v[184:187]
    v_fmac_f32 v124, v224, v236
    v_fmac_f32 v125, v225, v236
    v_mfma_f32_16x16x32_bf16 v[184:187], v[92:95], v[68:71], v[184:187]
    ds_read_b128 v[80:83], v5 offset:28672
    v_fmac_f32 v126, v226, v236
    v_mfma_f32_16x16x32_bf16 v[188:191], v[88:91], v[72:75], v[188:191]
    ds_read_b128 v[84:87], v5 offset:43008
    v_fmac_f32 v127, v227, v236
    v_mfma_f32_16x16x32_bf16 v[188:191], v[92:95], v[76:79], v[188:191]
    s_waitcnt lgkmcnt(4)
    buffer_load_dwordx4 a[208:211], v250, s[4:7], s100 offen offset:2048 sc1
    v_mfma_f32_16x16x32_bf16 v[192:195], v[208:211], v[64:67], v[192:195]
    v_fmac_f32 v136, v228, v232
    v_fmac_f32 v137, v229, v232
    v_mfma_f32_16x16x32_bf16 v[192:195], v[212:215], v[68:71], v[192:195]
    ds_read_b128 v[88:91], v6 offset:0
    v_fmac_f32 v138, v230, v232
    v_mfma_f32_16x16x32_bf16 v[196:199], v[208:211], v[72:75], v[196:199]
    ds_read_b128 v[92:95], v6 offset:14336
    v_fmac_f32 v139, v231, v232
    v_mfma_f32_16x16x32_bf16 v[196:199], v[212:215], v[76:79], v[196:199]
    s_waitcnt lgkmcnt(4)
    buffer_load_dwordx4 a[212:215], v250, s[4:7], s100 offen offset:3072 sc1
    v_mfma_f32_16x16x32_bf16 v[200:203], v[216:219], v[64:67], v[200:203]
    v_fmac_f32 v140, v228, v236
    v_fmac_f32 v141, v229, v236
    v_mfma_f32_16x16x32_bf16 v[200:203], v[220:223], v[68:71], v[200:203]
    ds_read_b128 v[208:211], v5 offset:29696
    v_fmac_f32 v142, v230, v236
    v_mfma_f32_16x16x32_bf16 v[204:207], v[216:219], v[72:75], v[204:207]
    ds_read_b128 v[212:215], v5 offset:44032
    v_fmac_f32 v143, v231, v236
    v_mfma_f32_16x16x32_bf16 v[204:207], v[220:223], v[76:79], v[204:207]
    s_waitcnt lgkmcnt(4)
    s_waitcnt vmcnt(17)
    buffer_load_dwordx4 a[216:219], v251, s[4:7], s100 offen offset:0 sc1
    s_mov_b32 vcc_lo, s26
    s_mov_b32 vcc_hi, 0
    v_mfma_f32_16x16x32_bf16 v[96:99], v[80:83], v[16:19], v[96:99]
    s_add_u32 s100, s100, 40960
    v_mfma_f32_16x16x32_bf16 v[96:99], v[84:87], v[20:23], v[96:99]
    ds_read_b128 v[216:219], v6 offset:1024
    v_mfma_f32_16x16x32_bf16 v[100:103], v[80:83], v[24:27], v[100:103]
    ds_read_b128 v[220:223], v6 offset:15360
    v_mfma_f32_16x16x32_bf16 v[100:103], v[84:87], v[28:31], v[100:103]
    s_waitcnt lgkmcnt(4)
    s_waitcnt vmcnt(14)
    v_add_u32 v11, 55296, v253
    v_mfma_f32_16x16x32_bf16 v[100:103], v[88:91], v[40:43], v[100:103]
    buffer_load_dwordx4 a[220:223], v250, s[4:7], s100 offen offset:0 sc1
    v_mfma_f32_16x16x32_bf16 v[100:103], v[92:95], v[44:47], v[100:103]
    ds_read_b128 v[80:83], v5 offset:30720
    v_mfma_f32_16x16x32_bf16 v[96:99], v[88:91], v[32:35], v[96:99]
    ds_read_b128 v[84:87], v5 offset:45056
    v_mfma_f32_16x16x32_bf16 v[96:99], v[92:95], v[36:39], v[96:99]
    s_waitcnt lgkmcnt(4)
    v_mfma_f32_16x16x32_bf16 v[104:107], v[208:211], v[16:19], v[104:107]
    buffer_load_dwordx4 a[224:227], v250, s[4:7], s100 offen offset:1024 sc1
    v_mfma_f32_16x16x32_bf16 v[104:107], v[212:215], v[20:23], v[104:107]
    ds_read_b128 v[88:91], v6 offset:2048
    v_mfma_f32_16x16x32_bf16 v[108:111], v[208:211], v[24:27], v[108:111]
    ds_read_b128 v[92:95], v6 offset:16384
    v_mfma_f32_16x16x32_bf16 v[108:111], v[212:215], v[28:31], v[108:111]
    s_waitcnt lgkmcnt(4)
    v_mfma_f32_16x16x32_bf16 v[108:111], v[216:219], v[40:43], v[108:111]
    buffer_load_dwordx4 a[228:231], v250, s[4:7], s100 offen offset:2048 sc1
    v_mfma_f32_16x16x32_bf16 v[108:111], v[220:223], v[44:47], v[108:111]
    ds_read_b128 v[208:211], v5 offset:31744
    v_mfma_f32_16x16x32_bf16 v[104:107], v[216:219], v[32:35], v[104:107]
    ds_read_b128 v[212:215], v5 offset:46080
    v_mfma_f32_16x16x32_bf16 v[104:107], v[220:223], v[36:39], v[104:107]
    s_waitcnt lgkmcnt(4)
    v_mfma_f32_16x16x32_bf16 v[112:115], v[80:83], v[16:19], v[112:115]
    buffer_load_dwordx4 a[232:235], v250, s[4:7], s100 offen offset:3072 sc1
    v_mfma_f32_16x16x32_bf16 v[112:115], v[84:87], v[20:23], v[112:115]
    ds_read_b128 v[216:219], v6 offset:3072
    v_mfma_f32_16x16x32_bf16 v[116:119], v[80:83], v[24:27], v[116:119]
    ds_read_b128 v[220:223], v6 offset:17408
    v_mfma_f32_16x16x32_bf16 v[116:119], v[84:87], v[28:31], v[116:119]
    s_waitcnt lgkmcnt(4)
    v_mul_f32 v100, v100, v238
    v_mul_f32 v101, v101, v238
    v_mul_f32 v102, v102, v238
    v_mfma_f32_16x16x32_bf16 v[116:119], v[88:91], v[40:43], v[116:119]
    buffer_load_dwordx4 a[236:239], v251, s[4:7], s100 offen offset:0 sc1
    v_mul_f32 v103, v103, v238
    v_mfma_f32_16x16x32_bf16 v[116:119], v[92:95], v[44:47], v[116:119]
    s_add_u32 s100, s100, s94
    ds_read_b128 v[80:83], v5 offset:32768
    v_mul_f32 v96, v96, v234
    v_mul_f32 v97, v97, v234
    v_mfma_f32_16x16x32_bf16 v[112:115], v[88:91], v[32:35], v[112:115]
    ds_read_b128 v[84:87], v5 offset:47104
    v_mul_f32 v98, v98, v234
    v_mul_f32 v99, v99, v234
    v_mfma_f32_16x16x32_bf16 v[112:115], v[92:95], v[36:39], v[112:115]
    s_waitcnt lgkmcnt(4)
    v_mul_f32 v100, v100, v108
    v_mul_f32 v101, v101, v109
    v_mul_f32 v102, v102, v110
    v_mfma_f32_16x16x32_bf16 v[120:123], v[208:211], v[16:19], v[120:123]
    v_mul_f32 v103, v103, v111
    v_cvt_pk_bf16_f32 v52, v100, v101
    v_cvt_pk_bf16_f32 v53, v102, v103
    v_mfma_f32_16x16x32_bf16 v[120:123], v[212:215], v[20:23], v[120:123]
    ds_read_b128 v[88:91], v6 offset:4096
    v_mul_f32 v96, v96, v104
    v_mfma_f32_16x16x32_bf16 v[124:127], v[208:211], v[24:27], v[124:127]
    ds_read_b128 v[92:95], v6 offset:18432
    v_mul_f32 v97, v97, v105
    v_mfma_f32_16x16x32_bf16 v[124:127], v[212:215], v[28:31], v[124:127]
    s_waitcnt lgkmcnt(4)
    buffer_load_dwordx4 a[240:243], v250, s[4:7], s100 offen offset:0 sc1
    v_mfma_f32_16x16x32_bf16 v[124:127], v[216:219], v[40:43], v[124:127]
    v_mul_f32 v98, v98, v106
    v_mul_f32 v99, v99, v107
    v_mfma_f32_16x16x32_bf16 v[124:127], v[220:223], v[44:47], v[124:127]
    ds_read_b128 v[208:211], v5 offset:33792
    v_cvt_pk_bf16_f32 v48, v96, v97
    v_mfma_f32_16x16x32_bf16 v[120:123], v[216:219], v[32:35], v[120:123]
    ds_read_b128 v[212:215], v5 offset:48128
    v_cvt_pk_bf16_f32 v49, v98, v99
    v_mfma_f32_16x16x32_bf16 v[120:123], v[220:223], v[36:39], v[120:123]
    s_waitcnt lgkmcnt(4)
    buffer_load_dwordx4 a[244:247], v250, s[4:7], s100 offen offset:1024 sc1
    v_mfma_f32_16x16x32_bf16 v[128:131], v[80:83], v[16:19], v[128:131]
    v_mfma_f32_16x16x32_bf16 v[128:131], v[84:87], v[20:23], v[128:131]
    ds_read_b128 v[216:219], v6 offset:5120
    v_mfma_f32_16x16x32_bf16 v[132:135], v[80:83], v[24:27], v[132:135]
    ds_read_b128 v[220:223], v6 offset:19456
    v_mfma_f32_16x16x32_bf16 v[132:135], v[84:87], v[28:31], v[132:135]
    s_waitcnt lgkmcnt(4)
    buffer_load_dwordx4 a[248:251], v250, s[4:7], s100 offen offset:2048 sc1
    v_mul_f32 v116, v116, v238
    v_mfma_f32_16x16x32_bf16 v[132:135], v[88:91], v[40:43], v[132:135]
    v_mul_f32 v117, v117, v238
    v_mul_f32 v118, v118, v238
    v_mul_f32 v119, v119, v238
    v_mfma_f32_16x16x32_bf16 v[132:135], v[92:95], v[44:47], v[132:135]
    ds_read_b128 v[80:83], v5 offset:34816
    v_mul_f32 v112, v112, v234
    v_mul_f32 v113, v113, v234
    v_mfma_f32_16x16x32_bf16 v[128:131], v[88:91], v[32:35], v[128:131]
    ds_read_b128 v[84:87], v5 offset:49152
    v_mul_f32 v114, v114, v234
    v_mul_f32 v115, v115, v234
    v_mfma_f32_16x16x32_bf16 v[128:131], v[92:95], v[36:39], v[128:131]
    s_waitcnt lgkmcnt(4)
    buffer_load_dwordx4 a[252:255], v250, s[4:7], s100 offen offset:3072 sc1
    v_mul_f32 v116, v116, v124
    v_mfma_f32_16x16x32_bf16 v[136:139], v[208:211], v[16:19], v[136:139]
    v_mul_f32 v117, v117, v125
    v_mul_f32 v118, v118, v126
    v_mul_f32 v119, v119, v127
    v_mfma_f32_16x16x32_bf16 v[136:139], v[212:215], v[20:23], v[136:139]
    ds_read_b128 v[88:91], v6 offset:6144
    v_cvt_pk_bf16_f32 v54, v116, v117
    v_cvt_pk_bf16_f32 v55, v118, v119
    v_mfma_f32_16x16x32_bf16 v[140:143], v[208:211], v[24:27], v[140:143]
    ds_read_b128 v[92:95], v6 offset:20480
    v_mul_f32 v112, v112, v120
    v_mul_f32 v113, v113, v121
    v_mfma_f32_16x16x32_bf16 v[140:143], v[212:215], v[28:31], v[140:143]
    s_waitcnt lgkmcnt(4)
    buffer_load_dwordx4 v[64:67], v251, s[4:7], s100 offen offset:0 sc1
    v_mfma_f32_16x16x32_bf16 v[140:143], v[216:219], v[40:43], v[140:143]
    s_add_u32 s100, s100, 40960
    v_mul_f32 v114, v114, v122
    v_mul_f32 v115, v115, v123
    v_mfma_f32_16x16x32_bf16 v[140:143], v[220:223], v[44:47], v[140:143]
    ds_read_b128 v[208:211], v5 offset:35840
    v_cvt_pk_bf16_f32 v50, v112, v113
    v_mfma_f32_16x16x32_bf16 v[136:139], v[216:219], v[32:35], v[136:139]
    ds_read_b128 v[212:215], v5 offset:50176
    v_cvt_pk_bf16_f32 v51, v114, v115
    v_mfma_f32_16x16x32_bf16 v[136:139], v[220:223], v[36:39], v[136:139]
    s_waitcnt lgkmcnt(4)
    buffer_load_dwordx4 v[68:71], v250, s[4:7], s100 offen offset:0 sc1
    buffer_store_dwordx4 v[48:51], v253, s[4:7], s33 offen offset:0 sc1
    buffer_store_dwordx4 v[52:55], v11, s[4:7], s33 offen offset:0 sc1
    v_mfma_f32_16x16x32_bf16 v[144:147], v[80:83], v[16:19], v[144:147]
    v_mfma_f32_16x16x32_bf16 v[144:147], v[84:87], v[20:23], v[144:147]
    ds_read_b128 v[216:219], v6 offset:7168
    v_mfma_f32_16x16x32_bf16 v[148:151], v[80:83], v[24:27], v[148:151]
    ds_read_b128 v[220:223], v6 offset:21504
    v_mfma_f32_16x16x32_bf16 v[148:151], v[84:87], v[28:31], v[148:151]
    s_waitcnt lgkmcnt(4)
    buffer_load_dwordx4 v[72:75], v250, s[4:7], s100 offen offset:1024 sc1
    v_mul_f32 v132, v132, v238
    v_mfma_f32_16x16x32_bf16 v[148:151], v[88:91], v[40:43], v[148:151]
    v_mul_f32 v133, v133, v238
    v_mul_f32 v134, v134, v238
    v_mul_f32 v135, v135, v238
    v_mfma_f32_16x16x32_bf16 v[148:151], v[92:95], v[44:47], v[148:151]
    ds_read_b128 v[80:83], v5 offset:36864
    v_mul_f32 v128, v128, v234
    v_mul_f32 v129, v129, v234
    v_mfma_f32_16x16x32_bf16 v[144:147], v[88:91], v[32:35], v[144:147]
    ds_read_b128 v[84:87], v5 offset:51200
    v_mul_f32 v130, v130, v234
    v_mul_f32 v131, v131, v234
    v_mfma_f32_16x16x32_bf16 v[144:147], v[92:95], v[36:39], v[144:147]
    s_waitcnt lgkmcnt(4)
    buffer_load_dwordx4 v[76:79], v250, s[4:7], s100 offen offset:2048 sc1
    v_mul_f32 v132, v132, v140
    v_mfma_f32_16x16x32_bf16 v[152:155], v[208:211], v[16:19], v[152:155]
    v_mul_f32 v133, v133, v141
    v_mul_f32 v134, v134, v142
    v_mul_f32 v135, v135, v143
    v_mfma_f32_16x16x32_bf16 v[152:155], v[212:215], v[20:23], v[152:155]
    ds_read_b128 v[88:91], v6 offset:8192
    v_cvt_pk_bf16_f32 v60, v132, v133
    v_cvt_pk_bf16_f32 v61, v134, v135
    v_mfma_f32_16x16x32_bf16 v[156:159], v[208:211], v[24:27], v[156:159]
    ds_read_b128 v[92:95], v6 offset:22528
    v_mul_f32 v128, v128, v136
    v_mul_f32 v129, v129, v137
    v_mfma_f32_16x16x32_bf16 v[156:159], v[212:215], v[28:31], v[156:159]
    s_waitcnt lgkmcnt(4)
    buffer_load_dwordx4 v[224:227], v250, s[4:7], s100 offen offset:3072 sc1
    v_mfma_f32_16x16x32_bf16 v[156:159], v[216:219], v[40:43], v[156:159]
    v_mul_f32 v130, v130, v138
    v_mul_f32 v131, v131, v139
    v_mfma_f32_16x16x32_bf16 v[156:159], v[220:223], v[44:47], v[156:159]
    ds_read_b128 v[208:211], v5 offset:37888
    v_cvt_pk_bf16_f32 v56, v128, v129
    v_mfma_f32_16x16x32_bf16 v[152:155], v[216:219], v[32:35], v[152:155]
    ds_read_b128 v[212:215], v5 offset:52224
    v_cvt_pk_bf16_f32 v57, v130, v131
    v_mfma_f32_16x16x32_bf16 v[152:155], v[220:223], v[36:39], v[152:155]
    s_waitcnt lgkmcnt(4)
    buffer_load_dwordx4 v[228:231], v251, s[4:7], s100 offen offset:0 sc1
    v_mfma_f32_16x16x32_bf16 v[160:163], v[80:83], v[16:19], v[160:163]
    s_add_u32 s100, s100, 40960
    v_mfma_f32_16x16x32_bf16 v[160:163], v[84:87], v[20:23], v[160:163]
    ds_read_b128 v[216:219], v6 offset:9216
    v_mfma_f32_16x16x32_bf16 v[164:167], v[80:83], v[24:27], v[164:167]
    ds_read_b128 v[220:223], v6 offset:23552
    v_mfma_f32_16x16x32_bf16 v[164:167], v[84:87], v[28:31], v[164:167]
    s_waitcnt lgkmcnt(4)
    v_mul_f32 v148, v148, v238
    v_mul_f32 v149, v149, v238
    v_mul_f32 v150, v150, v238
    v_mfma_f32_16x16x32_bf16 v[164:167], v[88:91], v[40:43], v[164:167]
    v_mul_f32 v151, v151, v238
    v_mul_f32 v144, v144, v234
    v_mul_f32 v145, v145, v234
    v_mfma_f32_16x16x32_bf16 v[164:167], v[92:95], v[44:47], v[164:167]
    ds_read_b128 v[80:83], v5 offset:38912
    v_mul_f32 v146, v146, v234
    v_mfma_f32_16x16x32_bf16 v[160:163], v[88:91], v[32:35], v[160:163]
    ds_read_b128 v[84:87], v5 offset:53248
    v_mul_f32 v147, v147, v234
    v_mfma_f32_16x16x32_bf16 v[160:163], v[92:95], v[36:39], v[160:163]
    s_waitcnt lgkmcnt(4)
    v_mul_f32 v148, v148, v156
    v_mul_f32 v149, v149, v157
    v_mfma_f32_16x16x32_bf16 v[168:171], v[208:211], v[16:19], v[168:171]
    v_mul_f32 v150, v150, v158
    v_mul_f32 v151, v151, v159
    v_mfma_f32_16x16x32_bf16 v[168:171], v[212:215], v[20:23], v[168:171]
    ds_read_b128 v[88:91], v6 offset:10240
    v_cvt_pk_bf16_f32 v62, v148, v149
    v_mfma_f32_16x16x32_bf16 v[172:175], v[208:211], v[24:27], v[172:175]
    ds_read_b128 v[92:95], v6 offset:24576
    v_cvt_pk_bf16_f32 v63, v150, v151
    v_mfma_f32_16x16x32_bf16 v[172:175], v[212:215], v[28:31], v[172:175]
    s_waitcnt lgkmcnt(4)
    v_mul_f32 v144, v144, v152
    v_mul_f32 v145, v145, v153
    v_mfma_f32_16x16x32_bf16 v[172:175], v[216:219], v[40:43], v[172:175]
    v_mul_f32 v146, v146, v154
    v_mul_f32 v147, v147, v155
    v_mfma_f32_16x16x32_bf16 v[172:175], v[220:223], v[44:47], v[172:175]
    ds_read_b128 v[208:211], v5 offset:39936
    v_cvt_pk_bf16_f32 v58, v144, v145
    v_mfma_f32_16x16x32_bf16 v[168:171], v[216:219], v[32:35], v[168:171]
    ds_read_b128 v[212:215], v5 offset:54272
    v_cvt_pk_bf16_f32 v59, v146, v147
    v_mfma_f32_16x16x32_bf16 v[168:171], v[220:223], v[36:39], v[168:171]
    s_waitcnt lgkmcnt(4)
    buffer_store_dwordx4 v[56:59], v253, s[4:7], s29 offen offset:1024 sc1
    buffer_store_dwordx4 v[60:63], v11, s[4:7], s29 offen offset:1024 sc1
    v_mfma_f32_16x16x32_bf16 v[176:179], v[80:83], v[16:19], v[176:179]
    v_mfma_f32_16x16x32_bf16 v[176:179], v[84:87], v[20:23], v[176:179]
    ds_read_b128 v[216:219], v6 offset:11264
    v_mfma_f32_16x16x32_bf16 v[180:183], v[80:83], v[24:27], v[180:183]
    ds_read_b128 v[220:223], v6 offset:25600
    v_mfma_f32_16x16x32_bf16 v[180:183], v[84:87], v[28:31], v[180:183]
    s_waitcnt lgkmcnt(4)
    v_mul_f32 v164, v164, v238
    v_mul_f32 v165, v165, v238
    v_mul_f32 v166, v166, v238
    v_mfma_f32_16x16x32_bf16 v[180:183], v[88:91], v[40:43], v[180:183]
    v_mul_f32 v167, v167, v238
    v_mul_f32 v160, v160, v234
    v_mul_f32 v161, v161, v234
    v_mfma_f32_16x16x32_bf16 v[180:183], v[92:95], v[44:47], v[180:183]
    ds_read_b128 v[80:83], v8 offset:28672
    v_mul_f32 v162, v162, v234
    v_mfma_f32_16x16x32_bf16 v[176:179], v[88:91], v[32:35], v[176:179]
    ds_read_b128 v[84:87], v8 offset:43008
    v_mul_f32 v163, v163, v234
    v_mfma_f32_16x16x32_bf16 v[176:179], v[92:95], v[36:39], v[176:179]
    s_waitcnt lgkmcnt(4)
    v_mul_f32 v164, v164, v172
    v_mul_f32 v165, v165, v173
    v_mfma_f32_16x16x32_bf16 v[184:187], v[208:211], v[16:19], v[184:187]
    v_mul_f32 v166, v166, v174
    v_mul_f32 v167, v167, v175
    v_mfma_f32_16x16x32_bf16 v[184:187], v[212:215], v[20:23], v[184:187]
    ds_read_b128 v[88:91], v9 offset:0
    v_cvt_pk_bf16_f32 v52, v164, v165
    v_mfma_f32_16x16x32_bf16 v[188:191], v[208:211], v[24:27], v[188:191]
    ds_read_b128 v[92:95], v9 offset:14336
    v_cvt_pk_bf16_f32 v53, v166, v167
    v_mfma_f32_16x16x32_bf16 v[188:191], v[212:215], v[28:31], v[188:191]
    s_waitcnt lgkmcnt(4)
    v_mul_f32 v160, v160, v168
    v_mul_f32 v161, v161, v169
    v_mfma_f32_16x16x32_bf16 v[188:191], v[216:219], v[40:43], v[188:191]
    v_mul_f32 v162, v162, v170
    v_mul_f32 v163, v163, v171
    v_mfma_f32_16x16x32_bf16 v[188:191], v[220:223], v[44:47], v[188:191]
    ds_read_b128 v[208:211], v8 offset:29696
    v_cvt_pk_bf16_f32 v48, v160, v161
    v_mfma_f32_16x16x32_bf16 v[184:187], v[216:219], v[32:35], v[184:187]
    ds_read_b128 v[212:215], v8 offset:44032
    v_cvt_pk_bf16_f32 v49, v162, v163
    v_mfma_f32_16x16x32_bf16 v[184:187], v[220:223], v[36:39], v[184:187]
    s_waitcnt lgkmcnt(4)
    v_mfma_f32_16x16x32_bf16 v[192:195], v[80:83], v[16:19], v[192:195]
    v_mfma_f32_16x16x32_bf16 v[192:195], v[84:87], v[20:23], v[192:195]
    ds_read_b128 v[216:219], v9 offset:1024
    v_mfma_f32_16x16x32_bf16 v[196:199], v[80:83], v[24:27], v[196:199]
    ds_read_b128 v[220:223], v9 offset:15360
    v_mfma_f32_16x16x32_bf16 v[196:199], v[84:87], v[28:31], v[196:199]
    s_waitcnt lgkmcnt(4)
    v_mul_f32 v180, v180, v238
    v_mul_f32 v181, v181, v238
    v_mfma_f32_16x16x32_bf16 v[196:199], v[88:91], v[40:43], v[196:199]
    v_mul_f32 v182, v182, v238
    v_mul_f32 v183, v183, v238
    v_mfma_f32_16x16x32_bf16 v[196:199], v[92:95], v[44:47], v[196:199]
    v_mul_f32 v176, v176, v234
    v_mul_f32 v177, v177, v234
    v_mfma_f32_16x16x32_bf16 v[192:195], v[88:91], v[32:35], v[192:195]
    v_mul_f32 v178, v178, v234
    v_mul_f32 v179, v179, v234
    v_mfma_f32_16x16x32_bf16 v[192:195], v[92:95], v[36:39], v[192:195]
    s_waitcnt lgkmcnt(2)
    v_mul_f32 v180, v180, v188
    v_mul_f32 v181, v181, v189
    v_mfma_f32_16x16x32_bf16 v[200:203], v[208:211], v[16:19], v[200:203]
    v_mul_f32 v182, v182, v190
    v_mul_f32 v183, v183, v191
    v_mfma_f32_16x16x32_bf16 v[200:203], v[212:215], v[20:23], v[200:203]
    v_cvt_pk_bf16_f32 v54, v180, v181
    v_cvt_pk_bf16_f32 v55, v182, v183
    v_mfma_f32_16x16x32_bf16 v[204:207], v[208:211], v[24:27], v[204:207]
    v_mul_f32 v176, v176, v184
    v_mul_f32 v177, v177, v185
    v_mfma_f32_16x16x32_bf16 v[204:207], v[212:215], v[28:31], v[204:207]
    s_waitcnt lgkmcnt(0)
    v_mul_f32 v178, v178, v186
    v_mfma_f32_16x16x32_bf16 v[204:207], v[216:219], v[40:43], v[204:207]
    v_mul_f32 v179, v179, v187
    v_mfma_f32_16x16x32_bf16 v[204:207], v[220:223], v[44:47], v[204:207]
    v_cvt_pk_bf16_f32 v50, v176, v177
    v_mfma_f32_16x16x32_bf16 v[200:203], v[216:219], v[32:35], v[200:203]
    v_cvt_pk_bf16_f32 v51, v178, v179
    v_mfma_f32_16x16x32_bf16 v[200:203], v[220:223], v[36:39], v[200:203]
    s_cbranch_vccz L_wt_31
    buffer_store_dwordx4 v[48:51], v253, s[4:7], s29 offen offset:2048
    buffer_store_dwordx4 v[52:55], v11, s[4:7], s29 offen offset:2048
L_wb_32:
    v_pk_mul_f32 v[196:197], v[196:197], v[238:239] op_sel_hi:[1,0]
    v_pk_mul_f32 v[198:199], v[198:199], v[238:239] op_sel_hi:[1,0]
    v_pk_mul_f32 v[192:193], v[192:193], v[234:235] op_sel_hi:[1,0]
    v_pk_mul_f32 v[194:195], v[194:195], v[234:235] op_sel_hi:[1,0]
    s_nop 1
    v_pk_mul_f32 v[196:197], v[196:197], v[204:205]
    v_pk_mul_f32 v[198:199], v[198:199], v[206:207]
    v_cvt_pk_bf16_f32 v60, v196, v197
    v_cvt_pk_bf16_f32 v61, v198, v199
    v_pk_mul_f32 v[192:193], v[192:193], v[200:201]
    v_pk_mul_f32 v[194:195], v[194:195], v[202:203]
    v_cvt_pk_bf16_f32 v56, v192, v193
    v_cvt_pk_bf16_f32 v57, v194, v195
    s_cbranch_vccz L_wt_33
    buffer_store_dwordx2 v[56:57], v253, s[4:7], s30 offen
    buffer_store_dwordx2 v[60:61], v11, s[4:7], s30 offen
L_wb_34:
    v_add_u32 v14, s92, v253
    v_lshrrev_b32 v15, 4, v1
    v_mul_u32_u24 v15, 64, v15
    v_add_u32 v15, v15, v241
    s_waitcnt vmcnt(0)
    s_cbranch_vccz L_wt_35
    buffer_store_dword v10, off, s[4:7], s69
L_wb_36:
    s_mov_b64 exec, 0xf000f
    s_mov_b32 s58, 200000
L_poll_37:
    buffer_load_dword v2, v15, s[4:7], s70 offen sc1
L_poll_37w:
    s_waitcnt vmcnt(0)
    v_cmp_eq_u32 vcc, 0, v2
    s_sub_u32 s58, s58, 1
    s_cbranch_scc1 L_pollout_38
    s_cbranch_vccnz L_poll_37
L_pollout_38:
    s_mov_b64 exec, -1
    buffer_load_dwordx4 v[100:103], v253, s[4:7], s73 offen offset:0 sc1
    buffer_load_dwordx4 v[104:107], v253, s[4:7], s73 offen offset:1024 sc1
    buffer_load_dwordx4 v[108:111], v253, s[4:7], s73 offen offset:2048 sc1
    buffer_load_dwordx4 v[112:115], v253, s[4:7], s73 offen offset:3072 sc1
    s_add_u32 s73, s73, 4096
    buffer_load_dwordx4 v[116:119], v253, s[4:7], s73 offen offset:0 sc1
    buffer_load_dwordx4 v[120:123], v253, s[4:7], s73 offen offset:1024 sc1
    buffer_load_dwordx4 v[124:127], v253, s[4:7], s73 offen offset:2048 sc1
    buffer_load_dwordx4 v[128:131], v253, s[4:7], s73 offen offset:3072 sc1
    s_add_u32 s73, s73, 4096
    s_waitcnt vmcnt(6)
    v_mfma_f32_16x16x32_bf16 v[36:39], a[0:3], v[100:103], 0
    buffer_load_dwordx4 v[132:135], v253, s[4:7], s73 offen offset:0 sc1
    v_mfma_f32_16x16x32_bf16 v[36:39], a[20:23], v[104:107], v[36:39]
    v_mfma_f32_16x16x32_bf16 v[40:43], a[4:7], v[100:103], 0
    v_mfma_f32_16x16x32_bf16 v[40:43], a[24:27], v[104:107], v[40:43]
    v_mfma_f32_16x16x32_bf16 v[44:47], a[8:11], v[100:103], 0
    buffer_load_dwordx4 v[136:139], v253, s[4:7], s73 offen offset:1024 sc1
    v_mfma_f32_16x16x32_bf16 v[44:47], a[28:31], v[104:107], v[44:47]
    v_mfma_f32_16x16x32_bf16 v[48:51], a[12:15], v[100:103], 0
    v_mfma_f32_16x16x32_bf16 v[48:51], a[32:35], v[104:107], v[48:51]
    v_mfma_f32_16x16x32_bf16 v[52:55], a[16:19], v[100:103], 0
    buffer_load_dwordx4 v[140:143], v253, s[4:7], s73 offen offset:2048 sc1
    v_mfma_f32_16x16x32_bf16 v[52:55], a[36:39], v[104:107], v[52:55]
    s_waitcnt vmcnt(7)
    v_mfma_f32_16x16x32_bf16 v[36:39], a[40:43], v[108:111], v[36:39]
    v_mfma_f32_16x16x32_bf16 v[36:39], a[60:63], v[112:115], v[36:39]
    v_mfma_f32_16x16x32_bf16 v[40:43], a[44:47], v[108:111], v[40:43]
    buffer_load_dwordx4 v[144:147], v253, s[4:7], s73 offen offset:3072 sc1
    v_mfma_f32_16x16x32_bf16 v[40:43], a[64:67], v[112:115], v[40:43]
    s_add_u32 s73, s73, 4096
    v_mfma_f32_16x16x32_bf16 v[44:47], a[48:51], v[108:111], v[44:47]
    v_mfma_f32_16x16x32_bf16 v[44:47], a[68:71], v[112:115], v[44:47]
    v_mfma_f32_16x16x32_bf16 v[48:51], a[52:55], v[108:111], v[48:51]
    buffer_load_dwordx4 v[148:151], v14, s[4:7], s73 offen offset:0 sc1
    v_mfma_f32_16x16x32_bf16 v[48:51], a[72:75], v[112:115], v[48:51]
    v_mfma_f32_16x16x32_bf16 v[52:55], a[56:59], v[108:111], v[52:55]
    v_mfma_f32_16x16x32_bf16 v[52:55], a[76:79], v[112:115], v[52:55]
    s_waitcnt vmcnt(7)
    v_mfma_f32_16x16x32_bf16 v[36:39], a[80:83], v[116:119], v[36:39]
    buffer_load_dwordx4 v[152:155], v14, s[4:7], s73 offen offset:1024 sc1
    v_mfma_f32_16x16x32_bf16 v[36:39], a[100:103], v[120:123], v[36:39]
    v_mfma_f32_16x16x32_bf16 v[40:43], a[84:87], v[116:119], v[40:43]
    v_mfma_f32_16x16x32_bf16 v[40:43], a[104:107], v[120:123], v[40:43]
    v_mfma_f32_16x16x32_bf16 v[44:47], a[88:91], v[116:119], v[44:47]
    buffer_load_dwordx4 v[156:159], v253, s[4:7], s74 offen offset:0 sc1
    v_mfma_f32_16x16x32_bf16 v[44:47], a[108:111], v[120:123], v[44:47]
    v_mfma_f32_16x16x32_bf16 v[48:51], a[92:95], v[116:119], v[48:51]
    v_mfma_f32_16x16x32_bf16 v[48:51], a[112:115], v[120:123], v[48:51]
    v_mfma_f32_16x16x32_bf16 v[52:55], a[96:99], v[116:119], v[52:55]
    buffer_load_dwordx4 v[160:163], v253, s[4:7], s74 offen offset:1024 sc1
    v_mfma_f32_16x16x32_bf16 v[52:55], a[116:119], v[120:123], v[52:55]
    s_waitcnt vmcnt(8)
    v_mfma_f32_16x16x32_bf16 v[36:39], a[120:123], v[124:127], v[36:39]
    v_mfma_f32_16x16x32_bf16 v[36:39], a[140:143], v[128:131], v[36:39]
    v_mfma_f32_16x16x32_bf16 v[40:43], a[124:127], v[124:127], v[40:43]
    buffer_load_dwordx4 v[164:167], v253, s[4:7], s74 offen offset:2048 sc1
    v_mfma_f32_16x16x32_bf16 v[40:43], a[144:147], v[128:131], v[40:43]
    v_mfma_f32_16x16x32_bf16 v[44:47], a[128:131], v[124:127], v[44:47]
    v_mfma_f32_16x16x32_bf16 v[44:47], a[148:151], v[128:131], v[44:47]
    v_mfma_f32_16x16x32_bf16 v[48:51], a[132:135], v[124:127], v[48:51]
    buffer_load_dwordx4 v[168:171], v253, s[4:7], s74 offen offset:3072 sc1
    v_mfma_f32_16x16x32_bf16 v[48:51], a[152:155], v[128:131], v[48:51]
    s_add_u32 s74, s74, 4096
    v_mfma_f32_16x16x32_bf16 v[52:55], a[136:139], v[124:127], v[52:55]
    v_mfma_f32_16x16x32_bf16 v[52:55], a[156:159], v[128:131], v[52:55]
    s_waitcnt vmcnt(8)
    v_mfma_f32_16x16x32_bf16 v[36:39], a[160:163], v[132:135], v[36:39]
    buffer_load_dwordx4 v[172:175], v253, s[4:7], s74 offen offset:0 sc1
    v_mfma_f32_16x16x32_bf16 v[36:39], a[180:183], v[136:139], v[36:39]
    v_mfma_f32_16x16x32_bf16 v[40:43], a[164:167], v[132:135], v[40:43]
    v_mfma_f32_16x16x32_bf16 v[40:43], a[184:187], v[136:139], v[40:43]
    v_mfma_f32_16x16x32_bf16 v[44:47], a[168:171], v[132:135], v[44:47]
    buffer_load_dwordx4 v[176:179], v253, s[4:7], s74 offen offset:1024 sc1
    v_mfma_f32_16x16x32_bf16 v[44:47], a[188:191], v[136:139], v[44:47]
    v_mfma_f32_16x16x32_bf16 v[48:51], a[172:175], v[132:135], v[48:51]
    v_mfma_f32_16x16x32_bf16 v[48:51], a[192:195], v[136:139], v[48:51]
    v_mfma_f32_16x16x32_bf16 v[52:55], a[176:179], v[132:135], v[52:55]
    buffer_load_dwordx4 v[180:183], v253, s[4:7], s74 offen offset:2048 sc1
    v_mfma_f32_16x16x32_bf16 v[52:55], a[196:199], v[136:139], v[52:55]
    s_waitcnt vmcnt(9)
    v_mfma_f32_16x16x32_bf16 v[36:39], a[200:203], v[140:143], v[36:39]
    v_mfma_f32_16x16x32_bf16 v[36:39], a[220:223], v[144:147], v[36:39]
    v_mfma_f32_16x16x32_bf16 v[40:43], a[204:207], v[140:143], v[40:43]
    buffer_load_dwordx4 v[184:187], v253, s[4:7], s74 offen offset:3072 sc1
    v_mfma_f32_16x16x32_bf16 v[40:43], a[224:227], v[144:147], v[40:43]
    s_add_u32 s74, s74, 4096
    v_mfma_f32_16x16x32_bf16 v[44:47], a[208:211], v[140:143], v[44:47]
    v_mfma_f32_16x16x32_bf16 v[44:47], a[228:231], v[144:147], v[44:47]
    v_mfma_f32_16x16x32_bf16 v[48:51], a[212:215], v[140:143], v[48:51]
    buffer_load_dwordx4 v[188:191], v253, s[4:7], s74 offen offset:0 sc1
    v_mfma_f32_16x16x32_bf16 v[48:51], a[232:235], v[144:147], v[48:51]
    v_mfma_f32_16x16x32_bf16 v[52:55], a[216:219], v[140:143], v[52:55]
    v_mfma_f32_16x16x32_bf16 v[52:55], a[236:239], v[144:147], v[52:55]
    s_waitcnt vmcnt(9)
    v_mfma_f32_16x16x32_bf16 v[36:39], a[240:243], v[148:151], v[36:39]
    buffer_load_dwordx4 v[192:195], v253, s[4:7], s74 offen offset:1024 sc1
    v_mfma_f32_16x16x32_bf16 v[36:39], v[68:71], v[152:155], v[36:39]
    v_mfma_f32_16x16x32_bf16 v[40:43], a[244:247], v[148:151], v[40:43]
    v_mfma_f32_16x16x32_bf16 v[40:43], v[72:75], v[152:155], v[40:43]
    v_mfma_f32_16x16x32_bf16 v[44:47], a[248:251], v[148:151], v[44:47]
    buffer_load_dwordx4 v[196:199], v253, s[4:7], s74 offen offset:2048 sc1
    v_mfma_f32_16x16x32_bf16 v[44:47], v[76:79], v[152:155], v[44:47]
    v_mfma_f32_16x16x32_bf16 v[48:51], a[252:255], v[148:151], v[48:51]
    v_mfma_f32_16x16x32_bf16 v[48:51], v[224:227], v[152:155], v[48:51]
    v_mfma_f32_16x16x32_bf16 v[52:55], v[64:67], v[148:151], v[52:55]
    buffer_load_dwordx4 v[200:203], v253, s[4:7], s74 offen offset:3072 sc1
    v_mfma_f32_16x16x32_bf16 v[52:55], v[228:231], v[152:155], v[52:55]
    s_waitcnt vmcnt(10)
    s_barrier
    v_mfma_f32_16x16x32_bf16 v[80:83], a[0:3], v[156:159], 0
    s_add_u32 s74, s74, 4096
    v_mfma_f32_16x16x32_bf16 v[80:83], a[20:23], v[160:163], v[80:83]
    v_mfma_f32_16x16x32_bf16 v[84:87], a[4:7], v[156:159], 0
    ds_write_b128 v242, v[36:39] offset:0
    v_mfma_f32_16x16x32_bf16 v[84:87], a[24:27], v[160:163], v[84:87]
    buffer_load_dwordx4 v[56:59], v14, s[4:7], s74 offen offset:0 sc1
    v_mfma_f32_16x16x32_bf16 v[88:91], a[8:11], v[156:159], 0
    v_mfma_f32_16x16x32_bf16 v[88:91], a[28:31], v[160:163], v[88:91]
    v_mfma_f32_16x16x32_bf16 v[92:95], a[12:15], v[156:159], 0
    buffer_load_dwordx4 v[60:63], v14, s[4:7], s74 offen offset:1024 sc1
    v_mfma_f32_16x16x32_bf16 v[92:95], a[32:35], v[160:163], v[92:95]
    ds_write_b128 v242, v[40:43] offset:1024
    v_mfma_f32_16x16x32_bf16 v[96:99], a[16:19], v[156:159], 0
    v_mfma_f32_16x16x32_bf16 v[96:99], a[36:39], v[160:163], v[96:99]
    s_waitcnt vmcnt(10)
    v_mfma_f32_16x16x32_bf16 v[80:83], a[40:43], v[164:167], v[80:83]
    buffer_load_dwordx4 v[100:103], v253, s[4:7], s75 offen offset:0 sc1
    v_mfma_f32_16x16x32_bf16 v[80:83], a[60:63], v[168:171], v[80:83]
    v_mfma_f32_16x16x32_bf16 v[84:87], a[44:47], v[164:167], v[84:87]
    ds_write_b128 v242, v[44:47] offset:2048
    v_mfma_f32_16x16x32_bf16 v[84:87], a[64:67], v[168:171], v[84:87]
    v_mfma_f32_16x16x32_bf16 v[88:91], a[48:51], v[164:167], v[88:91]
    buffer_load_dwordx4 v[104:107], v253, s[4:7], s75 offen offset:1024 sc1
    v_mfma_f32_16x16x32_bf16 v[88:91], a[68:71], v[168:171], v[88:91]
    v_mfma_f32_16x16x32_bf16 v[92:95], a[52:55], v[164:167], v[92:95]
    v_mfma_f32_16x16x32_bf16 v[92:95], a[72:75], v[168:171], v[92:95]
    ds_write_b128 v242, v[48:51] offset:3072
    v_mfma_f32_16x16x32_bf16 v[96:99], a[56:59], v[164:167], v[96:99]
    buffer_load_dwordx4 v[108:111], v253, s[4:7], s75 offen offset:2048 sc1
    v_mfma_f32_16x16x32_bf16 v[96:99], a[76:79], v[168:171], v[96:99]
    s_waitcnt vmcnt(11)
    v_mfma_f32_16x16x32_bf16 v[80:83], a[80:83], v[172:175], v[80:83]
    v_mfma_f32_16x16x32_bf16 v[80:83], a[100:103], v[176:179], v[80:83]
    v_mfma_f32_16x16x32_bf16 v[84:87], a[84:87], v[172:175], v[84:87]
    ds_write_b128 v242, v[52:55] offset:4096
    v_mfma_f32_16x16x32_bf16 v[84:87], a[104:107], v[176:179], v[84:87]
    buffer_load_dwordx4 v[112:115], v253, s[4:7], s75 offen offset:3072 sc1
    v_mfma_f32_16x16x32_bf16 v[88:91], a[88:91], v[172:175], v[88:91]
    s_add_u32 s75, s75, 4096
    v_mfma_f32_16x16x32_bf16 v[88:91], a[108:111], v[176:179], v[88:91]
    v_mfma_f32_16x16x32_bf16 v[92:95], a[92:95], v[172:175], v[92:95]
    buffer_load_dwordx4 v[116:119], v253, s[4:7], s75 offen offset:0 sc1
    v_mfma_f32_16x16x32_bf16 v[92:95], a[112:115], v[176:179], v[92:95]
    v_mfma_f32_16x16x32_bf16 v[96:99], a[96:99], v[172:175], v[96:99]
    v_mfma_f32_16x16x32_bf16 v[96:99], a[116:119], v[176:179], v[96:99]
    s_waitcnt vmcnt(11)
    v_mfma_f32_16x16x32_bf16 v[80:83], a[120:123], v[180:183], v[80:83]
    buffer_load_dwordx4 v[120:123], v253, s[4:7], s75 offen offset:1024 sc1
    v_mfma_f32_16x16x32_bf16 v[80:83], a[140:143], v[184:187], v[80:83]
    ds_read_b128 v[232:235], v0 offset:0
    v_mfma_f32_16x16x32_bf16 v[84:87], a[124:127], v[180:183], v[84:87]
    ds_read_b128 v[236:239], v0 offset:1024
    v_mfma_f32_16x16x32_bf16 v[84:87], a[144:147], v[184:187], v[84:87]
    v_mfma_f32_16x16x32_bf16 v[88:91], a[128:131], v[180:183], v[88:91]
    buffer_load_dwordx4 v[124:127], v253, s[4:7], s75 offen offset:2048 sc1
    v_mfma_f32_16x16x32_bf16 v[88:91], a[148:151], v[184:187], v[88:91]
    ds_read_b64 v[240:241], v0 offset:2048
    v_mfma_f32_16x16x32_bf16 v[92:95], a[132:135], v[180:183], v[92:95]
    v_mfma_f32_16x16x32_bf16 v[92:95], a[152:155], v[184:187], v[92:95]
    v_mfma_f32_16x16x32_bf16 v[96:99], a[136:139], v[180:183], v[96:99]
    buffer_load_dwordx4 v[128:131], v253, s[4:7], s75 offen offset:3072 sc1
    v_mfma_f32_16x16x32_bf16 v[96:99], a[156:159], v[184:187], v[96:99]
    s_waitcnt vmcnt(12)
    v_mfma_f32_16x16x32_bf16 v[80:83], a[160:163], v[188:191], v[80:83]
    s_add_u32 s75, s75, 4096
    v_mfma_f32_16x16x32_bf16 v[80:83], a[180:183], v[192:195], v[80:83]
    v_mfma_f32_16x16x32_bf16 v[84:87], a[164:167], v[188:191], v[84:87]
    buffer_load_dwordx4 v[132:135], v253, s[4:7], s75 offen offset:0 sc1
    v_mfma_f32_16x16x32_bf16 v[84:87], a[184:187], v[192:195], v[84:87]
sequential_preLN__softmax_full_mha__glu_gated_bilinear__prompt_kernel_pglate3:
    s_cbranch_execz sequential_preLN__softmax_full_mha__glu_gated_bilinear__prompt_kernel_wrlate
    v_mfma_f32_16x16x32_bf16 v[88:91], a[168:171], v[188:191], v[88:91]
    s_waitcnt lgkmcnt(0)
    v_mfma_f32_16x16x32_bf16 v[88:91], a[188:191], v[192:195], v[88:91]
    v_lshlrev_b32 v16, 16, v232
    v_and_b32 v17, 0xffff0000, v232
    v_mfma_f32_16x16x32_bf16 v[92:95], a[172:175], v[188:191], v[92:95]
    buffer_load_dwordx4 v[136:139], v253, s[4:7], s75 offen offset:1024 sc1
    v_mfma_f32_16x16x32_bf16 v[92:95], a[192:195], v[192:195], v[92:95]
    v_lshlrev_b32 v18, 16, v233
    v_and_b32 v19, 0xffff0000, v233
    v_mfma_f32_16x16x32_bf16 v[96:99], a[176:179], v[188:191], v[96:99]
    v_lshlrev_b32 v20, 16, v234
    v_and_b32 v21, 0xffff0000, v234
    v_mfma_f32_16x16x32_bf16 v[96:99], a[196:199], v[192:195], v[96:99]
    s_waitcnt vmcnt(12)
    v_lshlrev_b32 v22, 16, v235
    v_and_b32 v23, 0xffff0000, v235
    v_mfma_f32_16x16x32_bf16 v[80:83], a[200:203], v[196:199], v[80:83]
    buffer_load_dwordx4 v[140:143], v253, s[4:7], s75 offen offset:2048 sc1
    v_mfma_f32_16x16x32_bf16 v[80:83], a[220:223], v[200:203], v[80:83]
    v_lshlrev_b32 v24, 16, v236
    v_mfma_f32_16x16x32_bf16 v[84:87], a[204:207], v[196:199], v[84:87]
    v_and_b32 v25, 0xffff0000, v236
    v_mfma_f32_16x16x32_bf16 v[84:87], a[224:227], v[200:203], v[84:87]
    v_lshlrev_b32 v26, 16, v237
    v_mfma_f32_16x16x32_bf16 v[88:91], a[208:211], v[196:199], v[88:91]
    buffer_load_dwordx4 v[144:147], v253, s[4:7], s75 offen offset:3072 sc1
    v_mfma_f32_16x16x32_bf16 v[88:91], a[228:231], v[200:203], v[88:91]
    s_add_u32 s75, s75, 4096
    v_and_b32 v27, 0xffff0000, v237
    v_mfma_f32_16x16x32_bf16 v[92:95], a[212:215], v[196:199], v[92:95]
    v_lshlrev_b32 v28, 16, v238
    v_mfma_f32_16x16x32_bf16 v[92:95], a[232:235], v[200:203], v[92:95]
    v_and_b32 v29, 0xffff0000, v238
    v_mfma_f32_16x16x32_bf16 v[96:99], a[216:219], v[196:199], v[96:99]
    buffer_load_dwordx4 v[148:151], v14, s[4:7], s75 offen offset:0 sc1
    v_mfma_f32_16x16x32_bf16 v[96:99], a[236:239], v[200:203], v[96:99]
    s_waitcnt vmcnt(13)
    v_lshlrev_b32 v30, 16, v239
    v_mfma_f32_16x16x32_bf16 v[80:83], a[240:243], v[56:59], v[80:83]
    v_and_b32 v31, 0xffff0000, v239
    v_mfma_f32_16x16x32_bf16 v[80:83], v[68:71], v[60:63], v[80:83]
    v_lshlrev_b32 v32, 16, v240
    v_mfma_f32_16x16x32_bf16 v[84:87], a[244:247], v[56:59], v[84:87]
    buffer_load_dwordx4 v[152:155], v14, s[4:7], s75 offen offset:1024 sc1
    v_mfma_f32_16x16x32_bf16 v[84:87], v[72:75], v[60:63], v[84:87]
    v_and_b32 v33, 0xffff0000, v240
    v_mfma_f32_16x16x32_bf16 v[88:91], a[248:251], v[56:59], v[88:91]
    v_lshlrev_b32 v34, 16, v241
    v_mfma_f32_16x16x32_bf16 v[88:91], v[76:79], v[60:63], v[88:91]
    v_and_b32 v35, 0xffff0000, v241
    v_mfma_f32_16x16x32_bf16 v[92:95], a[252:255], v[56:59], v[92:95]
    buffer_load_dwordx4 v[156:159], v253, s[4:7], s72 offen offset:0 sc1
    v_mfma_f32_16x16x32_bf16 v[92:95], v[224:227], v[60:63], v[92:95]
    v_lshrrev_b32 v13, 4, v1
    v_mfma_f32_16x16x32_bf16 v[96:99], v[64:67], v[56:59], v[96:99]
    v_lshlrev_b32 v13, 3, v13
    v_mfma_f32_16x16x32_bf16 v[96:99], v[228:231], v[60:63], v[96:99]
    s_waitcnt vmcnt(13)
    v_sub_u32 v13, v246, v13
    v_mfma_f32_16x16x32_bf16 v[204:207], a[0:3], v[100:103], 0
    buffer_load_dwordx4 v[160:163], v253, s[4:7], s72 offen offset:1024 sc1
    v_mfma_f32_16x16x32_bf16 v[204:207], a[20:23], v[104:107], v[204:207]
    v_mfma_f32_16x16x32_bf16 v[208:211], a[4:7], v[100:103], 0
    ds_write_b128 v243, v[80:83] offset:0
    v_mfma_f32_16x16x32_bf16 v[208:211], a[24:27], v[104:107], v[208:211]
    v_mfma_f32_16x16x32_bf16 v[212:215], a[8:11], v[100:103], 0
    buffer_load_dwordx4 v[164:167], v253, s[4:7], s72 offen offset:2048 sc1
    v_mfma_f32_16x16x32_bf16 v[212:215], a[28:31], v[104:107], v[212:215]
    v_mfma_f32_16x16x32_bf16 v[216:219], a[12:15], v[100:103], 0
    v_mfma_f32_16x16x32_bf16 v[216:219], a[32:35], v[104:107], v[216:219]
    ds_write_b128 v243, v[84:87] offset:1024
    v_mfma_f32_16x16x32_bf16 v[220:223], a[16:19], v[100:103], 0
    buffer_load_dwordx4 v[168:171], v253, s[4:7], s72 offen offset:3072 sc1
    v_mfma_f32_16x16x32_bf16 v[220:223], a[36:39], v[104:107], v[220:223]
    s_waitcnt vmcnt(14)
    v_mfma_f32_16x16x32_bf16 v[204:207], a[40:43], v[108:111], v[204:207]
    s_add_u32 s72, s72, 4096
    v_mfma_f32_16x16x32_bf16 v[204:207], a[60:63], v[112:115], v[204:207]
    v_mfma_f32_16x16x32_bf16 v[208:211], a[44:47], v[108:111], v[208:211]
    ds_write_b128 v243, v[88:91] offset:2048
    v_mfma_f32_16x16x32_bf16 v[208:211], a[64:67], v[112:115], v[208:211]
    buffer_load_dwordx4 v[172:175], v253, s[4:7], s72 offen offset:0 sc1
    v_mfma_f32_16x16x32_bf16 v[212:215], a[48:51], v[108:111], v[212:215]
    v_mfma_f32_16x16x32_bf16 v[212:215], a[68:71], v[112:115], v[212:215]
    v_mfma_f32_16x16x32_bf16 v[216:219], a[52:55], v[108:111], v[216:219]
    buffer_load_dwordx4 v[176:179], v253, s[4:7], s72 offen offset:1024 sc1
    v_mfma_f32_16x16x32_bf16 v[216:219], a[72:75], v[112:115], v[216:219]
    ds_write_b128 v243, v[92:95] offset:3072
    v_mfma_f32_16x16x32_bf16 v[220:223], a[56:59], v[108:111], v[220:223]
    v_mfma_f32_16x16x32_bf16 v[220:223], a[76:79], v[112:115], v[220:223]
    s_waitcnt vmcnt(14)
    v_mfma_f32_16x16x32_bf16 v[204:207], a[80:83], v[116:119], v[204:207]
    buffer_load_dwordx4 v[180:183], v253, s[4:7], s72 offen offset:2048 sc1
    v_mfma_f32_16x16x32_bf16 v[204:207], a[100:103], v[120:123], v[204:207]
    v_mfma_f32_16x16x32_bf16 v[208:211], a[84:87], v[116:119], v[208:211]
    ds_write_b128 v243, v[96:99] offset:4096
    v_mfma_f32_16x16x32_bf16 v[208:211], a[104:107], v[120:123], v[208:211]
    v_mfma_f32_16x16x32_bf16 v[212:215], a[88:91], v[116:119], v[212:215]
    buffer_load_dwordx4 v[184:187], v253, s[4:7], s72 offen offset:3072 sc1
    v_mfma_f32_16x16x32_bf16 v[212:215], a[108:111], v[120:123], v[212:215]
    s_add_u32 s72, s72, 4096
    v_mfma_f32_16x16x32_bf16 v[216:219], a[92:95], v[116:119], v[216:219]
    v_mfma_f32_16x16x32_bf16 v[216:219], a[112:115], v[120:123], v[216:219]
    v_mfma_f32_16x16x32_bf16 v[220:223], a[96:99], v[116:119], v[220:223]
    buffer_load_dwordx4 v[188:191], v253, s[4:7], s72 offen offset:0 sc1
    v_mfma_f32_16x16x32_bf16 v[220:223], a[116:119], v[120:123], v[220:223]
    s_waitcnt vmcnt(15)
    v_mfma_f32_16x16x32_bf16 v[204:207], a[120:123], v[124:127], v[204:207]
    v_mfma_f32_16x16x32_bf16 v[204:207], a[140:143], v[128:131], v[204:207]
    v_mfma_f32_16x16x32_bf16 v[208:211], a[124:127], v[124:127], v[208:211]
    buffer_load_dwordx4 v[192:195], v253, s[4:7], s72 offen offset:1024 sc1
    v_mfma_f32_16x16x32_bf16 v[208:211], a[144:147], v[128:131], v[208:211]
    v_mfma_f32_16x16x32_bf16 v[212:215], a[128:131], v[124:127], v[212:215]
    v_mfma_f32_16x16x32_bf16 v[212:215], a[148:151], v[128:131], v[212:215]
    v_mfma_f32_16x16x32_bf16 v[216:219], a[132:135], v[124:127], v[216:219]
    buffer_load_dwordx4 v[196:199], v253, s[4:7], s72 offen offset:2048 sc1
    v_mfma_f32_16x16x32_bf16 v[216:219], a[152:155], v[128:131], v[216:219]
    v_mfma_f32_16x16x32_bf16 v[220:223], a[136:139], v[124:127], v[220:223]
    v_mfma_f32_16x16x32_bf16 v[220:223], a[156:159], v[128:131], v[220:223]
    s_waitcnt vmcnt(15)
    v_mfma_f32_16x16x32_bf16 v[204:207], a[160:163], v[132:135], v[204:207]
    buffer_load_dwordx4 v[200:203], v253, s[4:7], s72 offen offset:3072 sc1
    v_mfma_f32_16x16x32_bf16 v[204:207], a[180:183], v[136:139], v[204:207]
    s_add_u32 s72, s72, 4096
    v_mfma_f32_16x16x32_bf16 v[208:211], a[164:167], v[132:135], v[208:211]
    v_mfma_f32_16x16x32_bf16 v[208:211], a[184:187], v[136:139], v[208:211]
    v_mfma_f32_16x16x32_bf16 v[212:215], a[168:171], v[132:135], v[212:215]
    buffer_load_dwordx4 v[56:59], v14, s[4:7], s72 offen offset:0 sc1
    v_mfma_f32_16x16x32_bf16 v[212:215], a[188:191], v[136:139], v[212:215]
    v_mfma_f32_16x16x32_bf16 v[216:219], a[172:175], v[132:135], v[216:219]
    v_mfma_f32_16x16x32_bf16 v[216:219], a[192:195], v[136:139], v[216:219]
    v_mfma_f32_16x16x32_bf16 v[220:223], a[176:179], v[132:135], v[220:223]
    buffer_load_dwordx4 v[60:63], v14, s[4:7], s72 offen offset:1024 sc1
    v_mfma_f32_16x16x32_bf16 v[220:223], a[196:199], v[136:139], v[220:223]
    s_waitcnt vmcnt(16)
    v_mfma_f32_16x16x32_bf16 v[204:207], a[200:203], v[140:143], v[204:207]
    v_mfma_f32_16x16x32_bf16 v[204:207], a[220:223], v[144:147], v[204:207]
    v_mfma_f32_16x16x32_bf16 v[208:211], a[204:207], v[140:143], v[208:211]
    v_mfma_f32_16x16x32_bf16 v[208:211], a[224:227], v[144:147], v[208:211]
    v_mfma_f32_16x16x32_bf16 v[212:215], a[208:211], v[140:143], v[212:215]
    v_mfma_f32_16x16x32_bf16 v[212:215], a[228:231], v[144:147], v[212:215]
    v_mfma_f32_16x16x32_bf16 v[216:219], a[212:215], v[140:143], v[216:219]
    v_mfma_f32_16x16x32_bf16 v[216:219], a[232:235], v[144:147], v[216:219]
    v_mfma_f32_16x16x32_bf16 v[220:223], a[216:219], v[140:143], v[220:223]
    v_mfma_f32_16x16x32_bf16 v[220:223], a[236:239], v[144:147], v[220:223]
    s_waitcnt vmcnt(14)
    v_mfma_f32_16x16x32_bf16 v[204:207], a[240:243], v[148:151], v[204:207]
    s_mov_b32 s37, 1073741824
    s_cmp_eq_u32 s88, 0
    s_cbranch_scc1 L_wbk_39
    buffer_load_dword v248, off, s[4:7], s37
L_wbd_40:
    v_mfma_f32_16x16x32_bf16 v[204:207], v[68:71], v[152:155], v[204:207]
    v_mfma_f32_16x16x32_bf16 v[208:211], a[244:247], v[148:151], v[208:211]
    v_mfma_f32_16x16x32_bf16 v[208:211], v[72:75], v[152:155], v[208:211]
    v_mfma_f32_16x16x32_bf16 v[212:215], a[248:251], v[148:151], v[212:215]
    v_mfma_f32_16x16x32_bf16 v[212:215], v[76:79], v[152:155], v[212:215]
    v_mfma_f32_16x16x32_bf16 v[216:219], a[252:255], v[148:151], v[216:219]
    v_mfma_f32_16x16x32_bf16 v[216:219], v[224:227], v[152:155], v[216:219]
    v_mfma_f32_16x16x32_bf16 v[220:223], v[64:67], v[148:151], v[220:223]
    v_mfma_f32_16x16x32_bf16 v[220:223], v[228:231], v[152:155], v[220:223]
    s_waitcnt vmcnt(13)
    v_mfma_f32_16x16x32_bf16 v[16:19], a[0:3], v[156:159], v[16:19]
    v_mfma_f32_16x16x32_bf16 v[16:19], a[20:23], v[160:163], v[16:19]
    v_mfma_f32_16x16x32_bf16 v[20:23], a[4:7], v[156:159], v[20:23]
    ds_write_b128 v244, v[204:207] offset:0
    v_mfma_f32_16x16x32_bf16 v[20:23], a[24:27], v[160:163], v[20:23]
    v_mfma_f32_16x16x32_bf16 v[24:27], a[8:11], v[156:159], v[24:27]
    v_mfma_f32_16x16x32_bf16 v[24:27], a[28:31], v[160:163], v[24:27]
    v_mfma_f32_16x16x32_bf16 v[28:31], a[12:15], v[156:159], v[28:31]
    v_mfma_f32_16x16x32_bf16 v[28:31], a[32:35], v[160:163], v[28:31]
    ds_write_b128 v244, v[208:211] offset:1024
    v_mfma_f32_16x16x32_bf16 v[32:35], a[16:19], v[156:159], v[32:35]
    v_mfma_f32_16x16x32_bf16 v[32:35], a[36:39], v[160:163], v[32:35]
    s_waitcnt vmcnt(11)
    v_mfma_f32_16x16x32_bf16 v[16:19], a[40:43], v[164:167], v[16:19]
    v_mfma_f32_16x16x32_bf16 v[16:19], a[60:63], v[168:171], v[16:19]
    v_mfma_f32_16x16x32_bf16 v[20:23], a[44:47], v[164:167], v[20:23]
    ds_write_b128 v244, v[212:215] offset:2048
    v_mfma_f32_16x16x32_bf16 v[20:23], a[64:67], v[168:171], v[20:23]
    v_mfma_f32_16x16x32_bf16 v[24:27], a[48:51], v[164:167], v[24:27]
    v_mfma_f32_16x16x32_bf16 v[24:27], a[68:71], v[168:171], v[24:27]
    v_mfma_f32_16x16x32_bf16 v[28:31], a[52:55], v[164:167], v[28:31]
    v_mfma_f32_16x16x32_bf16 v[28:31], a[72:75], v[168:171], v[28:31]
    ds_write_b128 v244, v[216:219] offset:3072
    v_mfma_f32_16x16x32_bf16 v[32:35], a[56:59], v[164:167], v[32:35]
    v_mfma_f32_16x16x32_bf16 v[32:35], a[76:79], v[168:171], v[32:35]
    s_waitcnt vmcnt(9)
    v_mfma_f32_16x16x32_bf16 v[16:19], a[80:83], v[172:175], v[16:19]
    v_mfma_f32_16x16x32_bf16 v[16:19], a[100:103], v[176:179], v[16:19]
    v_mfma_f32_16x16x32_bf16 v[20:23], a[84:87], v[172:175], v[20:23]
    ds_write_b128 v244, v[220:223] offset:4096
    v_mfma_f32_16x16x32_bf16 v[20:23], a[104:107], v[176:179], v[20:23]
    v_mfma_f32_16x16x32_bf16 v[24:27], a[88:91], v[172:175], v[24:27]
    v_mfma_f32_16x16x32_bf16 v[24:27], a[108:111], v[176:179], v[24:27]
    v_mfma_f32_16x16x32_bf16 v[28:31], a[92:95], v[172:175], v[28:31]
    s_waitcnt lgkmcnt(0)
    s_barrier
    v_mfma_f32_16x16x32_bf16 v[28:31], a[112:115], v[176:179], v[28:31]
    ds_read_b128 v[36:39], v245 offset:0
    v_mfma_f32_16x16x32_bf16 v[32:35], a[96:99], v[172:175], v[32:35]
    ds_read_b128 v[40:43], v245 offset:1024
    v_mfma_f32_16x16x32_bf16 v[32:35], a[116:119], v[176:179], v[32:35]
    s_waitcnt vmcnt(7)
    ds_read_b128 v[44:47], v245 offset:2048
    v_mfma_f32_16x16x32_bf16 v[16:19], a[120:123], v[180:183], v[16:19]
    ds_read_b128 v[48:51], v245 offset:3072
    v_mfma_f32_16x16x32_bf16 v[16:19], a[140:143], v[184:187], v[16:19]
    ds_read_b128 v[52:55], v245 offset:4096
    v_mfma_f32_16x16x32_bf16 v[20:23], a[124:127], v[180:183], v[20:23]
    ds_read_b128 v[80:83], v245 offset:5120
    v_mfma_f32_16x16x32_bf16 v[20:23], a[144:147], v[184:187], v[20:23]
    ds_read_b128 v[84:87], v245 offset:6144
    v_mfma_f32_16x16x32_bf16 v[24:27], a[128:131], v[180:183], v[24:27]
    ds_read_b128 v[88:91], v245 offset:7168
    v_mfma_f32_16x16x32_bf16 v[24:27], a[148:151], v[184:187], v[24:27]
    ds_read_b128 v[92:95], v245 offset:8192
    v_mfma_f32_16x16x32_bf16 v[28:31], a[132:135], v[180:183], v[28:31]
    ds_read_b128 v[96:99], v245 offset:9216
    v_mfma_f32_16x16x32_bf16 v[28:31], a[152:155], v[184:187], v[28:31]
    ds_read_b128 v[204:207], v245 offset:10240
    v_mfma_f32_16x16x32_bf16 v[32:35], a[136:139], v[180:183], v[32:35]
    ds_read_b128 v[208:211], v245 offset:11264
    v_mfma_f32_16x16x32_bf16 v[32:35], a[156:159], v[184:187], v[32:35]
    s_waitcnt vmcnt(5)
    ds_read_b128 v[212:215], v245 offset:12288
    v_mfma_f32_16x16x32_bf16 v[16:19], a[160:163], v[188:191], v[16:19]
    ds_read_b128 v[216:219], v245 offset:13312
    v_mfma_f32_16x16x32_bf16 v[16:19], a[180:183], v[192:195], v[16:19]
    ds_read_b128 v[220:223], v245 offset:14336
    v_mfma_f32_16x16x32_bf16 v[20:23], a[164:167], v[188:191], v[20:23]
    v_mfma_f32_16x16x32_bf16 v[20:23], a[184:187], v[192:195], v[20:23]
    s_waitcnt lgkmcnt(5)
    v_mfma_f32_16x16x32_bf16 v[24:27], a[168:171], v[188:191], v[24:27]
    v_add_f32 v36, v36, v80
    v_add_f32 v37, v37, v81
    v_mfma_f32_16x16x32_bf16 v[24:27], a[188:191], v[192:195], v[24:27]
    v_add_f32 v38, v38, v82
    v_add_f32 v39, v39, v83
    v_mfma_f32_16x16x32_bf16 v[28:31], a[172:175], v[188:191], v[28:31]
    v_add_f32 v40, v40, v84
    v_add_f32 v41, v41, v85
    v_mfma_f32_16x16x32_bf16 v[28:31], a[192:195], v[192:195], v[28:31]
    v_add_f32 v42, v42, v86
    v_add_f32 v43, v43, v87
    v_mfma_f32_16x16x32_bf16 v[32:35], a[176:179], v[188:191], v[32:35]
    v_add_f32 v44, v44, v88
    v_add_f32 v45, v45, v89
    v_mfma_f32_16x16x32_bf16 v[32:35], a[196:199], v[192:195], v[32:35]
    s_waitcnt vmcnt(3)
    v_add_f32 v46, v46, v90
    v_add_f32 v47, v47, v91
    v_mfma_f32_16x16x32_bf16 v[16:19], a[200:203], v[196:199], v[16:19]
    v_add_f32 v48, v48, v92
    v_add_f32 v49, v49, v93
    v_mfma_f32_16x16x32_bf16 v[16:19], a[220:223], v[200:203], v[16:19]
    v_add_f32 v50, v50, v94
    v_add_f32 v51, v51, v95
    v_mfma_f32_16x16x32_bf16 v[20:23], a[204:207], v[196:199], v[20:23]
    v_add_f32 v52, v52, v96
    v_mfma_f32_16x16x32_bf16 v[20:23], a[224:227], v[200:203], v[20:23]
    v_add_f32 v53, v53, v97
    v_mfma_f32_16x16x32_bf16 v[24:27], a[208:211], v[196:199], v[24:27]
    v_add_f32 v54, v54, v98
    v_mfma_f32_16x16x32_bf16 v[24:27], a[228:231], v[200:203], v[24:27]
    s_waitcnt lgkmcnt(0)
    v_add_f32 v55, v55, v99
    v_mfma_f32_16x16x32_bf16 v[28:31], a[212:215], v[196:199], v[28:31]
    v_add_f32 v36, v36, v204
    v_add_f32 v37, v37, v205
    v_mfma_f32_16x16x32_bf16 v[28:31], a[232:235], v[200:203], v[28:31]
    v_add_f32 v38, v38, v206
    v_add_f32 v39, v39, v207
    v_mfma_f32_16x16x32_bf16 v[32:35], a[216:219], v[196:199], v[32:35]
    v_add_f32 v40, v40, v208
    v_add_f32 v41, v41, v209
    v_mfma_f32_16x16x32_bf16 v[32:35], a[236:239], v[200:203], v[32:35]
    s_waitcnt vmcnt(1)
    v_add_f32 v42, v42, v210
    v_add_f32 v43, v43, v211
    v_mfma_f32_16x16x32_bf16 v[16:19], a[240:243], v[56:59], v[16:19]
    v_add_f32 v44, v44, v212
    v_add_f32 v45, v45, v213
    v_mfma_f32_16x16x32_bf16 v[16:19], v[68:71], v[60:63], v[16:19]
    v_add_f32 v46, v46, v214
    v_add_f32 v47, v47, v215
    v_mfma_f32_16x16x32_bf16 v[20:23], a[244:247], v[56:59], v[20:23]
    v_add_f32 v48, v48, v216
    v_mfma_f32_16x16x32_bf16 v[20:23], v[72:75], v[60:63], v[20:23]
    v_add_f32 v49, v49, v217
    v_mfma_f32_16x16x32_bf16 v[24:27], a[248:251], v[56:59], v[24:27]
    v_add_f32 v50, v50, v218
    v_mfma_f32_16x16x32_bf16 v[24:27], v[76:79], v[60:63], v[24:27]
    v_add_f32 v51, v51, v219
    v_mfma_f32_16x16x32_bf16 v[28:31], a[252:255], v[56:59], v[28:31]
    v_add_f32 v52, v52, v220
    v_mfma_f32_16x16x32_bf16 v[28:31], v[224:227], v[60:63], v[28:31]
    v_add_f32 v53, v53, v221
    v_mfma_f32_16x16x32_bf16 v[32:35], v[64:67], v[56:59], v[32:35]
    v_add_f32 v54, v54, v222
    v_mfma_f32_16x16x32_bf16 v[32:35], v[228:231], v[60:63], v[32:35]
    v_add_f32 v55, v55, v223
    s_nop 1
    v_pk_add_f32 v[16:17], v[16:17], v[36:37]
    v_pk_add_f32 v[18:19], v[18:19], v[38:39]
    v_pk_add_f32 v[20:21], v[20:21], v[40:41]
    v_pk_add_f32 v[22:23], v[22:23], v[42:43]
    v_pk_add_f32 v[24:25], v[24:25], v[44:45]
    v_pk_add_f32 v[26:27], v[26:27], v[46:47]
    v_pk_add_f32 v[28:29], v[28:29], v[48:49]
    v_pk_add_f32 v[30:31], v[30:31], v[50:51]
    v_pk_add_f32 v[32:33], v[32:33], v[52:53]
    v_pk_add_f32 v[34:35], v[34:35], v[54:55]
    v_cvt_pk_bf16_f32 v232, v16, v17
    v_cvt_pk_bf16_f32 v233, v18, v19
    v_cvt_pk_bf16_f32 v234, v20, v21
    v_cvt_pk_bf16_f32 v235, v22, v23
    v_cvt_pk_bf16_f32 v236, v24, v25
    v_cvt_pk_bf16_f32 v237, v26, v27
    v_cvt_pk_bf16_f32 v238, v28, v29
    v_cvt_pk_bf16_f32 v239, v30, v31
    v_cvt_pk_bf16_f32 v240, v32, v33
    v_cvt_pk_bf16_f32 v241, v34, v35
    buffer_store_dwordx4 v[232:235], v246, s[12:15], s51 offen
    buffer_store_dwordx4 v[236:239], v246, s[12:15], s51 offen offset:64
    buffer_store_dwordx2 v[240:241], v13, s[12:15], s61 offen
    s_endpgm
sequential_preLN__softmax_full_mha__glu_gated_bilinear__prompt_kernel_frspin:
    s_mov_b32 s58, 200000
L_poll_41:
    buffer_load_dwordx4 v[216:219], v11, s[4:7], s101 offen sc1
L_poll_41w:
    s_waitcnt vmcnt(0)
    v_min_u32 v216, v216, v217
    v_min_u32 v216, v216, v218
    v_min_u32 v216, v216, v219
    v_cmp_eq_u32 vcc, 0, v216
    s_sub_u32 s58, s58, 1
    s_cbranch_scc1 L_pollout_42
    s_cbranch_vccz L_pollout_42
    s_sleep 8
    s_branch L_poll_41
L_pollout_42:
    s_branch sequential_preLN__softmax_full_mha__glu_gated_bilinear__prompt_kernel_frok
sequential_preLN__softmax_full_mha__glu_gated_bilinear__prompt_kernel_aslow:
    s_cmp_lg_u32 s32, 0
    s_cbranch_scc1 sequential_preLN__softmax_full_mha__glu_gated_bilinear__prompt_kernel_afin
    s_mov_b32 s32, 1
    s_mov_b32 s72, 0
    s_mov_b32 s74, 0
    v_mov_b32 v12, 0xff800000
    v_mov_b32 v13, 0xff800000
sequential_preLN__softmax_full_mha__glu_gated_bilinear__prompt_kernel_mloop:
    buffer_load_dwordx2 a[184:185], v137, s[12:15], s74 offen sc1
    s_add_u32 s74, s74, 5120
    buffer_load_dwordx4 a[136:139], v136, s[12:15], s72 offen offset:0 sc1
    buffer_load_dwordx4 a[140:143], v136, s[12:15], s72 offen offset:2560 sc1
    s_add_u32 s72, s72, 5120
    s_waitcnt vmcnt(0)
    v_mfma_f32_32x32x4_2b_bf16 v[16:47], a[184:185], a[128:129], 0 cbsz:1 abid:0
    s_nop 15
    s_nop 1
    v_mfma_f32_32x32x16_bf16 v[16:31], a[136:139], a[96:99], v[16:31]
    v_mfma_f32_32x32x16_bf16 v[32:47], a[136:139], a[100:103], v[32:47]
    s_nop 11
    v_max3_f32 v12, v12, v16, v17
    v_max3_f32 v12, v12, v18, v19
    v_max3_f32 v12, v12, v20, v21
    v_max3_f32 v12, v12, v22, v23
    v_max3_f32 v12, v12, v24, v25
    v_max3_f32 v12, v12, v26, v27
    v_max3_f32 v12, v12, v28, v29
    v_max3_f32 v12, v12, v30, v31
    v_max3_f32 v13, v13, v32, v33
    v_max3_f32 v13, v13, v34, v35
    v_max3_f32 v13, v13, v36, v37
    v_max3_f32 v13, v13, v38, v39
    v_max3_f32 v13, v13, v40, v41
    v_max3_f32 v13, v13, v42, v43
    v_max3_f32 v13, v13, v44, v45
    v_max3_f32 v13, v13, v46, v47
    v_mfma_f32_32x32x4_2b_bf16 v[16:47], a[184:185], a[128:129], 0 cbsz:1 abid:1
    s_nop 15
    s_nop 1
    v_mfma_f32_32x32x16_bf16 v[16:31], a[140:143], a[96:99], v[16:31]
    v_mfma_f32_32x32x16_bf16 v[32:47], a[140:143], a[100:103], v[32:47]
    s_nop 11
    v_max3_f32 v12, v12, v16, v17
    v_max3_f32 v12, v12, v18, v19
    v_max3_f32 v12, v12, v20, v21
    v_max3_f32 v12, v12, v22, v23
    v_max3_f32 v12, v12, v24, v25
    v_max3_f32 v12, v12, v26, v27
    v_max3_f32 v12, v12, v28, v29
    v_max3_f32 v12, v12, v30, v31
    v_max3_f32 v13, v13, v32, v33
    v_max3_f32 v13, v13, v34, v35
    v_max3_f32 v13, v13, v36, v37
    v_max3_f32 v13, v13, v38, v39
    v_max3_f32 v13, v13, v40, v41
    v_max3_f32 v13, v13, v42, v43
    v_max3_f32 v13, v13, v44, v45
    v_max3_f32 v13, v13, v46, v47
    s_cmp_lt_u32 s72, 163840
    s_cbranch_scc1 sequential_preLN__softmax_full_mha__glu_gated_bilinear__prompt_kernel_mloop
    v_mov_b32 v14, v12
    v_mov_b32 v15, v13
    s_nop 1
    v_permlane32_swap_b32 v12, v14
    v_permlane32_swap_b32 v13, v15
    s_nop 1
    v_max_f32 v12, v12, v14
    v_max_f32 v13, v13, v15
    v_sub_f32 v48, 0, v12
    v_mov_b32 v104, 0
    v_sub_f32 v49, 0, v12
    v_mov_b32 v105, 0
    v_sub_f32 v50, 0, v12
    v_mov_b32 v106, 0
    v_sub_f32 v51, 0, v12
    v_mov_b32 v107, 0
    v_sub_f32 v52, 0, v12
    v_mov_b32 v108, 0
    v_sub_f32 v53, 0, v12
    v_mov_b32 v109, 0
    v_sub_f32 v54, 0, v12
    v_mov_b32 v110, 0
    v_sub_f32 v55, 0, v12
    v_mov_b32 v111, 0
    v_sub_f32 v56, 0, v12
    v_mov_b32 v112, 0
    v_sub_f32 v57, 0, v12
    v_mov_b32 v113, 0
    v_sub_f32 v58, 0, v12
    v_mov_b32 v114, 0
    v_sub_f32 v59, 0, v12
    v_mov_b32 v115, 0
    v_sub_f32 v60, 0, v12
    v_mov_b32 v116, 0
    v_sub_f32 v61, 0, v12
    v_mov_b32 v117, 0
    v_sub_f32 v62, 0, v12
    v_mov_b32 v118, 0
    v_sub_f32 v63, 0, v12
    v_mov_b32 v119, 0
    v_sub_f32 v64, 0, v13
    v_mov_b32 v120, 0
    v_sub_f32 v65, 0, v13
    v_mov_b32 v121, 0
    v_sub_f32 v66, 0, v13
    v_mov_b32 v122, 0
    v_sub_f32 v67, 0, v13
    v_mov_b32 v123, 0
    v_sub_f32 v68, 0, v13
    v_mov_b32 v124, 0
    v_sub_f32 v69, 0, v13
    v_mov_b32 v125, 0
    v_sub_f32 v70, 0, v13
    v_mov_b32 v126, 0
    v_sub_f32 v71, 0, v13
    v_mov_b32 v127, 0
    v_sub_f32 v72, 0, v13
    v_mov_b32 v128, 0
    v_sub_f32 v73, 0, v13
    v_mov_b32 v129, 0
    v_sub_f32 v74, 0, v13
    v_mov_b32 v130, 0
    v_sub_f32 v75, 0, v13
    v_mov_b32 v131, 0
    v_sub_f32 v76, 0, v13
    v_mov_b32 v132, 0
    v_sub_f32 v77, 0, v13
    v_mov_b32 v133, 0
    v_sub_f32 v78, 0, v13
    v_mov_b32 v134, 0
    v_sub_f32 v79, 0, v13
    v_mov_b32 v135, 0
    s_mov_b32 s72, 0
    s_mov_b32 s74, 0
    s_add_u32 s73, s23, 655360
sequential_preLN__softmax_full_mha__glu_gated_bilinear__prompt_kernel_sloop:
    buffer_load_dwordx2 a[184:185], v137, s[12:15], s74 offen sc1
    s_add_u32 s74, s74, 5120
    buffer_load_dwordx4 a[136:139], v136, s[12:15], s72 offen offset:0 sc1
    buffer_load_dwordx4 a[140:143], v136, s[12:15], s72 offen offset:2560 sc1
    s_add_u32 s72, s72, 5120
    buffer_load_dwordx4 a[152:155], v138, s[4:7], s73 offen offset:0 sc1
    buffer_load_dwordx4 a[156:159], v138, s[4:7], s73 offen offset:2560 sc1
    s_add_u32 s73, s73, 5120
    buffer_load_dwordx4 a[160:163], v138, s[4:7], s73 offen offset:0 sc1
    buffer_load_dwordx4 a[164:167], v138, s[4:7], s73 offen offset:2560 sc1
    s_add_u32 s73, s73, 5120
    s_waitcnt vmcnt(0)
    v_mfma_f32_32x32x4_2b_bf16 v[16:47], a[184:185], a[128:129], v[48:79] cbsz:1 abid:0
    s_nop 15
    s_nop 1
    v_mfma_f32_32x32x16_bf16 v[16:31], a[136:139], a[96:99], v[16:31]
    v_mfma_f32_32x32x16_bf16 v[32:47], a[136:139], a[100:103], v[32:47]
    s_nop 11
    v_exp_f32 v16, v16
    v_exp_f32 v17, v17
    v_exp_f32 v18, v18
    v_exp_f32 v19, v19
    v_exp_f32 v20, v20
    v_exp_f32 v21, v21
    v_exp_f32 v22, v22
    v_exp_f32 v23, v23
    v_exp_f32 v24, v24
    v_exp_f32 v25, v25
    v_exp_f32 v26, v26
    v_exp_f32 v27, v27
    v_exp_f32 v28, v28
    v_exp_f32 v29, v29
    v_exp_f32 v30, v30
    v_exp_f32 v31, v31
    v_exp_f32 v32, v32
    v_exp_f32 v33, v33
    v_exp_f32 v34, v34
    v_exp_f32 v35, v35
    v_exp_f32 v36, v36
    v_exp_f32 v37, v37
    v_exp_f32 v38, v38
    v_exp_f32 v39, v39
    v_exp_f32 v40, v40
    v_exp_f32 v41, v41
    v_exp_f32 v42, v42
    v_exp_f32 v43, v43
    v_exp_f32 v44, v44
    v_exp_f32 v45, v45
    v_exp_f32 v46, v46
    v_exp_f32 v47, v47
    s_nop 0
    v_cvt_pk_bf16_f32 v80, v16, v17
    v_cvt_pk_bf16_f32 v81, v18, v19
    v_cvt_pk_bf16_f32 v82, v20, v21
    v_cvt_pk_bf16_f32 v83, v22, v23
    v_cvt_pk_bf16_f32 v84, v24, v25
    v_cvt_pk_bf16_f32 v85, v26, v27
    v_cvt_pk_bf16_f32 v86, v28, v29
    v_cvt_pk_bf16_f32 v87, v30, v31
    v_cvt_pk_bf16_f32 v88, v32, v33
    v_cvt_pk_bf16_f32 v89, v34, v35
    v_cvt_pk_bf16_f32 v90, v36, v37
    v_cvt_pk_bf16_f32 v91, v38, v39
    v_cvt_pk_bf16_f32 v92, v40, v41
    v_cvt_pk_bf16_f32 v93, v42, v43
    v_cvt_pk_bf16_f32 v94, v44, v45
    v_cvt_pk_bf16_f32 v95, v46, v47
    s_nop 1
    v_mfma_f32_32x32x16_bf16 v[104:119], a[152:155], v[80:83], v[104:119]
    v_mfma_f32_32x32x16_bf16 v[104:119], a[156:159], v[84:87], v[104:119]
    v_mfma_f32_32x32x16_bf16 v[120:135], a[152:155], v[88:91], v[120:135]
    v_mfma_f32_32x32x16_bf16 v[120:135], a[156:159], v[92:95], v[120:135]
    v_mfma_f32_32x32x4_2b_bf16 v[16:47], a[184:185], a[128:129], v[48:79] cbsz:1 abid:1
    s_nop 15
    s_nop 1
    v_mfma_f32_32x32x16_bf16 v[16:31], a[140:143], a[96:99], v[16:31]
    v_mfma_f32_32x32x16_bf16 v[32:47], a[140:143], a[100:103], v[32:47]
    s_nop 11
    v_exp_f32 v16, v16
    v_exp_f32 v17, v17
    v_exp_f32 v18, v18
    v_exp_f32 v19, v19
    v_exp_f32 v20, v20
    v_exp_f32 v21, v21
    v_exp_f32 v22, v22
    v_exp_f32 v23, v23
    v_exp_f32 v24, v24
    v_exp_f32 v25, v25
    v_exp_f32 v26, v26
    v_exp_f32 v27, v27
    v_exp_f32 v28, v28
    v_exp_f32 v29, v29
    v_exp_f32 v30, v30
    v_exp_f32 v31, v31
    v_exp_f32 v32, v32
    v_exp_f32 v33, v33
    v_exp_f32 v34, v34
    v_exp_f32 v35, v35
    v_exp_f32 v36, v36
    v_exp_f32 v37, v37
    v_exp_f32 v38, v38
    v_exp_f32 v39, v39
    v_exp_f32 v40, v40
    v_exp_f32 v41, v41
    v_exp_f32 v42, v42
    v_exp_f32 v43, v43
    v_exp_f32 v44, v44
    v_exp_f32 v45, v45
    v_exp_f32 v46, v46
    v_exp_f32 v47, v47
    s_nop 0
    v_cvt_pk_bf16_f32 v80, v16, v17
    v_cvt_pk_bf16_f32 v81, v18, v19
    v_cvt_pk_bf16_f32 v82, v20, v21
    v_cvt_pk_bf16_f32 v83, v22, v23
    v_cvt_pk_bf16_f32 v84, v24, v25
    v_cvt_pk_bf16_f32 v85, v26, v27
    v_cvt_pk_bf16_f32 v86, v28, v29
    v_cvt_pk_bf16_f32 v87, v30, v31
    v_cvt_pk_bf16_f32 v88, v32, v33
    v_cvt_pk_bf16_f32 v89, v34, v35
    v_cvt_pk_bf16_f32 v90, v36, v37
    v_cvt_pk_bf16_f32 v91, v38, v39
    v_cvt_pk_bf16_f32 v92, v40, v41
    v_cvt_pk_bf16_f32 v93, v42, v43
    v_cvt_pk_bf16_f32 v94, v44, v45
    v_cvt_pk_bf16_f32 v95, v46, v47
    s_nop 1
    v_mfma_f32_32x32x16_bf16 v[104:119], a[160:163], v[80:83], v[104:119]
    v_mfma_f32_32x32x16_bf16 v[104:119], a[164:167], v[84:87], v[104:119]
    v_mfma_f32_32x32x16_bf16 v[120:135], a[160:163], v[88:91], v[120:135]
    v_mfma_f32_32x32x16_bf16 v[120:135], a[164:167], v[92:95], v[120:135]
    s_cmp_lt_u32 s72, 163840
    s_cbranch_scc1 sequential_preLN__softmax_full_mha__glu_gated_bilinear__prompt_kernel_sloop
    s_nop 15
    s_branch sequential_preLN__softmax_full_mha__glu_gated_bilinear__prompt_kernel_anorm
sequential_preLN__softmax_full_mha__glu_gated_bilinear__prompt_kernel_rsspinq:
    s_mov_b32 s58, 200000
L_poll_43:
    buffer_load_dword v55, off, s[52:55], s22 sc1
L_poll_43w:
    s_waitcnt vmcnt(0)
    v_cmp_eq_u32 vcc, 0, v55
    s_sub_u32 s58, s58, 1
    s_cbranch_scc1 L_pollout_44
    s_cbranch_vccz L_pollout_44
    s_sleep 4
    s_branch L_poll_43
L_pollout_44:
    s_mov_b32 s58, 200000
L_poll_45:
    buffer_load_dword v2, v196, s[4:7], s22 offen sc1
L_poll_45w:
    s_waitcnt vmcnt(0)
    v_cmp_eq_u32 vcc, 0, v2
    s_sub_u32 s58, s58, 1
    s_cbranch_scc1 L_pollout_46
    s_cbranch_vccz L_pollout_46
    s_sleep 2
    s_branch L_poll_45
L_pollout_46:
    s_branch sequential_preLN__softmax_full_mha__glu_gated_bilinear__prompt_kernel_rsokq
sequential_preLN__softmax_full_mha__glu_gated_bilinear__prompt_kernel_rsspinv:
    s_mov_b32 s58, 200000
L_poll_47:
    buffer_load_dword v55, off, s[52:55], s22 sc1
L_poll_47w:
    s_waitcnt vmcnt(0)
    v_cmp_eq_u32 vcc, 0, v55
    s_sub_u32 s58, s58, 1
    s_cbranch_scc1 L_pollout_48
    s_cbranch_vccz L_pollout_48
    s_sleep 4
    s_branch L_poll_47
L_pollout_48:
    s_mov_b32 s58, 200000
L_poll_49:
    buffer_load_dword v2, v196, s[4:7], s22 offen sc1
L_poll_49w:
    s_waitcnt vmcnt(0)
    v_cmp_eq_u32 vcc, 0, v2
    s_sub_u32 s58, s58, 1
    s_cbranch_scc1 L_pollout_50
    s_cbranch_vccz L_pollout_50
    s_sleep 2
    s_branch L_poll_49
L_pollout_50:
    s_branch sequential_preLN__softmax_full_mha__glu_gated_bilinear__prompt_kernel_rsokv
sequential_preLN__softmax_full_mha__glu_gated_bilinear__prompt_kernel_raspin:
    s_mov_b32 s58, 200000
L_poll_51:
    buffer_load_dword v2, v54, s[4:7], s22 offen sc1
L_poll_51w:
    s_waitcnt vmcnt(0)
    v_cmp_eq_u32 vcc, 0, v2
    s_sub_u32 s58, s58, 1
    s_cbranch_scc1 L_pollout_52
    s_cbranch_vccz L_pollout_52
    s_sleep 2
    s_branch L_poll_51
L_pollout_52:
    s_branch sequential_preLN__softmax_full_mha__glu_gated_bilinear__prompt_kernel_raok
sequential_preLN__softmax_full_mha__glu_gated_bilinear__prompt_kernel_ospin0:
    s_mov_b32 s58, 200000
L_poll_53:
    buffer_load_dwordx2 v[112:113], v252, s[4:7], s53 offen offset:0 sc1
    buffer_load_dwordx2 v[114:115], v252, s[4:7], s53 offen offset:512 sc1
    buffer_load_dwordx4 v[96:99], v253, s[4:7], s81 offen offset:0 sc1
    buffer_load_dwordx4 v[100:103], v253, s[4:7], s81 offen offset:1024 sc1
    buffer_load_dwordx4 v[104:107], v253, s[4:7], s81 offen offset:2048 sc1
    buffer_load_dwordx4 v[108:111], v253, s[4:7], s81 offen offset:3072 sc1
    buffer_load_dwordx2 v[132:133], v252, s[4:7], s54 offen offset:0 sc1
    buffer_load_dwordx2 v[134:135], v252, s[4:7], s54 offen offset:512 sc1
    buffer_load_dwordx4 v[116:119], v253, s[4:7], s82 offen offset:0 sc1
    buffer_load_dwordx4 v[120:123], v253, s[4:7], s82 offen offset:1024 sc1
    buffer_load_dwordx4 v[124:127], v253, s[4:7], s82 offen offset:2048 sc1
    buffer_load_dwordx4 v[128:131], v253, s[4:7], s82 offen offset:3072 sc1
L_poll_53w:
    s_waitcnt vmcnt(0)
    v_max3_u32 v2, v96, v97, v98
    v_max3_u32 v2, v2, v99, v100
    v_max3_u32 v2, v2, v101, v102
    v_max3_u32 v2, v2, v103, v104
    v_max3_u32 v2, v2, v105, v106
    v_max3_u32 v2, v2, v107, v108
    v_max3_u32 v2, v2, v109, v110
    v_max3_u32 v2, v2, v111, v112
    v_max3_u32 v2, v2, v113, v114
    v_max_u32 v2, v2, v115
    v_not_b32 v2, v2
    v_cmp_eq_u32 vcc, 0, v2
    s_sub_u32 s58, s58, 1
    s_cbranch_scc1 L_pollout_54
    s_cbranch_vccnz L_poll_53
L_pollout_54:
    s_branch sequential_preLN__softmax_full_mha__glu_gated_bilinear__prompt_kernel_ook0
sequential_preLN__softmax_full_mha__glu_gated_bilinear__prompt_kernel_ospin1:
    s_mov_b32 s58, 200000
L_poll_55:
    buffer_load_dwordx2 v[132:133], v252, s[4:7], s54 offen offset:0 sc1
    buffer_load_dwordx2 v[134:135], v252, s[4:7], s54 offen offset:512 sc1
    buffer_load_dwordx4 v[116:119], v253, s[4:7], s82 offen offset:0 sc1
    buffer_load_dwordx4 v[120:123], v253, s[4:7], s82 offen offset:1024 sc1
    buffer_load_dwordx4 v[124:127], v253, s[4:7], s82 offen offset:2048 sc1
    buffer_load_dwordx4 v[128:131], v253, s[4:7], s82 offen offset:3072 sc1
L_poll_55w:
    s_waitcnt vmcnt(0)
    v_max3_u32 v2, v116, v117, v118
    v_max3_u32 v2, v2, v119, v120
    v_max3_u32 v2, v2, v121, v122
    v_max3_u32 v2, v2, v123, v124
    v_max3_u32 v2, v2, v125, v126
    v_max3_u32 v2, v2, v127, v128
    v_max3_u32 v2, v2, v129, v130
    v_max3_u32 v2, v2, v131, v132
    v_max3_u32 v2, v2, v133, v134
    v_max_u32 v2, v2, v135
    v_not_b32 v2, v2
    v_cmp_eq_u32 vcc, 0, v2
    s_sub_u32 s58, s58, 1
    s_cbranch_scc1 L_pollout_56
    s_cbranch_vccnz L_poll_55
L_pollout_56:
    s_branch sequential_preLN__softmax_full_mha__glu_gated_bilinear__prompt_kernel_ook1
sequential_preLN__softmax_full_mha__glu_gated_bilinear__prompt_kernel_ospin2:
    s_mov_b32 s58, 200000
L_poll_57:
    buffer_load_dwordx2 v[216:217], v252, s[4:7], s55 offen offset:0 sc1
    buffer_load_dwordx2 v[218:219], v252, s[4:7], s55 offen offset:512 sc1
    buffer_load_dwordx4 v[200:203], v253, s[4:7], s83 offen offset:0 sc1
    buffer_load_dwordx4 v[204:207], v253, s[4:7], s83 offen offset:1024 sc1
    buffer_load_dwordx4 v[208:211], v253, s[4:7], s83 offen offset:2048 sc1
    buffer_load_dwordx4 v[212:215], v253, s[4:7], s83 offen offset:3072 sc1
L_poll_57w:
    s_waitcnt vmcnt(0)
    v_max3_u32 v2, v200, v201, v202
    v_max3_u32 v2, v2, v203, v204
    v_max3_u32 v2, v2, v205, v206
    v_max3_u32 v2, v2, v207, v208
    v_max3_u32 v2, v2, v209, v210
    v_max3_u32 v2, v2, v211, v212
    v_max3_u32 v2, v2, v213, v214
    v_max3_u32 v2, v2, v215, v216
    v_max3_u32 v2, v2, v217, v218
    v_max_u32 v2, v2, v219
    v_not_b32 v2, v2
    v_cmp_eq_u32 vcc, 0, v2
    s_sub_u32 s58, s58, 1
    s_cbranch_scc1 L_pollout_58
    s_cbranch_vccnz L_poll_57
L_pollout_58:
    s_branch sequential_preLN__softmax_full_mha__glu_gated_bilinear__prompt_kernel_ook2
sequential_preLN__softmax_full_mha__glu_gated_bilinear__prompt_kernel_ospin3:
    s_mov_b32 s58, 200000
L_poll_59:
    buffer_load_dwordx2 v[236:237], v252, s[4:7], s52 offen offset:0 sc1
    buffer_load_dwordx2 v[238:239], v252, s[4:7], s52 offen offset:512 sc1
    buffer_load_dwordx4 v[220:223], v253, s[4:7], s80 offen offset:0 sc1
    buffer_load_dwordx4 v[224:227], v253, s[4:7], s80 offen offset:1024 sc1
    buffer_load_dwordx4 v[228:231], v253, s[4:7], s80 offen offset:2048 sc1
    buffer_load_dwordx4 v[232:235], v253, s[4:7], s80 offen offset:3072 sc1
L_poll_59w:
    s_waitcnt vmcnt(0)
    v_max3_u32 v2, v220, v221, v222
    v_max3_u32 v2, v2, v223, v224
    v_max3_u32 v2, v2, v225, v226
    v_max3_u32 v2, v2, v227, v228
    v_max3_u32 v2, v2, v229, v230
    v_max3_u32 v2, v2, v231, v232
    v_max3_u32 v2, v2, v233, v234
    v_max3_u32 v2, v2, v235, v236
    v_max3_u32 v2, v2, v237, v238
    v_max_u32 v2, v2, v239
    v_not_b32 v2, v2
    v_cmp_eq_u32 vcc, 0, v2
    s_sub_u32 s58, s58, 1
    s_cbranch_scc1 L_pollout_60
    s_cbranch_vccnz L_poll_59
L_pollout_60:
    s_branch sequential_preLN__softmax_full_mha__glu_gated_bilinear__prompt_kernel_ook3
L_wt_21:
    buffer_store_dwordx4 v[184:187], v253, s[4:7], s50 offen  sc1
    buffer_store_dwordx4 v[188:191], v253, s[4:7], s50 offen offset:1024  sc1
    buffer_store_dwordx2 v[192:193], v199, s[4:7], s60 offen  sc1
    s_branch L_wb_22
L_wt_23:
    buffer_store_dwordx2 v[112:113], v12, s[4:7], s65 offen sc1
    s_branch L_wb_24
L_wt_25:
    buffer_store_dword v10, off, s[4:7], s66 sc1
    s_branch L_wb_26
L_wt_29:
    buffer_store_dword v240, off, s[4:7], s66 sc1
    s_branch L_wb_30
sequential_preLN__softmax_full_mha__glu_gated_bilinear__prompt_kernel_f3spin:
    s_mov_b32 s58, 200000
L_poll_61:
    buffer_load_dwordx2 v[2:3], v15, s[4:7], s71 offen sc1
L_poll_61w:
    s_waitcnt vmcnt(0)
    v_min_u32 v2, v2, v3
    v_lshrrev_b32 v2, 1, v2
    v_cmp_eq_u32 vcc, 0, v2
    s_sub_u32 s58, s58, 1
    s_cbranch_scc1 L_pollout_62
    s_cbranch_vccz L_pollout_62
    s_sleep 4
    s_branch L_poll_61
L_pollout_62:
    s_branch sequential_preLN__softmax_full_mha__glu_gated_bilinear__prompt_kernel_f3ok
L_wt_31:
    buffer_store_dwordx4 v[48:51], v253, s[4:7], s29 offen offset:2048 sc1
    buffer_store_dwordx4 v[52:55], v11, s[4:7], s29 offen offset:2048 sc1
    s_branch L_wb_32
L_wt_33:
    buffer_store_dwordx2 v[56:57], v253, s[4:7], s30 offen sc1
    buffer_store_dwordx2 v[60:61], v11, s[4:7], s30 offen sc1
    s_branch L_wb_34
L_wt_35:
    buffer_store_dword v10, off, s[4:7], s69 sc1
    s_branch L_wb_36
L_wbk_39:
    buffer_wbl2 sc1
    s_branch L_wbd_40
sequential_preLN__softmax_full_mha__glu_gated_bilinear__prompt_kernel_end:
    s_endpgm
.section .rodata,"a"
.p2align 6
.amdhsa_kernel sequential_preLN__softmax_full_mha__glu_gated_bilinear__prompt_kernel
  .amdhsa_next_free_vgpr 512
  .amdhsa_next_free_sgpr 102
  .amdhsa_accum_offset 256
  .amdhsa_group_segment_fixed_size 0
  .amdhsa_kernarg_size 80
  .amdhsa_user_sgpr_count 2
  .amdhsa_user_sgpr_kernarg_segment_ptr 1
  .amdhsa_system_sgpr_workgroup_id_x 1
  .amdhsa_float_denorm_mode_32 3
.end_amdhsa_kernel
```
